```python
import torch

def _softmax(x, axis=-1):
    return torch.softmax(x, dim=axis)

def _gelu(x):
    return torch.nn.functional.gelu(x, approximate='tanh')

def _silu(x):
    return torch.nn.functional.silu(x)

def _sigmoid(x):
    return torch.sigmoid(x)

def _layernorm(x, axis=-1, eps=1e-05):
    m = x.mean(dim=axis, keepdim=True)
    v = x.var(dim=axis, keepdim=True, unbiased=False)
    return (x - m) / torch.sqrt(v + eps)

def _scatter_add(tgt, idx, src, axis=0):
    return tgt.clone().index_add_(axis, idx, src)

def _segment_sum(src, seg, n):
    out = torch.zeros((n,) + src.shape[1:], dtype=src.dtype)
    return out.index_add_(0, seg, src)

def _pad(x, pw):
    flat = tuple((v for pair in reversed(pw) for v in pair))
    return torch.nn.functional.pad(x, flat)
kernel_name = 'interleave_layers__linear_attn_block__mixer_gmlp__prompt'

def setup_inputs():

    _w = lambda a: (lambda t: t.to(torch.bfloat16) if t.is_floating_point() else t)(torch.as_tensor(a))

    def _A_setup():
        B, S, D = (1, 2048, 576)
        return {'x': _w((lambda *s: torch.randn(*s, dtype=torch.bfloat16) * 0.05)(B, S, D)), 'wqkv': _w((lambda *s: torch.randn(*s, dtype=torch.bfloat16) * 0.1)(D, 3 * D)), 'wo': _w((lambda *s: torch.randn(*s, dtype=torch.bfloat16) * 0.05)(D, D))}
    _A_in = _A_setup()

    def _B_setup():
        B, S, D, F = (1, 2048, 576, 4608)
        Fh = F // 2
        return {'x': _w((lambda *s: torch.randn(*s, dtype=torch.bfloat16) * 0.05)(B, S, D)), 'w_in': _w((lambda *s: torch.randn(*s, dtype=torch.bfloat16) * 0.2)(D, 2 * Fh)), 'w_sp': _w(0.01 * (lambda *s: torch.randn(*s, dtype=torch.bfloat16) * 0.2)(S, S)), 'b_sp': _w(1.0 + 0.01 * (lambda *s: torch.randn(*s, dtype=torch.bfloat16) * 0.05)(S)), 'w_out': _w((lambda *s: torch.randn(*s, dtype=torch.bfloat16) * 0.05)(Fh, D))}
    _B_in = _B_setup()
    return {'A_x': _A_in['x'], 'A_wqkv': _A_in['wqkv'], 'A_wo': _A_in['wo'], 'B_x': _B_in['x'], 'B_w_in': _B_in['w_in'], 'B_w_sp': _B_in['w_sp'], 'B_b_sp': _B_in['b_sp'], 'B_w_out': _B_in['w_out']}

def reference(A_x, A_wqkv, A_wo, B_x, B_w_in, B_w_sp, B_b_sp, B_w_out):

    def _A_ref(x, wqkv, wo):
        B, S, D = x.shape
        H = 32
        Dh = D // H
        qkv = (lambda x, *d: x.permute(*d))((x @ wqkv).reshape(B, S, 3, H, Dh), 2, 0, 3, 1, 4)
        q, k, v = (qkv[0], qkv[1], qkv[2])
        phi = lambda t: torch.where(t > 0, t + 1, torch.exp(t)) + 1e-06
        pq, pk = (phi(q), phi(k))
        kv = torch.einsum('bhsd,bhse->bhde', pk, v)
        z = torch.einsum('bhsd->bhd', pk)
        num = torch.einsum('bhqd,bhde->bhqe', pq, kv)
        den = torch.einsum('bhqd,bhd->bhq', pq, z)[..., None] + 1e-06
        o = num / den
        return (lambda x, *d: x.permute(*d))(o, 0, 2, 1, 3).reshape(B, S, D) @ wo

    def _B_ref(x, w_in, w_sp, b_sp, w_out):
        B, S, D = x.shape
        F = w_in.shape[-1]
        Fh = F // 2
        z = _gelu(torch.einsum('bsd,df->bsf', x, w_in))
        z1 = z[..., :Fh].clone()
        z2 = _layernorm(z[..., Fh:], axis=-1)
        g = torch.einsum('ts,bsf->btf', w_sp, z2) + b_sp[None, :, None]
        return torch.einsum('bsf,fd->bsd', z1 * g, w_out)
    x = A_x
    x = x + _A_ref(_layernorm(x, axis=-1), A_wqkv, A_wo)
    x = x + _B_ref(_layernorm(x, axis=-1), B_w_in, B_w_sp, B_b_sp, B_w_out)
    x = x + _A_ref(_layernorm(x, axis=-1), A_wqkv, A_wo)
    x = x + _B_ref(_layernorm(x, axis=-1), B_w_in, B_w_sp, B_b_sp, B_w_out)
    return x
```

```asm
; @launch kernel=p0_kernel grid=(556,1,1) block=(576,1,1) lds=90000
; @launch kernel=mega_kernel grid=(256,1,1) block=(256,1,1) lds=161920
.amdgcn_target "amdgcn-amd-amdhsa--gfx950"
.macro MF a, b, c, d
v_mfma_f32_16x16x32_bf16 \a, \b, \c, \d
.endm
.text
.globl p0_kernel
.p2align 8
.type p0_kernel,@function
p0_kernel:
s_cmp_ge_u32 s2,556
s_cbranch_scc0 GO_p0_kernel
s_endpgm
GO_p0_kernel:
s_load_dwordx2 s[80:81],s[0:1],80
s_load_dwordx2 s[82:83],s[0:1],0
s_load_dwordx2 s[84:85],s[0:1],8
s_load_dwordx2 s[86:87],s[0:1],16
s_load_dwordx2 s[88:89],s[0:1],32
s_load_dwordx2 s[90:91],s[0:1],40
s_load_dwordx2 s[92:93],s[0:1],56
v_lshrrev_b32 v1,6,v0
s_nop 0
v_readfirstlane_b32 s22,v1
v_and_b32 v0,63,v0
v_lshlrev_b32 v1,4,v0
v_and_b32 v14,15,v0
v_lshrrev_b32 v15,4,v0
s_and_b32 s3,s2,7
s_lshr_b32 s23,s2,3
s_waitcnt lgkmcnt(0)
s_mov_b32 s8,s80
s_and_b32 s9,s81,0xffff
s_mov_b32 s10,0x10000000
s_mov_b32 s11,0x00020000
s_mov_b32 s12,s82
s_and_b32 s13,s83,0xffff
s_mov_b32 s14,0x240000
s_mov_b32 s15,0x00020000
s_mov_b32 s16,s84
s_and_b32 s17,s85,0xffff
s_mov_b32 s18,0x1e6000
s_mov_b32 s19,0x00020000
s_mov_b32 s24,s86
s_and_b32 s25,s87,0xffff
s_mov_b32 s26,0xa2000
s_mov_b32 s27,0x00020000
s_mov_b32 s28,s88
s_and_b32 s29,s89,0xffff
s_mov_b32 s30,0x510000
s_mov_b32 s31,0x00020000
s_mov_b32 s32,s90
s_and_b32 s33,s91,0xffff
s_mov_b32 s34,0x800000
s_mov_b32 s35,0x00020000
s_mov_b32 s36,s92
s_and_b32 s37,s93,0xffff
s_mov_b32 s38,0x288000
s_mov_b32 s39,0x00020000
s_lshl_b32 s40,s22,6
v_add_u32 v3,s40,v0
s_cmp_ge_u32 s2,514
s_cbranch_scc1 P0_KZ
s_cmp_ge_u32 s2,498
s_cbranch_scc1 P0_WO
s_cmp_ge_u32 s2,434
s_cbranch_scc1 P0_WOUT
s_cmp_ge_u32 s2,338
s_cbranch_scc1 P0_WQ
s_cmp_ge_u32 s2,242
s_cbranch_scc1 P0_WI
s_cmp_ge_u32 s2,128
s_cbranch_scc1 P0_WS
v_mul_u32_u24 v2,1152,v14
v_lshl_add_u32 v2,v15,4,v2
s_mul_i32 s40,s2,18432
s_lshl_b32 s41,s22,7
s_add_u32 s41,s41,s40
s_lshl_b32 s42,s22,11
s_add_u32 s42,s42,s40
s_add_u32 s42,s42,0x1400000
buffer_load_dwordx4 v[16:19],v2,s[12:15],s41 offen offset:0
buffer_load_dwordx4 v[20:23],v2,s[12:15],s41 offen offset:64
s_getpc_b64 s[58:59]
P0_PC2:
s_mul_i32 s46,s23,9
s_add_u32 s46,s46,s22
s_lshl_b32 s46,s46,10
v_add_u32 v4,s46,v1
v_add_u32 v4,END_p0_kernel-P0_PC2,v4
v_min_u32 v4,CODE_END-P0_PC2-16,v4
v_and_b32 v4,-4,v4
global_load_dwordx4 v[40:43],v4,s[58:59]
v_mov_b32 v8,0
v_mov_b32 v9,0
v_mov_b32 v31,0x3f803f80
s_waitcnt vmcnt(2)
buffer_store_dwordx4 v[16:19],v1,s[8:11],s42 offen offset:0 sc1
v_dot2_f32_bf16 v8,v16,v31,v8
v_dot2_f32_bf16 v9,v16,v16,v9
v_dot2_f32_bf16 v8,v17,v31,v8
v_dot2_f32_bf16 v9,v17,v17,v9
v_dot2_f32_bf16 v8,v18,v31,v8
v_dot2_f32_bf16 v9,v18,v18,v9
v_dot2_f32_bf16 v8,v19,v31,v8
v_dot2_f32_bf16 v9,v19,v19,v9
s_waitcnt vmcnt(2)
buffer_store_dwordx4 v[20:23],v1,s[8:11],s42 offen offset:1024 sc1
v_dot2_f32_bf16 v8,v20,v31,v8
v_dot2_f32_bf16 v9,v20,v20,v9
v_dot2_f32_bf16 v8,v21,v31,v8
v_dot2_f32_bf16 v9,v21,v21,v9
v_dot2_f32_bf16 v8,v22,v31,v8
v_dot2_f32_bf16 v9,v22,v22,v9
v_dot2_f32_bf16 v8,v23,v31,v8
v_dot2_f32_bf16 v9,v23,v23,v9
s_nop 1
v_mov_b32 v10,v8
s_nop 1
v_permlane32_swap_b32 v8,v10
v_add_f32 v8,v8,v10
v_mov_b32 v10,v8
s_nop 1
v_permlane16_swap_b32 v8,v10
v_add_f32 v8,v8,v10
v_mov_b32 v10,v9
s_nop 1
v_permlane32_swap_b32 v9,v10
v_add_f32 v9,v9,v10
v_mov_b32 v10,v9
s_nop 1
v_permlane16_swap_b32 v9,v10
v_add_f32 v9,v9,v10
s_lshl_b32 s41,s22,7
v_lshlrev_b32 v4,3,v14
v_add_u32 v5,s41,v4
ds_write_b64 v5,v[8:9]
s_waitcnt lgkmcnt(0)
s_barrier
s_cmp_ge_u32 s22,1
s_cbranch_scc1 END_p0_kernel
ds_read_b64 v[16:17],v4 offset:0
ds_read_b64 v[18:19],v4 offset:128
ds_read_b64 v[20:21],v4 offset:256
ds_read_b64 v[22:23],v4 offset:384
ds_read_b64 v[24:25],v4 offset:512
ds_read_b64 v[26:27],v4 offset:640
ds_read_b64 v[28:29],v4 offset:768
ds_read_b64 v[30:31],v4 offset:896
ds_read_b64 v[32:33],v4 offset:1024
s_waitcnt lgkmcnt(0)
v_add_f32 v16,v16,v18
v_add_f32 v17,v17,v19
v_add_f32 v16,v16,v20
v_add_f32 v17,v17,v21
v_add_f32 v16,v16,v22
v_add_f32 v17,v17,v23
v_add_f32 v16,v16,v24
v_add_f32 v17,v17,v25
v_add_f32 v16,v16,v26
v_add_f32 v17,v17,v27
v_add_f32 v16,v16,v28
v_add_f32 v17,v17,v29
v_add_f32 v16,v16,v30
v_add_f32 v17,v17,v31
v_add_f32 v16,v16,v32
v_add_f32 v17,v17,v33
v_cmp_eq_u32 vcc,0,v15
s_nop 1
v_cndmask_b32 v8,0,v16,vcc
v_cndmask_b32 v9,0,v17,vcc
v_mov_b32 v10,0
v_mov_b32 v11,0
v_lshl_add_u32 v2,v15,14,v4
s_lshl_b32 s40,s2,7
s_add_u32 s40,s40,0x1e00000
s_add_u32 s41,s40,65536
buffer_store_dwordx2 v[8:9],v2,s[8:11],s40 offen sc1
buffer_store_dwordx2 v[10:11],v2,s[8:11],s41 offen sc1
s_endpgm
P0_WQ:
s_nop 7
s_nop 3
s_sub_u32 s45,s2,338
s_and_b32 s44,s45,1
s_lshr_b32 s45,s45,1
s_mul_i32 s43,s44,9
s_add_u32 s43,s43,s22
s_mul_i32 s40,s43,110592
s_mul_i32 s41,s45,72
s_add_u32 s40,s40,s41
s_mul_i32 s47,s22,3072
s_add_u32 s47,s47,2048
v_add_u32 v4,0,v0
v_min_u32 v4,287,v4
s_mov_b32 s41,7282
v_mul_u32_u24 v5,s41,v4
v_lshrrev_b32 v5,16,v5
v_mul_u32_u24 v6,9,v5
v_sub_u32 v6,v4,v6
v_lshlrev_b32 v6,3,v6
v_mul_u32_u24 v7,96,v5
v_add3_u32 v8,v7,v6,s47
v_mul_u32_u24 v5,3456,v5
v_add_u32 v6,v6,v5
buffer_load_dwordx2 v[16:17],v6,s[16:19],s40 offen
v_add_u32 v4,64,v0
v_min_u32 v4,287,v4
s_mov_b32 s41,7282
v_mul_u32_u24 v5,s41,v4
v_lshrrev_b32 v5,16,v5
v_mul_u32_u24 v6,9,v5
v_sub_u32 v6,v4,v6
v_lshlrev_b32 v6,3,v6
v_mul_u32_u24 v7,96,v5
v_add3_u32 v9,v7,v6,s47
v_mul_u32_u24 v5,3456,v5
v_add_u32 v6,v6,v5
buffer_load_dwordx2 v[18:19],v6,s[16:19],s40 offen
v_add_u32 v4,128,v0
v_min_u32 v4,287,v4
s_mov_b32 s41,7282
v_mul_u32_u24 v5,s41,v4
v_lshrrev_b32 v5,16,v5
v_mul_u32_u24 v6,9,v5
v_sub_u32 v6,v4,v6
v_lshlrev_b32 v6,3,v6
v_mul_u32_u24 v7,96,v5
v_add3_u32 v10,v7,v6,s47
v_mul_u32_u24 v5,3456,v5
v_add_u32 v6,v6,v5
buffer_load_dwordx2 v[20:21],v6,s[16:19],s40 offen
v_add_u32 v4,192,v0
v_min_u32 v4,287,v4
s_mov_b32 s41,7282
v_mul_u32_u24 v5,s41,v4
v_lshrrev_b32 v5,16,v5
v_mul_u32_u24 v6,9,v5
v_sub_u32 v6,v4,v6
v_lshlrev_b32 v6,3,v6
v_mul_u32_u24 v7,96,v5
v_add3_u32 v11,v7,v6,s47
v_mul_u32_u24 v5,3456,v5
v_add_u32 v6,v6,v5
buffer_load_dwordx2 v[22:23],v6,s[16:19],s40 offen
v_add_u32 v4,256,v0
v_min_u32 v4,287,v4
s_mov_b32 s41,7282
v_mul_u32_u24 v5,s41,v4
v_lshrrev_b32 v5,16,v5
v_mul_u32_u24 v6,9,v5
v_sub_u32 v6,v4,v6
v_lshlrev_b32 v6,3,v6
v_mul_u32_u24 v7,96,v5
v_add3_u32 v12,v7,v6,s47
v_mul_u32_u24 v5,3456,v5
v_add_u32 v6,v6,v5
buffer_load_dwordx2 v[24:25],v6,s[16:19],s40 offen
v_lshrrev_b32 v4,2,v14
v_lshl_add_u32 v4,v15,3,v4
v_mul_u32_u24 v4,96,v4
v_and_b32 v5,3,v14
v_lshl_add_u32 v4,v5,3,v4
v_add_u32 v4,s47,v4
s_lshr_b32 s41,s45,4
s_and_b32 s42,s45,15
s_mul_i32 s46,s43,6
s_mul_i32 s48,s41,3
s_add_u32 s46,s46,s48
s_sub_u32 s46,s46,3
s_mul_i32 s49,s43,3
s_add_u32 s49,s49,108
s_cmp_eq_u32 s41,0
s_cselect_b32 s46,s49,s46
s_mul_i32 s49,s42,162
s_add_u32 s46,s46,s49
s_lshl_b32 s46,s46,10
s_add_u32 s46,s46,0x0
v_mov_b32 v52,0x3f803f80
v_cmp_gt_u32 vcc,4,v14
s_waitcnt vmcnt(4)
ds_write_b64 v8,v[16:17]
s_waitcnt vmcnt(3)
ds_write_b64 v9,v[18:19]
s_waitcnt vmcnt(2)
ds_write_b64 v10,v[20:21]
s_waitcnt vmcnt(1)
ds_write_b64 v11,v[22:23]
s_waitcnt vmcnt(0)
ds_write_b64 v12,v[24:25]
s_waitcnt lgkmcnt(0)
ds_read_b64_tr_b16 v[32:33],v4 offset:0
ds_read_b64_tr_b16 v[34:35],v4 offset:384
ds_read_b64_tr_b16 v[36:37],v4 offset:32
ds_read_b64_tr_b16 v[38:39],v4 offset:416
ds_read_b64_tr_b16 v[40:41],v4 offset:64
ds_read_b64_tr_b16 v[42:43],v4 offset:448
s_waitcnt lgkmcnt(0)
v_cndmask_b32 v40,0,v40,vcc
v_cndmask_b32 v41,0,v41,vcc
v_cndmask_b32 v42,0,v42,vcc
v_cndmask_b32 v43,0,v43,vcc
buffer_store_dwordx4 v[32:35],v1,s[8:11],s46 offen offset:0 sc1
v_mov_b32 v48,0
v_dot2_f32_bf16 v48,v32,v52,v48
v_dot2_f32_bf16 v48,v33,v52,v48
v_dot2_f32_bf16 v48,v34,v52,v48
v_dot2_f32_bf16 v48,v35,v52,v48
buffer_store_dwordx4 v[36:39],v1,s[8:11],s46 offen offset:1024 sc1
v_mov_b32 v49,0
v_dot2_f32_bf16 v49,v36,v52,v49
v_dot2_f32_bf16 v49,v37,v52,v49
v_dot2_f32_bf16 v49,v38,v52,v49
v_dot2_f32_bf16 v49,v39,v52,v49
buffer_store_dwordx4 v[40:43],v1,s[8:11],s46 offen offset:2048 sc1
v_mov_b32 v50,0
v_dot2_f32_bf16 v50,v40,v52,v50
v_dot2_f32_bf16 v50,v41,v52,v50
v_dot2_f32_bf16 v50,v42,v52,v50
v_dot2_f32_bf16 v50,v43,v52,v50
v_mov_b32 v44,v48
v_mov_b32 v45,v49
s_nop 0
v_mov_b32 v46,v50
v_permlane32_swap_b32 v48,v44
v_permlane32_swap_b32 v49,v45
v_permlane32_swap_b32 v50,v46
v_add_f32 v48,v48,v44
v_add_f32 v49,v49,v45
v_add_f32 v50,v50,v46
v_mov_b32 v44,v48
v_mov_b32 v45,v49
v_mov_b32 v46,v50
v_permlane16_swap_b32 v48,v44
v_permlane16_swap_b32 v49,v45
v_permlane16_swap_b32 v50,v46
v_add_f32 v48,v48,v44
v_add_f32 v49,v49,v45
v_add_f32 v50,v50,v46
v_cmp_eq_u32 vcc,1,v15
s_nop 1
v_cndmask_b32 v48,v48,v49,vcc
v_cmp_eq_u32 vcc,2,v15
s_nop 1
v_cndmask_b32 v48,v48,v50,vcc
s_mul_i32 s47,s22,192
v_lshlrev_b32 v5,2,v0
v_add_u32 v6,s47,v5
s_mov_b32 exec_lo,0xffffffff
s_mov_b32 exec_hi,0xffff
ds_write_b32 v6,v48
s_waitcnt lgkmcnt(0)
s_barrier
s_cmp_ge_u32 s22,1
s_cbranch_scc1 END_p0_kernel
ds_read_b32 v16,v5 offset:0
ds_read_b32 v17,v5 offset:192
ds_read_b32 v18,v5 offset:384
ds_read_b32 v19,v5 offset:576
ds_read_b32 v20,v5 offset:768
ds_read_b32 v21,v5 offset:960
ds_read_b32 v22,v5 offset:1152
ds_read_b32 v23,v5 offset:1344
ds_read_b32 v24,v5 offset:1536
s_waitcnt lgkmcnt(0)
v_add_f32 v16,v16,v17
v_add_f32 v16,v16,v18
v_add_f32 v16,v16,v19
v_add_f32 v16,v16,v20
v_add_f32 v16,v16,v21
v_add_f32 v16,v16,v22
v_add_f32 v16,v16,v23
v_add_f32 v16,v16,v24
s_mul_i32 s43,s44,9216
s_mul_i32 s40,s42,576
s_add_u32 s43,s43,s40
s_mul_i32 s40,s41,192
s_add_u32 s43,s43,s40
s_add_u32 s43,s43,0x290000
buffer_store_dword v16,v5,s[8:11],s43 offen sc1
s_endpgm
P0_WO:
s_nop 7
s_nop 3
s_sub_u32 s45,s2,498
s_and_b32 s44,s45,1
s_lshr_b32 s45,s45,1
s_mul_i32 s43,s44,9
s_add_u32 s43,s43,s22
s_mul_i32 s40,s43,36864
s_mul_i32 s41,s45,144
s_add_u32 s40,s40,s41
s_mul_i32 s47,s22,5120
v_add_u32 v8,s47,v1
v_add_u32 v4,0,v0
v_min_u32 v4,287,v4
s_mov_b32 s41,7282
v_mul_u32_u24 v5,s41,v4
v_lshrrev_b32 v5,16,v5
v_mul_u32_u24 v6,9,v5
v_sub_u32 v6,v4,v6
v_lshlrev_b32 v6,4,v6
v_mul_u32_u24 v5,1152,v5
v_add_u32 v6,v6,v5
buffer_load_dwordx4 v[16:19],v6,s[24:27],s40 offen
v_add_u32 v4,64,v0
v_min_u32 v4,287,v4
s_mov_b32 s41,7282
v_mul_u32_u24 v5,s41,v4
v_lshrrev_b32 v5,16,v5
v_mul_u32_u24 v6,9,v5
v_sub_u32 v6,v4,v6
v_lshlrev_b32 v6,4,v6
v_mul_u32_u24 v5,1152,v5
v_add_u32 v6,v6,v5
buffer_load_dwordx4 v[20:23],v6,s[24:27],s40 offen
v_add_u32 v4,128,v0
v_min_u32 v4,287,v4
s_mov_b32 s41,7282
v_mul_u32_u24 v5,s41,v4
v_lshrrev_b32 v5,16,v5
v_mul_u32_u24 v6,9,v5
v_sub_u32 v6,v4,v6
v_lshlrev_b32 v6,4,v6
v_mul_u32_u24 v5,1152,v5
v_add_u32 v6,v6,v5
buffer_load_dwordx4 v[24:27],v6,s[24:27],s40 offen
v_add_u32 v4,192,v0
v_min_u32 v4,287,v4
s_mov_b32 s41,7282
v_mul_u32_u24 v5,s41,v4
v_lshrrev_b32 v5,16,v5
v_mul_u32_u24 v6,9,v5
v_sub_u32 v6,v4,v6
v_lshlrev_b32 v6,4,v6
v_mul_u32_u24 v5,1152,v5
v_add_u32 v6,v6,v5
buffer_load_dwordx4 v[28:31],v6,s[24:27],s40 offen
v_add_u32 v4,256,v0
v_min_u32 v4,287,v4
s_mov_b32 s41,7282
v_mul_u32_u24 v5,s41,v4
v_lshrrev_b32 v5,16,v5
v_mul_u32_u24 v6,9,v5
v_sub_u32 v6,v4,v6
v_lshlrev_b32 v6,4,v6
v_mul_u32_u24 v5,1152,v5
v_add_u32 v6,v6,v5
buffer_load_dwordx4 v[32:35],v6,s[24:27],s40 offen
v_lshrrev_b32 v4,2,v14
v_lshl_add_u32 v4,v15,3,v4
v_mul_u32_u24 v4,144,v4
v_and_b32 v5,3,v14
v_lshl_add_u32 v4,v5,3,v4
v_add_u32 v4,s47,v4
v_lshl_add_u32 v9,v15,3,v14
v_lshlrev_b32 v9,4,v9
v_add_u32 v9,4096,v9
v_cmp_gt_u32 vcc,8,v14
v_mov_b32 v5,0x7ff00000
s_nop 0
v_cndmask_b32 v9,v5,v9,vcc
s_mul_i32 s46,s45,18
s_add_u32 s46,s46,s43
s_mul_i32 s46,s46,4608
s_add_u32 s46,s46,0x2a0000
s_waitcnt vmcnt(4)
ds_write_b128 v8,v[16:19] offset:0
s_waitcnt vmcnt(3)
ds_write_b128 v8,v[20:23] offset:1024
s_waitcnt vmcnt(2)
ds_write_b128 v8,v[24:27] offset:2048
s_waitcnt vmcnt(1)
ds_write_b128 v8,v[28:31] offset:3072
s_waitcnt vmcnt(0)
ds_write_b128 v8,v[32:35] offset:4096
s_waitcnt lgkmcnt(0)
ds_read_b64_tr_b16 v[36:37],v4 offset:0
ds_read_b64_tr_b16 v[38:39],v4 offset:576
ds_read_b64_tr_b16 v[40:41],v4 offset:32
ds_read_b64_tr_b16 v[42:43],v4 offset:608
ds_read_b64_tr_b16 v[44:45],v4 offset:64
ds_read_b64_tr_b16 v[46:47],v4 offset:640
ds_read_b64_tr_b16 v[48:49],v4 offset:96
ds_read_b64_tr_b16 v[50:51],v4 offset:672
ds_read_b64_tr_b16 v[52:53],v4 offset:128
ds_read_b64_tr_b16 v[54:55],v4 offset:704
s_waitcnt lgkmcnt(8)
buffer_store_dwordx4 v[36:39],v1,s[8:11],s46 offen offset:0 sc1
s_waitcnt lgkmcnt(6)
buffer_store_dwordx4 v[40:43],v1,s[8:11],s46 offen offset:1024 sc1
s_waitcnt lgkmcnt(4)
buffer_store_dwordx4 v[44:47],v1,s[8:11],s46 offen offset:2048 sc1
s_waitcnt lgkmcnt(2)
buffer_store_dwordx4 v[48:51],v1,s[8:11],s46 offen offset:3072 sc1
s_waitcnt lgkmcnt(0)
buffer_store_dwordx4 v[52:55],v9,s[8:11],s46 offen sc1
s_endpgm
P0_WI:
s_nop 7
s_nop 3
s_sub_u32 s45,s2,242
s_and_b32 s44,s45,1
s_lshr_b32 s45,s45,1
s_mul_i32 s43,s44,9
s_add_u32 s43,s43,s22
s_mul_i32 s40,s43,294912
s_mul_i32 s41,s45,192
s_add_u32 s40,s40,s41
s_mul_i32 s47,s22,6144
s_add_u32 s47,s47,4096
v_add_u32 v8,s47,v1
v_add_u32 v4,0,v0
s_mov_b32 s41,5462
v_mul_u32_u24 v5,s41,v4
v_lshrrev_b32 v5,16,v5
v_mul_u32_u24 v6,12,v5
v_sub_u32 v6,v4,v6
v_lshlrev_b32 v6,4,v6
v_mul_u32_u24 v5,9216,v5
v_add_u32 v6,v6,v5
buffer_load_dwordx4 v[16:19],v6,s[28:31],s40 offen
v_add_u32 v4,64,v0
s_mov_b32 s41,5462
v_mul_u32_u24 v5,s41,v4
v_lshrrev_b32 v5,16,v5
v_mul_u32_u24 v6,12,v5
v_sub_u32 v6,v4,v6
v_lshlrev_b32 v6,4,v6
v_mul_u32_u24 v5,9216,v5
v_add_u32 v6,v6,v5
buffer_load_dwordx4 v[20:23],v6,s[28:31],s40 offen
v_add_u32 v4,128,v0
s_mov_b32 s41,5462
v_mul_u32_u24 v5,s41,v4
v_lshrrev_b32 v5,16,v5
v_mul_u32_u24 v6,12,v5
v_sub_u32 v6,v4,v6
v_lshlrev_b32 v6,4,v6
v_mul_u32_u24 v5,9216,v5
v_add_u32 v6,v6,v5
buffer_load_dwordx4 v[24:27],v6,s[28:31],s40 offen
v_add_u32 v4,192,v0
s_mov_b32 s41,5462
v_mul_u32_u24 v5,s41,v4
v_lshrrev_b32 v5,16,v5
v_mul_u32_u24 v6,12,v5
v_sub_u32 v6,v4,v6
v_lshlrev_b32 v6,4,v6
v_mul_u32_u24 v5,9216,v5
v_add_u32 v6,v6,v5
buffer_load_dwordx4 v[28:31],v6,s[28:31],s40 offen
v_add_u32 v4,256,v0
s_mov_b32 s41,5462
v_mul_u32_u24 v5,s41,v4
v_lshrrev_b32 v5,16,v5
v_mul_u32_u24 v6,12,v5
v_sub_u32 v6,v4,v6
v_lshlrev_b32 v6,4,v6
v_mul_u32_u24 v5,9216,v5
v_add_u32 v6,v6,v5
buffer_load_dwordx4 v[32:35],v6,s[28:31],s40 offen
v_add_u32 v4,320,v0
s_mov_b32 s41,5462
v_mul_u32_u24 v5,s41,v4
v_lshrrev_b32 v5,16,v5
v_mul_u32_u24 v6,12,v5
v_sub_u32 v6,v4,v6
v_lshlrev_b32 v6,4,v6
v_mul_u32_u24 v5,9216,v5
v_add_u32 v6,v6,v5
buffer_load_dwordx4 v[36:39],v6,s[28:31],s40 offen
v_lshrrev_b32 v4,2,v14
v_lshl_add_u32 v4,v15,3,v4
v_mul_u32_u24 v4,192,v4
v_and_b32 v5,3,v14
v_lshl_add_u32 v4,v5,3,v4
v_add_u32 v4,s47,v4
v_mov_b32 v9,0x3f803f80
s_mul_i32 s47,s22,384
v_lshlrev_b32 v10,2,v14
v_add_u32 v10,s47,v10
s_waitcnt vmcnt(5)
ds_write_b128 v8,v[16:19] offset:0
s_waitcnt vmcnt(4)
ds_write_b128 v8,v[20:23] offset:1024
s_waitcnt vmcnt(3)
ds_write_b128 v8,v[24:27] offset:2048
s_waitcnt vmcnt(2)
ds_write_b128 v8,v[28:31] offset:3072
s_waitcnt vmcnt(1)
ds_write_b128 v8,v[32:35] offset:4096
s_waitcnt vmcnt(0)
ds_write_b128 v8,v[36:39] offset:5120
s_waitcnt lgkmcnt(0)
ds_read_b64_tr_b16 v[16:17],v4 offset:0
ds_read_b64_tr_b16 v[18:19],v4 offset:768
ds_read_b64_tr_b16 v[20:21],v4 offset:32
ds_read_b64_tr_b16 v[22:23],v4 offset:800
ds_read_b64_tr_b16 v[24:25],v4 offset:64
ds_read_b64_tr_b16 v[26:27],v4 offset:832
ds_read_b64_tr_b16 v[28:29],v4 offset:96
ds_read_b64_tr_b16 v[30:31],v4 offset:864
ds_read_b64_tr_b16 v[32:33],v4 offset:128
ds_read_b64_tr_b16 v[34:35],v4 offset:896
ds_read_b64_tr_b16 v[36:37],v4 offset:160
ds_read_b64_tr_b16 v[38:39],v4 offset:928
s_mul_i32 s48,s45,6
s_add_u32 s48,s48,0
s_cmp_lt_u32 s48,144
s_cselect_b32 s49,1,0
s_cselect_b32 s50,0,144
s_sub_u32 s48,s48,s50
s_mul_i32 s50,s48,57
s_lshr_b32 s50,s50,9
s_mul_i32 s51,s50,9
s_sub_u32 s51,s48,s51
s_lshl_b32 s50,s50,1
s_add_u32 s50,s50,s49
s_mul_i32 s46,s50,18
s_add_u32 s46,s46,s43
s_mul_i32 s46,s46,9
s_add_u32 s46,s46,s51
s_lshl_b32 s46,s46,10
s_add_u32 s46,s46,0x350000
s_waitcnt lgkmcnt(10)
buffer_store_dwordx4 v[16:19],v1,s[8:11],s46 offen sc1
v_mov_b32 v40,0
v_dot2_f32_bf16 v40,v16,v9,v40
v_dot2_f32_bf16 v40,v17,v9,v40
v_dot2_f32_bf16 v40,v18,v9,v40
v_dot2_f32_bf16 v40,v19,v9,v40
s_mul_i32 s48,s45,6
s_add_u32 s48,s48,1
s_cmp_lt_u32 s48,144
s_cselect_b32 s49,1,0
s_cselect_b32 s50,0,144
s_sub_u32 s48,s48,s50
s_mul_i32 s50,s48,57
s_lshr_b32 s50,s50,9
s_mul_i32 s51,s50,9
s_sub_u32 s51,s48,s51
s_lshl_b32 s50,s50,1
s_add_u32 s50,s50,s49
s_mul_i32 s46,s50,18
s_add_u32 s46,s46,s43
s_mul_i32 s46,s46,9
s_add_u32 s46,s46,s51
s_lshl_b32 s46,s46,10
s_add_u32 s46,s46,0x350000
s_waitcnt lgkmcnt(8)
buffer_store_dwordx4 v[20:23],v1,s[8:11],s46 offen sc1
v_mov_b32 v41,0
v_dot2_f32_bf16 v41,v20,v9,v41
v_dot2_f32_bf16 v41,v21,v9,v41
v_dot2_f32_bf16 v41,v22,v9,v41
v_dot2_f32_bf16 v41,v23,v9,v41
s_mul_i32 s48,s45,6
s_add_u32 s48,s48,2
s_cmp_lt_u32 s48,144
s_cselect_b32 s49,1,0
s_cselect_b32 s50,0,144
s_sub_u32 s48,s48,s50
s_mul_i32 s50,s48,57
s_lshr_b32 s50,s50,9
s_mul_i32 s51,s50,9
s_sub_u32 s51,s48,s51
s_lshl_b32 s50,s50,1
s_add_u32 s50,s50,s49
s_mul_i32 s46,s50,18
s_add_u32 s46,s46,s43
s_mul_i32 s46,s46,9
s_add_u32 s46,s46,s51
s_lshl_b32 s46,s46,10
s_add_u32 s46,s46,0x350000
s_waitcnt lgkmcnt(6)
buffer_store_dwordx4 v[24:27],v1,s[8:11],s46 offen sc1
v_mov_b32 v42,0
v_dot2_f32_bf16 v42,v24,v9,v42
v_dot2_f32_bf16 v42,v25,v9,v42
v_dot2_f32_bf16 v42,v26,v9,v42
v_dot2_f32_bf16 v42,v27,v9,v42
s_mul_i32 s48,s45,6
s_add_u32 s48,s48,3
s_cmp_lt_u32 s48,144
s_cselect_b32 s49,1,0
s_cselect_b32 s50,0,144
s_sub_u32 s48,s48,s50
s_mul_i32 s50,s48,57
s_lshr_b32 s50,s50,9
s_mul_i32 s51,s50,9
s_sub_u32 s51,s48,s51
s_lshl_b32 s50,s50,1
s_add_u32 s50,s50,s49
s_mul_i32 s46,s50,18
s_add_u32 s46,s46,s43
s_mul_i32 s46,s46,9
s_add_u32 s46,s46,s51
s_lshl_b32 s46,s46,10
s_add_u32 s46,s46,0x350000
s_waitcnt lgkmcnt(4)
buffer_store_dwordx4 v[28:31],v1,s[8:11],s46 offen sc1
v_mov_b32 v43,0
v_dot2_f32_bf16 v43,v28,v9,v43
v_dot2_f32_bf16 v43,v29,v9,v43
v_dot2_f32_bf16 v43,v30,v9,v43
v_dot2_f32_bf16 v43,v31,v9,v43
s_mul_i32 s48,s45,6
s_add_u32 s48,s48,4
s_cmp_lt_u32 s48,144
s_cselect_b32 s49,1,0
s_cselect_b32 s50,0,144
s_sub_u32 s48,s48,s50
s_mul_i32 s50,s48,57
s_lshr_b32 s50,s50,9
s_mul_i32 s51,s50,9
s_sub_u32 s51,s48,s51
s_lshl_b32 s50,s50,1
s_add_u32 s50,s50,s49
s_mul_i32 s46,s50,18
s_add_u32 s46,s46,s43
s_mul_i32 s46,s46,9
s_add_u32 s46,s46,s51
s_lshl_b32 s46,s46,10
s_add_u32 s46,s46,0x350000
s_waitcnt lgkmcnt(2)
buffer_store_dwordx4 v[32:35],v1,s[8:11],s46 offen sc1
v_mov_b32 v44,0
v_dot2_f32_bf16 v44,v32,v9,v44
v_dot2_f32_bf16 v44,v33,v9,v44
v_dot2_f32_bf16 v44,v34,v9,v44
v_dot2_f32_bf16 v44,v35,v9,v44
s_mul_i32 s48,s45,6
s_add_u32 s48,s48,5
s_cmp_lt_u32 s48,144
s_cselect_b32 s49,1,0
s_cselect_b32 s50,0,144
s_sub_u32 s48,s48,s50
s_mul_i32 s50,s48,57
s_lshr_b32 s50,s50,9
s_mul_i32 s51,s50,9
s_sub_u32 s51,s48,s51
s_lshl_b32 s50,s50,1
s_add_u32 s50,s50,s49
s_mul_i32 s46,s50,18
s_add_u32 s46,s46,s43
s_mul_i32 s46,s46,9
s_add_u32 s46,s46,s51
s_lshl_b32 s46,s46,10
s_add_u32 s46,s46,0x350000
s_waitcnt lgkmcnt(0)
buffer_store_dwordx4 v[36:39],v1,s[8:11],s46 offen sc1
v_mov_b32 v45,0
v_dot2_f32_bf16 v45,v36,v9,v45
v_dot2_f32_bf16 v45,v37,v9,v45
v_dot2_f32_bf16 v45,v38,v9,v45
v_dot2_f32_bf16 v45,v39,v9,v45
v_mov_b32 v46,v40
v_mov_b32 v47,v41
v_mov_b32 v48,v42
v_mov_b32 v49,v43
v_mov_b32 v50,v44
v_mov_b32 v51,v45
v_permlane32_swap_b32 v40,v46
v_permlane32_swap_b32 v41,v47
v_permlane32_swap_b32 v42,v48
v_permlane32_swap_b32 v43,v49
v_permlane32_swap_b32 v44,v50
v_permlane32_swap_b32 v45,v51
v_add_f32 v40,v40,v46
v_add_f32 v41,v41,v47
v_add_f32 v42,v42,v48
v_add_f32 v43,v43,v49
v_add_f32 v44,v44,v50
v_add_f32 v45,v45,v51
v_mov_b32 v46,v40
v_mov_b32 v47,v41
v_mov_b32 v48,v42
v_mov_b32 v49,v43
v_mov_b32 v50,v44
v_mov_b32 v51,v45
v_permlane16_swap_b32 v40,v46
v_permlane16_swap_b32 v41,v47
v_permlane16_swap_b32 v42,v48
v_permlane16_swap_b32 v43,v49
v_permlane16_swap_b32 v44,v50
v_permlane16_swap_b32 v45,v51
v_add_f32 v40,v40,v46
v_add_f32 v41,v41,v47
v_add_f32 v42,v42,v48
v_add_f32 v43,v43,v49
v_add_f32 v44,v44,v50
v_add_f32 v45,v45,v51
s_mov_b32 exec_lo,0xffff
s_mov_b32 exec_hi,0x0
ds_write_b32 v10,v40 offset:0
ds_write_b32 v10,v41 offset:64
ds_write_b32 v10,v42 offset:128
ds_write_b32 v10,v43 offset:192
ds_write_b32 v10,v44 offset:256
ds_write_b32 v10,v45 offset:320
s_mov_b64 exec,-1
s_waitcnt lgkmcnt(0)
s_barrier
s_cmp_ge_u32 s22,6
s_cbranch_scc1 END_p0_kernel
s_lshl_b32 s47,s22,6
v_lshlrev_b32 v5,2,v14
v_add_u32 v6,s47,v5
ds_read_b32 v16,v6 offset:0
ds_read_b32 v17,v6 offset:384
ds_read_b32 v18,v6 offset:768
ds_read_b32 v19,v6 offset:1152
ds_read_b32 v20,v6 offset:1536
ds_read_b32 v21,v6 offset:1920
ds_read_b32 v22,v6 offset:2304
ds_read_b32 v23,v6 offset:2688
ds_read_b32 v24,v6 offset:3072
s_mul_i32 s45,s45,6
s_add_u32 s48,s45,s22
s_cmp_lt_u32 s48,144
s_cselect_b32 s49,1,0
s_cselect_b32 s50,0,144
s_sub_u32 s48,s48,s50
s_mul_i32 s50,s48,57
s_lshr_b32 s50,s50,9
s_mul_i32 s51,s50,9
s_sub_u32 s51,s48,s51
s_lshl_b32 s50,s50,1
s_add_u32 s50,s50,s49
s_mul_i32 s50,s50,9
s_add_u32 s50,s50,s51
s_lshl_b32 s50,s50,6
s_mul_i32 s43,s44,18432
s_add_u32 s43,s43,s50
s_add_u32 s43,s43,0x860000
s_waitcnt lgkmcnt(0)
v_add_f32 v16,v16,v17
v_add_f32 v16,v16,v18
v_add_f32 v16,v16,v19
v_add_f32 v16,v16,v20
v_add_f32 v16,v16,v21
v_add_f32 v16,v16,v22
v_add_f32 v16,v16,v23
v_add_f32 v16,v16,v24
s_mov_b32 exec_lo,0xffff
s_mov_b32 exec_hi,0x0
buffer_store_dword v16,v5,s[8:11],s43 offen sc1
s_endpgm
P0_WOUT:
s_nop 7
s_nop 3
s_sub_u32 s45,s2,434
s_and_b32 s44,s45,7
s_lshr_b32 s45,s45,3
s_mul_i32 s43,s44,9
s_add_u32 s43,s43,s22
s_mul_i32 s40,s43,36864
s_mul_i32 s41,s45,144
s_add_u32 s40,s40,s41
s_mul_i32 s47,s22,5120
v_add_u32 v8,s47,v1
v_add_u32 v4,0,v0
v_min_u32 v4,287,v4
s_mov_b32 s41,7282
v_mul_u32_u24 v5,s41,v4
v_lshrrev_b32 v5,16,v5
v_mul_u32_u24 v6,9,v5
v_sub_u32 v6,v4,v6
v_lshlrev_b32 v6,4,v6
v_mul_u32_u24 v5,1152,v5
v_add_u32 v6,v6,v5
buffer_load_dwordx4 v[16:19],v6,s[36:39],s40 offen
v_add_u32 v4,64,v0
v_min_u32 v4,287,v4
s_mov_b32 s41,7282
v_mul_u32_u24 v5,s41,v4
v_lshrrev_b32 v5,16,v5
v_mul_u32_u24 v6,9,v5
v_sub_u32 v6,v4,v6
v_lshlrev_b32 v6,4,v6
v_mul_u32_u24 v5,1152,v5
v_add_u32 v6,v6,v5
buffer_load_dwordx4 v[20:23],v6,s[36:39],s40 offen
v_add_u32 v4,128,v0
v_min_u32 v4,287,v4
s_mov_b32 s41,7282
v_mul_u32_u24 v5,s41,v4
v_lshrrev_b32 v5,16,v5
v_mul_u32_u24 v6,9,v5
v_sub_u32 v6,v4,v6
v_lshlrev_b32 v6,4,v6
v_mul_u32_u24 v5,1152,v5
v_add_u32 v6,v6,v5
buffer_load_dwordx4 v[24:27],v6,s[36:39],s40 offen
v_add_u32 v4,192,v0
v_min_u32 v4,287,v4
s_mov_b32 s41,7282
v_mul_u32_u24 v5,s41,v4
v_lshrrev_b32 v5,16,v5
v_mul_u32_u24 v6,9,v5
v_sub_u32 v6,v4,v6
v_lshlrev_b32 v6,4,v6
v_mul_u32_u24 v5,1152,v5
v_add_u32 v6,v6,v5
buffer_load_dwordx4 v[28:31],v6,s[36:39],s40 offen
v_add_u32 v4,256,v0
v_min_u32 v4,287,v4
s_mov_b32 s41,7282
v_mul_u32_u24 v5,s41,v4
v_lshrrev_b32 v5,16,v5
v_mul_u32_u24 v6,9,v5
v_sub_u32 v6,v4,v6
v_lshlrev_b32 v6,4,v6
v_mul_u32_u24 v5,1152,v5
v_add_u32 v6,v6,v5
buffer_load_dwordx4 v[32:35],v6,s[36:39],s40 offen
v_lshrrev_b32 v4,2,v14
v_lshl_add_u32 v4,v15,3,v4
v_mul_u32_u24 v4,144,v4
v_and_b32 v5,3,v14
v_lshl_add_u32 v4,v5,3,v4
v_add_u32 v4,s47,v4
v_lshl_add_u32 v9,v15,3,v14
v_lshlrev_b32 v9,4,v9
v_add_u32 v9,4096,v9
v_cmp_gt_u32 vcc,8,v14
v_mov_b32 v5,0x7ff00000
s_nop 0
v_cndmask_b32 v9,v5,v9,vcc
s_mul_i32 s46,s45,72
s_add_u32 s46,s46,s43
s_mul_i32 s46,s46,4608
s_add_u32 s46,s46,0x1080000
s_waitcnt vmcnt(4)
ds_write_b128 v8,v[16:19] offset:0
s_waitcnt vmcnt(3)
ds_write_b128 v8,v[20:23] offset:1024
s_waitcnt vmcnt(2)
ds_write_b128 v8,v[24:27] offset:2048
s_waitcnt vmcnt(1)
ds_write_b128 v8,v[28:31] offset:3072
s_waitcnt vmcnt(0)
ds_write_b128 v8,v[32:35] offset:4096
s_waitcnt lgkmcnt(0)
ds_read_b64_tr_b16 v[36:37],v4 offset:0
ds_read_b64_tr_b16 v[38:39],v4 offset:576
ds_read_b64_tr_b16 v[40:41],v4 offset:32
ds_read_b64_tr_b16 v[42:43],v4 offset:608
ds_read_b64_tr_b16 v[44:45],v4 offset:64
ds_read_b64_tr_b16 v[46:47],v4 offset:640
ds_read_b64_tr_b16 v[48:49],v4 offset:96
ds_read_b64_tr_b16 v[50:51],v4 offset:672
ds_read_b64_tr_b16 v[52:53],v4 offset:128
ds_read_b64_tr_b16 v[54:55],v4 offset:704
s_waitcnt lgkmcnt(8)
buffer_store_dwordx4 v[36:39],v1,s[8:11],s46 offen offset:0 sc1
s_waitcnt lgkmcnt(6)
buffer_store_dwordx4 v[40:43],v1,s[8:11],s46 offen offset:1024 sc1
s_waitcnt lgkmcnt(4)
buffer_store_dwordx4 v[44:47],v1,s[8:11],s46 offen offset:2048 sc1
s_waitcnt lgkmcnt(2)
buffer_store_dwordx4 v[48:51],v1,s[8:11],s46 offen offset:3072 sc1
s_waitcnt lgkmcnt(0)
buffer_store_dwordx4 v[52:55],v9,s[8:11],s46 offen sc1
s_endpgm
P0_WS:
s_nop 7
s_nop 3
s_sub_u32 s45,s2,128
s_mul_i32 s45,s45,9
s_add_u32 s45,s45,s22
s_cmp_ge_u32 s45,1024
s_cbranch_scc1 END_p0_kernel
v_lshrrev_b32 v4,5,v0
v_and_b32 v5,31,v0
v_lshlrev_b32 v6,12,v4
v_lshl_add_u32 v6,v5,4,v6
s_lshr_b32 s40,s45,3
s_lshl_b32 s40,s40,16
s_and_b32 s41,s45,7
s_lshl_b32 s41,s41,9
s_add_u32 s40,s40,s41
buffer_load_dwordx4 v[16:19],v6,s[32:35],s40 offen
s_add_u32 s40,s40,8192
buffer_load_dwordx4 v[20:23],v6,s[32:35],s40 offen
s_add_u32 s40,s40,8192
buffer_load_dwordx4 v[24:27],v6,s[32:35],s40 offen
s_add_u32 s40,s40,8192
buffer_load_dwordx4 v[28:31],v6,s[32:35],s40 offen
s_add_u32 s40,s40,8192
buffer_load_dwordx4 v[32:35],v6,s[32:35],s40 offen
s_add_u32 s40,s40,8192
buffer_load_dwordx4 v[36:39],v6,s[32:35],s40 offen
s_add_u32 s40,s40,8192
buffer_load_dwordx4 v[40:43],v6,s[32:35],s40 offen
s_add_u32 s40,s40,8192
buffer_load_dwordx4 v[44:47],v6,s[32:35],s40 offen
s_mul_i32 s47,s22,8448
v_mul_u32_u24 v7,528,v4
v_lshl_add_u32 v7,v5,4,v7
v_add_u32 v7,s47,v7
v_mul_u32_u24 v8,528,v14
v_lshl_add_u32 v8,v15,4,v8
v_add_u32 v8,s47,v8
s_lshl_b32 s46,s45,13
s_add_u32 s46,s46,0x880000
s_add_u32 s47,s46,4096
s_waitcnt vmcnt(7)
ds_write_b128 v7,v[16:19] offset:0
s_waitcnt vmcnt(6)
ds_write_b128 v7,v[20:23] offset:1056
s_waitcnt vmcnt(5)
ds_write_b128 v7,v[24:27] offset:2112
s_waitcnt vmcnt(4)
ds_write_b128 v7,v[28:31] offset:3168
s_waitcnt vmcnt(3)
ds_write_b128 v7,v[32:35] offset:4224
s_waitcnt vmcnt(2)
ds_write_b128 v7,v[36:39] offset:5280
s_waitcnt vmcnt(1)
ds_write_b128 v7,v[40:43] offset:6336
s_waitcnt vmcnt(0)
ds_write_b128 v7,v[44:47] offset:7392
s_waitcnt lgkmcnt(0)
ds_read_b128 v[16:19],v8 offset:0
ds_read_b128 v[20:23],v8 offset:64
ds_read_b128 v[24:27],v8 offset:128
ds_read_b128 v[28:31],v8 offset:192
ds_read_b128 v[32:35],v8 offset:256
ds_read_b128 v[36:39],v8 offset:320
ds_read_b128 v[40:43],v8 offset:384
ds_read_b128 v[44:47],v8 offset:448
s_waitcnt lgkmcnt(7)
buffer_store_dwordx4 v[16:19],v1,s[8:11],s46 offen offset:0 sc1
s_waitcnt lgkmcnt(6)
buffer_store_dwordx4 v[20:23],v1,s[8:11],s46 offen offset:1024 sc1
s_waitcnt lgkmcnt(5)
buffer_store_dwordx4 v[24:27],v1,s[8:11],s46 offen offset:2048 sc1
s_waitcnt lgkmcnt(4)
buffer_store_dwordx4 v[28:31],v1,s[8:11],s46 offen offset:3072 sc1
s_waitcnt lgkmcnt(3)
buffer_store_dwordx4 v[32:35],v1,s[8:11],s47 offen offset:0 sc1
s_waitcnt lgkmcnt(2)
buffer_store_dwordx4 v[36:39],v1,s[8:11],s47 offen offset:1024 sc1
s_waitcnt lgkmcnt(1)
buffer_store_dwordx4 v[40:43],v1,s[8:11],s47 offen offset:2048 sc1
s_waitcnt lgkmcnt(0)
buffer_store_dwordx4 v[44:47],v1,s[8:11],s47 offen offset:3072 sc1
s_endpgm
P0_KZ:
s_nop 7
s_nop 3
s_cmp_ge_u32 s22,8
s_cbranch_scc1 END_p0_kernel
s_getpc_b64 s[58:59]
P0_PC:
s_sub_u32 s45,s2,514
s_lshl_b32 s46,s45,3
s_add_u32 s46,s46,s22
s_lshl_b32 s46,s46,10
v_add_u32 v4,s46,v1
v_min_u32 v4,CODE_END-P0_PC-16,v4
v_and_b32 v4,-4,v4
global_load_dwordx4 v[16:19],v4,s[58:59]
s_lshr_b32 s43,s45,4
s_and_b32 s42,s45,15
s_mov_b32 s44,-1
s_lshl_b32 s42,s42,16
s_lshl_b32 s40,s22,13
s_add_u32 s42,s42,s40
s_mul_i32 s47,s43,0x2000000
s_add_u32 s47,s47,0x2240000
s_cmp_ge_u32 s43,2
s_cselect_b32 s47,0x1310000,s47
s_cselect_b32 s44,0,s44
s_add_u32 s42,s42,s47
s_add_u32 s47,s40,0x860000
s_cmp_eq_u32 s45,999
s_cselect_b32 s42,s47,s42
v_mov_b32 v8,s44
v_mov_b32 v9,s44
v_mov_b32 v10,s44
v_mov_b32 v11,s44
buffer_store_dwordx4 v[8:11],v1,s[8:11],s42 offen offset:0 sc1
buffer_store_dwordx4 v[8:11],v1,s[8:11],s42 offen offset:1024 sc1
buffer_store_dwordx4 v[8:11],v1,s[8:11],s42 offen offset:2048 sc1
buffer_store_dwordx4 v[8:11],v1,s[8:11],s42 offen offset:3072 sc1
s_add_u32 s42,s42,4096
buffer_store_dwordx4 v[8:11],v1,s[8:11],s42 offen offset:0 sc1
buffer_store_dwordx4 v[8:11],v1,s[8:11],s42 offen offset:1024 sc1
buffer_store_dwordx4 v[8:11],v1,s[8:11],s42 offen offset:2048 sc1
buffer_store_dwordx4 v[8:11],v1,s[8:11],s42 offen offset:3072 sc1
END_p0_kernel:
s_nop 7
s_nop 3
s_endpgm

.text
.globl mega_kernel
.p2align 8
.type mega_kernel,@function
mega_kernel:
s_cmp_ge_u32 s2,256
s_cbranch_scc0 GO_mega_kernel
s_endpgm
GO_mega_kernel:
s_load_dwordx2 s[80:81],s[0:1],80
s_load_dwordx2 s[82:83],s[0:1],48
s_load_dwordx2 s[84:85],s[0:1],64
v_lshrrev_b32 v1,6,v0
s_nop 0
v_readfirstlane_b32 s22,v1
v_and_b32 v0,63,v0
v_lshlrev_b32 v1,4,v0
v_and_b32 v14,15,v0
v_lshrrev_b32 v15,4,v0
s_and_b32 s3,s2,7
s_lshr_b32 s23,s2,3
s_waitcnt lgkmcnt(0)
s_mov_b32 s8,s80
s_and_b32 s9,s81,0xffff
s_mov_b32 s10,0x10000000
s_mov_b32 s11,0x00020000
s_mov_b32 s12,s82
s_and_b32 s13,s83,0xffff
s_mov_b32 s14,0x1000
s_mov_b32 s15,0x00020000
s_mov_b32 s16,s84
s_and_b32 s17,s85,0xffff
s_mov_b32 s18,0x240000
s_mov_b32 s19,0x00020000
s_load_dwordx4 s[84:87],s[0:1],24
s_load_dwordx2 s[88:89],s[0:1],40
s_load_dwordx2 s[98:99],s[0:1],56
s_waitcnt lgkmcnt(0)
s_getpc_b64 s[58:59]
PC_mega_kernel_1:
s_mul_i32 s46,s23,4
s_add_u32 s46,s46,s22
s_lshl_b32 s46,s46,10
v_add_u32 v13,s46,v1
v_min_u32 v13,PH_k2_0-PC_mega_kernel_1-16,v13
v_and_b32 v13,-4,v13
global_load_dwordx4 a[252:255],v13,s[58:59]
PH_k1_0:
s_and_b32 s44,s3,1
s_lshl_b32 s44,s44,3
s_and_b32 s45,s23,7
s_add_u32 s44,s44,s45
s_lshr_b32 s45,s3,1
s_lshl_b32 s45,s45,2
s_lshr_b32 s46,s23,3
s_add_u32 s45,s45,s46
s_lshl_b32 s49,s22,10
s_lshr_b32 s48,s3,1
s_lshl_b32 s48,s48,2
s_lshr_b32 s20,s23,3
s_add_u32 s48,s48,s20
s_mul_i32 s48,s48,165888
s_add_u32 s48,s48,0x0
s_add_u32 s48,s48,s49
v_add_u32 v253,4096,v1
v_add_u32 v254,8192,v1
v_add_u32 v255,12288,v1
v_add_u32 v2,65536,v1
v_add_u32 v3,131072,v1
s_lshl_b32 s46,s44,3
s_lshl_b32 s47,s22,1
s_add_u32 s46,s46,s47
s_mul_i32 s24,s46,18432
s_add_u32 s24,s24,0x1400000
s_add_u32 s27,s24,18432
s_add_u32 s29,s24,16384
s_add_u32 s21,s27,16384
s_lshl_b32 s79,s44,11
s_add_u32 s79,s79,0x1310000
s_add_u32 m0,s49,0
s_add_u32 s20,s48,0
buffer_load_dwordx4 v1,s[8:11],s20 offen sc1 lds
s_add_u32 m0,s49,4096
s_nop 0
buffer_load_dwordx4 v253,s[8:11],s20 offen sc1 lds
s_add_u32 m0,s49,8192
s_nop 0
buffer_load_dwordx4 v254,s[8:11],s20 offen sc1 lds
s_mul_i32 s31,s45,576
s_add_u32 s31,s31,0x290000
s_lshl_b32 s46,s22,8
v_lshlrev_b32 v12,2,v0
v_add_u32 v238,s46,v12
v_min_u32 v238,572,v238
buffer_load_dword v192,v238,s[8:11],s31 offen
s_add_u32 s31,s31,9216
buffer_load_dword v193,v238,s[8:11],s31 offen
s_lshl_b32 s46,s22,8
s_mul_i32 s50,s45,49152
s_add_u32 s50,s50,0x2240000
s_mul_i32 s51,s44,3072
s_add_u32 s51,s51,s50
v_lshlrev_b32 v4,2,v0
v_add_u32 v4,s46,v4
v_lshlrev_b32 v5,2,v4
v_cmp_gt_u32 vcc,684,v4
v_mov_b32 v6,0x7ff00000
s_nop 0
v_cndmask_b32 v237,v6,v5,vcc
v_min_u32 v4,680,v4
s_mov_b32 s41,3641
v_add_u32 v48,0,v4
v_add_u32 v64,1,v4
v_add_u32 v80,2,v4
v_add_u32 v96,3,v4
v_mul_u32_u24 v49,s41,v48
v_mul_u32_u24 v65,s41,v64
v_mul_u32_u24 v81,s41,v80
v_mul_u32_u24 v97,s41,v96
v_lshrrev_b32 v49,16,v49
v_lshrrev_b32 v65,16,v65
v_lshrrev_b32 v81,16,v81
v_lshrrev_b32 v97,16,v97
v_mul_u32_u24 v50,18,v49
v_mul_u32_u24 v66,18,v65
v_mul_u32_u24 v82,18,v81
v_mul_u32_u24 v98,18,v97
v_sub_u32 v50,v48,v50
v_sub_u32 v66,v64,v66
v_sub_u32 v82,v80,v82
v_sub_u32 v98,v96,v98
v_cmp_le_u32 s[32:33],19,v49
v_cmp_le_u32 s[34:35],19,v65
v_cmp_le_u32 s[36:37],19,v81
v_cmp_le_u32 s[38:39],19,v97
v_cndmask_b32 v51,0,1,s[32:33]
v_cndmask_b32 v67,0,1,s[34:35]
v_cndmask_b32 v83,0,1,s[36:37]
v_cndmask_b32 v99,0,1,s[38:39]
v_mul_u32_u24 v52,19,v51
v_mul_u32_u24 v68,19,v67
v_mul_u32_u24 v84,19,v83
v_mul_u32_u24 v100,19,v99
v_sub_u32 v52,v49,v52
v_sub_u32 v68,v65,v68
v_sub_u32 v84,v81,v84
v_sub_u32 v100,v97,v100
v_mad_u32_u24 v53,v51,18,v50
v_mad_u32_u24 v69,v67,18,v66
v_mad_u32_u24 v85,v83,18,v82
v_mad_u32_u24 v101,v99,18,v98
v_mad_u32_u24 v54,v51,18,v52
v_mad_u32_u24 v70,v67,18,v68
v_mad_u32_u24 v86,v83,18,v84
v_mad_u32_u24 v102,v99,18,v100
v_cmp_eq_u32 s[32:33],18,v52
v_cmp_eq_u32 s[34:35],18,v68
v_cmp_eq_u32 s[36:37],18,v84
v_cmp_eq_u32 s[38:39],18,v100
v_lshrrev_b32 v55,4,v53
v_lshrrev_b32 v71,4,v69
v_lshrrev_b32 v87,4,v85
v_lshrrev_b32 v103,4,v101
v_lshrrev_b32 v56,4,v54
v_lshrrev_b32 v72,4,v70
v_lshrrev_b32 v88,4,v86
v_lshrrev_b32 v104,4,v102
v_mad_u32_u24 v56,v55,3,v56
v_mad_u32_u24 v72,v71,3,v72
v_mad_u32_u24 v88,v87,3,v88
v_mad_u32_u24 v104,v103,3,v104
v_add_u32 v55,9,v55
v_add_u32 v71,9,v71
v_add_u32 v87,9,v87
v_add_u32 v103,9,v103
v_cndmask_b32 v55,v56,v55,s[32:33]
v_cndmask_b32 v71,v72,v71,s[34:35]
v_cndmask_b32 v87,v88,v87,s[36:37]
v_cndmask_b32 v103,v104,v103,s[38:39]
v_and_b32 v56,15,v54
v_and_b32 v72,15,v70
v_and_b32 v88,15,v86
v_and_b32 v104,15,v102
v_lshlrev_b32 v55,10,v55
v_lshlrev_b32 v71,10,v71
v_lshlrev_b32 v87,10,v87
v_lshlrev_b32 v103,10,v103
v_lshl_add_u32 v55,v56,4,v55
v_lshl_add_u32 v71,v72,4,v71
v_lshl_add_u32 v87,v88,4,v87
v_lshl_add_u32 v103,v104,4,v103
v_bfe_u32 v49,v53,2,2
v_bfe_u32 v65,v69,2,2
v_bfe_u32 v81,v85,2,2
v_bfe_u32 v97,v101,2,2
v_lshl_add_u32 v55,v49,8,v55
v_lshl_add_u32 v71,v65,8,v71
v_lshl_add_u32 v87,v81,8,v87
v_lshl_add_u32 v103,v97,8,v103
v_and_b32 v50,3,v53
v_and_b32 v66,3,v69
v_and_b32 v82,3,v85
v_and_b32 v98,3,v101
v_lshl_add_u32 v55,v50,2,v55
v_lshl_add_u32 v71,v66,2,v71
v_lshl_add_u32 v87,v82,2,v87
v_lshl_add_u32 v103,v98,2,v103
v_add_u32 v248,8192,v55
v_add_u32 v249,8192,v71
v_add_u32 v250,8192,v87
v_add_u32 v251,8192,v103
v_bfe_u32 v52,v53,4,1
v_bfe_u32 v68,v69,4,1
v_bfe_u32 v84,v85,4,1
v_bfe_u32 v100,v101,4,1
v_lshl_add_u32 v50,v52,2,v50
v_lshl_add_u32 v66,v68,2,v66
v_lshl_add_u32 v82,v84,2,v82
v_lshl_add_u32 v98,v100,2,v98
v_lshlrev_b32 v50,1,v50
v_lshlrev_b32 v66,1,v66
v_lshlrev_b32 v82,1,v82
v_lshlrev_b32 v98,1,v98
v_lshrrev_b32 v52,5,v53
v_lshrrev_b32 v68,5,v69
v_lshrrev_b32 v84,5,v85
v_lshrrev_b32 v100,5,v101
v_lshrrev_b32 v54,4,v54
v_lshrrev_b32 v70,4,v70
v_lshrrev_b32 v86,4,v86
v_lshrrev_b32 v102,4,v102
v_lshl_add_u32 v54,v54,1,v52
v_lshl_add_u32 v70,v70,1,v68
v_lshl_add_u32 v86,v86,1,v84
v_lshl_add_u32 v102,v102,1,v100
v_lshlrev_b32 v54,10,v54
v_lshlrev_b32 v70,10,v70
v_lshlrev_b32 v86,10,v86
v_lshlrev_b32 v102,10,v102
v_lshl_add_u32 v54,v49,8,v54
v_lshl_add_u32 v70,v65,8,v70
v_lshl_add_u32 v86,v81,8,v86
v_lshl_add_u32 v102,v97,8,v102
v_lshl_add_u32 v54,v56,4,v54
v_lshl_add_u32 v70,v72,4,v70
v_lshl_add_u32 v86,v88,4,v86
v_lshl_add_u32 v102,v104,4,v102
v_lshl_add_u32 v51,v51,1,v52
v_lshl_add_u32 v67,v67,1,v68
v_lshl_add_u32 v83,v83,1,v84
v_lshl_add_u32 v99,v99,1,v100
v_lshlrev_b32 v51,6,v51
v_lshlrev_b32 v67,6,v67
v_lshlrev_b32 v83,6,v83
v_lshlrev_b32 v99,6,v99
v_lshl_add_u32 v51,v49,4,v51
v_lshl_add_u32 v67,v65,4,v67
v_lshl_add_u32 v83,v81,4,v83
v_lshl_add_u32 v99,v97,4,v99
v_add_u32 v51,6144,v51
v_add_u32 v67,6144,v67
v_add_u32 v83,6144,v83
v_add_u32 v99,6144,v99
v_cndmask_b32 v54,v54,v51,s[32:33]
v_cndmask_b32 v70,v70,v67,s[34:35]
v_cndmask_b32 v86,v86,v83,s[36:37]
v_cndmask_b32 v102,v102,v99,s[38:39]
v_add_u32 v54,v54,v50
v_add_u32 v70,v70,v66
v_add_u32 v86,v86,v82
v_add_u32 v102,v102,v98
v_mov_b32 v56,7168
v_mov_b32 v72,7168
v_mov_b32 v88,7168
v_mov_b32 v104,7168
v_cndmask_b32 v54,v56,v54,vcc
v_cndmask_b32 v70,v72,v70,vcc
v_cndmask_b32 v86,v88,v86,vcc
v_cndmask_b32 v102,v104,v102,vcc
v_add_u32 v240,57344,v54
v_add_u32 v241,57344,v70
v_add_u32 v242,57344,v86
v_add_u32 v243,57344,v102
s_mul_i32 s46,s45,36
v_lshlrev_b32 v13,2,v15
v_add_u32 v13,s46,v13
v_lshrrev_b32 v244,3,v13
v_lshlrev_b32 v244,8,v244
v_lshl_add_u32 v244,v14,4,v244
v_and_b32 v8,4,v13
v_lshl_add_u32 v244,v8,1,v244
v_add_u32 v13,16,v13
v_lshrrev_b32 v245,3,v13
v_lshlrev_b32 v245,8,v245
v_lshl_add_u32 v245,v14,4,v245
v_and_b32 v8,4,v13
v_lshl_add_u32 v245,v8,1,v245
v_add_u32 v13,16,v13
v_lshrrev_b32 v246,3,v13
v_lshlrev_b32 v246,8,v246
v_lshl_add_u32 v246,v14,4,v246
v_and_b32 v8,4,v13
v_lshl_add_u32 v246,v8,1,v246
v_cmp_eq_u32 vcc,0,v15
v_mov_b32 v8,0x7ff00000
s_nop 0
v_cndmask_b32 v246,v8,v246,vcc
v_mov_b32 v232,0x3f803f80
v_mov_b32 v233,0x3f803f80
v_mov_b32 v234,0x3f803f80
v_mov_b32 v235,0x3f803f80
v_mov_b32 v184,0x3fb8aa3b
v_mov_b32 v185,0x358637bd
s_mul_i32 s46,s22,12288
s_add_u32 s46,s46,8192
v_add_u32 v236,s46,v1
s_lshl_b32 s46,s44,3
s_lshl_b32 s47,s22,1
s_add_u32 s46,s46,s47
s_mul_i32 s46,s46,18432
s_add_u32 s54,s46,0x2000000
s_add_u32 s55,s54,18432
s_getpc_b64 s[58:59]
PC_mega_kernel_2:
s_mul_i32 s46,s23,4
s_add_u32 s46,s46,s22
s_lshl_b32 s46,s46,10
v_add_u32 v13,s46,v1
v_add_u32 v13,PH_k2_0-PC_mega_kernel_2,v13
v_min_u32 v13,PH_k3_0-PC_mega_kernel_2-16,v13
v_and_b32 v13,-4,v13
global_load_dwordx4 a[252:255],v13,s[58:59]
v_and_b32 v12,31,v0
v_lshlrev_b32 v12,3,v12
v_lshrrev_b32 v13,5,v0
v_lshl_add_u32 v12,v13,16,v12
s_lshl_b32 s46,s44,10
s_lshl_b32 s47,s22,8
s_add_u32 s46,s46,s47
s_add_u32 s46,s46,0x1e00000
buffer_load_dwordx2 v[4:5],v12,s[8:11],s46 offen sc1
s_add_u32 s46,s46,16384
buffer_load_dwordx2 v[6:7],v12,s[8:11],s46 offen sc1
s_add_u32 s46,s46,16384
buffer_load_dwordx2 v[8:9],v12,s[8:11],s46 offen sc1
s_add_u32 s46,s46,16384
buffer_load_dwordx2 v[10:11],v12,s[8:11],s46 offen sc1
buffer_load_dwordx4 a[0:3],v1,s[8:11],s24 offen offset:0 sc1
buffer_load_dwordx4 a[4:7],v1,s[8:11],s27 offen offset:0 sc1
s_add_u32 m0,s49,12288
s_nop 0
buffer_load_dwordx4 v255,s[8:11],s20 offen sc1 lds
s_add_u32 m0,s49,16384
s_add_u32 s20,s48,16384
buffer_load_dwordx4 v1,s[8:11],s20 offen sc1 lds
s_add_u32 m0,s49,20480
s_nop 0
buffer_load_dwordx4 v253,s[8:11],s20 offen sc1 lds
s_add_u32 m0,s49,24576
s_nop 0
buffer_load_dwordx4 v254,s[8:11],s20 offen sc1 lds
s_add_u32 m0,s49,28672
s_nop 0
buffer_load_dwordx4 v255,s[8:11],s20 offen sc1 lds
s_add_u32 m0,s49,32768
s_add_u32 s20,s48,32768
buffer_load_dwordx4 v1,s[8:11],s20 offen sc1 lds
s_waitcnt lgkmcnt(0)
s_waitcnt vmcnt(15)
s_barrier
ds_read_b128 v[16:19],v1 offset:0
ds_read_b128 v[20:23],v1 offset:1024
ds_read_b128 v[24:27],v1 offset:2048
ds_read_b128 v[28:31],v1 offset:3072
ds_read_b128 v[32:35],v1 offset:4096
ds_read_b128 v[36:39],v1 offset:5120
ds_read_b128 v[40:43],v1 offset:6144
s_waitcnt vmcnt(6)
s_waitcnt lgkmcnt(5)
MF v[48:51],a[0:3],v[16:19],0
buffer_load_dwordx4 a[8:11],v1,s[8:11],s24 offen offset:1024 sc1
MF v[72:75],a[4:7],v[16:19],0
ds_read_b128 v[44:47],v1 offset:7168
MF v[52:55],a[0:3],v[20:23],0
buffer_load_dwordx4 a[12:15],v1,s[8:11],s27 offen offset:1024 sc1
MF v[76:79],a[4:7],v[20:23],0
ds_read_b128 v[16:19],v1 offset:8192
s_waitcnt lgkmcnt(5)
MF v[56:59],a[0:3],v[24:27],0
buffer_load_dwordx4 a[16:19],v1,s[8:11],s24 offen offset:2048 sc1
MF v[80:83],a[4:7],v[24:27],0
ds_read_b128 v[20:23],v1 offset:9216
MF v[60:63],a[0:3],v[28:31],0
buffer_load_dwordx4 a[20:23],v1,s[8:11],s27 offen offset:2048 sc1
MF v[84:87],a[4:7],v[28:31],0
ds_read_b128 v[24:27],v1 offset:10240
s_waitcnt lgkmcnt(5)
MF v[64:67],a[0:3],v[32:35],0
buffer_load_dwordx4 a[24:27],v1,s[8:11],s24 offen offset:3072 sc1
MF v[88:91],a[4:7],v[32:35],0
ds_read_b128 v[28:31],v1 offset:11264
MF v[68:71],a[0:3],v[36:39],0
buffer_load_dwordx4 a[28:31],v1,s[8:11],s27 offen offset:3072 sc1
MF v[92:95],a[4:7],v[36:39],0
s_waitcnt vmcnt(6)
s_barrier
ds_read_b128 v[32:35],v1 offset:12288
s_waitcnt vmcnt(4)
s_waitcnt lgkmcnt(5)
MF v[48:51],a[8:11],v[40:43],v[48:51]
buffer_load_dwordx4 a[32:35],v253,s[8:11],s24 offen offset:0 sc1
MF v[72:75],a[12:15],v[40:43],v[72:75]
ds_read_b128 v[36:39],v1 offset:13312
MF v[52:55],a[8:11],v[44:47],v[52:55]
buffer_load_dwordx4 a[36:39],v253,s[8:11],s27 offen offset:0 sc1
MF v[76:79],a[12:15],v[44:47],v[76:79]
ds_read_b128 v[40:43],v1 offset:14336
s_waitcnt lgkmcnt(5)
s_add_u32 m0,s49,36864
MF v[56:59],a[8:11],v[16:19],v[56:59]
buffer_load_dwordx4 v253,s[8:11],s20 offen sc1 lds
MF v[80:83],a[12:15],v[16:19],v[80:83]
ds_read_b128 v[44:47],v1 offset:15360
v_add_f32 v192,v192,v193
v_add_u32 v238,160768,v238
ds_write_b32 v238,v192
s_add_u32 m0,s49,40960
MF v[60:63],a[8:11],v[20:23],v[60:63]
buffer_load_dwordx4 v254,s[8:11],s20 offen sc1 lds
MF v[84:87],a[12:15],v[20:23],v[84:87]
ds_read_b128 v[16:19],v1 offset:16384
s_waitcnt lgkmcnt(6)
s_add_u32 m0,s49,45056
MF v[64:67],a[8:11],v[24:27],v[64:67]
buffer_load_dwordx4 v255,s[8:11],s20 offen sc1 lds
MF v[88:91],a[12:15],v[24:27],v[88:91]
ds_read_b128 v[20:23],v1 offset:17408
s_add_u32 m0,s49,49152
s_add_u32 s20,s48,49152
MF v[68:71],a[8:11],v[28:31],v[68:71]
buffer_load_dwordx4 v1,s[8:11],s20 offen sc1 lds
MF v[92:95],a[12:15],v[28:31],v[92:95]
ds_read_b128 v[24:27],v1 offset:18432
s_waitcnt vmcnt(8)
s_waitcnt lgkmcnt(6)
s_add_u32 m0,s49,53248
MF v[48:51],a[16:19],v[32:35],v[48:51]
buffer_load_dwordx4 v253,s[8:11],s20 offen sc1 lds
MF v[72:75],a[20:23],v[32:35],v[72:75]
ds_read_b128 v[28:31],v1 offset:19456
s_add_u32 m0,s49,57344
MF v[52:55],a[16:19],v[36:39],v[52:55]
buffer_load_dwordx4 v254,s[8:11],s20 offen sc1 lds
MF v[76:79],a[20:23],v[36:39],v[76:79]
ds_read_b128 v[32:35],v1 offset:20480
s_waitcnt lgkmcnt(6)
s_add_u32 m0,s49,61440
MF v[56:59],a[16:19],v[40:43],v[56:59]
buffer_load_dwordx4 v255,s[8:11],s20 offen sc1 lds
MF v[80:83],a[20:23],v[40:43],v[80:83]
ds_read_b128 v[36:39],v1 offset:21504
s_add_u32 m0,s49,65536
s_add_u32 s20,s48,65536
MF v[60:63],a[16:19],v[44:47],v[60:63]
buffer_load_dwordx4 v1,s[8:11],s20 offen sc1 lds
MF v[84:87],a[20:23],v[44:47],v[84:87]
ds_read_b128 v[40:43],v1 offset:22528
s_waitcnt lgkmcnt(5)
s_add_u32 m0,s49,69632
MF v[64:67],a[16:19],v[16:19],v[64:67]
buffer_load_dwordx4 v253,s[8:11],s20 offen sc1 lds
MF v[88:91],a[20:23],v[16:19],v[88:91]
ds_read_b128 v[44:47],v1 offset:23552
MF v[68:71],a[16:19],v[20:23],v[68:71]
buffer_load_dwordx4 a[40:43],v253,s[8:11],s24 offen offset:1024 sc1
MF v[92:95],a[20:23],v[20:23],v[92:95]
ds_read_b128 v[16:19],v1 offset:24576
s_waitcnt vmcnt(12)
s_waitcnt lgkmcnt(5)
MF v[48:51],a[24:27],v[24:27],v[48:51]
buffer_load_dwordx4 a[44:47],v253,s[8:11],s27 offen offset:1024 sc1
MF v[72:75],a[28:31],v[24:27],v[72:75]
ds_read_b128 v[20:23],v1 offset:25600
MF v[52:55],a[24:27],v[28:31],v[52:55]
buffer_load_dwordx4 a[48:51],v253,s[8:11],s24 offen offset:2048 sc1
MF v[76:79],a[28:31],v[28:31],v[76:79]
ds_read_b128 v[24:27],v1 offset:26624
s_waitcnt lgkmcnt(5)
MF v[56:59],a[24:27],v[32:35],v[56:59]
buffer_load_dwordx4 a[52:55],v253,s[8:11],s27 offen offset:2048 sc1
MF v[80:83],a[28:31],v[32:35],v[80:83]
ds_read_b128 v[28:31],v1 offset:27648
MF v[60:63],a[24:27],v[36:39],v[60:63]
buffer_load_dwordx4 a[56:59],v253,s[8:11],s24 offen offset:3072 sc1
MF v[84:87],a[28:31],v[36:39],v[84:87]
ds_read_b128 v[32:35],v1 offset:28672
s_waitcnt lgkmcnt(5)
MF v[64:67],a[24:27],v[40:43],v[64:67]
buffer_load_dwordx4 a[60:63],v253,s[8:11],s27 offen offset:3072 sc1
MF v[88:91],a[28:31],v[40:43],v[88:91]
ds_read_b128 v[36:39],v1 offset:29696
MF v[68:71],a[24:27],v[44:47],v[68:71]
buffer_load_dwordx4 a[64:67],v254,s[8:11],s24 offen offset:0 sc1
MF v[92:95],a[28:31],v[44:47],v[92:95]
ds_read_b128 v[40:43],v1 offset:30720
s_waitcnt vmcnt(16)
s_waitcnt lgkmcnt(5)
MF v[48:51],a[32:35],v[16:19],v[48:51]
buffer_load_dwordx4 a[68:71],v254,s[8:11],s27 offen offset:0 sc1
MF v[72:75],a[36:39],v[16:19],v[72:75]
ds_read_b128 v[44:47],v1 offset:31744
MF v[52:55],a[32:35],v[20:23],v[52:55]
buffer_load_dwordx4 a[72:75],v254,s[8:11],s24 offen offset:1024 sc1
MF v[76:79],a[36:39],v[20:23],v[76:79]
ds_read_b128 v[16:19],v1 offset:32768
s_waitcnt lgkmcnt(5)
MF v[56:59],a[32:35],v[24:27],v[56:59]
buffer_load_dwordx4 a[76:79],v254,s[8:11],s27 offen offset:1024 sc1
MF v[80:83],a[36:39],v[24:27],v[80:83]
ds_read_b128 v[20:23],v1 offset:33792
MF v[60:63],a[32:35],v[28:31],v[60:63]
buffer_load_dwordx4 a[80:83],v254,s[8:11],s24 offen offset:2048 sc1
MF v[84:87],a[36:39],v[28:31],v[84:87]
ds_read_b128 v[24:27],v1 offset:34816
s_waitcnt lgkmcnt(5)
MF v[64:67],a[32:35],v[32:35],v[64:67]
buffer_load_dwordx4 a[84:87],v254,s[8:11],s27 offen offset:2048 sc1
MF v[88:91],a[36:39],v[32:35],v[88:91]
ds_read_b128 v[28:31],v1 offset:35840
s_add_u32 m0,s49,73728
MF v[68:71],a[32:35],v[36:39],v[68:71]
buffer_load_dwordx4 v254,s[8:11],s20 offen sc1 lds
MF v[92:95],a[36:39],v[36:39],v[92:95]
s_waitcnt vmcnt(13)
s_barrier
ds_read_b128 v[32:35],v1 offset:36864
s_waitcnt vmcnt(11)
s_waitcnt lgkmcnt(5)
s_add_u32 m0,s49,77824
MF v[48:51],a[40:43],v[40:43],v[48:51]
buffer_load_dwordx4 v255,s[8:11],s20 offen sc1 lds
MF v[72:75],a[44:47],v[40:43],v[72:75]
ds_read_b128 v[36:39],v1 offset:37888
s_add_u32 m0,s49,81920
s_add_u32 s20,s48,81920
MF v[52:55],a[40:43],v[44:47],v[52:55]
buffer_load_dwordx4 v1,s[8:11],s20 offen sc1 lds
MF v[76:79],a[44:47],v[44:47],v[76:79]
ds_read_b128 v[40:43],v1 offset:38912
s_waitcnt lgkmcnt(5)
s_add_u32 m0,s49,86016
MF v[56:59],a[40:43],v[16:19],v[56:59]
buffer_load_dwordx4 v253,s[8:11],s20 offen sc1 lds
MF v[80:83],a[44:47],v[16:19],v[80:83]
ds_read_b128 v[44:47],v1 offset:39936
s_add_u32 m0,s49,90112
MF v[60:63],a[40:43],v[20:23],v[60:63]
buffer_load_dwordx4 v254,s[8:11],s20 offen sc1 lds
MF v[84:87],a[44:47],v[20:23],v[84:87]
ds_read_b128 v[16:19],v1 offset:40960
s_waitcnt lgkmcnt(5)
s_add_u32 m0,s49,94208
MF v[64:67],a[40:43],v[24:27],v[64:67]
buffer_load_dwordx4 v255,s[8:11],s20 offen sc1 lds
MF v[88:91],a[44:47],v[24:27],v[88:91]
ds_read_b128 v[20:23],v1 offset:41984
s_add_u32 m0,s49,98304
s_add_u32 s20,s48,98304
MF v[68:71],a[40:43],v[28:31],v[68:71]
buffer_load_dwordx4 v1,s[8:11],s20 offen sc1 lds
MF v[92:95],a[44:47],v[28:31],v[92:95]
ds_read_b128 v[24:27],v1 offset:43008
s_waitcnt vmcnt(15)
s_waitcnt lgkmcnt(5)
s_add_u32 m0,s49,102400
MF v[48:51],a[48:51],v[32:35],v[48:51]
buffer_load_dwordx4 v253,s[8:11],s20 offen sc1 lds
MF v[72:75],a[52:55],v[32:35],v[72:75]
ds_read_b128 v[28:31],v1 offset:44032
s_add_u32 m0,s49,106496
MF v[52:55],a[48:51],v[36:39],v[52:55]
buffer_load_dwordx4 v254,s[8:11],s20 offen sc1 lds
MF v[76:79],a[52:55],v[36:39],v[76:79]
ds_read_b128 v[32:35],v1 offset:45056
s_waitcnt lgkmcnt(5)
MF v[56:59],a[48:51],v[40:43],v[56:59]
buffer_load_dwordx4 a[88:91],v254,s[8:11],s24 offen offset:3072 sc1
MF v[80:83],a[52:55],v[40:43],v[80:83]
ds_read_b128 v[36:39],v1 offset:46080
MF v[60:63],a[48:51],v[44:47],v[60:63]
buffer_load_dwordx4 a[92:95],v254,s[8:11],s27 offen offset:3072 sc1
MF v[84:87],a[52:55],v[44:47],v[84:87]
ds_read_b128 v[40:43],v1 offset:47104
s_waitcnt lgkmcnt(5)
MF v[64:67],a[48:51],v[16:19],v[64:67]
buffer_load_dwordx4 a[96:99],v255,s[8:11],s24 offen offset:0 sc1
MF v[88:91],a[52:55],v[16:19],v[88:91]
ds_read_b128 v[44:47],v1 offset:48128
MF v[68:71],a[48:51],v[20:23],v[68:71]
buffer_load_dwordx4 a[100:103],v255,s[8:11],s27 offen offset:0 sc1
MF v[92:95],a[52:55],v[20:23],v[92:95]
ds_read_b128 v[16:19],v1 offset:49152
s_waitcnt vmcnt(19)
s_waitcnt lgkmcnt(5)
MF v[48:51],a[56:59],v[24:27],v[48:51]
buffer_load_dwordx4 a[104:107],v255,s[8:11],s24 offen offset:1024 sc1
MF v[72:75],a[60:63],v[24:27],v[72:75]
ds_read_b128 v[20:23],v1 offset:50176
MF v[52:55],a[56:59],v[28:31],v[52:55]
buffer_load_dwordx4 a[108:111],v255,s[8:11],s27 offen offset:1024 sc1
MF v[76:79],a[60:63],v[28:31],v[76:79]
ds_read_b128 v[24:27],v1 offset:51200
s_waitcnt lgkmcnt(5)
MF v[56:59],a[56:59],v[32:35],v[56:59]
buffer_load_dwordx4 a[112:115],v255,s[8:11],s24 offen offset:2048 sc1
MF v[80:83],a[60:63],v[32:35],v[80:83]
ds_read_b128 v[28:31],v1 offset:52224
MF v[60:63],a[56:59],v[36:39],v[60:63]
buffer_load_dwordx4 a[116:119],v255,s[8:11],s27 offen offset:2048 sc1
MF v[84:87],a[60:63],v[36:39],v[84:87]
ds_read_b128 v[32:35],v1 offset:53248
s_waitcnt lgkmcnt(5)
MF v[64:67],a[56:59],v[40:43],v[64:67]
buffer_load_dwordx4 a[120:123],v255,s[8:11],s24 offen offset:3072 sc1
MF v[88:91],a[60:63],v[40:43],v[88:91]
ds_read_b128 v[36:39],v1 offset:54272
MF v[68:71],a[56:59],v[44:47],v[68:71]
buffer_load_dwordx4 a[124:127],v255,s[8:11],s27 offen offset:3072 sc1
MF v[92:95],a[60:63],v[44:47],v[92:95]
ds_read_b128 v[40:43],v1 offset:55296
s_waitcnt vmcnt(23)
s_waitcnt lgkmcnt(5)
MF v[48:51],a[64:67],v[16:19],v[48:51]
buffer_load_dwordx4 a[128:131],v1,s[8:11],s29 offen offset:0 sc1
MF v[72:75],a[68:71],v[16:19],v[72:75]
ds_read_b128 v[44:47],v1 offset:56320
MF v[52:55],a[64:67],v[20:23],v[52:55]
buffer_load_dwordx4 a[132:135],v1,s[8:11],s21 offen offset:0 sc1
MF v[76:79],a[68:71],v[20:23],v[76:79]
ds_read_b128 v[16:19],v1 offset:57344
s_waitcnt lgkmcnt(5)
s_add_u32 m0,s49,110592
MF v[56:59],a[64:67],v[24:27],v[56:59]
buffer_load_dwordx4 v255,s[8:11],s20 offen sc1 lds
MF v[80:83],a[68:71],v[24:27],v[80:83]
ds_read_b128 v[20:23],v1 offset:58368
s_add_u32 m0,s49,114688
s_add_u32 s20,s48,114688
MF v[60:63],a[64:67],v[28:31],v[60:63]
buffer_load_dwordx4 v1,s[8:11],s20 offen sc1 lds
MF v[84:87],a[68:71],v[28:31],v[84:87]
ds_read_b128 v[24:27],v1 offset:59392
s_waitcnt lgkmcnt(5)
s_add_u32 m0,s49,118784
MF v[64:67],a[64:67],v[32:35],v[64:67]
buffer_load_dwordx4 v253,s[8:11],s20 offen sc1 lds
MF v[88:91],a[68:71],v[32:35],v[88:91]
ds_read_b128 v[28:31],v1 offset:60416
s_add_u32 m0,s49,122880
MF v[68:71],a[64:67],v[36:39],v[68:71]
buffer_load_dwordx4 v254,s[8:11],s20 offen sc1 lds
MF v[92:95],a[68:71],v[36:39],v[92:95]
ds_read_b128 v[32:35],v1 offset:61440
s_waitcnt vmcnt(27)
s_waitcnt lgkmcnt(5)
s_add_u32 m0,s49,126976
MF v[48:51],a[72:75],v[40:43],v[48:51]
buffer_load_dwordx4 v255,s[8:11],s20 offen sc1 lds
MF v[72:75],a[76:79],v[40:43],v[72:75]
ds_read_b128 v[36:39],v1 offset:62464
s_add_u32 m0,s49,131072
s_add_u32 s20,s48,131072
MF v[52:55],a[72:75],v[44:47],v[52:55]
buffer_load_dwordx4 v1,s[8:11],s20 offen sc1 lds
MF v[76:79],a[76:79],v[44:47],v[76:79]
ds_read_b128 v[40:43],v1 offset:63488
s_waitcnt lgkmcnt(5)
s_add_u32 m0,s49,135168
MF v[56:59],a[72:75],v[16:19],v[56:59]
buffer_load_dwordx4 v253,s[8:11],s20 offen sc1 lds
v_add_f32 v4,v4,v6
v_add_f32 v8,v8,v10
v_add_f32 v4,v4,v8
v_add_f32 v5,v5,v7
v_add_f32 v9,v9,v11
v_add_f32 v5,v5,v9
v_mov_b32 v6,v4
s_nop 1
v_permlane32_swap_b32 v4,v6
v_add_f32 v4,v4,v6
v_mov_b32 v6,v5
s_nop 1
v_permlane32_swap_b32 v5,v6
v_add_f32 v5,v5,v6
v_mul_f32 v4,0xbae38e39,v4
v_mul_f32 v5,0x3ae38e39,v5
v_mul_f32 v6,v4,v4
v_sub_f32 v5,v5,v6
v_max_f32 v5,0,v5
v_add_f32 v5,0x3727c5ac,v5
v_rsq_f32 v5,v5
v_cmp_gt_u32 vcc,32,v0
s_nop 1
v_cndmask_b32 v4,v5,v4,vcc
s_lshl_b32 s30,s22,8
s_add_u32 s30,s30,159744
v_lshlrev_b32 v6,2,v0
v_add_u32 v6,s30,v6
ds_write_b32 v6,v4
MF v[80:83],a[76:79],v[16:19],v[80:83]
ds_read_b128 v[44:47],v1 offset:64512
v_lshlrev_b32 v12,4,v15
v_add_u32 v12,s30,v12
v_lshlrev_b32 v13,2,v14
v_add_u32 v13,s30,v13
s_add_u32 m0,s49,139264
MF v[60:63],a[72:75],v[20:23],v[60:63]
buffer_load_dwordx4 v254,s[8:11],s20 offen sc1 lds
ds_read_b128 v[212:215],v12 offset:0
MF v[84:87],a[76:79],v[20:23],v[84:87]
ds_read_b128 v[16:19],v2 offset:0
s_waitcnt lgkmcnt(7)
s_add_u32 m0,s49,143360
MF v[64:67],a[72:75],v[24:27],v[64:67]
buffer_load_dwordx4 v255,s[8:11],s20 offen sc1 lds
ds_read_b128 v[220:223],v12 offset:128
MF v[88:91],a[76:79],v[24:27],v[88:91]
ds_read_b128 v[20:23],v2 offset:1024
ds_read_b32 v228,v13 offset:0
MF v[68:71],a[72:75],v[28:31],v[68:71]
buffer_load_dwordx4 a[136:139],v1,s[8:11],s29 offen offset:1024 sc1
ds_read_b32 v230,v13 offset:128
MF v[92:95],a[76:79],v[28:31],v[92:95]
ds_read_b128 v[24:27],v2 offset:2048
s_waitcnt vmcnt(31)
s_waitcnt lgkmcnt(10)
MF v[48:51],a[80:83],v[32:35],v[48:51]
buffer_load_dwordx4 a[140:143],v1,s[8:11],s21 offen offset:1024 sc1
ds_read_b128 v[216:219],v12 offset:64
MF v[72:75],a[84:87],v[32:35],v[72:75]
ds_read_b128 v[28:31],v2 offset:3072
ds_read_b128 v[224:227],v12 offset:192
s_add_u32 m0,s49,147456
s_add_u32 s20,s48,147456
MF v[52:55],a[80:83],v[36:39],v[52:55]
buffer_load_dwordx4 v1,s[8:11],s20 offen sc1 lds
ds_read_b32 v229,v13 offset:64
MF v[76:79],a[84:87],v[36:39],v[76:79]
ds_read_b128 v[32:35],v2 offset:4096
s_waitcnt lgkmcnt(12)
s_add_u32 m0,s49,151552
MF v[56:59],a[80:83],v[40:43],v[56:59]
buffer_load_dwordx4 v253,s[8:11],s20 offen sc1 lds
ds_read_b32 v231,v13 offset:192
MF v[80:83],a[84:87],v[40:43],v[80:83]
ds_read_b128 v[36:39],v2 offset:5120
v_lshlrev_b32 v12,4,v15
v_add_u32 v12,160768,v12
v_lshlrev_b32 v13,2,v14
v_add_u32 v13,160768,v13
s_add_u32 m0,s49,155648
MF v[60:63],a[80:83],v[44:47],v[60:63]
buffer_load_dwordx4 v254,s[8:11],s20 offen sc1 lds
ds_read_b32 v192,v13 offset:192
MF v[84:87],a[84:87],v[44:47],v[84:87]
s_waitcnt lgkmcnt(12)
ds_read_b128 v[40:43],v2 offset:6144
s_waitcnt lgkmcnt(12)
s_add_u32 m0,s49,0
MF v[64:67],a[80:83],v[16:19],v[64:67]
buffer_load_dwordx4 v255,s[8:11],s20 offen sc1 lds
ds_read_b32 v193,v13 offset:256
MF v[88:91],a[84:87],v[16:19],v[88:91]
ds_read_b128 v[44:47],v2 offset:7168
ds_read_b32 v194,v13 offset:320
s_add_u32 m0,s49,4096
s_add_u32 s20,s48,163840
MF v[68:71],a[80:83],v[20:23],v[68:71]
buffer_load_dwordx4 v1,s[8:11],s20 offen sc1 lds
s_waitcnt lgkmcnt(12)
ds_read_b32 v195,v13 offset:384
MF v[92:95],a[84:87],v[20:23],v[92:95]
s_waitcnt vmcnt(28)
s_barrier
ds_read_b128 v[16:19],v2 offset:8192
s_waitcnt vmcnt(26)
s_waitcnt lgkmcnt(12)
MF v[48:51],a[88:91],v[24:27],v[48:51]
ds_read_b32 v196,v13 offset:448
ds_read_b32 v197,v13 offset:512
MF v[72:75],a[92:95],v[24:27],v[72:75]
ds_read_b128 v[20:23],v2 offset:9216
s_waitcnt lgkmcnt(12)
ds_read_b128 v[200:203],v12 offset:0
MF v[52:55],a[88:91],v[28:31],v[52:55]
ds_read_b128 v[204:207],v12 offset:64
ds_read_b128 v[208:211],v12 offset:128
MF v[76:79],a[92:95],v[28:31],v[76:79]
s_waitcnt lgkmcnt(12)
ds_read_b128 v[24:27],v2 offset:10240
MF v[56:59],a[88:91],v[32:35],v[56:59]
MF v[80:83],a[92:95],v[32:35],v[80:83]
ds_read_b128 v[28:31],v2 offset:11264
MF v[60:63],a[88:91],v[36:39],v[60:63]
MF v[84:87],a[92:95],v[36:39],v[84:87]
ds_read_b128 v[32:35],v2 offset:12288
s_waitcnt lgkmcnt(12)
MF v[64:67],a[88:91],v[40:43],v[64:67]
MF v[88:91],a[92:95],v[40:43],v[88:91]
ds_read_b128 v[36:39],v2 offset:13312
MF v[68:71],a[88:91],v[44:47],v[68:71]
MF v[92:95],a[92:95],v[44:47],v[92:95]
ds_read_b128 v[40:43],v2 offset:14336
s_waitcnt vmcnt(24)
s_waitcnt lgkmcnt(8)
MF v[48:51],a[96:99],v[16:19],v[48:51]
MF v[72:75],a[100:103],v[16:19],v[72:75]
ds_read_b128 v[44:47],v2 offset:15360
MF v[52:55],a[96:99],v[20:23],v[52:55]
MF v[76:79],a[100:103],v[20:23],v[76:79]
ds_read_b128 v[16:19],v2 offset:16384
s_waitcnt lgkmcnt(5)
MF v[56:59],a[96:99],v[24:27],v[56:59]
MF v[80:83],a[100:103],v[24:27],v[80:83]
ds_read_b128 v[20:23],v2 offset:17408
MF v[60:63],a[96:99],v[28:31],v[60:63]
MF v[84:87],a[100:103],v[28:31],v[84:87]
ds_read_b128 v[24:27],v2 offset:18432
s_waitcnt lgkmcnt(5)
MF v[64:67],a[96:99],v[32:35],v[64:67]
MF v[88:91],a[100:103],v[32:35],v[88:91]
ds_read_b128 v[28:31],v2 offset:19456
MF v[68:71],a[96:99],v[36:39],v[68:71]
MF v[92:95],a[100:103],v[36:39],v[92:95]
ds_read_b128 v[32:35],v2 offset:20480
s_waitcnt vmcnt(22)
s_waitcnt lgkmcnt(5)
MF v[48:51],a[104:107],v[40:43],v[48:51]
MF v[72:75],a[108:111],v[40:43],v[72:75]
ds_read_b128 v[36:39],v2 offset:21504
MF v[52:55],a[104:107],v[44:47],v[52:55]
MF v[76:79],a[108:111],v[44:47],v[76:79]
ds_read_b128 v[40:43],v2 offset:22528
s_waitcnt lgkmcnt(5)
MF v[56:59],a[104:107],v[16:19],v[56:59]
MF v[80:83],a[108:111],v[16:19],v[80:83]
ds_read_b128 v[44:47],v2 offset:23552
MF v[60:63],a[104:107],v[20:23],v[60:63]
MF v[84:87],a[108:111],v[20:23],v[84:87]
ds_read_b128 v[16:19],v2 offset:24576
s_waitcnt lgkmcnt(5)
MF v[64:67],a[104:107],v[24:27],v[64:67]
MF v[88:91],a[108:111],v[24:27],v[88:91]
ds_read_b128 v[20:23],v2 offset:25600
MF v[68:71],a[104:107],v[28:31],v[68:71]
MF v[92:95],a[108:111],v[28:31],v[92:95]
ds_read_b128 v[24:27],v2 offset:26624
s_waitcnt vmcnt(20)
s_waitcnt lgkmcnt(5)
MF v[48:51],a[112:115],v[32:35],v[48:51]
MF v[72:75],a[116:119],v[32:35],v[72:75]
ds_read_b128 v[28:31],v2 offset:27648
MF v[52:55],a[112:115],v[36:39],v[52:55]
MF v[76:79],a[116:119],v[36:39],v[76:79]
ds_read_b128 v[32:35],v2 offset:28672
s_waitcnt lgkmcnt(5)
MF v[56:59],a[112:115],v[40:43],v[56:59]
MF v[80:83],a[116:119],v[40:43],v[80:83]
ds_read_b128 v[36:39],v2 offset:29696
MF v[60:63],a[112:115],v[44:47],v[60:63]
MF v[84:87],a[116:119],v[44:47],v[84:87]
ds_read_b128 v[40:43],v2 offset:30720
s_waitcnt lgkmcnt(5)
MF v[64:67],a[112:115],v[16:19],v[64:67]
MF v[88:91],a[116:119],v[16:19],v[88:91]
ds_read_b128 v[44:47],v2 offset:31744
MF v[68:71],a[112:115],v[20:23],v[68:71]
MF v[92:95],a[116:119],v[20:23],v[92:95]
ds_read_b128 v[16:19],v2 offset:32768
s_waitcnt vmcnt(18)
s_waitcnt lgkmcnt(5)
MF v[48:51],a[120:123],v[24:27],v[48:51]
MF v[72:75],a[124:127],v[24:27],v[72:75]
ds_read_b128 v[20:23],v2 offset:33792
MF v[52:55],a[120:123],v[28:31],v[52:55]
MF v[76:79],a[124:127],v[28:31],v[76:79]
ds_read_b128 v[24:27],v2 offset:34816
s_waitcnt lgkmcnt(5)
MF v[56:59],a[120:123],v[32:35],v[56:59]
MF v[80:83],a[124:127],v[32:35],v[80:83]
ds_read_b128 v[28:31],v2 offset:35840
MF v[60:63],a[120:123],v[36:39],v[60:63]
MF v[84:87],a[124:127],v[36:39],v[84:87]
ds_read_b128 v[32:35],v2 offset:36864
s_waitcnt lgkmcnt(5)
MF v[64:67],a[120:123],v[40:43],v[64:67]
MF v[88:91],a[124:127],v[40:43],v[88:91]
ds_read_b128 v[36:39],v2 offset:37888
MF v[68:71],a[120:123],v[44:47],v[68:71]
MF v[92:95],a[124:127],v[44:47],v[92:95]
ds_read_b128 v[40:43],v2 offset:38912
s_waitcnt vmcnt(16)
s_waitcnt lgkmcnt(5)
MF v[48:51],a[128:131],v[16:19],v[48:51]
MF v[72:75],a[132:135],v[16:19],v[72:75]
ds_read_b128 v[44:47],v2 offset:39936
MF v[52:55],a[128:131],v[20:23],v[52:55]
MF v[76:79],a[132:135],v[20:23],v[76:79]
ds_read_b128 v[16:19],v2 offset:40960
s_waitcnt lgkmcnt(5)
MF v[56:59],a[128:131],v[24:27],v[56:59]
MF v[80:83],a[132:135],v[24:27],v[80:83]
ds_read_b128 v[20:23],v2 offset:41984
MF v[60:63],a[128:131],v[28:31],v[60:63]
MF v[84:87],a[132:135],v[28:31],v[84:87]
ds_read_b128 v[24:27],v2 offset:43008
s_waitcnt lgkmcnt(5)
MF v[64:67],a[128:131],v[32:35],v[64:67]
MF v[88:91],a[132:135],v[32:35],v[88:91]
ds_read_b128 v[28:31],v2 offset:44032
MF v[68:71],a[128:131],v[36:39],v[68:71]
MF v[92:95],a[132:135],v[36:39],v[92:95]
s_waitcnt vmcnt(7)
s_barrier
ds_read_b128 v[32:35],v2 offset:45056
s_waitcnt vmcnt(5)
s_waitcnt lgkmcnt(5)
MF v[48:51],a[136:139],v[40:43],v[48:51]
MF v[72:75],a[140:143],v[40:43],v[72:75]
ds_read_b128 v[36:39],v2 offset:46080
MF v[52:55],a[136:139],v[44:47],v[52:55]
MF v[76:79],a[140:143],v[44:47],v[76:79]
ds_read_b128 v[40:43],v2 offset:47104
s_waitcnt lgkmcnt(5)
MF v[56:59],a[136:139],v[16:19],v[56:59]
MF v[80:83],a[140:143],v[16:19],v[80:83]
ds_read_b128 v[44:47],v2 offset:48128
MF v[60:63],a[136:139],v[20:23],v[60:63]
MF v[84:87],a[140:143],v[20:23],v[84:87]
ds_read_b128 v[16:19],v2 offset:49152
s_waitcnt lgkmcnt(5)
MF v[64:67],a[136:139],v[24:27],v[64:67]
MF v[88:91],a[140:143],v[24:27],v[88:91]
ds_read_b128 v[20:23],v2 offset:50176
MF v[68:71],a[136:139],v[28:31],v[68:71]
MF v[92:95],a[140:143],v[28:31],v[92:95]
s_waitcnt lgkmcnt(0)
v_mov_b32 v8,0
v_mov_b32 v9,0
v_mov_b32 v10,0
v_mov_b32 v11,0
s_lshl_b32 s46,s22,11
s_add_u32 s46,s46,57344
v_add_u32 v12,s46,v1
ds_write_b128 v12,v[8:11]
ds_write_b128 v12,v[8:11] offset:1024
s_nop 7
v_pk_fma_f32 v[48:49],v[212:213],v[192:193],v[48:49] op_sel_hi:[1,0,1]
v_pk_fma_f32 v[50:51],v[214:215],v[192:193],v[50:51] op_sel_hi:[1,0,1]
v_pk_fma_f32 v[72:73],v[216:217],v[192:193],v[72:73] op_sel_hi:[1,0,1]
v_pk_fma_f32 v[74:75],v[218:219],v[192:193],v[74:75] op_sel_hi:[1,0,1]
v_pk_mul_f32 v[48:49],v[48:49],v[220:221]
v_pk_mul_f32 v[50:51],v[50:51],v[222:223]
v_pk_mul_f32 v[72:73],v[72:73],v[224:225]
v_pk_mul_f32 v[74:75],v[74:75],v[226:227]
v_pk_mul_f32 v[168:169],v[48:49],v[184:185] op_sel_hi:[1,0]
v_pk_mul_f32 v[170:171],v[50:51],v[184:185] op_sel_hi:[1,0]
v_pk_mul_f32 v[172:173],v[72:73],v[184:185] op_sel_hi:[1,0]
v_pk_mul_f32 v[174:175],v[74:75],v[184:185] op_sel_hi:[1,0]
v_pk_add_f32 v[48:49],v[48:49],v[184:185] op_sel:[0,1]
v_pk_add_f32 v[50:51],v[50:51],v[184:185] op_sel:[0,1]
v_pk_add_f32 v[72:73],v[72:73],v[184:185] op_sel:[0,1]
v_pk_add_f32 v[74:75],v[74:75],v[184:185] op_sel:[0,1]
v_min_f32 v168,0,v168
v_min_f32 v170,0,v170
v_min_f32 v172,0,v172
v_min_f32 v174,0,v174
v_min_f32 v169,0,v169
v_min_f32 v171,0,v171
v_min_f32 v173,0,v173
v_min_f32 v175,0,v175
v_exp_f32 v168,v168
v_exp_f32 v170,v170
v_exp_f32 v172,v172
v_exp_f32 v174,v174
v_exp_f32 v169,v169
v_exp_f32 v171,v171
v_exp_f32 v173,v173
v_exp_f32 v175,v175
v_max_f32 v48,v48,v185
v_max_f32 v50,v50,v185
v_max_f32 v72,v72,v185
v_max_f32 v74,v74,v185
v_max_f32 v49,v49,v185
v_max_f32 v51,v51,v185
v_max_f32 v73,v73,v185
v_max_f32 v75,v75,v185
v_pk_add_f32 v[48:49],v[48:49],v[168:169]
v_pk_add_f32 v[50:51],v[50:51],v[170:171]
v_pk_add_f32 v[72:73],v[72:73],v[172:173]
v_pk_add_f32 v[74:75],v[74:75],v[174:175]
v_cvt_pk_bf16_f32 v144,v48,v49
v_cvt_pk_bf16_f32 v145,v50,v51
v_cvt_pk_bf16_f32 v146,v72,v73
v_cvt_pk_bf16_f32 v147,v74,v75
v_pk_fma_f32 v[52:53],v[212:213],v[192:193],v[52:53] op_sel:[0,1,0]
v_pk_fma_f32 v[54:55],v[214:215],v[192:193],v[54:55] op_sel:[0,1,0]
v_pk_fma_f32 v[76:77],v[216:217],v[192:193],v[76:77] op_sel:[0,1,0]
v_pk_fma_f32 v[78:79],v[218:219],v[192:193],v[78:79] op_sel:[0,1,0]
v_pk_mul_f32 v[52:53],v[52:53],v[220:221]
v_pk_mul_f32 v[54:55],v[54:55],v[222:223]
v_pk_mul_f32 v[76:77],v[76:77],v[224:225]
v_pk_mul_f32 v[78:79],v[78:79],v[226:227]
v_pk_mul_f32 v[168:169],v[52:53],v[184:185] op_sel_hi:[1,0]
v_pk_mul_f32 v[170:171],v[54:55],v[184:185] op_sel_hi:[1,0]
v_pk_mul_f32 v[172:173],v[76:77],v[184:185] op_sel_hi:[1,0]
v_pk_mul_f32 v[174:175],v[78:79],v[184:185] op_sel_hi:[1,0]
v_pk_add_f32 v[52:53],v[52:53],v[184:185] op_sel:[0,1]
v_pk_add_f32 v[54:55],v[54:55],v[184:185] op_sel:[0,1]
v_pk_add_f32 v[76:77],v[76:77],v[184:185] op_sel:[0,1]
v_pk_add_f32 v[78:79],v[78:79],v[184:185] op_sel:[0,1]
v_min_f32 v168,0,v168
v_min_f32 v170,0,v170
v_min_f32 v172,0,v172
v_min_f32 v174,0,v174
v_min_f32 v169,0,v169
v_min_f32 v171,0,v171
v_min_f32 v173,0,v173
v_min_f32 v175,0,v175
v_exp_f32 v168,v168
v_exp_f32 v170,v170
v_exp_f32 v172,v172
v_exp_f32 v174,v174
v_exp_f32 v169,v169
v_exp_f32 v171,v171
v_exp_f32 v173,v173
v_exp_f32 v175,v175
v_max_f32 v52,v52,v185
v_max_f32 v54,v54,v185
v_max_f32 v76,v76,v185
v_max_f32 v78,v78,v185
v_max_f32 v53,v53,v185
v_max_f32 v55,v55,v185
v_max_f32 v77,v77,v185
v_max_f32 v79,v79,v185
v_pk_add_f32 v[52:53],v[52:53],v[168:169]
v_pk_add_f32 v[54:55],v[54:55],v[170:171]
v_pk_add_f32 v[76:77],v[76:77],v[172:173]
v_pk_add_f32 v[78:79],v[78:79],v[174:175]
v_cvt_pk_bf16_f32 v148,v52,v53
v_cvt_pk_bf16_f32 v149,v54,v55
v_cvt_pk_bf16_f32 v150,v76,v77
v_cvt_pk_bf16_f32 v151,v78,v79
v_pk_fma_f32 v[56:57],v[212:213],v[194:195],v[56:57] op_sel_hi:[1,0,1]
v_pk_fma_f32 v[58:59],v[214:215],v[194:195],v[58:59] op_sel_hi:[1,0,1]
v_pk_fma_f32 v[80:81],v[216:217],v[194:195],v[80:81] op_sel_hi:[1,0,1]
v_pk_fma_f32 v[82:83],v[218:219],v[194:195],v[82:83] op_sel_hi:[1,0,1]
v_pk_mul_f32 v[56:57],v[56:57],v[220:221]
v_pk_mul_f32 v[58:59],v[58:59],v[222:223]
v_pk_mul_f32 v[80:81],v[80:81],v[224:225]
v_pk_mul_f32 v[82:83],v[82:83],v[226:227]
v_pk_mul_f32 v[168:169],v[56:57],v[184:185] op_sel_hi:[1,0]
v_pk_mul_f32 v[170:171],v[58:59],v[184:185] op_sel_hi:[1,0]
v_pk_mul_f32 v[172:173],v[80:81],v[184:185] op_sel_hi:[1,0]
v_pk_mul_f32 v[174:175],v[82:83],v[184:185] op_sel_hi:[1,0]
v_pk_add_f32 v[56:57],v[56:57],v[184:185] op_sel:[0,1]
v_pk_add_f32 v[58:59],v[58:59],v[184:185] op_sel:[0,1]
v_pk_add_f32 v[80:81],v[80:81],v[184:185] op_sel:[0,1]
v_pk_add_f32 v[82:83],v[82:83],v[184:185] op_sel:[0,1]
v_min_f32 v168,0,v168
v_min_f32 v170,0,v170
v_min_f32 v172,0,v172
v_min_f32 v174,0,v174
v_min_f32 v169,0,v169
v_min_f32 v171,0,v171
v_min_f32 v173,0,v173
v_min_f32 v175,0,v175
v_exp_f32 v168,v168
v_exp_f32 v170,v170
v_exp_f32 v172,v172
v_exp_f32 v174,v174
v_exp_f32 v169,v169
v_exp_f32 v171,v171
v_exp_f32 v173,v173
v_exp_f32 v175,v175
v_max_f32 v56,v56,v185
v_max_f32 v58,v58,v185
v_max_f32 v80,v80,v185
v_max_f32 v82,v82,v185
v_max_f32 v57,v57,v185
v_max_f32 v59,v59,v185
v_max_f32 v81,v81,v185
v_max_f32 v83,v83,v185
v_pk_add_f32 v[56:57],v[56:57],v[168:169]
v_pk_add_f32 v[58:59],v[58:59],v[170:171]
v_pk_add_f32 v[80:81],v[80:81],v[172:173]
v_pk_add_f32 v[82:83],v[82:83],v[174:175]
v_cvt_pk_bf16_f32 v152,v56,v57
v_cvt_pk_bf16_f32 v153,v58,v59
v_cvt_pk_bf16_f32 v154,v80,v81
v_cvt_pk_bf16_f32 v155,v82,v83
v_pk_fma_f32 v[60:61],v[212:213],v[194:195],v[60:61] op_sel:[0,1,0]
v_pk_fma_f32 v[62:63],v[214:215],v[194:195],v[62:63] op_sel:[0,1,0]
v_pk_fma_f32 v[84:85],v[216:217],v[194:195],v[84:85] op_sel:[0,1,0]
v_pk_fma_f32 v[86:87],v[218:219],v[194:195],v[86:87] op_sel:[0,1,0]
v_pk_mul_f32 v[60:61],v[60:61],v[220:221]
v_pk_mul_f32 v[62:63],v[62:63],v[222:223]
v_pk_mul_f32 v[84:85],v[84:85],v[224:225]
v_pk_mul_f32 v[86:87],v[86:87],v[226:227]
v_cvt_pk_bf16_f32 v156,v60,v61
v_cvt_pk_bf16_f32 v157,v62,v63
v_cvt_pk_bf16_f32 v158,v84,v85
v_cvt_pk_bf16_f32 v159,v86,v87
v_pk_fma_f32 v[64:65],v[212:213],v[196:197],v[64:65] op_sel_hi:[1,0,1]
v_pk_fma_f32 v[66:67],v[214:215],v[196:197],v[66:67] op_sel_hi:[1,0,1]
v_pk_fma_f32 v[88:89],v[216:217],v[196:197],v[88:89] op_sel_hi:[1,0,1]
v_pk_fma_f32 v[90:91],v[218:219],v[196:197],v[90:91] op_sel_hi:[1,0,1]
v_pk_mul_f32 v[64:65],v[64:65],v[220:221]
v_pk_mul_f32 v[66:67],v[66:67],v[222:223]
v_pk_mul_f32 v[88:89],v[88:89],v[224:225]
v_pk_mul_f32 v[90:91],v[90:91],v[226:227]
v_cvt_pk_bf16_f32 v160,v64,v65
v_cvt_pk_bf16_f32 v161,v66,v67
v_cvt_pk_bf16_f32 v162,v88,v89
v_cvt_pk_bf16_f32 v163,v90,v91
v_pk_fma_f32 v[68:69],v[212:213],v[196:197],v[68:69] op_sel:[0,1,0]
v_pk_fma_f32 v[70:71],v[214:215],v[196:197],v[70:71] op_sel:[0,1,0]
v_pk_fma_f32 v[92:93],v[216:217],v[196:197],v[92:93] op_sel:[0,1,0]
v_pk_fma_f32 v[94:95],v[218:219],v[196:197],v[94:95] op_sel:[0,1,0]
v_pk_mul_f32 v[68:69],v[68:69],v[220:221]
v_pk_mul_f32 v[70:71],v[70:71],v[222:223]
v_pk_mul_f32 v[92:93],v[92:93],v[224:225]
v_pk_mul_f32 v[94:95],v[94:95],v[226:227]
v_cvt_pk_bf16_f32 v164,v68,v69
v_cvt_pk_bf16_f32 v165,v70,v71
v_cvt_pk_bf16_f32 v166,v92,v93
v_cvt_pk_bf16_f32 v167,v94,v95
MF v[48:51],v[144:147],v[156:159],0
MF v[52:55],v[144:147],v[160:163],0
MF v[56:59],v[144:147],v[164:167],0
MF v[84:87],v[144:147],v[232:235],0
MF v[60:63],v[148:151],v[156:159],0
MF v[64:67],v[148:151],v[160:163],0
MF v[68:71],v[148:151],v[164:167],0
MF v[88:91],v[148:151],v[232:235],0
MF v[72:75],v[152:155],v[156:159],0
MF v[76:79],v[152:155],v[160:163],0
MF v[80:83],v[152:155],v[164:167],0
MF v[92:95],v[152:155],v[232:235],0
ds_write_b128 v236,v[48:51] offset:0
ds_write_b128 v236,v[52:55] offset:1024
ds_write_b128 v236,v[56:59] offset:2048
ds_write_b128 v236,v[84:87] offset:9216
ds_write_b128 v236,v[60:63] offset:3072
ds_write_b128 v236,v[64:67] offset:4096
ds_write_b128 v236,v[68:71] offset:5120
ds_write_b128 v236,v[88:91] offset:10240
ds_write_b128 v236,v[72:75] offset:6144
ds_write_b128 v236,v[76:79] offset:7168
ds_write_b128 v236,v[80:83] offset:8192
ds_write_b128 v236,v[92:95] offset:11264
s_waitcnt lgkmcnt(0)
s_barrier
ds_read_b32 v168,v248 offset:0
ds_read_b32 v169,v248 offset:12288
ds_read_b32 v170,v248 offset:24576
ds_read_b32 v171,v248 offset:36864
ds_read_b32 v172,v249 offset:0
ds_read_b32 v173,v249 offset:12288
ds_read_b32 v174,v249 offset:24576
ds_read_b32 v175,v249 offset:36864
ds_read_b32 v176,v250 offset:0
ds_read_b32 v177,v250 offset:12288
ds_read_b32 v178,v250 offset:24576
ds_read_b32 v179,v250 offset:36864
ds_read_b32 v180,v251 offset:0
ds_read_b32 v181,v251 offset:12288
ds_read_b32 v182,v251 offset:24576
s_waitcnt lgkmcnt(12)
ds_read_b32 v183,v251 offset:36864
s_waitcnt lgkmcnt(0)
v_add_f32 v168,v168,v169
v_add_f32 v170,v170,v171
v_add_f32 v8,v168,v170
v_add_f32 v172,v172,v173
v_add_f32 v174,v174,v175
v_add_f32 v9,v172,v174
v_add_f32 v176,v176,v177
v_add_f32 v178,v178,v179
v_add_f32 v10,v176,v178
v_add_f32 v180,v180,v181
v_add_f32 v182,v182,v183
v_add_f32 v11,v180,v182
buffer_store_dwordx4 v[8:11],v237,s[8:11],s51 offen sc0 sc1
ds_read_b128 v[24:27],v2 offset:51200
MF v[120:123],v[32:35],a[0:3],0
MF v[132:135],v[32:35],a[4:7],0
ds_read_b128 v[28:31],v2 offset:52224
MF v[124:127],v[36:39],a[0:3],0
MF v[136:139],v[36:39],a[4:7],0
ds_read_b128 v[32:35],v2 offset:53248
MF v[128:131],v[40:43],a[0:3],0
MF v[140:143],v[40:43],a[4:7],0
ds_read_b128 v[36:39],v2 offset:54272
MF v[120:123],v[44:47],a[8:11],v[120:123]
MF v[132:135],v[44:47],a[12:15],v[132:135]
ds_read_b128 v[40:43],v2 offset:55296
MF v[124:127],v[16:19],a[8:11],v[124:127]
MF v[136:139],v[16:19],a[12:15],v[136:139]
ds_read_b128 v[44:47],v2 offset:56320
MF v[128:131],v[20:23],a[8:11],v[128:131]
MF v[140:143],v[20:23],a[12:15],v[140:143]
ds_read_b128 v[16:19],v2 offset:57344
s_waitcnt lgkmcnt(5)
MF v[120:123],v[24:27],a[16:19],v[120:123]
v_and_b32 v247,7,v0
v_lshl_add_u32 v247,v15,3,v247
v_lshlrev_b32 v247,4,v247
v_add_u32 v247,4096,v247
s_mul_i32 s48,s22,5
s_mov_b32 s49,0
s_cmp_eq_u32 s22,3
s_cselect_b32 s20,1,0
s_sub_u32 s48,s48,s20
s_cmp_ge_u32 s22,2
s_cselect_b32 s49,0x40000000,0
s_lshr_b32 s20,s23,2
s_mul_i32 s20,s20,18
s_add_u32 s48,s48,s20
s_mul_i32 s48,s48,4608
s_add_u32 s48,s48,0x2a0000
buffer_load_dwordx4 a[0:3],v1,s[8:11],s48 offen offset:0 sc1
MF v[132:135],v[24:27],a[20:23],v[132:135]
ds_read_b128 v[20:23],v2 offset:58368
MF v[124:127],v[28:31],a[16:19],v[124:127]
MF v[136:139],v[28:31],a[20:23],v[136:139]
ds_read_b128 v[24:27],v2 offset:59392
s_waitcnt lgkmcnt(5)
MF v[128:131],v[32:35],a[16:19],v[128:131]
buffer_load_dwordx4 a[4:7],v1,s[8:11],s48 offen offset:1024 sc1
MF v[140:143],v[32:35],a[20:23],v[140:143]
ds_read_b128 v[28:31],v2 offset:60416
MF v[120:123],v[36:39],a[24:27],v[120:123]
buffer_load_dwordx4 a[8:11],v1,s[8:11],s48 offen offset:2048 sc1
MF v[132:135],v[36:39],a[28:31],v[132:135]
ds_read_b128 v[32:35],v2 offset:61440
s_waitcnt lgkmcnt(5)
MF v[124:127],v[40:43],a[24:27],v[124:127]
MF v[136:139],v[40:43],a[28:31],v[136:139]
ds_read_b128 v[36:39],v2 offset:62464
MF v[128:131],v[44:47],a[24:27],v[128:131]
buffer_load_dwordx4 a[12:15],v1,s[8:11],s48 offen offset:3072 sc1
MF v[140:143],v[44:47],a[28:31],v[140:143]
ds_read_b128 v[40:43],v2 offset:63488
s_waitcnt lgkmcnt(5)
MF v[120:123],v[16:19],a[32:35],v[120:123]
MF v[132:135],v[16:19],a[36:39],v[132:135]
ds_read_b128 v[44:47],v2 offset:64512
buffer_load_dwordx4 a[16:19],v247,s[8:11],s48 offen sc1
MF v[124:127],v[20:23],a[32:35],v[124:127]
MF v[136:139],v[20:23],a[36:39],v[136:139]
ds_read_b128 v[16:19],v3 offset:0
s_waitcnt lgkmcnt(5)
MF v[128:131],v[24:27],a[32:35],v[128:131]
s_add_u32 s48,s48,4608
buffer_load_dwordx4 a[20:23],v1,s[8:11],s48 offen offset:0 sc1
MF v[140:143],v[24:27],a[36:39],v[140:143]
ds_read_b128 v[20:23],v3 offset:1024
MF v[120:123],v[28:31],a[40:43],v[120:123]
MF v[132:135],v[28:31],a[44:47],v[132:135]
ds_read_b128 v[24:27],v3 offset:2048
s_waitcnt lgkmcnt(5)
MF v[124:127],v[32:35],a[40:43],v[124:127]
buffer_load_dwordx4 a[24:27],v1,s[8:11],s48 offen offset:1024 sc1
MF v[136:139],v[32:35],a[44:47],v[136:139]
ds_read_b128 v[28:31],v3 offset:3072
MF v[128:131],v[36:39],a[40:43],v[128:131]
buffer_load_dwordx4 a[28:31],v1,s[8:11],s48 offen offset:2048 sc1
MF v[140:143],v[36:39],a[44:47],v[140:143]
ds_read_b128 v[32:35],v3 offset:4096
s_waitcnt lgkmcnt(5)
MF v[120:123],v[40:43],a[48:51],v[120:123]
MF v[132:135],v[40:43],a[52:55],v[132:135]
ds_read_b128 v[36:39],v3 offset:5120
MF v[124:127],v[44:47],a[48:51],v[124:127]
buffer_load_dwordx4 a[32:35],v1,s[8:11],s48 offen offset:3072 sc1
MF v[136:139],v[44:47],a[52:55],v[136:139]
ds_read_b128 v[40:43],v3 offset:6144
s_waitcnt lgkmcnt(5)
MF v[128:131],v[16:19],a[48:51],v[128:131]
MF v[140:143],v[16:19],a[52:55],v[140:143]
ds_read_b128 v[44:47],v3 offset:7168
buffer_load_dwordx4 a[36:39],v247,s[8:11],s48 offen sc1
MF v[120:123],v[20:23],a[56:59],v[120:123]
MF v[132:135],v[20:23],a[60:63],v[132:135]
ds_read_b128 v[16:19],v3 offset:8192
s_waitcnt lgkmcnt(5)
MF v[124:127],v[24:27],a[56:59],v[124:127]
s_add_u32 s48,s48,4608
buffer_load_dwordx4 a[40:43],v1,s[8:11],s48 offen offset:0 sc1
MF v[136:139],v[24:27],a[60:63],v[136:139]
ds_read_b128 v[20:23],v3 offset:9216
MF v[128:131],v[28:31],a[56:59],v[128:131]
MF v[140:143],v[28:31],a[60:63],v[140:143]
ds_read_b128 v[24:27],v3 offset:10240
s_waitcnt lgkmcnt(5)
MF v[120:123],v[32:35],a[64:67],v[120:123]
buffer_load_dwordx4 a[44:47],v1,s[8:11],s48 offen offset:1024 sc1
MF v[132:135],v[32:35],a[68:71],v[132:135]
ds_read_b128 v[28:31],v3 offset:11264
MF v[124:127],v[36:39],a[64:67],v[124:127]
buffer_load_dwordx4 a[48:51],v1,s[8:11],s48 offen offset:2048 sc1
MF v[136:139],v[36:39],a[68:71],v[136:139]
ds_read_b128 v[32:35],v3 offset:12288
s_waitcnt lgkmcnt(5)
MF v[128:131],v[40:43],a[64:67],v[128:131]
MF v[140:143],v[40:43],a[68:71],v[140:143]
ds_read_b128 v[36:39],v3 offset:13312
MF v[120:123],v[44:47],a[72:75],v[120:123]
buffer_load_dwordx4 a[52:55],v1,s[8:11],s48 offen offset:3072 sc1
MF v[132:135],v[44:47],a[76:79],v[132:135]
ds_read_b128 v[40:43],v3 offset:14336
s_waitcnt lgkmcnt(5)
MF v[124:127],v[16:19],a[72:75],v[124:127]
MF v[136:139],v[16:19],a[76:79],v[136:139]
ds_read_b128 v[44:47],v3 offset:15360
buffer_load_dwordx4 a[56:59],v247,s[8:11],s48 offen sc1
MF v[128:131],v[20:23],a[72:75],v[128:131]
MF v[140:143],v[20:23],a[76:79],v[140:143]
s_waitcnt vmcnt(16)
s_barrier
ds_read_b128 v[16:19],v3 offset:16384
s_waitcnt lgkmcnt(5)
MF v[120:123],v[24:27],a[80:83],v[120:123]
s_add_u32 s48,s48,4608
buffer_load_dwordx4 a[60:63],v1,s[8:11],s48 offen offset:0 sc1
MF v[132:135],v[24:27],a[84:87],v[132:135]
ds_read_b128 v[20:23],v3 offset:17408
MF v[124:127],v[28:31],a[80:83],v[124:127]
MF v[136:139],v[28:31],a[84:87],v[136:139]
ds_read_b128 v[24:27],v3 offset:18432
s_waitcnt lgkmcnt(5)
MF v[128:131],v[32:35],a[80:83],v[128:131]
buffer_load_dwordx4 a[64:67],v1,s[8:11],s48 offen offset:1024 sc1
MF v[140:143],v[32:35],a[84:87],v[140:143]
ds_read_b128 v[28:31],v3 offset:19456
MF v[120:123],v[36:39],a[88:91],v[120:123]
buffer_load_dwordx4 a[68:71],v1,s[8:11],s48 offen offset:2048 sc1
MF v[132:135],v[36:39],a[92:95],v[132:135]
ds_read_b128 v[32:35],v3 offset:20480
s_waitcnt lgkmcnt(5)
MF v[124:127],v[40:43],a[88:91],v[124:127]
MF v[136:139],v[40:43],a[92:95],v[136:139]
ds_read_b128 v[36:39],v3 offset:21504
MF v[128:131],v[44:47],a[88:91],v[128:131]
buffer_load_dwordx4 a[72:75],v1,s[8:11],s48 offen offset:3072 sc1
MF v[140:143],v[44:47],a[92:95],v[140:143]
ds_read_b128 v[40:43],v3 offset:22528
s_waitcnt lgkmcnt(5)
MF v[120:123],v[16:19],a[96:99],v[120:123]
MF v[132:135],v[16:19],a[100:103],v[132:135]
ds_read_b128 v[44:47],v3 offset:23552
buffer_load_dwordx4 a[76:79],v247,s[8:11],s48 offen sc1
MF v[124:127],v[20:23],a[96:99],v[124:127]
MF v[136:139],v[20:23],a[100:103],v[136:139]
ds_read_b128 v[16:19],v3 offset:24576
s_waitcnt lgkmcnt(5)
MF v[128:131],v[24:27],a[96:99],v[128:131]
s_add_u32 s48,s48,4608
s_add_u32 s48,s48,s49
buffer_load_dwordx4 a[80:83],v1,s[8:11],s48 offen offset:0 sc1
MF v[140:143],v[24:27],a[100:103],v[140:143]
ds_read_b128 v[20:23],v3 offset:25600
MF v[120:123],v[28:31],a[104:107],v[120:123]
MF v[132:135],v[28:31],a[108:111],v[132:135]
ds_read_b128 v[24:27],v3 offset:26624
s_waitcnt lgkmcnt(5)
MF v[124:127],v[32:35],a[104:107],v[124:127]
buffer_load_dwordx4 a[84:87],v1,s[8:11],s48 offen offset:1024 sc1
MF v[136:139],v[32:35],a[108:111],v[136:139]
ds_read_b128 v[28:31],v3 offset:27648
MF v[128:131],v[36:39],a[104:107],v[128:131]
s_add_u32 s52,s50,0
MF v[140:143],v[36:39],a[108:111],v[140:143]
ds_read_b128 v[32:35],v1 offset:0
s_waitcnt lgkmcnt(5)
MF v[120:123],v[40:43],a[112:115],v[120:123]
buffer_load_dwordx4 v[48:51],v237,s[8:11],s52 offen sc0 sc1
s_add_u32 s52,s50,3072
MF v[132:135],v[40:43],a[116:119],v[132:135]
ds_read_b128 v[36:39],v1 offset:1024
buffer_load_dwordx4 v[52:55],v237,s[8:11],s52 offen sc0 sc1
MF v[124:127],v[44:47],a[112:115],v[124:127]
s_add_u32 s52,s50,6144
buffer_load_dwordx4 v[56:59],v237,s[8:11],s52 offen sc0 sc1
MF v[136:139],v[44:47],a[116:119],v[136:139]
ds_read_b128 v[40:43],v1 offset:2048
s_waitcnt lgkmcnt(5)
MF v[128:131],v[16:19],a[112:115],v[128:131]
s_add_u32 s52,s50,9216
buffer_load_dwordx4 v[60:63],v237,s[8:11],s52 offen sc0 sc1
MF v[140:143],v[16:19],a[116:119],v[140:143]
ds_read_b128 v[44:47],v1 offset:3072
s_add_u32 s52,s50,12288
MF v[120:123],v[20:23],a[120:123],v[120:123]
buffer_load_dwordx4 v[64:67],v237,s[8:11],s52 offen sc0 sc1
s_add_u32 s52,s50,15360
MF v[132:135],v[20:23],a[124:127],v[132:135]
ds_read_b128 v[16:19],v1 offset:4096
s_waitcnt lgkmcnt(5)
MF v[124:127],v[24:27],a[120:123],v[124:127]
buffer_load_dwordx4 v[68:71],v237,s[8:11],s52 offen sc0 sc1
s_add_u32 s52,s50,18432
MF v[136:139],v[24:27],a[124:127],v[136:139]
ds_read_b128 v[20:23],v1 offset:5120
buffer_load_dwordx4 v[72:75],v237,s[8:11],s52 offen sc0 sc1
MF v[128:131],v[28:31],a[120:123],v[128:131]
s_add_u32 s52,s50,21504
buffer_load_dwordx4 v[76:79],v237,s[8:11],s52 offen sc0 sc1
MF v[140:143],v[28:31],a[124:127],v[140:143]
s_waitcnt lgkmcnt(4)
s_add_u32 s52,s50,24576
MF v[120:123],v[32:35],a[128:131],v[120:123]
buffer_load_dwordx4 v[80:83],v237,s[8:11],s52 offen sc0 sc1
s_add_u32 s52,s50,27648
MF v[132:135],v[32:35],a[132:135],v[132:135]
buffer_load_dwordx4 v[84:87],v237,s[8:11],s52 offen sc0 sc1
MF v[124:127],v[36:39],a[128:131],v[124:127]
s_add_u32 s52,s50,30720
buffer_load_dwordx4 v[88:91],v237,s[8:11],s52 offen sc0 sc1
MF v[136:139],v[36:39],a[132:135],v[136:139]
s_waitcnt lgkmcnt(2)
s_add_u32 s52,s50,33792
MF v[128:131],v[40:43],a[128:131],v[128:131]
buffer_load_dwordx4 v[92:95],v237,s[8:11],s52 offen sc0 sc1
s_add_u32 s52,s50,36864
MF v[140:143],v[40:43],a[132:135],v[140:143]
buffer_load_dwordx4 v[96:99],v237,s[8:11],s52 offen sc0 sc1
MF v[120:123],v[44:47],a[136:139],v[120:123]
s_add_u32 s52,s50,39936
buffer_load_dwordx4 v[100:103],v237,s[8:11],s52 offen sc0 sc1
MF v[132:135],v[44:47],a[140:143],v[132:135]
s_waitcnt lgkmcnt(0)
s_add_u32 s52,s50,43008
MF v[124:127],v[16:19],a[136:139],v[124:127]
buffer_load_dwordx4 v[104:107],v237,s[8:11],s52 offen sc0 sc1
s_add_u32 s52,s50,46080
MF v[136:139],v[16:19],a[140:143],v[136:139]
buffer_load_dwordx4 v[108:111],v237,s[8:11],s52 offen sc0 sc1
MF v[128:131],v[20:23],a[136:139],v[128:131]
MF v[140:143],v[20:23],a[140:143],v[140:143]
s_nop 7
v_pk_fma_f32 v[120:121],v[228:229],v[200:201],v[120:121] op_sel_hi:[0,1,1]
v_pk_fma_f32 v[122:123],v[228:229],v[202:203],v[122:123] op_sel_hi:[0,1,1]
v_pk_fma_f32 v[132:133],v[228:229],v[200:201],v[132:133] op_sel:[1,0,0]
v_pk_fma_f32 v[134:135],v[228:229],v[202:203],v[134:135] op_sel:[1,0,0]
v_pk_mul_f32 v[120:121],v[120:121],v[230:231] op_sel_hi:[1,0]
v_pk_mul_f32 v[122:123],v[122:123],v[230:231] op_sel_hi:[1,0]
v_pk_mul_f32 v[132:133],v[132:133],v[230:231] op_sel:[0,1]
v_pk_mul_f32 v[134:135],v[134:135],v[230:231] op_sel:[0,1]
v_pk_mul_f32 v[16:17],v[120:121],v[184:185] op_sel_hi:[1,0]
v_pk_mul_f32 v[18:19],v[122:123],v[184:185] op_sel_hi:[1,0]
v_pk_mul_f32 v[20:21],v[132:133],v[184:185] op_sel_hi:[1,0]
v_pk_mul_f32 v[22:23],v[134:135],v[184:185] op_sel_hi:[1,0]
v_pk_add_f32 v[120:121],v[120:121],v[184:185] op_sel:[0,1]
v_pk_add_f32 v[122:123],v[122:123],v[184:185] op_sel:[0,1]
v_pk_add_f32 v[132:133],v[132:133],v[184:185] op_sel:[0,1]
v_pk_add_f32 v[134:135],v[134:135],v[184:185] op_sel:[0,1]
v_min_f32 v16,0,v16
v_min_f32 v18,0,v18
v_min_f32 v20,0,v20
v_min_f32 v22,0,v22
v_min_f32 v17,0,v17
v_min_f32 v19,0,v19
v_min_f32 v21,0,v21
v_min_f32 v23,0,v23
v_exp_f32 v16,v16
v_exp_f32 v18,v18
v_exp_f32 v20,v20
v_exp_f32 v22,v22
v_exp_f32 v17,v17
v_exp_f32 v19,v19
v_exp_f32 v21,v21
v_exp_f32 v23,v23
v_max_f32 v120,v120,v185
v_max_f32 v122,v122,v185
v_max_f32 v132,v132,v185
v_max_f32 v134,v134,v185
v_max_f32 v121,v121,v185
v_max_f32 v123,v123,v185
v_max_f32 v133,v133,v185
v_max_f32 v135,v135,v185
v_pk_add_f32 v[120:121],v[120:121],v[16:17]
v_pk_add_f32 v[122:123],v[122:123],v[18:19]
v_pk_add_f32 v[132:133],v[132:133],v[20:21]
v_pk_add_f32 v[134:135],v[134:135],v[22:23]
v_cvt_pk_bf16_f32 v144,v120,v121
v_cvt_pk_bf16_f32 v145,v122,v123
v_cvt_pk_bf16_f32 v152,v132,v133
v_cvt_pk_bf16_f32 v153,v134,v135
buffer_load_dwordx4 a[88:91],v1,s[8:11],s48 offen offset:2048 sc1
buffer_load_dwordx4 a[92:95],v1,s[8:11],s48 offen offset:3072 sc1
buffer_load_dwordx4 a[96:99],v247,s[8:11],s48 offen sc1
v_pk_fma_f32 v[124:125],v[228:229],v[204:205],v[124:125] op_sel_hi:[0,1,1]
v_pk_fma_f32 v[126:127],v[228:229],v[206:207],v[126:127] op_sel_hi:[0,1,1]
v_pk_fma_f32 v[136:137],v[228:229],v[204:205],v[136:137] op_sel:[1,0,0]
v_pk_fma_f32 v[138:139],v[228:229],v[206:207],v[138:139] op_sel:[1,0,0]
v_pk_mul_f32 v[124:125],v[124:125],v[230:231] op_sel_hi:[1,0]
v_pk_mul_f32 v[126:127],v[126:127],v[230:231] op_sel_hi:[1,0]
v_pk_mul_f32 v[136:137],v[136:137],v[230:231] op_sel:[0,1]
v_pk_mul_f32 v[138:139],v[138:139],v[230:231] op_sel:[0,1]
v_pk_mul_f32 v[16:17],v[124:125],v[184:185] op_sel_hi:[1,0]
v_pk_mul_f32 v[18:19],v[126:127],v[184:185] op_sel_hi:[1,0]
v_pk_mul_f32 v[20:21],v[136:137],v[184:185] op_sel_hi:[1,0]
v_pk_mul_f32 v[22:23],v[138:139],v[184:185] op_sel_hi:[1,0]
v_pk_add_f32 v[124:125],v[124:125],v[184:185] op_sel:[0,1]
v_pk_add_f32 v[126:127],v[126:127],v[184:185] op_sel:[0,1]
v_pk_add_f32 v[136:137],v[136:137],v[184:185] op_sel:[0,1]
v_pk_add_f32 v[138:139],v[138:139],v[184:185] op_sel:[0,1]
v_min_f32 v16,0,v16
v_min_f32 v18,0,v18
v_min_f32 v20,0,v20
v_min_f32 v22,0,v22
v_min_f32 v17,0,v17
v_min_f32 v19,0,v19
v_min_f32 v21,0,v21
v_min_f32 v23,0,v23
v_exp_f32 v16,v16
v_exp_f32 v18,v18
v_exp_f32 v20,v20
v_exp_f32 v22,v22
v_exp_f32 v17,v17
v_exp_f32 v19,v19
v_exp_f32 v21,v21
v_exp_f32 v23,v23
v_max_f32 v124,v124,v185
v_max_f32 v126,v126,v185
v_max_f32 v136,v136,v185
v_max_f32 v138,v138,v185
v_max_f32 v125,v125,v185
v_max_f32 v127,v127,v185
v_max_f32 v137,v137,v185
v_max_f32 v139,v139,v185
v_pk_add_f32 v[124:125],v[124:125],v[16:17]
v_pk_add_f32 v[126:127],v[126:127],v[18:19]
v_pk_add_f32 v[136:137],v[136:137],v[20:21]
v_pk_add_f32 v[138:139],v[138:139],v[22:23]
v_cvt_pk_bf16_f32 v146,v124,v125
v_cvt_pk_bf16_f32 v147,v126,v127
v_cvt_pk_bf16_f32 v154,v136,v137
v_cvt_pk_bf16_f32 v155,v138,v139
v_pk_fma_f32 v[128:129],v[228:229],v[208:209],v[128:129] op_sel_hi:[0,1,1]
v_pk_fma_f32 v[130:131],v[228:229],v[210:211],v[130:131] op_sel_hi:[0,1,1]
v_pk_fma_f32 v[140:141],v[228:229],v[208:209],v[140:141] op_sel:[1,0,0]
v_pk_fma_f32 v[142:143],v[228:229],v[210:211],v[142:143] op_sel:[1,0,0]
v_pk_mul_f32 v[128:129],v[128:129],v[230:231] op_sel_hi:[1,0]
v_pk_mul_f32 v[130:131],v[130:131],v[230:231] op_sel_hi:[1,0]
v_pk_mul_f32 v[140:141],v[140:141],v[230:231] op_sel:[0,1]
v_pk_mul_f32 v[142:143],v[142:143],v[230:231] op_sel:[0,1]
v_pk_mul_f32 v[16:17],v[128:129],v[184:185] op_sel_hi:[1,0]
v_pk_mul_f32 v[18:19],v[130:131],v[184:185] op_sel_hi:[1,0]
v_pk_mul_f32 v[20:21],v[140:141],v[184:185] op_sel_hi:[1,0]
v_pk_mul_f32 v[22:23],v[142:143],v[184:185] op_sel_hi:[1,0]
v_pk_add_f32 v[128:129],v[128:129],v[184:185] op_sel:[0,1]
v_pk_add_f32 v[130:131],v[130:131],v[184:185] op_sel:[0,1]
v_pk_add_f32 v[140:141],v[140:141],v[184:185] op_sel:[0,1]
v_pk_add_f32 v[142:143],v[142:143],v[184:185] op_sel:[0,1]
v_min_f32 v16,0,v16
v_min_f32 v18,0,v18
v_min_f32 v20,0,v20
v_min_f32 v22,0,v22
v_min_f32 v17,0,v17
v_min_f32 v19,0,v19
v_min_f32 v21,0,v21
v_min_f32 v23,0,v23
v_exp_f32 v16,v16
v_exp_f32 v18,v18
v_exp_f32 v20,v20
v_exp_f32 v22,v22
v_exp_f32 v17,v17
v_exp_f32 v19,v19
v_exp_f32 v21,v21
v_exp_f32 v23,v23
v_max_f32 v128,v128,v185
v_max_f32 v130,v130,v185
v_max_f32 v140,v140,v185
v_max_f32 v142,v142,v185
v_max_f32 v129,v129,v185
v_max_f32 v131,v131,v185
v_max_f32 v141,v141,v185
v_max_f32 v143,v143,v185
v_pk_add_f32 v[128:129],v[128:129],v[16:17]
v_pk_add_f32 v[130:131],v[130:131],v[18:19]
v_pk_add_f32 v[140:141],v[140:141],v[20:21]
v_pk_add_f32 v[142:143],v[142:143],v[22:23]
v_cvt_pk_bf16_f32 v148,v128,v129
v_cvt_pk_bf16_f32 v149,v130,v131
v_cvt_pk_bf16_f32 v156,v140,v141
v_cvt_pk_bf16_f32 v157,v142,v143
v_mov_b32 v150,0
v_mov_b32 v151,0
v_mov_b32 v158,0
v_mov_b32 v159,0
s_waitcnt vmcnt(3)
v_max_u32 v8,v48,v49
v_max3_u32 v8,v8,v50,v51
v_max3_u32 v8,v8,v52,v53
v_max3_u32 v8,v8,v54,v55
v_max3_u32 v8,v8,v56,v57
v_max3_u32 v8,v8,v58,v59
v_max3_u32 v8,v8,v60,v61
v_max3_u32 v8,v8,v62,v63
v_max3_u32 v8,v8,v64,v65
v_max3_u32 v8,v8,v66,v67
v_max3_u32 v8,v8,v68,v69
v_max3_u32 v8,v8,v70,v71
v_max3_u32 v8,v8,v72,v73
v_max3_u32 v8,v8,v74,v75
v_max3_u32 v8,v8,v76,v77
v_max3_u32 v8,v8,v78,v79
v_max3_u32 v8,v8,v80,v81
v_max3_u32 v8,v8,v82,v83
v_max3_u32 v8,v8,v84,v85
v_max3_u32 v8,v8,v86,v87
v_max3_u32 v8,v8,v88,v89
v_max3_u32 v8,v8,v90,v91
v_max3_u32 v8,v8,v92,v93
v_max3_u32 v8,v8,v94,v95
v_max3_u32 v8,v8,v96,v97
v_max3_u32 v8,v8,v98,v99
v_max3_u32 v8,v8,v100,v101
v_max3_u32 v8,v8,v102,v103
v_max3_u32 v8,v8,v104,v105
v_max3_u32 v8,v8,v106,v107
v_max3_u32 v8,v8,v108,v109
v_max3_u32 v8,v8,v110,v111
v_cmp_eq_u32 vcc,-1,v8
s_cbranch_vccz k1_0_P1G
s_mov_b32 s53,0
k1_0_P1:
s_nop 7
s_nop 3
s_add_u32 s52,s50,0
buffer_load_dwordx4 v[48:51],v237,s[8:11],s52 offen sc0 sc1
s_add_u32 s52,s50,3072
buffer_load_dwordx4 v[52:55],v237,s[8:11],s52 offen sc0 sc1
s_add_u32 s52,s50,6144
buffer_load_dwordx4 v[56:59],v237,s[8:11],s52 offen sc0 sc1
s_add_u32 s52,s50,9216
buffer_load_dwordx4 v[60:63],v237,s[8:11],s52 offen sc0 sc1
s_add_u32 s52,s50,12288
buffer_load_dwordx4 v[64:67],v237,s[8:11],s52 offen sc0 sc1
s_add_u32 s52,s50,15360
buffer_load_dwordx4 v[68:71],v237,s[8:11],s52 offen sc0 sc1
s_add_u32 s52,s50,18432
buffer_load_dwordx4 v[72:75],v237,s[8:11],s52 offen sc0 sc1
s_add_u32 s52,s50,21504
buffer_load_dwordx4 v[76:79],v237,s[8:11],s52 offen sc0 sc1
s_add_u32 s52,s50,24576
buffer_load_dwordx4 v[80:83],v237,s[8:11],s52 offen sc0 sc1
s_add_u32 s52,s50,27648
buffer_load_dwordx4 v[84:87],v237,s[8:11],s52 offen sc0 sc1
s_add_u32 s52,s50,30720
buffer_load_dwordx4 v[88:91],v237,s[8:11],s52 offen sc0 sc1
s_add_u32 s52,s50,33792
buffer_load_dwordx4 v[92:95],v237,s[8:11],s52 offen sc0 sc1
s_add_u32 s52,s50,36864
buffer_load_dwordx4 v[96:99],v237,s[8:11],s52 offen sc0 sc1
s_add_u32 s52,s50,39936
buffer_load_dwordx4 v[100:103],v237,s[8:11],s52 offen sc0 sc1
s_add_u32 s52,s50,43008
buffer_load_dwordx4 v[104:107],v237,s[8:11],s52 offen sc0 sc1
s_add_u32 s52,s50,46080
buffer_load_dwordx4 v[108:111],v237,s[8:11],s52 offen sc0 sc1
s_add_u32 s53,s53,1
s_waitcnt vmcnt(0)
v_max_u32 v8,v48,v49
v_max3_u32 v8,v8,v50,v51
v_max3_u32 v8,v8,v52,v53
v_max3_u32 v8,v8,v54,v55
v_max3_u32 v8,v8,v56,v57
v_max3_u32 v8,v8,v58,v59
v_max3_u32 v8,v8,v60,v61
v_max3_u32 v8,v8,v62,v63
v_max3_u32 v8,v8,v64,v65
v_max3_u32 v8,v8,v66,v67
v_max3_u32 v8,v8,v68,v69
v_max3_u32 v8,v8,v70,v71
v_max3_u32 v8,v8,v72,v73
v_max3_u32 v8,v8,v74,v75
v_max3_u32 v8,v8,v76,v77
v_max3_u32 v8,v8,v78,v79
v_max3_u32 v8,v8,v80,v81
v_max3_u32 v8,v8,v82,v83
v_max3_u32 v8,v8,v84,v85
v_max3_u32 v8,v8,v86,v87
v_max3_u32 v8,v8,v88,v89
v_max3_u32 v8,v8,v90,v91
v_max3_u32 v8,v8,v92,v93
v_max3_u32 v8,v8,v94,v95
v_max3_u32 v8,v8,v96,v97
v_max3_u32 v8,v8,v98,v99
v_max3_u32 v8,v8,v100,v101
v_max3_u32 v8,v8,v102,v103
v_max3_u32 v8,v8,v104,v105
v_max3_u32 v8,v8,v106,v107
v_max3_u32 v8,v8,v108,v109
v_max3_u32 v8,v8,v110,v111
v_cmp_eq_u32 vcc,-1,v8
s_cbranch_vccz k1_0_P1G
s_cmp_lt_u32 s53,100000
s_cbranch_scc1 k1_0_P1
k1_0_P1G:
s_nop 7
s_nop 3
v_pk_add_f32 v[48:49],v[48:49],v[80:81]
v_pk_add_f32 v[50:51],v[50:51],v[82:83]
v_pk_add_f32 v[52:53],v[52:53],v[84:85]
v_pk_add_f32 v[54:55],v[54:55],v[86:87]
v_pk_add_f32 v[56:57],v[56:57],v[88:89]
v_pk_add_f32 v[58:59],v[58:59],v[90:91]
v_pk_add_f32 v[60:61],v[60:61],v[92:93]
v_pk_add_f32 v[62:63],v[62:63],v[94:95]
v_pk_add_f32 v[64:65],v[64:65],v[96:97]
v_pk_add_f32 v[66:67],v[66:67],v[98:99]
v_pk_add_f32 v[68:69],v[68:69],v[100:101]
v_pk_add_f32 v[70:71],v[70:71],v[102:103]
v_pk_add_f32 v[72:73],v[72:73],v[104:105]
v_pk_add_f32 v[74:75],v[74:75],v[106:107]
v_pk_add_f32 v[76:77],v[76:77],v[108:109]
v_pk_add_f32 v[78:79],v[78:79],v[110:111]
v_pk_add_f32 v[48:49],v[48:49],v[64:65]
v_pk_add_f32 v[50:51],v[50:51],v[66:67]
v_pk_add_f32 v[52:53],v[52:53],v[68:69]
v_pk_add_f32 v[54:55],v[54:55],v[70:71]
v_pk_add_f32 v[56:57],v[56:57],v[72:73]
v_pk_add_f32 v[58:59],v[58:59],v[74:75]
v_pk_add_f32 v[60:61],v[60:61],v[76:77]
v_pk_add_f32 v[62:63],v[62:63],v[78:79]
v_pk_add_f32 v[48:49],v[48:49],v[56:57]
v_pk_add_f32 v[50:51],v[50:51],v[58:59]
v_pk_add_f32 v[52:53],v[52:53],v[60:61]
v_pk_add_f32 v[54:55],v[54:55],v[62:63]
v_pk_add_f32 v[48:49],v[48:49],v[52:53]
v_pk_add_f32 v[50:51],v[50:51],v[54:55]
v_cvt_pk_bf16_f32 v48,v48,v48
ds_write_b16 v240,v48
v_cvt_pk_bf16_f32 v49,v49,v49
ds_write_b16 v241,v49
v_cvt_pk_bf16_f32 v50,v50,v50
ds_write_b16 v242,v50
v_cvt_pk_bf16_f32 v51,v51,v51
ds_write_b16 v243,v51
v_add_u32 v12,57344,v1
v_lshlrev_b32 v13,4,v15
v_add_u32 v13,63488,v13
s_mov_b32 s32,0xffff
s_mov_b32 s33,0
s_waitcnt lgkmcnt(0)
s_barrier
ds_read_b128 v[40:43],v13 offset:0
ds_read_b128 v[44:47],v13 offset:64
ds_read_b128 v[48:51],v13 offset:128
ds_read_b128 v[52:55],v13 offset:192
ds_read_b128 v[16:19],v12 offset:0
ds_read_b128 v[20:23],v12 offset:1024
ds_read_b128 v[24:27],v12 offset:2048
ds_read_b128 v[28:31],v12 offset:3072
ds_read_b128 v[32:35],v12 offset:4096
ds_read_b128 v[36:39],v12 offset:5120
s_waitcnt lgkmcnt(0)
MF v[60:63],v[40:43],v[144:147],0
MF v[64:67],v[48:51],v[144:147],0
MF v[68:71],v[40:43],v[152:155],0
MF v[72:75],v[48:51],v[152:155],0
MF v[60:63],v[44:47],v[148:151],v[60:63]
MF v[64:67],v[52:55],v[148:151],v[64:67]
MF v[68:71],v[44:47],v[156:159],v[68:71]
MF v[72:75],v[52:55],v[156:159],v[72:75]
MF v[80:83],v[16:19],v[144:147],0
MF v[84:87],v[24:27],v[144:147],0
MF v[88:91],v[32:35],v[144:147],0
MF v[92:95],v[16:19],v[152:155],0
MF v[96:99],v[24:27],v[152:155],0
MF v[100:103],v[32:35],v[152:155],0
MF v[80:83],v[20:23],v[148:151],v[80:83]
MF v[84:87],v[28:31],v[148:151],v[84:87]
MF v[88:91],v[36:39],v[148:151],v[88:91]
MF v[92:95],v[20:23],v[156:159],v[92:95]
MF v[96:99],v[28:31],v[156:159],v[96:99]
MF v[100:103],v[36:39],v[156:159],v[100:103]
v_add_f32 v60,0x358637bd,v60
v_rcp_f32 v60,v60
v_add_f32 v64,0x358637bd,v64
v_rcp_f32 v64,v64
s_nop 0
v_cndmask_b32 v61,v64,v60,s[32:33]
v_add_f32 v68,0x358637bd,v68
v_rcp_f32 v68,v68
v_add_f32 v72,0x358637bd,v72
v_rcp_f32 v72,v72
s_nop 0
v_cndmask_b32 v69,v72,v68,s[32:33]
v_mul_f32 v80,v80,v60
v_mul_f32 v81,v81,v60
v_mul_f32 v82,v82,v60
v_mul_f32 v83,v83,v60
v_cvt_pk_bf16_f32 v80,v80,v81
v_cvt_pk_bf16_f32 v81,v82,v83
buffer_store_dwordx2 v[80:81],v244,s[8:11],s54 offen sc1
v_mul_f32 v84,v84,v61
v_mul_f32 v85,v85,v61
v_mul_f32 v86,v86,v64
v_mul_f32 v87,v87,v64
v_cvt_pk_bf16_f32 v84,v84,v85
v_cvt_pk_bf16_f32 v85,v86,v87
buffer_store_dwordx2 v[84:85],v245,s[8:11],s54 offen sc1
v_mul_f32 v88,v88,v64
v_mul_f32 v89,v89,v64
v_mul_f32 v90,v90,v64
v_mul_f32 v91,v91,v64
v_cvt_pk_bf16_f32 v88,v88,v89
v_cvt_pk_bf16_f32 v89,v90,v91
buffer_store_dwordx2 v[88:89],v246,s[8:11],s54 offen sc1
v_mul_f32 v92,v92,v68
v_mul_f32 v93,v93,v68
v_mul_f32 v94,v94,v68
v_mul_f32 v95,v95,v68
v_cvt_pk_bf16_f32 v92,v92,v93
v_cvt_pk_bf16_f32 v93,v94,v95
buffer_store_dwordx2 v[92:93],v244,s[8:11],s55 offen sc1
v_mul_f32 v96,v96,v69
v_mul_f32 v97,v97,v69
v_mul_f32 v98,v98,v72
v_mul_f32 v99,v99,v72
v_cvt_pk_bf16_f32 v96,v96,v97
v_cvt_pk_bf16_f32 v97,v98,v99
buffer_store_dwordx2 v[96:97],v245,s[8:11],s55 offen sc1
v_mul_f32 v100,v100,v72
v_mul_f32 v101,v101,v72
v_mul_f32 v102,v102,v72
v_mul_f32 v103,v103,v72
v_cvt_pk_bf16_f32 v100,v100,v101
v_cvt_pk_bf16_f32 v101,v102,v103
buffer_store_dwordx2 v[100:101],v246,s[8:11],s55 offen sc1
s_lshl_b32 s78,s44,11
s_lshl_b32 s47,s45,4
s_add_u32 s78,s78,s47
s_lshl_b32 s47,s22,2
s_add_u32 s78,s78,s47
s_add_u32 s78,s78,0x1310000
PH_k2_0:
s_lshl_b32 s44,s3,2
s_and_b32 s45,s23,3
s_add_u32 s44,s44,s45
s_lshr_b32 s45,s23,2
v_and_b32 v2,7,v0
v_lshl_add_u32 v2,v15,3,v2
v_lshlrev_b32 v2,4,v2
v_add_u32 v2,4096,v2
s_mul_i32 s55,s22,5
s_mov_b32 s56,0
s_cmp_eq_u32 s22,3
s_cselect_b32 s46,1,0
s_sub_u32 s55,s55,s46
s_cmp_ge_u32 s22,2
s_cselect_b32 s56,0x40000000,0
s_add_u32 s46,s22,0
s_and_b32 s46,s46,3
s_lshl_b32 s47,s44,2
s_add_u32 s46,s46,s47
s_mul_i32 s46,s46,18
s_add_u32 s46,s46,s55
s_lshl_b32 s46,s46,10
s_add_u32 s24,s46,0x2000000
s_add_u32 s46,s22,1
s_and_b32 s46,s46,3
s_lshl_b32 s47,s44,2
s_add_u32 s46,s46,s47
s_mul_i32 s46,s46,18
s_add_u32 s46,s46,s55
s_lshl_b32 s46,s46,10
s_add_u32 s25,s46,0x2000000
s_add_u32 s46,s22,2
s_and_b32 s46,s46,3
s_lshl_b32 s47,s44,2
s_add_u32 s46,s46,s47
s_mul_i32 s46,s46,18
s_add_u32 s46,s46,s55
s_lshl_b32 s46,s46,10
s_add_u32 s26,s46,0x2000000
s_add_u32 s46,s22,3
s_and_b32 s46,s46,3
s_lshl_b32 s47,s44,2
s_add_u32 s46,s46,s47
s_mul_i32 s46,s46,18
s_add_u32 s46,s46,s55
s_lshl_b32 s46,s46,10
s_add_u32 s27,s46,0x2000000
s_mul_i32 s46,s45,18
s_add_u32 s46,s46,s55
s_mul_i32 s28,s46,4608
s_add_u32 s28,s28,0x2a0000
s_add_u32 s28,s28,18432
s_lshr_b32 s51,s44,1
s_lshl_b32 s79,s51,11
s_add_u32 s79,s79,0x1310000
v_mov_b32 v13,1
v_mov_b32 v12,0
s_waitcnt vmcnt(0)
s_mov_b32 exec_lo,0x1
s_mov_b32 exec_hi,0x0
buffer_atomic_or v13,v12,s[8:11],s78 offen sc1
s_mov_b64 exec,-1
v_lshlrev_b32 v198,2,v0
s_cmp_eq_u32 s22,0
s_cselect_b32 s79,s79,0x40000000
v_mov_b32 v199,0
buffer_atomic_or v199,v198,s[8:11],s79 offen sc0 sc1
s_mul_i32 s46,s45,72
v_lshlrev_b32 v4,2,v15
v_add_u32 v4,s46,v4
v_lshrrev_b32 v5,3,v4
v_lshlrev_b32 v5,8,v5
v_lshl_add_u32 v5,v14,4,v5
v_and_b32 v10,4,v4
v_lshl_add_u32 v5,v10,1,v5
v_add_u32 v4,16,v4
v_lshrrev_b32 v6,3,v4
v_lshlrev_b32 v6,8,v6
v_lshl_add_u32 v6,v14,4,v6
v_and_b32 v10,4,v4
v_lshl_add_u32 v6,v10,1,v6
v_add_u32 v4,16,v4
v_lshrrev_b32 v7,3,v4
v_lshlrev_b32 v7,8,v7
v_lshl_add_u32 v7,v14,4,v7
v_and_b32 v10,4,v4
v_lshl_add_u32 v7,v10,1,v7
v_add_u32 v4,16,v4
v_lshrrev_b32 v8,3,v4
v_lshlrev_b32 v8,8,v8
v_lshl_add_u32 v8,v14,4,v8
v_and_b32 v10,4,v4
v_lshl_add_u32 v8,v10,1,v8
v_add_u32 v4,16,v4
v_lshrrev_b32 v9,3,v4
v_lshlrev_b32 v9,8,v9
v_lshl_add_u32 v9,v14,4,v9
v_and_b32 v10,4,v4
v_lshl_add_u32 v9,v10,1,v9
v_cmp_gt_u32 vcc,2,v15
v_mov_b32 v10,0x7ff00000
s_nop 0
v_cndmask_b32 v9,v10,v9,vcc
s_lshl_b32 s50,s44,2
s_add_u32 s50,s50,s22
s_mul_i32 s52,s50,18432
s_add_u32 s54,s52,0x1400000
s_add_u32 s57,s52,0x1680000
buffer_load_dwordx2 v[206:207],v5,s[8:11],s54 offen sc1
buffer_load_dwordx2 v[208:209],v6,s[8:11],s54 offen sc1
buffer_load_dwordx2 v[210:211],v7,s[8:11],s54 offen sc1
buffer_load_dwordx2 v[212:213],v8,s[8:11],s54 offen sc1
buffer_load_dwordx2 v[214:215],v9,s[8:11],s54 offen sc1
s_add_u32 s46,s22,1
s_and_b32 s46,s46,3
s_mul_i32 s46,s46,3
s_add_u32 s46,s46,0
s_mul_i32 s46,s46,5120
s_add_u32 s46,s46,98304
v_add_u32 v241,s46,v1
s_add_u32 s46,s22,2
s_and_b32 s46,s46,3
s_mul_i32 s46,s46,3
s_add_u32 s46,s46,1
s_mul_i32 s46,s46,5120
s_add_u32 s46,s46,98304
v_add_u32 v242,s46,v1
s_add_u32 s46,s22,3
s_and_b32 s46,s46,3
s_mul_i32 s46,s46,3
s_add_u32 s46,s46,2
s_mul_i32 s46,s46,5120
s_add_u32 s46,s46,98304
v_add_u32 v243,s46,v1
s_mul_i32 s46,s22,15360
s_add_u32 s46,s46,98304
v_add_u32 v240,s46,v1
v_mov_b32 v244,0
v_mov_b32 v245,0
v_mov_b32 v246,0
v_mov_b32 v247,0
s_lshl_b32 s46,s50,7
s_lshl_b32 s47,s45,14
s_add_u32 s46,s46,s47
s_add_u32 s29,s46,0x1e20000
v_lshlrev_b32 v248,3,v14
s_waitcnt vmcnt(0)
v_lshlrev_b32 v216,16,v206
v_and_b32 v217,0xffff0000,v206
v_lshlrev_b32 v218,16,v207
v_and_b32 v219,0xffff0000,v207
v_lshlrev_b32 v220,16,v208
v_and_b32 v221,0xffff0000,v208
v_lshlrev_b32 v222,16,v209
v_and_b32 v223,0xffff0000,v209
v_lshlrev_b32 v224,16,v210
v_and_b32 v225,0xffff0000,v210
v_lshlrev_b32 v226,16,v211
v_and_b32 v227,0xffff0000,v211
v_lshlrev_b32 v228,16,v212
v_and_b32 v229,0xffff0000,v212
v_lshlrev_b32 v230,16,v213
v_and_b32 v231,0xffff0000,v213
v_lshlrev_b32 v232,16,v214
v_and_b32 v233,0xffff0000,v214
v_lshlrev_b32 v234,16,v215
v_and_b32 v235,0xffff0000,v215
s_getpc_b64 s[58:59]
PC_mega_kernel_3:
s_mul_i32 s46,s23,4
s_add_u32 s46,s46,s22
s_lshl_b32 s46,s46,10
v_add_u32 v13,s46,v1
v_add_u32 v13,PH_k3_0-PC_mega_kernel_3,v13
v_min_u32 v13,PH_k4_0-PC_mega_kernel_3-16,v13
v_and_b32 v13,-4,v13
global_load_dwordx4 a[252:255],v13,s[58:59]
v_cmp_eq_u32 vcc,0,v199
s_cbranch_vccz DW_mega_kernel_4G
s_mov_b32 s53,0
s_cmp_lg_u32 s22,0
s_cbranch_scc1 DW_mega_kernel_4G
DW_mega_kernel_4:
s_nop 7
s_nop 3
v_mov_b32 v199,0
buffer_atomic_or v199,v198,s[8:11],s79 offen sc0 sc1
s_add_u32 s53,s53,1
s_waitcnt vmcnt(0)
v_cmp_eq_u32 vcc,0,v199
s_cbranch_vccz DW_mega_kernel_4G
s_cmp_lt_u32 s53,100000
s_cbranch_scc1 DW_mega_kernel_4
DW_mega_kernel_4G:
s_nop 7
s_nop 3
s_barrier
buffer_load_dwordx4 v[16:19],v1,s[8:11],s24 offen offset:0 sc1
buffer_load_dwordx4 v[20:23],v1,s[8:11],s25 offen offset:0 sc1
buffer_load_dwordx4 v[24:27],v1,s[8:11],s26 offen offset:0 sc1
buffer_load_dwordx4 v[28:31],v1,s[8:11],s27 offen offset:0 sc1
buffer_load_dwordx4 v[52:55],v1,s[8:11],s24 offen offset:1024 sc1
buffer_load_dwordx4 v[56:59],v1,s[8:11],s25 offen offset:1024 sc1
buffer_load_dwordx4 v[60:63],v1,s[8:11],s26 offen offset:1024 sc1
buffer_load_dwordx4 v[64:67],v1,s[8:11],s27 offen offset:1024 sc1
buffer_load_dwordx4 v[88:91],v1,s[8:11],s24 offen offset:2048 sc1
buffer_load_dwordx4 v[92:95],v1,s[8:11],s25 offen offset:2048 sc1
buffer_load_dwordx4 v[96:99],v1,s[8:11],s26 offen offset:2048 sc1
buffer_load_dwordx4 v[100:103],v1,s[8:11],s27 offen offset:2048 sc1
buffer_load_dwordx4 v[124:127],v1,s[8:11],s24 offen offset:3072 sc1
buffer_load_dwordx4 v[128:131],v1,s[8:11],s25 offen offset:3072 sc1
buffer_load_dwordx4 v[132:135],v1,s[8:11],s26 offen offset:3072 sc1
buffer_load_dwordx4 v[136:139],v1,s[8:11],s27 offen offset:3072 sc1
s_add_u32 s24,s24,4096
s_add_u32 s25,s25,4096
s_add_u32 s26,s26,4096
s_add_u32 s27,s27,4096
s_add_u32 s24,s24,s56
s_add_u32 s25,s25,s56
s_add_u32 s26,s26,s56
s_add_u32 s27,s27,s56
buffer_load_dwordx4 v[160:163],v1,s[8:11],s24 offen offset:0 sc1
buffer_load_dwordx4 v[164:167],v1,s[8:11],s25 offen offset:0 sc1
buffer_load_dwordx4 v[168:171],v1,s[8:11],s26 offen offset:0 sc1
buffer_load_dwordx4 v[172:175],v1,s[8:11],s27 offen offset:0 sc1
s_waitcnt vmcnt(19)
MF v[216:219],a[0:3],v[16:19],v[216:219]
MF v[220:223],a[4:7],v[16:19],v[220:223]
MF v[224:227],a[8:11],v[16:19],v[224:227]
MF v[228:231],a[12:15],v[16:19],v[228:231]
MF v[232:235],a[16:19],v[16:19],v[232:235]
s_waitcnt vmcnt(18)
MF a[100:103],a[0:3],v[20:23],0
MF a[104:107],a[4:7],v[20:23],0
MF a[108:111],a[8:11],v[20:23],0
MF a[112:115],a[12:15],v[20:23],0
MF a[116:119],a[16:19],v[20:23],0
s_waitcnt vmcnt(17)
MF a[120:123],a[0:3],v[24:27],0
MF a[124:127],a[4:7],v[24:27],0
MF a[128:131],a[8:11],v[24:27],0
MF a[132:135],a[12:15],v[24:27],0
MF a[136:139],a[16:19],v[24:27],0
s_waitcnt vmcnt(16)
MF a[140:143],a[0:3],v[28:31],0
MF a[144:147],a[4:7],v[28:31],0
MF a[148:151],a[8:11],v[28:31],0
MF a[152:155],a[12:15],v[28:31],0
MF a[156:159],a[16:19],v[28:31],0
s_waitcnt vmcnt(15)
MF v[216:219],a[20:23],v[52:55],v[216:219]
s_lshl_b32 s49,s22,10
s_lshr_b32 s48,s3,1
s_lshl_b32 s48,s48,2
s_lshr_b32 s20,s23,3
s_add_u32 s48,s48,s20
s_mul_i32 s48,s48,331776
s_add_u32 s48,s48,0x350000
s_add_u32 s48,s48,s49
v_add_u32 v253,4096,v1
v_add_u32 v254,8192,v1
v_add_u32 v255,12288,v1
s_add_u32 m0,s49,0
s_add_u32 s20,s48,0
buffer_load_dwordx4 v1,s[8:11],s20 offen sc1 lds
MF v[220:223],a[24:27],v[52:55],v[220:223]
MF v[224:227],a[28:31],v[52:55],v[224:227]
s_add_u32 m0,s49,4096
s_nop 0
buffer_load_dwordx4 v253,s[8:11],s20 offen sc1 lds
MF v[228:231],a[32:35],v[52:55],v[228:231]
MF v[232:235],a[36:39],v[52:55],v[232:235]
s_add_u32 m0,s49,8192
s_nop 0
buffer_load_dwordx4 v254,s[8:11],s20 offen sc1 lds
s_waitcnt vmcnt(17)
MF a[100:103],a[20:23],v[56:59],a[100:103]
MF a[104:107],a[24:27],v[56:59],a[104:107]
s_add_u32 m0,s49,12288
s_nop 0
buffer_load_dwordx4 v255,s[8:11],s20 offen sc1 lds
MF a[108:111],a[28:31],v[56:59],a[108:111]
MF a[112:115],a[32:35],v[56:59],a[112:115]
s_add_u32 m0,s49,16384
s_add_u32 s20,s48,16384
buffer_load_dwordx4 v1,s[8:11],s20 offen sc1 lds
MF a[116:119],a[36:39],v[56:59],a[116:119]
s_waitcnt vmcnt(18)
MF a[120:123],a[20:23],v[60:63],a[120:123]
s_add_u32 m0,s49,20480
s_nop 0
buffer_load_dwordx4 v253,s[8:11],s20 offen sc1 lds
MF a[124:127],a[24:27],v[60:63],a[124:127]
MF a[128:131],a[28:31],v[60:63],a[128:131]
s_add_u32 m0,s49,24576
s_nop 0
buffer_load_dwordx4 v254,s[8:11],s20 offen sc1 lds
MF a[132:135],a[32:35],v[60:63],a[132:135]
MF a[136:139],a[36:39],v[60:63],a[136:139]
s_add_u32 m0,s49,28672
s_nop 0
buffer_load_dwordx4 v255,s[8:11],s20 offen sc1 lds
s_waitcnt vmcnt(20)
MF a[140:143],a[20:23],v[64:67],a[140:143]
MF a[144:147],a[24:27],v[64:67],a[144:147]
MF a[148:151],a[28:31],v[64:67],a[148:151]
MF a[152:155],a[32:35],v[64:67],a[152:155]
MF a[156:159],a[36:39],v[64:67],a[156:159]
s_waitcnt vmcnt(19)
MF v[216:219],a[40:43],v[88:91],v[216:219]
s_add_u32 m0,s49,32768
s_add_u32 s20,s48,32768
buffer_load_dwordx4 v1,s[8:11],s20 offen sc1 lds
MF v[220:223],a[44:47],v[88:91],v[220:223]
MF v[224:227],a[48:51],v[88:91],v[224:227]
s_add_u32 m0,s49,36864
s_nop 0
buffer_load_dwordx4 v253,s[8:11],s20 offen sc1 lds
MF v[228:231],a[52:55],v[88:91],v[228:231]
MF v[232:235],a[56:59],v[88:91],v[232:235]
s_add_u32 m0,s49,40960
s_nop 0
buffer_load_dwordx4 v254,s[8:11],s20 offen sc1 lds
s_waitcnt vmcnt(21)
MF a[100:103],a[40:43],v[92:95],a[100:103]
MF a[104:107],a[44:47],v[92:95],a[104:107]
s_add_u32 m0,s49,45056
s_nop 0
buffer_load_dwordx4 v255,s[8:11],s20 offen sc1 lds
MF a[108:111],a[48:51],v[92:95],a[108:111]
MF a[112:115],a[52:55],v[92:95],a[112:115]
s_add_u32 m0,s49,49152
s_add_u32 s20,s48,49152
buffer_load_dwordx4 v1,s[8:11],s20 offen sc1 lds
MF a[116:119],a[56:59],v[92:95],a[116:119]
s_waitcnt vmcnt(22)
MF a[120:123],a[40:43],v[96:99],a[120:123]
s_add_u32 m0,s49,53248
s_nop 0
buffer_load_dwordx4 v253,s[8:11],s20 offen sc1 lds
MF a[124:127],a[44:47],v[96:99],a[124:127]
MF a[128:131],a[48:51],v[96:99],a[128:131]
s_add_u32 m0,s49,57344
s_nop 0
buffer_load_dwordx4 v254,s[8:11],s20 offen sc1 lds
MF a[132:135],a[52:55],v[96:99],a[132:135]
MF a[136:139],a[56:59],v[96:99],a[136:139]
s_add_u32 m0,s49,61440
s_nop 0
buffer_load_dwordx4 v255,s[8:11],s20 offen sc1 lds
s_waitcnt vmcnt(24)
MF a[140:143],a[40:43],v[100:103],a[140:143]
MF a[144:147],a[44:47],v[100:103],a[144:147]
MF a[148:151],a[48:51],v[100:103],a[148:151]
MF a[152:155],a[52:55],v[100:103],a[152:155]
MF a[156:159],a[56:59],v[100:103],a[156:159]
s_waitcnt vmcnt(23)
MF v[216:219],a[60:63],v[124:127],v[216:219]
s_add_u32 m0,s49,65536
s_add_u32 s20,s48,65536
buffer_load_dwordx4 v1,s[8:11],s20 offen sc1 lds
MF v[220:223],a[64:67],v[124:127],v[220:223]
MF v[224:227],a[68:71],v[124:127],v[224:227]
s_add_u32 m0,s49,69632
s_nop 0
buffer_load_dwordx4 v253,s[8:11],s20 offen sc1 lds
MF v[228:231],a[72:75],v[124:127],v[228:231]
MF v[232:235],a[76:79],v[124:127],v[232:235]
s_add_u32 m0,s49,73728
s_nop 0
buffer_load_dwordx4 v254,s[8:11],s20 offen sc1 lds
s_waitcnt vmcnt(25)
MF a[100:103],a[60:63],v[128:131],a[100:103]
MF a[104:107],a[64:67],v[128:131],a[104:107]
s_add_u32 m0,s49,77824
s_nop 0
buffer_load_dwordx4 v255,s[8:11],s20 offen sc1 lds
MF a[108:111],a[68:71],v[128:131],a[108:111]
MF a[112:115],a[72:75],v[128:131],a[112:115]
s_add_u32 m0,s49,81920
s_add_u32 s20,s48,81920
buffer_load_dwordx4 v1,s[8:11],s20 offen sc1 lds
MF a[116:119],a[76:79],v[128:131],a[116:119]
s_waitcnt vmcnt(26)
MF a[120:123],a[60:63],v[132:135],a[120:123]
s_add_u32 m0,s49,86016
s_nop 0
buffer_load_dwordx4 v253,s[8:11],s20 offen sc1 lds
MF a[124:127],a[64:67],v[132:135],a[124:127]
MF a[128:131],a[68:71],v[132:135],a[128:131]
s_add_u32 m0,s49,90112
s_nop 0
buffer_load_dwordx4 v254,s[8:11],s20 offen sc1 lds
MF a[132:135],a[72:75],v[132:135],a[132:135]
MF a[136:139],a[76:79],v[132:135],a[136:139]
s_add_u32 m0,s49,94208
s_nop 0
buffer_load_dwordx4 v255,s[8:11],s20 offen sc1 lds
s_waitcnt vmcnt(28)
MF a[140:143],a[60:63],v[136:139],a[140:143]
MF a[144:147],a[64:67],v[136:139],a[144:147]
MF a[148:151],a[68:71],v[136:139],a[148:151]
MF a[152:155],a[72:75],v[136:139],a[152:155]
MF a[156:159],a[76:79],v[136:139],a[156:159]
s_waitcnt vmcnt(26)
MF a[100:103],a[80:83],v[164:167],a[100:103]
MF a[104:107],a[84:87],v[164:167],a[104:107]
MF a[108:111],a[88:91],v[164:167],a[108:111]
MF a[112:115],a[92:95],v[164:167],a[112:115]
MF a[116:119],a[96:99],v[164:167],a[116:119]
s_waitcnt vmcnt(25)
MF a[120:123],a[80:83],v[168:171],a[120:123]
MF a[124:127],a[84:87],v[168:171],a[124:127]
MF a[128:131],a[88:91],v[168:171],a[128:131]
ds_write_b128 v241,a[100:103] offset:0
MF a[132:135],a[92:95],v[168:171],a[132:135]
ds_write_b128 v241,a[104:107] offset:1024
MF a[136:139],a[96:99],v[168:171],a[136:139]
ds_write_b128 v241,a[108:111] offset:2048
s_waitcnt vmcnt(24)
MF a[140:143],a[80:83],v[172:175],a[140:143]
ds_write_b128 v241,a[112:115] offset:3072
MF a[144:147],a[84:87],v[172:175],a[144:147]
ds_write_b128 v241,a[116:119] offset:4096
MF a[148:151],a[88:91],v[172:175],a[148:151]
ds_write_b128 v242,a[120:123] offset:0
MF a[152:155],a[92:95],v[172:175],a[152:155]
ds_write_b128 v242,a[124:127] offset:1024
MF a[156:159],a[96:99],v[172:175],a[156:159]
ds_write_b128 v242,a[128:131] offset:2048
MF v[216:219],a[80:83],v[160:163],v[216:219]
ds_write_b128 v242,a[132:135] offset:3072
MF v[220:223],a[84:87],v[160:163],v[220:223]
ds_write_b128 v242,a[136:139] offset:4096
MF v[224:227],a[88:91],v[160:163],v[224:227]
ds_write_b128 v243,a[140:143] offset:0
MF v[228:231],a[92:95],v[160:163],v[228:231]
ds_write_b128 v243,a[144:147] offset:1024
MF v[232:235],a[96:99],v[160:163],v[232:235]
ds_write_b128 v243,a[148:151] offset:2048
ds_write_b128 v243,a[152:155] offset:3072
ds_write_b128 v243,a[156:159] offset:4096
s_waitcnt lgkmcnt(0)
s_barrier
ds_read_b128 v[16:19],v240 offset:0
ds_read_b128 v[20:23],v240 offset:5120
ds_read_b128 v[24:27],v240 offset:10240
ds_read_b128 v[28:31],v240 offset:1024
ds_read_b128 v[32:35],v240 offset:6144
ds_read_b128 v[36:39],v240 offset:11264
ds_read_b128 v[40:43],v240 offset:2048
ds_read_b128 v[44:47],v240 offset:7168
ds_read_b128 v[48:51],v240 offset:12288
ds_read_b128 v[52:55],v240 offset:3072
ds_read_b128 v[56:59],v240 offset:8192
ds_read_b128 v[60:63],v240 offset:13312
ds_read_b128 v[64:67],v240 offset:4096
ds_read_b128 v[68:71],v240 offset:9216
ds_read_b128 v[72:75],v240 offset:14336
s_waitcnt lgkmcnt(12)
v_pk_add_f32 v[16:17],v[16:17],v[20:21]
v_pk_add_f32 v[216:217],v[216:217],v[24:25]
v_pk_add_f32 v[18:19],v[18:19],v[22:23]
v_pk_add_f32 v[218:219],v[218:219],v[26:27]
v_pk_add_f32 v[216:217],v[216:217],v[16:17]
v_pk_add_f32 v[218:219],v[218:219],v[18:19]
v_cvt_pk_bf16_f32 v16,v216,v217
v_cvt_pk_bf16_f32 v17,v218,v219
buffer_store_dwordx2 v[16:17],v5,s[8:11],s57 offen sc1
v_pk_add_f32 v[244:245],v[244:245],v[216:217]
v_pk_fma_f32 v[246:247],v[216:217],v[216:217],v[246:247]
v_pk_add_f32 v[244:245],v[244:245],v[218:219]
v_pk_fma_f32 v[246:247],v[218:219],v[218:219],v[246:247]
s_waitcnt lgkmcnt(9)
v_pk_add_f32 v[28:29],v[28:29],v[32:33]
v_pk_add_f32 v[220:221],v[220:221],v[36:37]
v_pk_add_f32 v[30:31],v[30:31],v[34:35]
v_pk_add_f32 v[222:223],v[222:223],v[38:39]
v_pk_add_f32 v[220:221],v[220:221],v[28:29]
v_pk_add_f32 v[222:223],v[222:223],v[30:31]
v_cvt_pk_bf16_f32 v28,v220,v221
v_cvt_pk_bf16_f32 v29,v222,v223
buffer_store_dwordx2 v[28:29],v6,s[8:11],s57 offen sc1
v_pk_add_f32 v[244:245],v[244:245],v[220:221]
v_pk_fma_f32 v[246:247],v[220:221],v[220:221],v[246:247]
v_pk_add_f32 v[244:245],v[244:245],v[222:223]
v_pk_fma_f32 v[246:247],v[222:223],v[222:223],v[246:247]
s_waitcnt lgkmcnt(6)
v_pk_add_f32 v[40:41],v[40:41],v[44:45]
v_pk_add_f32 v[224:225],v[224:225],v[48:49]
v_pk_add_f32 v[42:43],v[42:43],v[46:47]
v_pk_add_f32 v[226:227],v[226:227],v[50:51]
v_pk_add_f32 v[224:225],v[224:225],v[40:41]
v_pk_add_f32 v[226:227],v[226:227],v[42:43]
v_cvt_pk_bf16_f32 v40,v224,v225
v_cvt_pk_bf16_f32 v41,v226,v227
buffer_store_dwordx2 v[40:41],v7,s[8:11],s57 offen sc1
v_pk_add_f32 v[244:245],v[244:245],v[224:225]
v_pk_fma_f32 v[246:247],v[224:225],v[224:225],v[246:247]
v_pk_add_f32 v[244:245],v[244:245],v[226:227]
v_pk_fma_f32 v[246:247],v[226:227],v[226:227],v[246:247]
s_waitcnt lgkmcnt(3)
v_pk_add_f32 v[52:53],v[52:53],v[56:57]
v_pk_add_f32 v[228:229],v[228:229],v[60:61]
v_pk_add_f32 v[54:55],v[54:55],v[58:59]
v_pk_add_f32 v[230:231],v[230:231],v[62:63]
v_pk_add_f32 v[228:229],v[228:229],v[52:53]
v_pk_add_f32 v[230:231],v[230:231],v[54:55]
v_cvt_pk_bf16_f32 v52,v228,v229
v_cvt_pk_bf16_f32 v53,v230,v231
buffer_store_dwordx2 v[52:53],v8,s[8:11],s57 offen sc1
v_pk_add_f32 v[244:245],v[244:245],v[228:229]
v_pk_fma_f32 v[246:247],v[228:229],v[228:229],v[246:247]
v_pk_add_f32 v[244:245],v[244:245],v[230:231]
v_pk_fma_f32 v[246:247],v[230:231],v[230:231],v[246:247]
s_waitcnt lgkmcnt(0)
s_mov_b32 exec_lo,0xffffffff
s_mov_b32 exec_hi,0x0
v_pk_add_f32 v[64:65],v[64:65],v[68:69]
v_pk_add_f32 v[232:233],v[232:233],v[72:73]
v_pk_add_f32 v[66:67],v[66:67],v[70:71]
v_pk_add_f32 v[234:235],v[234:235],v[74:75]
v_pk_add_f32 v[232:233],v[232:233],v[64:65]
v_pk_add_f32 v[234:235],v[234:235],v[66:67]
v_cvt_pk_bf16_f32 v64,v232,v233
v_cvt_pk_bf16_f32 v65,v234,v235
buffer_store_dwordx2 v[64:65],v9,s[8:11],s57 offen sc1
v_pk_add_f32 v[244:245],v[244:245],v[232:233]
v_pk_fma_f32 v[246:247],v[232:233],v[232:233],v[246:247]
v_pk_add_f32 v[244:245],v[244:245],v[234:235]
v_pk_fma_f32 v[246:247],v[234:235],v[234:235],v[246:247]
s_mov_b64 exec,-1
v_add_f32 v12,v244,v245
v_add_f32 v13,v246,v247
v_mov_b32 v10,v12
v_mov_b32 v11,v13
s_nop 0
v_permlane32_swap_b32 v12,v10
v_permlane32_swap_b32 v13,v11
v_add_f32 v12,v12,v10
v_add_f32 v13,v13,v11
v_mov_b32 v10,v12
v_mov_b32 v11,v13
s_nop 0
v_permlane16_swap_b32 v12,v10
v_permlane16_swap_b32 v13,v11
v_add_f32 v12,v12,v10
v_add_f32 v13,v13,v11
s_mov_b64 exec,0xffff
buffer_store_dwordx2 v[12:13],v248,s[8:11],s29 offen sc1
s_mov_b64 exec,-1
s_barrier
s_mov_b64 exec,-1
s_and_b32 s46,s44,1
s_lshl_b32 s46,s46,3
s_add_u32 s46,s46,s45
s_lshl_b32 s78,s51,11
s_lshl_b32 s47,s46,4
s_add_u32 s78,s78,s47
s_lshl_b32 s47,s22,2
s_add_u32 s78,s78,s47
s_add_u32 s78,s78,0x1318000
s_mov_b64 exec,-1
PH_k3_0:
s_and_b32 s44,s3,1
s_lshl_b32 s44,s44,3
s_and_b32 s45,s23,7
s_add_u32 s44,s44,s45
s_lshr_b32 s45,s3,1
s_lshl_b32 s45,s45,2
s_lshr_b32 s46,s23,3
s_add_u32 s45,s45,s46
v_add_u32 v2,65536,v1
v_add_u32 v3,131072,v1
s_lshl_b32 s46,s44,3
s_lshl_b32 s47,s22,1
s_add_u32 s46,s46,s47
s_mul_i32 s24,s46,18432
s_add_u32 s24,s24,0x1680000
s_add_u32 s27,s24,18432
s_add_u32 s29,s24,16384
s_add_u32 s21,s27,16384
s_lshl_b32 s79,s44,11
s_add_u32 s79,s79,0x1318000
v_mov_b32 v13,1
v_mov_b32 v12,0
s_waitcnt vmcnt(0)
s_mov_b32 exec_lo,0x1
s_mov_b32 exec_hi,0x0
buffer_atomic_or v13,v12,s[8:11],s78 offen sc1
s_mov_b64 exec,-1
v_lshlrev_b32 v198,2,v0
s_cmp_eq_u32 s22,0
s_cselect_b32 s79,s79,0x40000000
v_mov_b32 v199,0
buffer_atomic_or v199,v198,s[8:11],s79 offen sc0 sc1
s_add_u32 m0,s49,98304
s_add_u32 s20,s48,98304
buffer_load_dwordx4 v1,s[8:11],s20 offen sc1 lds
s_add_u32 m0,s49,102400
s_nop 0
buffer_load_dwordx4 v253,s[8:11],s20 offen sc1 lds
s_add_u32 m0,s49,106496
s_nop 0
buffer_load_dwordx4 v254,s[8:11],s20 offen sc1 lds
s_add_u32 m0,s49,110592
s_nop 0
buffer_load_dwordx4 v255,s[8:11],s20 offen sc1 lds
s_add_u32 m0,s49,114688
s_add_u32 s20,s48,114688
buffer_load_dwordx4 v1,s[8:11],s20 offen sc1 lds
s_add_u32 m0,s49,118784
s_nop 0
buffer_load_dwordx4 v253,s[8:11],s20 offen sc1 lds
s_mul_i32 s31,s45,1152
s_add_u32 s31,s31,0x860000
s_lshl_b32 s46,s22,9
v_lshlrev_b32 v12,3,v0
v_add_u32 v201,s46,v12
v_min_u32 v201,1144,v201
buffer_load_dwordx2 v[192:193],v201,s[8:11],s31 offen sc1
s_add_u32 s31,s31,18432
buffer_load_dwordx2 v[194:195],v201,s[8:11],s31 offen sc1
v_mov_b32 v248,0xbdd2d3e8
v_mov_b32 v249,0xc0135761
v_mov_b32 v250,1.0
v_mov_b32 v224,0
v_mov_b32 v225,0
v_mov_b32 v226,0
v_mov_b32 v227,0
v_mov_b32 v228,0
v_mov_b32 v229,0
v_mov_b32 v230,0
v_mov_b32 v231,0
v_mov_b32 v232,0
v_mov_b32 v233,0
v_mov_b32 v234,0
v_mov_b32 v235,0
v_mov_b32 v236,0
v_mov_b32 v237,0
v_mov_b32 v238,0
v_mov_b32 v239,0
s_lshl_b32 s50,s44,2
s_add_u32 s50,s50,s22
s_lshl_b32 s51,s50,12
s_add_u32 s51,s51,0x2300000
s_lshl_b32 s52,s45,8
s_add_u32 s52,s52,s51
s_lshl_b32 s30,s22,8
s_add_u32 s30,s30,159744
v_lshlrev_b32 v252,4,v15
v_add_u32 v252,s30,v252
v_lshrrev_b32 v4,1,v15
v_lshl_add_u32 v4,v4,4,v14
v_lshlrev_b32 v4,4,v4
v_and_b32 v5,1,v15
v_lshl_add_u32 v222,v5,3,v4
v_and_b32 v4,1,v0
v_lshlrev_b32 v4,7,v4
v_lshrrev_b32 v6,1,v0
v_lshl_add_u32 v4,v6,2,v4
v_add_u32 v223,s30,v4
s_lshl_b32 s46,s45,6
s_add_u32 s46,s46,s50
s_mul_i32 s46,s46,9216
s_add_u32 s34,s46,0x2400000
s_add_u32 s35,s34,4096
s_add_u32 s36,s34,8192
s_getpc_b64 s[58:59]
PC_mega_kernel_5:
s_mul_i32 s46,s23,4
s_add_u32 s46,s46,s22
s_lshl_b32 s46,s46,10
v_add_u32 v13,s46,v1
v_add_u32 v13,PH_k4_0-PC_mega_kernel_5,v13
v_min_u32 v13,PH_k5_0-PC_mega_kernel_5-16,v13
v_and_b32 v13,-4,v13
global_load_dwordx4 a[252:255],v13,s[58:59]
s_waitcnt vmcnt(9)
v_cmp_eq_u32 vcc,0,v199
s_cbranch_vccz DW_mega_kernel_6G
s_mov_b32 s53,0
s_cmp_lg_u32 s22,0
s_cbranch_scc1 DW_mega_kernel_6G
DW_mega_kernel_6:
s_nop 7
s_nop 3
v_mov_b32 v199,0
buffer_atomic_or v199,v198,s[8:11],s79 offen sc0 sc1
s_add_u32 s53,s53,1
s_waitcnt vmcnt(0)
v_cmp_eq_u32 vcc,0,v199
s_cbranch_vccz DW_mega_kernel_6G
s_cmp_lt_u32 s53,100000
s_cbranch_scc1 DW_mega_kernel_6
DW_mega_kernel_6G:
s_nop 7
s_nop 3
s_barrier
s_lshl_b32 s78,s45,11
s_lshl_b32 s47,s44,4
s_add_u32 s78,s78,s47
s_lshl_b32 s47,s22,2
s_add_u32 s78,s78,s47
s_add_u32 s78,s78,0x1320000
v_and_b32 v12,31,v0
v_lshlrev_b32 v12,3,v12
v_lshrrev_b32 v13,5,v0
v_lshl_add_u32 v12,v13,16,v12
s_lshl_b32 s46,s44,10
s_lshl_b32 s47,s22,8
s_add_u32 s46,s46,s47
s_add_u32 s46,s46,0x1e20000
buffer_load_dwordx2 v[4:5],v12,s[8:11],s46 offen sc1
s_add_u32 s46,s46,16384
buffer_load_dwordx2 v[6:7],v12,s[8:11],s46 offen sc1
s_add_u32 s46,s46,16384
buffer_load_dwordx2 v[8:9],v12,s[8:11],s46 offen sc1
s_add_u32 s46,s46,16384
buffer_load_dwordx2 v[10:11],v12,s[8:11],s46 offen sc1
buffer_load_dwordx4 a[0:3],v1,s[8:11],s24 offen offset:0 sc1
buffer_load_dwordx4 a[4:7],v1,s[8:11],s27 offen offset:0 sc1
buffer_load_dwordx4 a[8:11],v1,s[8:11],s24 offen offset:1024 sc1
buffer_load_dwordx4 a[12:15],v1,s[8:11],s27 offen offset:1024 sc1
buffer_load_dwordx4 a[16:19],v1,s[8:11],s24 offen offset:2048 sc1
buffer_load_dwordx4 a[20:23],v1,s[8:11],s27 offen offset:2048 sc1
buffer_load_dwordx4 a[24:27],v1,s[8:11],s24 offen offset:3072 sc1
buffer_load_dwordx4 a[28:31],v1,s[8:11],s27 offen offset:3072 sc1
s_waitcnt lgkmcnt(0)
s_barrier
ds_read_b128 v[16:19],v1 offset:0
ds_read_b128 v[20:23],v1 offset:1024
ds_read_b128 v[24:27],v1 offset:2048
ds_read_b128 v[28:31],v1 offset:3072
ds_read_b128 v[32:35],v1 offset:4096
ds_read_b128 v[36:39],v1 offset:5120
ds_read_b128 v[40:43],v1 offset:6144
s_waitcnt vmcnt(6)
s_waitcnt lgkmcnt(5)
MF v[48:51],a[0:3],v[16:19],0
buffer_load_dwordx4 a[32:35],v253,s[8:11],s24 offen offset:0 sc1
MF v[84:87],a[4:7],v[16:19],0
ds_read_b128 v[44:47],v1 offset:7168
MF v[52:55],a[0:3],v[20:23],0
MF v[88:91],a[4:7],v[20:23],0
ds_read_b128 v[16:19],v1 offset:8192
s_waitcnt lgkmcnt(5)
MF v[56:59],a[0:3],v[24:27],0
MF v[92:95],a[4:7],v[24:27],0
ds_read_b128 v[20:23],v1 offset:9216
MF v[60:63],a[0:3],v[28:31],0
buffer_load_dwordx4 a[36:39],v253,s[8:11],s27 offen offset:0 sc1
MF v[96:99],a[4:7],v[28:31],0
ds_read_b128 v[24:27],v1 offset:10240
s_waitcnt lgkmcnt(5)
MF v[64:67],a[0:3],v[32:35],0
MF v[100:103],a[4:7],v[32:35],0
ds_read_b128 v[28:31],v1 offset:11264
v_add_f32 v192,v192,v194
v_add_f32 v193,v193,v195
v_add_u32 v201,160768,v201
ds_write_b64 v201,v[192:193]
MF v[68:71],a[0:3],v[36:39],0
MF v[104:107],a[4:7],v[36:39],0
s_barrier
ds_read_b128 v[32:35],v1 offset:12288
s_waitcnt lgkmcnt(6)
MF v[72:75],a[0:3],v[40:43],0
buffer_load_dwordx4 a[40:43],v253,s[8:11],s24 offen offset:1024 sc1
MF v[108:111],a[4:7],v[40:43],0
ds_read_b128 v[36:39],v1 offset:13312
MF v[76:79],a[0:3],v[44:47],0
MF v[112:115],a[4:7],v[44:47],0
ds_read_b128 v[40:43],v1 offset:14336
s_waitcnt lgkmcnt(6)
MF v[80:83],a[0:3],v[16:19],0
MF v[116:119],a[4:7],v[16:19],0
ds_read_b128 v[44:47],v1 offset:15360
s_waitcnt vmcnt(7)
MF v[48:51],a[8:11],v[20:23],v[48:51]
buffer_load_dwordx4 a[44:47],v253,s[8:11],s27 offen offset:1024 sc1
MF v[84:87],a[12:15],v[20:23],v[84:87]
ds_read_b128 v[16:19],v1 offset:16384
s_waitcnt lgkmcnt(6)
MF v[52:55],a[8:11],v[24:27],v[52:55]
MF v[88:91],a[12:15],v[24:27],v[88:91]
ds_read_b128 v[20:23],v1 offset:17408
MF v[56:59],a[8:11],v[28:31],v[56:59]
MF v[92:95],a[12:15],v[28:31],v[92:95]
ds_read_b128 v[24:27],v1 offset:18432
s_waitcnt lgkmcnt(5)
MF v[60:63],a[8:11],v[32:35],v[60:63]
buffer_load_dwordx4 a[48:51],v253,s[8:11],s24 offen offset:2048 sc1
MF v[96:99],a[12:15],v[32:35],v[96:99]
ds_read_b128 v[28:31],v1 offset:19456
MF v[64:67],a[8:11],v[36:39],v[64:67]
MF v[100:103],a[12:15],v[36:39],v[100:103]
ds_read_b128 v[32:35],v1 offset:20480
s_waitcnt lgkmcnt(5)
MF v[68:71],a[8:11],v[40:43],v[68:71]
MF v[104:107],a[12:15],v[40:43],v[104:107]
ds_read_b128 v[36:39],v1 offset:21504
MF v[72:75],a[8:11],v[44:47],v[72:75]
buffer_load_dwordx4 a[52:55],v253,s[8:11],s27 offen offset:2048 sc1
MF v[108:111],a[12:15],v[44:47],v[108:111]
ds_read_b128 v[40:43],v1 offset:22528
s_waitcnt lgkmcnt(5)
MF v[76:79],a[8:11],v[16:19],v[76:79]
MF v[112:115],a[12:15],v[16:19],v[112:115]
ds_read_b128 v[44:47],v1 offset:23552
MF v[80:83],a[8:11],v[20:23],v[80:83]
MF v[116:119],a[12:15],v[20:23],v[116:119]
ds_read_b128 v[16:19],v1 offset:24576
s_waitcnt vmcnt(8)
s_waitcnt lgkmcnt(5)
MF v[48:51],a[16:19],v[24:27],v[48:51]
buffer_load_dwordx4 a[56:59],v253,s[8:11],s24 offen offset:3072 sc1
MF v[84:87],a[20:23],v[24:27],v[84:87]
ds_read_b128 v[20:23],v1 offset:25600
MF v[52:55],a[16:19],v[28:31],v[52:55]
MF v[88:91],a[20:23],v[28:31],v[88:91]
ds_read_b128 v[24:27],v1 offset:26624
s_waitcnt lgkmcnt(5)
MF v[56:59],a[16:19],v[32:35],v[56:59]
MF v[92:95],a[20:23],v[32:35],v[92:95]
ds_read_b128 v[28:31],v1 offset:27648
MF v[60:63],a[16:19],v[36:39],v[60:63]
buffer_load_dwordx4 a[60:63],v253,s[8:11],s27 offen offset:3072 sc1
MF v[96:99],a[20:23],v[36:39],v[96:99]
ds_read_b128 v[32:35],v1 offset:28672
s_waitcnt lgkmcnt(5)
MF v[64:67],a[16:19],v[40:43],v[64:67]
MF v[100:103],a[20:23],v[40:43],v[100:103]
ds_read_b128 v[36:39],v1 offset:29696
MF v[68:71],a[16:19],v[44:47],v[68:71]
MF v[104:107],a[20:23],v[44:47],v[104:107]
ds_read_b128 v[40:43],v1 offset:30720
s_waitcnt lgkmcnt(5)
MF v[72:75],a[16:19],v[16:19],v[72:75]
buffer_load_dwordx4 a[64:67],v254,s[8:11],s24 offen offset:0 sc1
MF v[108:111],a[20:23],v[16:19],v[108:111]
ds_read_b128 v[44:47],v1 offset:31744
MF v[76:79],a[16:19],v[20:23],v[76:79]
MF v[112:115],a[20:23],v[20:23],v[112:115]
ds_read_b128 v[16:19],v1 offset:32768
s_waitcnt lgkmcnt(5)
MF v[80:83],a[16:19],v[24:27],v[80:83]
MF v[116:119],a[20:23],v[24:27],v[116:119]
ds_read_b128 v[20:23],v1 offset:33792
s_waitcnt vmcnt(9)
MF v[48:51],a[24:27],v[28:31],v[48:51]
buffer_load_dwordx4 a[68:71],v254,s[8:11],s27 offen offset:0 sc1
MF v[84:87],a[28:31],v[28:31],v[84:87]
ds_read_b128 v[24:27],v1 offset:34816
s_waitcnt lgkmcnt(5)
MF v[52:55],a[24:27],v[32:35],v[52:55]
MF v[88:91],a[28:31],v[32:35],v[88:91]
ds_read_b128 v[28:31],v1 offset:35840
MF v[56:59],a[24:27],v[36:39],v[56:59]
MF v[92:95],a[28:31],v[36:39],v[92:95]
s_barrier
ds_read_b128 v[32:35],v1 offset:36864
s_waitcnt lgkmcnt(5)
MF v[60:63],a[24:27],v[40:43],v[60:63]
buffer_load_dwordx4 a[72:75],v254,s[8:11],s24 offen offset:1024 sc1
MF v[96:99],a[28:31],v[40:43],v[96:99]
ds_read_b128 v[36:39],v1 offset:37888
MF v[64:67],a[24:27],v[44:47],v[64:67]
MF v[100:103],a[28:31],v[44:47],v[100:103]
ds_read_b128 v[40:43],v1 offset:38912
s_waitcnt lgkmcnt(5)
MF v[68:71],a[24:27],v[16:19],v[68:71]
MF v[104:107],a[28:31],v[16:19],v[104:107]
ds_read_b128 v[44:47],v1 offset:39936
MF v[72:75],a[24:27],v[20:23],v[72:75]
buffer_load_dwordx4 a[76:79],v254,s[8:11],s27 offen offset:1024 sc1
MF v[108:111],a[28:31],v[20:23],v[108:111]
ds_read_b128 v[16:19],v1 offset:40960
s_waitcnt lgkmcnt(5)
MF v[76:79],a[24:27],v[24:27],v[76:79]
MF v[112:115],a[28:31],v[24:27],v[112:115]
ds_read_b128 v[20:23],v1 offset:41984
MF v[80:83],a[24:27],v[28:31],v[80:83]
MF v[116:119],a[28:31],v[28:31],v[116:119]
ds_read_b128 v[24:27],v1 offset:43008
s_waitcnt vmcnt(10)
s_waitcnt lgkmcnt(5)
MF v[48:51],a[32:35],v[32:35],v[48:51]
buffer_load_dwordx4 a[80:83],v254,s[8:11],s24 offen offset:2048 sc1
MF v[84:87],a[36:39],v[32:35],v[84:87]
ds_read_b128 v[28:31],v1 offset:44032
MF v[52:55],a[32:35],v[36:39],v[52:55]
MF v[88:91],a[36:39],v[36:39],v[88:91]
ds_read_b128 v[32:35],v1 offset:45056
s_waitcnt lgkmcnt(5)
MF v[56:59],a[32:35],v[40:43],v[56:59]
v_add_f32 v4,v4,v6
v_add_f32 v8,v8,v10
v_add_f32 v4,v4,v8
v_add_f32 v5,v5,v7
v_add_f32 v9,v9,v11
v_add_f32 v5,v5,v9
v_mov_b32 v6,v4
s_nop 1
v_permlane32_swap_b32 v4,v6
v_add_f32 v4,v4,v6
v_mov_b32 v6,v5
s_nop 1
v_permlane32_swap_b32 v5,v6
v_add_f32 v5,v5,v6
v_mul_f32 v4,0xbae38e39,v4
v_mul_f32 v5,0x3ae38e39,v5
v_mul_f32 v6,v4,v4
v_sub_f32 v5,v5,v6
v_max_f32 v5,0,v5
v_add_f32 v5,0x3727c5ac,v5
v_rsq_f32 v5,v5
v_cmp_gt_u32 vcc,32,v0
s_nop 1
v_cndmask_b32 v4,v5,v4,vcc
s_lshl_b32 s30,s22,8
s_add_u32 s30,s30,159744
v_lshlrev_b32 v6,2,v0
v_add_u32 v6,s30,v6
ds_write_b32 v6,v4
MF v[92:95],a[36:39],v[40:43],v[92:95]
ds_read_b128 v[36:39],v1 offset:46080
v_lshlrev_b32 v13,2,v14
v_add_u32 v13,s30,v13
MF v[60:63],a[32:35],v[44:47],v[60:63]
buffer_load_dwordx4 a[84:87],v254,s[8:11],s27 offen offset:2048 sc1
ds_read_b128 v[202:205],v252 offset:0
MF v[96:99],a[36:39],v[44:47],v[96:99]
ds_read_b128 v[40:43],v1 offset:47104
s_waitcnt lgkmcnt(7)
MF v[64:67],a[32:35],v[16:19],v[64:67]
ds_read_b128 v[210:213],v252 offset:128
ds_read_b32 v218,v13 offset:0
MF v[100:103],a[36:39],v[16:19],v[100:103]
ds_read_b128 v[44:47],v1 offset:48128
ds_read_b32 v220,v13 offset:128
MF v[68:71],a[32:35],v[20:23],v[68:71]
ds_read_b128 v[206:209],v252 offset:64
ds_read_b128 v[214:217],v252 offset:192
MF v[104:107],a[36:39],v[20:23],v[104:107]
ds_read_b128 v[16:19],v1 offset:49152
s_waitcnt lgkmcnt(12)
MF v[72:75],a[32:35],v[24:27],v[72:75]
buffer_load_dwordx4 a[88:91],v254,s[8:11],s24 offen offset:3072 sc1
ds_read_b32 v219,v13 offset:64
MF v[108:111],a[36:39],v[24:27],v[108:111]
ds_read_b128 v[20:23],v1 offset:50176
ds_read_b32 v221,v13 offset:192
MF v[76:79],a[32:35],v[28:31],v[76:79]
v_lshlrev_b32 v13,2,v14
v_add_u32 v13,160768,v13
MF v[112:115],a[36:39],v[28:31],v[112:115]
s_waitcnt lgkmcnt(12)
ds_read_b128 v[24:27],v1 offset:51200
MF v[80:83],a[32:35],v[32:35],v[80:83]
ds_read_b32 v192,v13 offset:0
ds_read_b32 v193,v13 offset:64
MF v[116:119],a[36:39],v[32:35],v[116:119]
s_waitcnt lgkmcnt(12)
ds_read_b128 v[28:31],v1 offset:52224
s_waitcnt vmcnt(11)
MF v[48:51],a[40:43],v[36:39],v[48:51]
buffer_load_dwordx4 a[92:95],v254,s[8:11],s27 offen offset:3072 sc1
ds_read_b32 v194,v13 offset:128
MF v[84:87],a[44:47],v[36:39],v[84:87]
ds_read_b128 v[32:35],v1 offset:53248
s_waitcnt lgkmcnt(13)
MF v[52:55],a[40:43],v[40:43],v[52:55]
ds_read_b32 v195,v13 offset:192
ds_read_b32 v196,v13 offset:256
MF v[88:91],a[44:47],v[40:43],v[88:91]
s_waitcnt lgkmcnt(12)
ds_read_b128 v[36:39],v1 offset:54272
MF v[56:59],a[40:43],v[44:47],v[56:59]
ds_read_b32 v197,v13 offset:320
ds_read_b32 v198,v13 offset:384
MF v[92:95],a[44:47],v[44:47],v[92:95]
s_waitcnt lgkmcnt(12)
ds_read_b128 v[40:43],v1 offset:55296
s_add_u32 m0,s49,122880
MF v[60:63],a[40:43],v[16:19],v[60:63]
buffer_load_dwordx4 v254,s[8:11],s20 offen sc1 lds
ds_read_b32 v199,v13 offset:448
MF v[96:99],a[44:47],v[16:19],v[96:99]
ds_read_b128 v[44:47],v1 offset:56320
s_waitcnt lgkmcnt(12)
ds_read_b32 v200,v13 offset:512
MF v[64:67],a[40:43],v[20:23],v[64:67]
MF v[100:103],a[44:47],v[20:23],v[100:103]
ds_read_b128 v[16:19],v1 offset:57344
s_waitcnt lgkmcnt(12)
MF v[68:71],a[40:43],v[24:27],v[68:71]
MF v[104:107],a[44:47],v[24:27],v[104:107]
ds_read_b128 v[20:23],v1 offset:58368
s_add_u32 m0,s49,126976
MF v[72:75],a[40:43],v[28:31],v[72:75]
buffer_load_dwordx4 v255,s[8:11],s20 offen sc1 lds
MF v[108:111],a[44:47],v[28:31],v[108:111]
ds_read_b128 v[24:27],v1 offset:59392
s_waitcnt lgkmcnt(9)
MF v[76:79],a[40:43],v[32:35],v[76:79]
MF v[112:115],a[44:47],v[32:35],v[112:115]
ds_read_b128 v[28:31],v1 offset:60416
MF v[80:83],a[40:43],v[36:39],v[80:83]
MF v[116:119],a[44:47],v[36:39],v[116:119]
ds_read_b128 v[32:35],v1 offset:61440
s_waitcnt vmcnt(12)
s_waitcnt lgkmcnt(6)
s_add_u32 m0,s49,131072
s_add_u32 s20,s48,131072
MF v[48:51],a[48:51],v[40:43],v[48:51]
buffer_load_dwordx4 v1,s[8:11],s20 offen sc1 lds
MF v[84:87],a[52:55],v[40:43],v[84:87]
ds_read_b128 v[36:39],v1 offset:62464
MF v[52:55],a[48:51],v[44:47],v[52:55]
MF v[88:91],a[52:55],v[44:47],v[88:91]
ds_read_b128 v[40:43],v1 offset:63488
s_waitcnt lgkmcnt(5)
MF v[56:59],a[48:51],v[16:19],v[56:59]
MF v[92:95],a[52:55],v[16:19],v[92:95]
ds_read_b128 v[44:47],v1 offset:64512
s_add_u32 m0,s49,135168
MF v[60:63],a[48:51],v[20:23],v[60:63]
buffer_load_dwordx4 v253,s[8:11],s20 offen sc1 lds
MF v[96:99],a[52:55],v[20:23],v[96:99]
ds_read_b128 v[16:19],v2 offset:0
s_waitcnt lgkmcnt(5)
MF v[64:67],a[48:51],v[24:27],v[64:67]
MF v[100:103],a[52:55],v[24:27],v[100:103]
ds_read_b128 v[20:23],v2 offset:1024
MF v[68:71],a[48:51],v[28:31],v[68:71]
MF v[104:107],a[52:55],v[28:31],v[104:107]
ds_read_b128 v[24:27],v2 offset:2048
s_waitcnt lgkmcnt(5)
s_add_u32 m0,s49,139264
MF v[72:75],a[48:51],v[32:35],v[72:75]
buffer_load_dwordx4 v254,s[8:11],s20 offen sc1 lds
MF v[108:111],a[52:55],v[32:35],v[108:111]
ds_read_b128 v[28:31],v2 offset:3072
MF v[76:79],a[48:51],v[36:39],v[76:79]
MF v[112:115],a[52:55],v[36:39],v[112:115]
ds_read_b128 v[32:35],v2 offset:4096
s_waitcnt lgkmcnt(5)
MF v[80:83],a[48:51],v[40:43],v[80:83]
MF v[116:119],a[52:55],v[40:43],v[116:119]
ds_read_b128 v[36:39],v2 offset:5120
s_waitcnt vmcnt(13)
s_add_u32 m0,s49,143360
MF v[48:51],a[56:59],v[44:47],v[48:51]
buffer_load_dwordx4 v255,s[8:11],s20 offen sc1 lds
MF v[84:87],a[60:63],v[44:47],v[84:87]
ds_read_b128 v[40:43],v2 offset:6144
s_waitcnt lgkmcnt(5)
MF v[52:55],a[56:59],v[16:19],v[52:55]
MF v[88:91],a[60:63],v[16:19],v[88:91]
ds_read_b128 v[44:47],v2 offset:7168
MF v[56:59],a[56:59],v[20:23],v[56:59]
MF v[92:95],a[60:63],v[20:23],v[92:95]
s_barrier
ds_read_b128 v[16:19],v2 offset:8192
s_waitcnt lgkmcnt(5)
MF v[60:63],a[56:59],v[24:27],v[60:63]
buffer_load_dwordx4 a[96:99],v255,s[8:11],s24 offen offset:0 sc1
MF v[96:99],a[60:63],v[24:27],v[96:99]
ds_read_b128 v[20:23],v2 offset:9216
MF v[64:67],a[56:59],v[28:31],v[64:67]
MF v[100:103],a[60:63],v[28:31],v[100:103]
ds_read_b128 v[24:27],v2 offset:10240
s_waitcnt lgkmcnt(5)
MF v[68:71],a[56:59],v[32:35],v[68:71]
MF v[104:107],a[60:63],v[32:35],v[104:107]
ds_read_b128 v[28:31],v2 offset:11264
MF v[72:75],a[56:59],v[36:39],v[72:75]
buffer_load_dwordx4 a[100:103],v255,s[8:11],s27 offen offset:0 sc1
MF v[108:111],a[60:63],v[36:39],v[108:111]
ds_read_b128 v[32:35],v2 offset:12288
s_waitcnt lgkmcnt(5)
MF v[76:79],a[56:59],v[40:43],v[76:79]
MF v[112:115],a[60:63],v[40:43],v[112:115]
ds_read_b128 v[36:39],v2 offset:13312
MF v[80:83],a[56:59],v[44:47],v[80:83]
MF v[116:119],a[60:63],v[44:47],v[116:119]
ds_read_b128 v[40:43],v2 offset:14336
s_waitcnt vmcnt(14)
s_waitcnt lgkmcnt(5)
MF v[48:51],a[64:67],v[16:19],v[48:51]
buffer_load_dwordx4 a[104:107],v255,s[8:11],s24 offen offset:1024 sc1
MF v[84:87],a[68:71],v[16:19],v[84:87]
ds_read_b128 v[44:47],v2 offset:15360
MF v[52:55],a[64:67],v[20:23],v[52:55]
MF v[88:91],a[68:71],v[20:23],v[88:91]
ds_read_b128 v[16:19],v2 offset:16384
s_waitcnt lgkmcnt(5)
MF v[56:59],a[64:67],v[24:27],v[56:59]
MF v[92:95],a[68:71],v[24:27],v[92:95]
ds_read_b128 v[20:23],v2 offset:17408
MF v[60:63],a[64:67],v[28:31],v[60:63]
buffer_load_dwordx4 a[108:111],v255,s[8:11],s27 offen offset:1024 sc1
MF v[96:99],a[68:71],v[28:31],v[96:99]
ds_read_b128 v[24:27],v2 offset:18432
s_waitcnt lgkmcnt(5)
MF v[64:67],a[64:67],v[32:35],v[64:67]
MF v[100:103],a[68:71],v[32:35],v[100:103]
ds_read_b128 v[28:31],v2 offset:19456
MF v[68:71],a[64:67],v[36:39],v[68:71]
MF v[104:107],a[68:71],v[36:39],v[104:107]
ds_read_b128 v[32:35],v2 offset:20480
s_waitcnt lgkmcnt(5)
MF v[72:75],a[64:67],v[40:43],v[72:75]
buffer_load_dwordx4 a[112:115],v255,s[8:11],s24 offen offset:2048 sc1
MF v[108:111],a[68:71],v[40:43],v[108:111]
ds_read_b128 v[36:39],v2 offset:21504
MF v[76:79],a[64:67],v[44:47],v[76:79]
MF v[112:115],a[68:71],v[44:47],v[112:115]
ds_read_b128 v[40:43],v2 offset:22528
s_waitcnt lgkmcnt(5)
MF v[80:83],a[64:67],v[16:19],v[80:83]
MF v[116:119],a[68:71],v[16:19],v[116:119]
ds_read_b128 v[44:47],v2 offset:23552
s_waitcnt vmcnt(15)
MF v[48:51],a[72:75],v[20:23],v[48:51]
buffer_load_dwordx4 a[116:119],v255,s[8:11],s27 offen offset:2048 sc1
MF v[84:87],a[76:79],v[20:23],v[84:87]
ds_read_b128 v[16:19],v2 offset:24576
s_waitcnt lgkmcnt(5)
MF v[52:55],a[72:75],v[24:27],v[52:55]
MF v[88:91],a[76:79],v[24:27],v[88:91]
ds_read_b128 v[20:23],v2 offset:25600
MF v[56:59],a[72:75],v[28:31],v[56:59]
MF v[92:95],a[76:79],v[28:31],v[92:95]
ds_read_b128 v[24:27],v2 offset:26624
s_waitcnt lgkmcnt(5)
MF v[60:63],a[72:75],v[32:35],v[60:63]
buffer_load_dwordx4 a[120:123],v255,s[8:11],s24 offen offset:3072 sc1
MF v[96:99],a[76:79],v[32:35],v[96:99]
ds_read_b128 v[28:31],v2 offset:27648
MF v[64:67],a[72:75],v[36:39],v[64:67]
MF v[100:103],a[76:79],v[36:39],v[100:103]
ds_read_b128 v[32:35],v2 offset:28672
s_waitcnt lgkmcnt(5)
MF v[68:71],a[72:75],v[40:43],v[68:71]
MF v[104:107],a[76:79],v[40:43],v[104:107]
ds_read_b128 v[36:39],v2 offset:29696
MF v[72:75],a[72:75],v[44:47],v[72:75]
buffer_load_dwordx4 a[124:127],v255,s[8:11],s27 offen offset:3072 sc1
MF v[108:111],a[76:79],v[44:47],v[108:111]
ds_read_b128 v[40:43],v2 offset:30720
s_waitcnt lgkmcnt(5)
MF v[76:79],a[72:75],v[16:19],v[76:79]
MF v[112:115],a[76:79],v[16:19],v[112:115]
ds_read_b128 v[44:47],v2 offset:31744
MF v[80:83],a[72:75],v[20:23],v[80:83]
MF v[116:119],a[76:79],v[20:23],v[116:119]
ds_read_b128 v[16:19],v2 offset:32768
s_waitcnt vmcnt(16)
s_waitcnt lgkmcnt(5)
s_add_u32 m0,s49,147456
s_add_u32 s20,s48,147456
MF v[48:51],a[80:83],v[24:27],v[48:51]
buffer_load_dwordx4 v1,s[8:11],s20 offen sc1 lds
MF v[84:87],a[84:87],v[24:27],v[84:87]
ds_read_b128 v[20:23],v2 offset:33792
MF v[52:55],a[80:83],v[28:31],v[52:55]
MF v[88:91],a[84:87],v[28:31],v[88:91]
ds_read_b128 v[24:27],v2 offset:34816
s_waitcnt lgkmcnt(5)
MF v[56:59],a[80:83],v[32:35],v[56:59]
MF v[92:95],a[84:87],v[32:35],v[92:95]
ds_read_b128 v[28:31],v2 offset:35840
s_add_u32 m0,s49,151552
MF v[60:63],a[80:83],v[36:39],v[60:63]
buffer_load_dwordx4 v253,s[8:11],s20 offen sc1 lds
MF v[96:99],a[84:87],v[36:39],v[96:99]
ds_read_b128 v[32:35],v2 offset:36864
s_waitcnt lgkmcnt(5)
MF v[64:67],a[80:83],v[40:43],v[64:67]
MF v[100:103],a[84:87],v[40:43],v[100:103]
ds_read_b128 v[36:39],v2 offset:37888
MF v[68:71],a[80:83],v[44:47],v[68:71]
MF v[104:107],a[84:87],v[44:47],v[104:107]
ds_read_b128 v[40:43],v2 offset:38912
s_waitcnt lgkmcnt(5)
s_add_u32 m0,s49,155648
MF v[72:75],a[80:83],v[16:19],v[72:75]
buffer_load_dwordx4 v254,s[8:11],s20 offen sc1 lds
MF v[108:111],a[84:87],v[16:19],v[108:111]
ds_read_b128 v[44:47],v2 offset:39936
MF v[76:79],a[80:83],v[20:23],v[76:79]
MF v[112:115],a[84:87],v[20:23],v[112:115]
ds_read_b128 v[16:19],v2 offset:40960
s_waitcnt lgkmcnt(5)
MF v[80:83],a[80:83],v[24:27],v[80:83]
MF v[116:119],a[84:87],v[24:27],v[116:119]
ds_read_b128 v[20:23],v2 offset:41984
s_waitcnt vmcnt(17)
s_add_u32 m0,s49,0
MF v[48:51],a[88:91],v[28:31],v[48:51]
buffer_load_dwordx4 v255,s[8:11],s20 offen sc1 lds
MF v[84:87],a[92:95],v[28:31],v[84:87]
ds_read_b128 v[24:27],v2 offset:43008
s_waitcnt lgkmcnt(5)
MF v[52:55],a[88:91],v[32:35],v[52:55]
MF v[88:91],a[92:95],v[32:35],v[88:91]
ds_read_b128 v[28:31],v2 offset:44032
MF v[56:59],a[88:91],v[36:39],v[56:59]
MF v[92:95],a[92:95],v[36:39],v[92:95]
s_waitcnt vmcnt(12)
s_barrier
ds_read_b128 v[32:35],v2 offset:45056
s_waitcnt lgkmcnt(5)
s_add_u32 m0,s49,4096
s_add_u32 s20,s48,163840
MF v[60:63],a[88:91],v[40:43],v[60:63]
buffer_load_dwordx4 v1,s[8:11],s20 offen sc1 lds
MF v[96:99],a[92:95],v[40:43],v[96:99]
ds_read_b128 v[36:39],v2 offset:46080
MF v[64:67],a[88:91],v[44:47],v[64:67]
MF v[100:103],a[92:95],v[44:47],v[100:103]
ds_read_b128 v[40:43],v2 offset:47104
s_waitcnt lgkmcnt(5)
MF v[68:71],a[88:91],v[16:19],v[68:71]
MF v[104:107],a[92:95],v[16:19],v[104:107]
ds_read_b128 v[44:47],v2 offset:48128
s_add_u32 m0,s49,8192
MF v[72:75],a[88:91],v[20:23],v[72:75]
buffer_load_dwordx4 v253,s[8:11],s20 offen sc1 lds
MF v[108:111],a[92:95],v[20:23],v[108:111]
ds_read_b128 v[16:19],v2 offset:49152
s_waitcnt lgkmcnt(5)
MF v[76:79],a[88:91],v[24:27],v[76:79]
MF v[112:115],a[92:95],v[24:27],v[112:115]
ds_read_b128 v[20:23],v2 offset:50176
MF v[80:83],a[88:91],v[28:31],v[80:83]
MF v[116:119],a[92:95],v[28:31],v[116:119]
ds_read_b128 v[24:27],v2 offset:51200
s_waitcnt vmcnt(12)
s_waitcnt lgkmcnt(5)
s_add_u32 m0,s49,12288
MF v[48:51],a[96:99],v[32:35],v[48:51]
buffer_load_dwordx4 v254,s[8:11],s20 offen sc1 lds
MF v[84:87],a[100:103],v[32:35],v[84:87]
ds_read_b128 v[28:31],v2 offset:52224
MF v[52:55],a[96:99],v[36:39],v[52:55]
MF v[88:91],a[100:103],v[36:39],v[88:91]
ds_read_b128 v[32:35],v2 offset:53248
s_waitcnt lgkmcnt(5)
MF v[56:59],a[96:99],v[40:43],v[56:59]
MF v[92:95],a[100:103],v[40:43],v[92:95]
ds_read_b128 v[36:39],v2 offset:54272
s_add_u32 m0,s49,16384
MF v[60:63],a[96:99],v[44:47],v[60:63]
buffer_load_dwordx4 v255,s[8:11],s20 offen sc1 lds
MF v[96:99],a[100:103],v[44:47],v[96:99]
ds_read_b128 v[40:43],v2 offset:55296
s_waitcnt lgkmcnt(5)
MF v[64:67],a[96:99],v[16:19],v[64:67]
MF v[100:103],a[100:103],v[16:19],v[100:103]
ds_read_b128 v[44:47],v2 offset:56320
MF v[68:71],a[96:99],v[20:23],v[68:71]
MF v[104:107],a[100:103],v[20:23],v[104:107]
ds_read_b128 v[16:19],v2 offset:57344
s_waitcnt lgkmcnt(5)
s_add_u32 m0,s49,20480
s_add_u32 s20,s48,180224
MF v[72:75],a[96:99],v[24:27],v[72:75]
buffer_load_dwordx4 v1,s[8:11],s20 offen sc1 lds
MF v[108:111],a[100:103],v[24:27],v[108:111]
ds_read_b128 v[20:23],v2 offset:58368
MF v[76:79],a[96:99],v[28:31],v[76:79]
MF v[112:115],a[100:103],v[28:31],v[112:115]
ds_read_b128 v[24:27],v2 offset:59392
s_waitcnt lgkmcnt(5)
MF v[80:83],a[96:99],v[32:35],v[80:83]
MF v[116:119],a[100:103],v[32:35],v[116:119]
ds_read_b128 v[28:31],v2 offset:60416
s_waitcnt vmcnt(13)
MF v[48:51],a[104:107],v[36:39],v[48:51]
buffer_load_dwordx4 a[128:131],v1,s[8:11],s29 offen offset:0 sc1
MF v[84:87],a[108:111],v[36:39],v[84:87]
ds_read_b128 v[32:35],v2 offset:61440
s_waitcnt lgkmcnt(5)
MF v[52:55],a[104:107],v[40:43],v[52:55]
MF v[88:91],a[108:111],v[40:43],v[88:91]
ds_read_b128 v[36:39],v2 offset:62464
MF v[56:59],a[104:107],v[44:47],v[56:59]
MF v[92:95],a[108:111],v[44:47],v[92:95]
ds_read_b128 v[40:43],v2 offset:63488
s_waitcnt lgkmcnt(5)
MF v[60:63],a[104:107],v[16:19],v[60:63]
buffer_load_dwordx4 a[132:135],v1,s[8:11],s21 offen offset:0 sc1
MF v[96:99],a[108:111],v[16:19],v[96:99]
ds_read_b128 v[44:47],v2 offset:64512
MF v[64:67],a[104:107],v[20:23],v[64:67]
MF v[100:103],a[108:111],v[20:23],v[100:103]
ds_read_b128 v[16:19],v3 offset:0
s_waitcnt lgkmcnt(5)
MF v[68:71],a[104:107],v[24:27],v[68:71]
MF v[104:107],a[108:111],v[24:27],v[104:107]
ds_read_b128 v[20:23],v3 offset:1024
MF v[72:75],a[104:107],v[28:31],v[72:75]
buffer_load_dwordx4 a[136:139],v1,s[8:11],s29 offen offset:1024 sc1
MF v[108:111],a[108:111],v[28:31],v[108:111]
ds_read_b128 v[24:27],v3 offset:2048
s_waitcnt lgkmcnt(5)
MF v[76:79],a[104:107],v[32:35],v[76:79]
MF v[112:115],a[108:111],v[32:35],v[112:115]
ds_read_b128 v[28:31],v3 offset:3072
MF v[80:83],a[104:107],v[36:39],v[80:83]
MF v[116:119],a[108:111],v[36:39],v[116:119]
ds_read_b128 v[32:35],v3 offset:4096
s_waitcnt vmcnt(14)
s_waitcnt lgkmcnt(5)
MF v[48:51],a[112:115],v[40:43],v[48:51]
buffer_load_dwordx4 a[140:143],v1,s[8:11],s21 offen offset:1024 sc1
MF v[84:87],a[116:119],v[40:43],v[84:87]
ds_read_b128 v[36:39],v3 offset:5120
MF v[52:55],a[112:115],v[44:47],v[52:55]
MF v[88:91],a[116:119],v[44:47],v[88:91]
ds_read_b128 v[40:43],v3 offset:6144
s_waitcnt lgkmcnt(5)
MF v[56:59],a[112:115],v[16:19],v[56:59]
MF v[92:95],a[116:119],v[16:19],v[92:95]
ds_read_b128 v[44:47],v3 offset:7168
s_add_u32 m0,s49,24576
MF v[60:63],a[112:115],v[20:23],v[60:63]
buffer_load_dwordx4 v253,s[8:11],s20 offen sc1 lds
MF v[96:99],a[116:119],v[20:23],v[96:99]
ds_read_b128 v[16:19],v3 offset:8192
s_waitcnt lgkmcnt(5)
MF v[64:67],a[112:115],v[24:27],v[64:67]
MF v[100:103],a[116:119],v[24:27],v[100:103]
ds_read_b128 v[20:23],v3 offset:9216
MF v[68:71],a[112:115],v[28:31],v[68:71]
MF v[104:107],a[116:119],v[28:31],v[104:107]
ds_read_b128 v[24:27],v3 offset:10240
s_waitcnt lgkmcnt(5)
s_add_u32 m0,s49,28672
MF v[72:75],a[112:115],v[32:35],v[72:75]
buffer_load_dwordx4 v254,s[8:11],s20 offen sc1 lds
MF v[108:111],a[116:119],v[32:35],v[108:111]
ds_read_b128 v[28:31],v3 offset:11264
MF v[76:79],a[112:115],v[36:39],v[76:79]
MF v[112:115],a[116:119],v[36:39],v[112:115]
ds_read_b128 v[32:35],v3 offset:12288
s_waitcnt lgkmcnt(5)
MF v[80:83],a[112:115],v[40:43],v[80:83]
MF v[116:119],a[116:119],v[40:43],v[116:119]
ds_read_b128 v[36:39],v3 offset:13312
s_waitcnt vmcnt(15)
s_add_u32 m0,s49,32768
MF v[48:51],a[120:123],v[44:47],v[48:51]
buffer_load_dwordx4 v255,s[8:11],s20 offen sc1 lds
MF v[84:87],a[124:127],v[44:47],v[84:87]
ds_read_b128 v[40:43],v3 offset:14336
s_waitcnt lgkmcnt(5)
MF v[52:55],a[120:123],v[16:19],v[52:55]
MF v[88:91],a[124:127],v[16:19],v[88:91]
ds_read_b128 v[44:47],v3 offset:15360
MF v[56:59],a[120:123],v[20:23],v[56:59]
MF v[92:95],a[124:127],v[20:23],v[92:95]
s_waitcnt vmcnt(7)
s_barrier
ds_read_b128 v[16:19],v3 offset:16384
s_waitcnt lgkmcnt(5)
s_add_u32 m0,s49,36864
s_add_u32 s20,s48,196608
MF v[60:63],a[120:123],v[24:27],v[60:63]
buffer_load_dwordx4 v1,s[8:11],s20 offen sc1 lds
MF v[96:99],a[124:127],v[24:27],v[96:99]
ds_read_b128 v[20:23],v3 offset:17408
MF v[64:67],a[120:123],v[28:31],v[64:67]
MF v[100:103],a[124:127],v[28:31],v[100:103]
ds_read_b128 v[24:27],v3 offset:18432
s_waitcnt lgkmcnt(5)
MF v[68:71],a[120:123],v[32:35],v[68:71]
MF v[104:107],a[124:127],v[32:35],v[104:107]
ds_read_b128 v[28:31],v3 offset:19456
s_add_u32 m0,s49,40960
MF v[72:75],a[120:123],v[36:39],v[72:75]
buffer_load_dwordx4 v253,s[8:11],s20 offen sc1 lds
MF v[108:111],a[124:127],v[36:39],v[108:111]
ds_read_b128 v[32:35],v3 offset:20480
s_waitcnt lgkmcnt(5)
MF v[76:79],a[120:123],v[40:43],v[76:79]
MF v[112:115],a[124:127],v[40:43],v[112:115]
ds_read_b128 v[36:39],v3 offset:21504
MF v[80:83],a[120:123],v[44:47],v[80:83]
MF v[116:119],a[124:127],v[44:47],v[116:119]
ds_read_b128 v[40:43],v3 offset:22528
s_waitcnt vmcnt(7)
s_waitcnt lgkmcnt(5)
s_add_u32 m0,s49,45056
MF v[48:51],a[128:131],v[16:19],v[48:51]
buffer_load_dwordx4 v254,s[8:11],s20 offen sc1 lds
MF v[84:87],a[132:135],v[16:19],v[84:87]
ds_read_b128 v[44:47],v3 offset:23552
MF v[52:55],a[128:131],v[20:23],v[52:55]
MF v[88:91],a[132:135],v[20:23],v[88:91]
ds_read_b128 v[16:19],v3 offset:24576
s_waitcnt lgkmcnt(5)
MF v[56:59],a[128:131],v[24:27],v[56:59]
MF v[92:95],a[132:135],v[24:27],v[92:95]
ds_read_b128 v[20:23],v3 offset:25600
s_add_u32 m0,s49,49152
MF v[60:63],a[128:131],v[28:31],v[60:63]
buffer_load_dwordx4 v255,s[8:11],s20 offen sc1 lds
MF v[96:99],a[132:135],v[28:31],v[96:99]
ds_read_b128 v[24:27],v3 offset:26624
s_waitcnt lgkmcnt(5)
MF v[64:67],a[128:131],v[32:35],v[64:67]
MF v[100:103],a[132:135],v[32:35],v[100:103]
ds_read_b128 v[28:31],v3 offset:27648
MF v[68:71],a[128:131],v[36:39],v[68:71]
MF v[104:107],a[132:135],v[36:39],v[104:107]
ds_read_b128 v[32:35],v1 offset:0
s_waitcnt lgkmcnt(5)
s_add_u32 m0,s49,53248
s_add_u32 s20,s48,212992
MF v[72:75],a[128:131],v[40:43],v[72:75]
buffer_load_dwordx4 v1,s[8:11],s20 offen sc1 lds
MF v[108:111],a[132:135],v[40:43],v[108:111]
ds_read_b128 v[36:39],v1 offset:1024
MF v[76:79],a[128:131],v[44:47],v[76:79]
MF v[112:115],a[132:135],v[44:47],v[112:115]
ds_read_b128 v[40:43],v1 offset:2048
s_waitcnt lgkmcnt(5)
MF v[80:83],a[128:131],v[16:19],v[80:83]
MF v[116:119],a[132:135],v[16:19],v[116:119]
ds_read_b128 v[44:47],v1 offset:3072
s_waitcnt vmcnt(8)
s_add_u32 m0,s49,57344
MF v[48:51],a[136:139],v[20:23],v[48:51]
buffer_load_dwordx4 v253,s[8:11],s20 offen sc1 lds
MF v[84:87],a[140:143],v[20:23],v[84:87]
ds_read_b128 v[16:19],v1 offset:4096
s_waitcnt lgkmcnt(5)
MF v[52:55],a[136:139],v[24:27],v[52:55]
MF v[88:91],a[140:143],v[24:27],v[88:91]
ds_read_b128 v[20:23],v1 offset:5120
MF v[56:59],a[136:139],v[28:31],v[56:59]
MF v[92:95],a[140:143],v[28:31],v[92:95]
ds_read_b128 v[24:27],v1 offset:6144
s_waitcnt lgkmcnt(5)
s_add_u32 m0,s49,61440
MF v[60:63],a[136:139],v[32:35],v[60:63]
buffer_load_dwordx4 v254,s[8:11],s20 offen sc1 lds
MF v[96:99],a[140:143],v[32:35],v[96:99]
ds_read_b128 v[28:31],v1 offset:7168
MF v[64:67],a[136:139],v[36:39],v[64:67]
MF v[100:103],a[140:143],v[36:39],v[100:103]
ds_read_b128 v[32:35],v1 offset:8192
s_waitcnt lgkmcnt(5)
MF v[68:71],a[136:139],v[40:43],v[68:71]
MF v[104:107],a[140:143],v[40:43],v[104:107]
ds_read_b128 v[36:39],v1 offset:9216
s_add_u32 m0,s49,65536
MF v[72:75],a[136:139],v[44:47],v[72:75]
buffer_load_dwordx4 v255,s[8:11],s20 offen sc1 lds
MF v[108:111],a[140:143],v[44:47],v[108:111]
ds_read_b128 v[40:43],v1 offset:10240
s_waitcnt lgkmcnt(5)
MF v[76:79],a[136:139],v[16:19],v[76:79]
MF v[112:115],a[140:143],v[16:19],v[112:115]
ds_read_b128 v[44:47],v1 offset:11264
MF v[80:83],a[136:139],v[20:23],v[80:83]
MF v[116:119],a[140:143],v[20:23],v[116:119]
s_waitcnt lgkmcnt(0)
s_nop 7
v_pk_fma_f32 v[48:49],v[202:203],v[192:193],v[48:49] op_sel_hi:[1,0,1]
v_pk_fma_f32 v[50:51],v[204:205],v[192:193],v[50:51] op_sel_hi:[1,0,1]
v_pk_fma_f32 v[84:85],v[206:207],v[192:193],v[84:85] op_sel_hi:[1,0,1]
v_pk_mul_f32 v[48:49],v[48:49],v[210:211]
v_pk_mul_f32 v[50:51],v[50:51],v[212:213]
v_pk_mul_f32 v[84:85],v[84:85],v[214:215]
v_pk_mul_f32 v[240:241],v[48:49],v[48:49]
v_pk_mul_f32 v[242:243],v[50:51],v[50:51]
v_pk_mul_f32 v[244:245],v[84:85],v[84:85]
v_pk_fma_f32 v[240:241],v[240:241],v[248:249],v[248:249] op_sel:[0,0,1] op_sel_hi:[1,0,1]
v_pk_fma_f32 v[242:243],v[242:243],v[248:249],v[248:249] op_sel:[0,0,1] op_sel_hi:[1,0,1]
v_pk_fma_f32 v[244:245],v[244:245],v[248:249],v[248:249] op_sel:[0,0,1] op_sel_hi:[1,0,1]
v_pk_mul_f32 v[240:241],v[240:241],v[48:49]
v_pk_mul_f32 v[242:243],v[242:243],v[50:51]
v_pk_mul_f32 v[244:245],v[244:245],v[84:85]
v_exp_f32 v240,v240
v_pk_fma_f32 v[86:87],v[208:209],v[192:193],v[86:87] op_sel_hi:[1,0,1]
v_exp_f32 v242,v242
v_pk_fma_f32 v[52:53],v[202:203],v[192:193],v[52:53] op_sel:[0,1,0]
v_exp_f32 v241,v241
v_pk_mul_f32 v[86:87],v[86:87],v[216:217]
v_exp_f32 v243,v243
v_pk_add_f32 v[240:241],v[240:241],v[250:251] op_sel_hi:[1,0]
v_exp_f32 v244,v244
v_pk_add_f32 v[242:243],v[242:243],v[250:251] op_sel_hi:[1,0]
v_rcp_f32 v240,v240
s_add_u32 m0,s49,69632
s_add_u32 s20,s48,229376
buffer_load_dwordx4 v1,s[8:11],s20 offen sc1 lds
v_pk_mul_f32 v[246:247],v[86:87],v[86:87]
v_rcp_f32 v242,v242
v_pk_mul_f32 v[52:53],v[52:53],v[210:211]
v_rcp_f32 v241,v241
v_pk_fma_f32 v[246:247],v[246:247],v[248:249],v[248:249] op_sel:[0,0,1] op_sel_hi:[1,0,1]
v_rcp_f32 v243,v243
v_pk_mul_f32 v[48:49],v[48:49],v[240:241]
v_exp_f32 v245,v245
v_pk_mul_f32 v[50:51],v[50:51],v[242:243]
v_pk_add_f32 v[224:225],v[224:225],v[48:49]
v_pk_add_f32 v[244:245],v[244:245],v[250:251] op_sel_hi:[1,0]
v_pk_add_f32 v[226:227],v[226:227],v[50:51]
v_pk_fma_f32 v[232:233],v[48:49],v[48:49],v[232:233]
v_rcp_f32 v244,v244
v_pk_fma_f32 v[234:235],v[50:51],v[50:51],v[234:235]
v_pk_mul_f32 v[246:247],v[246:247],v[86:87]
v_rcp_f32 v245,v245
v_pk_mul_f32 v[4:5],v[52:53],v[52:53]
v_exp_f32 v246,v246
v_pk_mul_f32 v[84:85],v[84:85],v[244:245]
v_pk_fma_f32 v[4:5],v[4:5],v[248:249],v[248:249] op_sel:[0,0,1] op_sel_hi:[1,0,1]
v_exp_f32 v247,v247
v_pk_add_f32 v[228:229],v[228:229],v[84:85]
v_pk_mul_f32 v[4:5],v[4:5],v[52:53]
v_pk_add_f32 v[246:247],v[246:247],v[250:251] op_sel_hi:[1,0]
v_pk_fma_f32 v[236:237],v[84:85],v[84:85],v[236:237]
s_add_u32 m0,s49,73728
s_nop 0
buffer_load_dwordx4 v253,s[8:11],s20 offen sc1 lds
v_exp_f32 v4,v4
v_pk_fma_f32 v[54:55],v[204:205],v[192:193],v[54:55] op_sel:[0,1,0]
v_rcp_f32 v246,v246
v_pk_fma_f32 v[88:89],v[206:207],v[192:193],v[88:89] op_sel:[0,1,0]
v_exp_f32 v5,v5
v_pk_mul_f32 v[54:55],v[54:55],v[212:213]
v_rcp_f32 v247,v247
v_pk_add_f32 v[4:5],v[4:5],v[250:251] op_sel_hi:[1,0]
v_pk_mul_f32 v[6:7],v[54:55],v[54:55]
v_pk_mul_f32 v[86:87],v[86:87],v[246:247]
v_rcp_f32 v4,v4
v_pk_fma_f32 v[6:7],v[6:7],v[248:249],v[248:249] op_sel:[0,0,1] op_sel_hi:[1,0,1]
v_pk_add_f32 v[230:231],v[230:231],v[86:87]
v_rcp_f32 v5,v5
v_pk_mul_f32 v[6:7],v[6:7],v[54:55]
v_pk_fma_f32 v[238:239],v[86:87],v[86:87],v[238:239]
v_pk_mul_f32 v[52:53],v[52:53],v[4:5]
v_exp_f32 v6,v6
v_pk_mul_f32 v[88:89],v[88:89],v[214:215]
v_pk_add_f32 v[224:225],v[224:225],v[52:53]
v_exp_f32 v7,v7
v_pk_mul_f32 v[8:9],v[88:89],v[88:89]
v_pk_fma_f32 v[232:233],v[52:53],v[52:53],v[232:233]
v_pk_add_f32 v[6:7],v[6:7],v[250:251] op_sel_hi:[1,0]
v_pk_fma_f32 v[8:9],v[8:9],v[248:249],v[248:249] op_sel:[0,0,1] op_sel_hi:[1,0,1]
v_pk_fma_f32 v[90:91],v[208:209],v[192:193],v[90:91] op_sel:[0,1,0]
s_add_u32 m0,s49,77824
s_nop 0
buffer_load_dwordx4 v254,s[8:11],s20 offen sc1 lds
v_rcp_f32 v6,v6
v_pk_mul_f32 v[8:9],v[8:9],v[88:89]
v_pk_mul_f32 v[90:91],v[90:91],v[216:217]
v_rcp_f32 v7,v7
v_pk_fma_f32 v[56:57],v[202:203],v[194:195],v[56:57] op_sel_hi:[1,0,1]
v_exp_f32 v8,v8
v_pk_mul_f32 v[54:55],v[54:55],v[6:7]
v_pk_mul_f32 v[10:11],v[90:91],v[90:91]
v_exp_f32 v9,v9
v_pk_add_f32 v[226:227],v[226:227],v[54:55]
v_pk_fma_f32 v[10:11],v[10:11],v[248:249],v[248:249] op_sel:[0,0,1] op_sel_hi:[1,0,1]
v_pk_add_f32 v[8:9],v[8:9],v[250:251] op_sel_hi:[1,0]
v_pk_fma_f32 v[234:235],v[54:55],v[54:55],v[234:235]
v_pk_mul_f32 v[10:11],v[10:11],v[90:91]
v_rcp_f32 v8,v8
v_pk_mul_f32 v[56:57],v[56:57],v[210:211]
v_exp_f32 v10,v10
v_pk_fma_f32 v[58:59],v[204:205],v[194:195],v[58:59] op_sel_hi:[1,0,1]
v_rcp_f32 v9,v9
v_pk_mul_f32 v[240:241],v[56:57],v[56:57]
v_exp_f32 v11,v11
v_pk_mul_f32 v[88:89],v[88:89],v[8:9]
v_pk_fma_f32 v[240:241],v[240:241],v[248:249],v[248:249] op_sel:[0,0,1] op_sel_hi:[1,0,1]
v_pk_add_f32 v[10:11],v[10:11],v[250:251] op_sel_hi:[1,0]
v_pk_add_f32 v[228:229],v[228:229],v[88:89]
v_pk_mul_f32 v[240:241],v[240:241],v[56:57]
s_add_u32 m0,s49,81920
s_nop 0
buffer_load_dwordx4 v255,s[8:11],s20 offen sc1 lds
v_rcp_f32 v10,v10
v_pk_fma_f32 v[236:237],v[88:89],v[88:89],v[236:237]
v_exp_f32 v240,v240
v_pk_mul_f32 v[58:59],v[58:59],v[212:213]
v_rcp_f32 v11,v11
v_pk_fma_f32 v[92:93],v[206:207],v[194:195],v[92:93] op_sel_hi:[1,0,1]
v_exp_f32 v241,v241
v_pk_mul_f32 v[90:91],v[90:91],v[10:11]
v_pk_mul_f32 v[242:243],v[58:59],v[58:59]
v_pk_add_f32 v[240:241],v[240:241],v[250:251] op_sel_hi:[1,0]
v_pk_add_f32 v[230:231],v[230:231],v[90:91]
v_pk_fma_f32 v[242:243],v[242:243],v[248:249],v[248:249] op_sel:[0,0,1] op_sel_hi:[1,0,1]
v_rcp_f32 v240,v240
v_pk_fma_f32 v[238:239],v[90:91],v[90:91],v[238:239]
v_pk_mul_f32 v[242:243],v[242:243],v[58:59]
v_rcp_f32 v241,v241
v_pk_mul_f32 v[92:93],v[92:93],v[214:215]
v_exp_f32 v242,v242
v_pk_mul_f32 v[56:57],v[56:57],v[240:241]
v_pk_mul_f32 v[244:245],v[92:93],v[92:93]
v_exp_f32 v243,v243
v_pk_add_f32 v[224:225],v[224:225],v[56:57]
v_pk_fma_f32 v[244:245],v[244:245],v[248:249],v[248:249] op_sel:[0,0,1] op_sel_hi:[1,0,1]
v_pk_add_f32 v[242:243],v[242:243],v[250:251] op_sel_hi:[1,0]
v_pk_fma_f32 v[232:233],v[56:57],v[56:57],v[232:233]
v_pk_mul_f32 v[244:245],v[244:245],v[92:93]
s_add_u32 m0,s49,86016
s_add_u32 s20,s48,245760
buffer_load_dwordx4 v1,s[8:11],s20 offen sc1 lds
v_rcp_f32 v242,v242
v_pk_fma_f32 v[94:95],v[208:209],v[194:195],v[94:95] op_sel_hi:[1,0,1]
v_exp_f32 v244,v244
v_pk_fma_f32 v[60:61],v[202:203],v[194:195],v[60:61] op_sel:[0,1,0]
v_rcp_f32 v243,v243
v_pk_mul_f32 v[94:95],v[94:95],v[216:217]
v_exp_f32 v245,v245
v_pk_mul_f32 v[58:59],v[58:59],v[242:243]
v_pk_mul_f32 v[246:247],v[94:95],v[94:95]
v_pk_add_f32 v[244:245],v[244:245],v[250:251] op_sel_hi:[1,0]
v_pk_add_f32 v[226:227],v[226:227],v[58:59]
v_pk_fma_f32 v[246:247],v[246:247],v[248:249],v[248:249] op_sel:[0,0,1] op_sel_hi:[1,0,1]
v_rcp_f32 v244,v244
v_pk_fma_f32 v[234:235],v[58:59],v[58:59],v[234:235]
v_pk_mul_f32 v[246:247],v[246:247],v[94:95]
v_rcp_f32 v245,v245
v_pk_mul_f32 v[60:61],v[60:61],v[210:211]
v_exp_f32 v246,v246
v_pk_mul_f32 v[92:93],v[92:93],v[244:245]
v_pk_mul_f32 v[4:5],v[60:61],v[60:61]
v_exp_f32 v247,v247
v_pk_add_f32 v[228:229],v[228:229],v[92:93]
v_pk_fma_f32 v[4:5],v[4:5],v[248:249],v[248:249] op_sel:[0,0,1] op_sel_hi:[1,0,1]
v_pk_add_f32 v[246:247],v[246:247],v[250:251] op_sel_hi:[1,0]
v_pk_fma_f32 v[236:237],v[92:93],v[92:93],v[236:237]
v_pk_mul_f32 v[4:5],v[4:5],v[60:61]
s_add_u32 m0,s49,90112
s_nop 0
buffer_load_dwordx4 v253,s[8:11],s20 offen sc1 lds
v_rcp_f32 v246,v246
v_pk_fma_f32 v[62:63],v[204:205],v[194:195],v[62:63] op_sel:[0,1,0]
v_exp_f32 v4,v4
v_pk_fma_f32 v[96:97],v[206:207],v[194:195],v[96:97] op_sel:[0,1,0]
v_rcp_f32 v247,v247
v_pk_mul_f32 v[62:63],v[62:63],v[212:213]
v_exp_f32 v5,v5
v_pk_mul_f32 v[94:95],v[94:95],v[246:247]
v_pk_mul_f32 v[6:7],v[62:63],v[62:63]
v_pk_add_f32 v[4:5],v[4:5],v[250:251] op_sel_hi:[1,0]
v_pk_add_f32 v[230:231],v[230:231],v[94:95]
v_pk_fma_f32 v[6:7],v[6:7],v[248:249],v[248:249] op_sel:[0,0,1] op_sel_hi:[1,0,1]
v_rcp_f32 v4,v4
v_pk_fma_f32 v[238:239],v[94:95],v[94:95],v[238:239]
v_pk_mul_f32 v[6:7],v[6:7],v[62:63]
v_rcp_f32 v5,v5
v_pk_mul_f32 v[96:97],v[96:97],v[214:215]
v_exp_f32 v6,v6
v_pk_mul_f32 v[60:61],v[60:61],v[4:5]
v_pk_mul_f32 v[8:9],v[96:97],v[96:97]
v_exp_f32 v7,v7
v_pk_add_f32 v[224:225],v[224:225],v[60:61]
v_pk_fma_f32 v[8:9],v[8:9],v[248:249],v[248:249] op_sel:[0,0,1] op_sel_hi:[1,0,1]
v_pk_add_f32 v[6:7],v[6:7],v[250:251] op_sel_hi:[1,0]
v_pk_fma_f32 v[232:233],v[60:61],v[60:61],v[232:233]
v_pk_mul_f32 v[8:9],v[8:9],v[96:97]
s_add_u32 m0,s49,94208
s_nop 0
buffer_load_dwordx4 v254,s[8:11],s20 offen sc1 lds
v_rcp_f32 v6,v6
v_pk_fma_f32 v[98:99],v[208:209],v[194:195],v[98:99] op_sel:[0,1,0]
v_exp_f32 v8,v8
v_pk_fma_f32 v[64:65],v[202:203],v[196:197],v[64:65] op_sel_hi:[1,0,1]
v_rcp_f32 v7,v7
v_pk_mul_f32 v[98:99],v[98:99],v[216:217]
v_exp_f32 v9,v9
v_pk_mul_f32 v[62:63],v[62:63],v[6:7]
v_pk_mul_f32 v[10:11],v[98:99],v[98:99]
v_pk_add_f32 v[8:9],v[8:9],v[250:251] op_sel_hi:[1,0]
v_pk_add_f32 v[226:227],v[226:227],v[62:63]
v_pk_fma_f32 v[10:11],v[10:11],v[248:249],v[248:249] op_sel:[0,0,1] op_sel_hi:[1,0,1]
v_rcp_f32 v8,v8
v_pk_fma_f32 v[234:235],v[62:63],v[62:63],v[234:235]
v_pk_mul_f32 v[10:11],v[10:11],v[98:99]
v_rcp_f32 v9,v9
v_pk_mul_f32 v[64:65],v[64:65],v[210:211]
v_exp_f32 v10,v10
v_pk_mul_f32 v[96:97],v[96:97],v[8:9]
v_pk_mul_f32 v[240:241],v[64:65],v[64:65]
v_exp_f32 v11,v11
v_pk_add_f32 v[228:229],v[228:229],v[96:97]
v_pk_fma_f32 v[240:241],v[240:241],v[248:249],v[248:249] op_sel:[0,0,1] op_sel_hi:[1,0,1]
v_pk_add_f32 v[10:11],v[10:11],v[250:251] op_sel_hi:[1,0]
v_pk_fma_f32 v[236:237],v[96:97],v[96:97],v[236:237]
v_pk_mul_f32 v[240:241],v[240:241],v[64:65]
s_add_u32 m0,s49,98304
s_nop 0
buffer_load_dwordx4 v255,s[8:11],s20 offen sc1 lds
v_rcp_f32 v10,v10
v_pk_fma_f32 v[66:67],v[204:205],v[196:197],v[66:67] op_sel_hi:[1,0,1]
v_exp_f32 v240,v240
v_pk_fma_f32 v[100:101],v[206:207],v[196:197],v[100:101] op_sel_hi:[1,0,1]
v_rcp_f32 v11,v11
v_pk_mul_f32 v[66:67],v[66:67],v[212:213]
v_exp_f32 v241,v241
v_pk_mul_f32 v[98:99],v[98:99],v[10:11]
v_pk_mul_f32 v[242:243],v[66:67],v[66:67]
v_pk_add_f32 v[240:241],v[240:241],v[250:251] op_sel_hi:[1,0]
v_pk_add_f32 v[230:231],v[230:231],v[98:99]
v_pk_fma_f32 v[242:243],v[242:243],v[248:249],v[248:249] op_sel:[0,0,1] op_sel_hi:[1,0,1]
v_rcp_f32 v240,v240
v_pk_fma_f32 v[238:239],v[98:99],v[98:99],v[238:239]
v_pk_mul_f32 v[242:243],v[242:243],v[66:67]
v_rcp_f32 v241,v241
v_pk_mul_f32 v[100:101],v[100:101],v[214:215]
v_exp_f32 v242,v242
v_pk_mul_f32 v[64:65],v[64:65],v[240:241]
v_pk_mul_f32 v[244:245],v[100:101],v[100:101]
v_exp_f32 v243,v243
v_pk_add_f32 v[224:225],v[224:225],v[64:65]
v_pk_fma_f32 v[244:245],v[244:245],v[248:249],v[248:249] op_sel:[0,0,1] op_sel_hi:[1,0,1]
v_pk_add_f32 v[242:243],v[242:243],v[250:251] op_sel_hi:[1,0]
v_pk_fma_f32 v[232:233],v[64:65],v[64:65],v[232:233]
v_pk_mul_f32 v[244:245],v[244:245],v[100:101]
s_add_u32 m0,s49,102400
s_add_u32 s20,s48,262144
buffer_load_dwordx4 v1,s[8:11],s20 offen sc1 lds
v_rcp_f32 v242,v242
v_pk_fma_f32 v[102:103],v[208:209],v[196:197],v[102:103] op_sel_hi:[1,0,1]
v_exp_f32 v244,v244
v_pk_fma_f32 v[68:69],v[202:203],v[196:197],v[68:69] op_sel:[0,1,0]
v_rcp_f32 v243,v243
v_pk_mul_f32 v[102:103],v[102:103],v[216:217]
v_exp_f32 v245,v245
v_pk_mul_f32 v[66:67],v[66:67],v[242:243]
v_pk_mul_f32 v[246:247],v[102:103],v[102:103]
v_pk_add_f32 v[244:245],v[244:245],v[250:251] op_sel_hi:[1,0]
v_pk_add_f32 v[226:227],v[226:227],v[66:67]
v_pk_fma_f32 v[246:247],v[246:247],v[248:249],v[248:249] op_sel:[0,0,1] op_sel_hi:[1,0,1]
v_rcp_f32 v244,v244
v_pk_fma_f32 v[234:235],v[66:67],v[66:67],v[234:235]
v_pk_mul_f32 v[246:247],v[246:247],v[102:103]
v_rcp_f32 v245,v245
v_pk_mul_f32 v[68:69],v[68:69],v[210:211]
v_exp_f32 v246,v246
v_pk_mul_f32 v[100:101],v[100:101],v[244:245]
v_pk_mul_f32 v[4:5],v[68:69],v[68:69]
v_exp_f32 v247,v247
v_pk_add_f32 v[228:229],v[228:229],v[100:101]
v_pk_fma_f32 v[4:5],v[4:5],v[248:249],v[248:249] op_sel:[0,0,1] op_sel_hi:[1,0,1]
v_pk_add_f32 v[246:247],v[246:247],v[250:251] op_sel_hi:[1,0]
v_pk_fma_f32 v[236:237],v[100:101],v[100:101],v[236:237]
v_pk_mul_f32 v[4:5],v[4:5],v[68:69]
s_add_u32 m0,s49,106496
s_nop 0
buffer_load_dwordx4 v253,s[8:11],s20 offen sc1 lds
v_rcp_f32 v246,v246
v_pk_fma_f32 v[70:71],v[204:205],v[196:197],v[70:71] op_sel:[0,1,0]
v_exp_f32 v4,v4
v_pk_fma_f32 v[104:105],v[206:207],v[196:197],v[104:105] op_sel:[0,1,0]
v_rcp_f32 v247,v247
v_pk_mul_f32 v[70:71],v[70:71],v[212:213]
v_exp_f32 v5,v5
v_pk_mul_f32 v[102:103],v[102:103],v[246:247]
v_pk_mul_f32 v[6:7],v[70:71],v[70:71]
v_pk_add_f32 v[4:5],v[4:5],v[250:251] op_sel_hi:[1,0]
v_pk_add_f32 v[230:231],v[230:231],v[102:103]
v_pk_fma_f32 v[6:7],v[6:7],v[248:249],v[248:249] op_sel:[0,0,1] op_sel_hi:[1,0,1]
v_rcp_f32 v4,v4
v_pk_fma_f32 v[238:239],v[102:103],v[102:103],v[238:239]
v_pk_mul_f32 v[6:7],v[6:7],v[70:71]
v_rcp_f32 v5,v5
v_pk_mul_f32 v[104:105],v[104:105],v[214:215]
v_exp_f32 v6,v6
v_pk_mul_f32 v[68:69],v[68:69],v[4:5]
v_pk_mul_f32 v[8:9],v[104:105],v[104:105]
v_exp_f32 v7,v7
v_pk_add_f32 v[224:225],v[224:225],v[68:69]
v_pk_fma_f32 v[8:9],v[8:9],v[248:249],v[248:249] op_sel:[0,0,1] op_sel_hi:[1,0,1]
v_pk_add_f32 v[6:7],v[6:7],v[250:251] op_sel_hi:[1,0]
v_pk_fma_f32 v[232:233],v[68:69],v[68:69],v[232:233]
v_pk_mul_f32 v[8:9],v[8:9],v[104:105]
s_add_u32 m0,s49,110592
s_nop 0
buffer_load_dwordx4 v254,s[8:11],s20 offen sc1 lds
v_rcp_f32 v6,v6
v_pk_fma_f32 v[106:107],v[208:209],v[196:197],v[106:107] op_sel:[0,1,0]
v_exp_f32 v8,v8
v_pk_fma_f32 v[72:73],v[202:203],v[198:199],v[72:73] op_sel_hi:[1,0,1]
v_rcp_f32 v7,v7
v_pk_mul_f32 v[106:107],v[106:107],v[216:217]
v_exp_f32 v9,v9
v_pk_mul_f32 v[70:71],v[70:71],v[6:7]
v_pk_mul_f32 v[10:11],v[106:107],v[106:107]
v_pk_add_f32 v[8:9],v[8:9],v[250:251] op_sel_hi:[1,0]
v_pk_add_f32 v[226:227],v[226:227],v[70:71]
v_pk_fma_f32 v[10:11],v[10:11],v[248:249],v[248:249] op_sel:[0,0,1] op_sel_hi:[1,0,1]
v_rcp_f32 v8,v8
v_pk_fma_f32 v[234:235],v[70:71],v[70:71],v[234:235]
v_pk_mul_f32 v[10:11],v[10:11],v[106:107]
v_rcp_f32 v9,v9
v_pk_mul_f32 v[72:73],v[72:73],v[210:211]
v_exp_f32 v10,v10
v_pk_mul_f32 v[104:105],v[104:105],v[8:9]
v_pk_mul_f32 v[240:241],v[72:73],v[72:73]
v_exp_f32 v11,v11
v_pk_add_f32 v[228:229],v[228:229],v[104:105]
v_pk_fma_f32 v[240:241],v[240:241],v[248:249],v[248:249] op_sel:[0,0,1] op_sel_hi:[1,0,1]
v_pk_add_f32 v[10:11],v[10:11],v[250:251] op_sel_hi:[1,0]
v_pk_fma_f32 v[236:237],v[104:105],v[104:105],v[236:237]
v_pk_mul_f32 v[240:241],v[240:241],v[72:73]
s_add_u32 m0,s49,114688
s_nop 0
buffer_load_dwordx4 v255,s[8:11],s20 offen sc1 lds
v_rcp_f32 v10,v10
v_pk_fma_f32 v[74:75],v[204:205],v[198:199],v[74:75] op_sel_hi:[1,0,1]
v_exp_f32 v240,v240
v_pk_fma_f32 v[108:109],v[206:207],v[198:199],v[108:109] op_sel_hi:[1,0,1]
v_rcp_f32 v11,v11
v_pk_mul_f32 v[74:75],v[74:75],v[212:213]
v_exp_f32 v241,v241
v_pk_mul_f32 v[106:107],v[106:107],v[10:11]
v_pk_mul_f32 v[242:243],v[74:75],v[74:75]
v_pk_add_f32 v[240:241],v[240:241],v[250:251] op_sel_hi:[1,0]
v_pk_add_f32 v[230:231],v[230:231],v[106:107]
v_pk_fma_f32 v[242:243],v[242:243],v[248:249],v[248:249] op_sel:[0,0,1] op_sel_hi:[1,0,1]
v_rcp_f32 v240,v240
v_pk_fma_f32 v[238:239],v[106:107],v[106:107],v[238:239]
v_pk_mul_f32 v[242:243],v[242:243],v[74:75]
v_rcp_f32 v241,v241
v_pk_mul_f32 v[108:109],v[108:109],v[214:215]
v_exp_f32 v242,v242
v_pk_mul_f32 v[72:73],v[72:73],v[240:241]
v_pk_mul_f32 v[244:245],v[108:109],v[108:109]
v_exp_f32 v243,v243
v_pk_add_f32 v[224:225],v[224:225],v[72:73]
v_pk_fma_f32 v[244:245],v[244:245],v[248:249],v[248:249] op_sel:[0,0,1] op_sel_hi:[1,0,1]
v_pk_add_f32 v[242:243],v[242:243],v[250:251] op_sel_hi:[1,0]
v_pk_fma_f32 v[232:233],v[72:73],v[72:73],v[232:233]
v_pk_mul_f32 v[244:245],v[244:245],v[108:109]
s_add_u32 m0,s49,118784
s_add_u32 s20,s48,278528
buffer_load_dwordx4 v1,s[8:11],s20 offen sc1 lds
v_rcp_f32 v242,v242
v_pk_fma_f32 v[110:111],v[208:209],v[198:199],v[110:111] op_sel_hi:[1,0,1]
v_exp_f32 v244,v244
v_pk_fma_f32 v[76:77],v[202:203],v[198:199],v[76:77] op_sel:[0,1,0]
v_rcp_f32 v243,v243
v_pk_mul_f32 v[110:111],v[110:111],v[216:217]
v_exp_f32 v245,v245
v_pk_mul_f32 v[74:75],v[74:75],v[242:243]
v_pk_mul_f32 v[246:247],v[110:111],v[110:111]
v_pk_add_f32 v[244:245],v[244:245],v[250:251] op_sel_hi:[1,0]
v_pk_add_f32 v[226:227],v[226:227],v[74:75]
v_pk_fma_f32 v[246:247],v[246:247],v[248:249],v[248:249] op_sel:[0,0,1] op_sel_hi:[1,0,1]
v_rcp_f32 v244,v244
v_pk_fma_f32 v[234:235],v[74:75],v[74:75],v[234:235]
v_pk_mul_f32 v[246:247],v[246:247],v[110:111]
v_rcp_f32 v245,v245
v_pk_mul_f32 v[76:77],v[76:77],v[210:211]
v_exp_f32 v246,v246
v_pk_mul_f32 v[108:109],v[108:109],v[244:245]
v_pk_mul_f32 v[4:5],v[76:77],v[76:77]
v_exp_f32 v247,v247
v_pk_add_f32 v[228:229],v[228:229],v[108:109]
v_pk_fma_f32 v[4:5],v[4:5],v[248:249],v[248:249] op_sel:[0,0,1] op_sel_hi:[1,0,1]
v_pk_add_f32 v[246:247],v[246:247],v[250:251] op_sel_hi:[1,0]
v_pk_fma_f32 v[236:237],v[108:109],v[108:109],v[236:237]
v_pk_mul_f32 v[4:5],v[4:5],v[76:77]
s_add_u32 m0,s49,122880
s_nop 0
buffer_load_dwordx4 v253,s[8:11],s20 offen sc1 lds
v_rcp_f32 v246,v246
v_pk_fma_f32 v[78:79],v[204:205],v[198:199],v[78:79] op_sel:[0,1,0]
v_exp_f32 v4,v4
v_pk_fma_f32 v[112:113],v[206:207],v[198:199],v[112:113] op_sel:[0,1,0]
v_rcp_f32 v247,v247
v_pk_mul_f32 v[78:79],v[78:79],v[212:213]
v_exp_f32 v5,v5
v_pk_mul_f32 v[110:111],v[110:111],v[246:247]
v_pk_mul_f32 v[6:7],v[78:79],v[78:79]
v_pk_add_f32 v[4:5],v[4:5],v[250:251] op_sel_hi:[1,0]
v_pk_add_f32 v[230:231],v[230:231],v[110:111]
v_pk_fma_f32 v[6:7],v[6:7],v[248:249],v[248:249] op_sel:[0,0,1] op_sel_hi:[1,0,1]
v_rcp_f32 v4,v4
v_pk_fma_f32 v[238:239],v[110:111],v[110:111],v[238:239]
v_pk_mul_f32 v[6:7],v[6:7],v[78:79]
v_rcp_f32 v5,v5
v_pk_mul_f32 v[112:113],v[112:113],v[214:215]
v_exp_f32 v6,v6
v_pk_mul_f32 v[76:77],v[76:77],v[4:5]
v_pk_mul_f32 v[8:9],v[112:113],v[112:113]
v_exp_f32 v7,v7
v_pk_add_f32 v[224:225],v[224:225],v[76:77]
v_pk_fma_f32 v[8:9],v[8:9],v[248:249],v[248:249] op_sel:[0,0,1] op_sel_hi:[1,0,1]
v_pk_add_f32 v[6:7],v[6:7],v[250:251] op_sel_hi:[1,0]
v_pk_fma_f32 v[232:233],v[76:77],v[76:77],v[232:233]
v_pk_mul_f32 v[8:9],v[8:9],v[112:113]
s_add_u32 m0,s49,126976
s_nop 0
buffer_load_dwordx4 v254,s[8:11],s20 offen sc1 lds
v_rcp_f32 v6,v6
v_pk_fma_f32 v[114:115],v[208:209],v[198:199],v[114:115] op_sel:[0,1,0]
v_exp_f32 v8,v8
v_pk_fma_f32 v[80:81],v[202:203],v[200:201],v[80:81] op_sel_hi:[1,0,1]
v_rcp_f32 v7,v7
v_pk_mul_f32 v[114:115],v[114:115],v[216:217]
v_exp_f32 v9,v9
v_pk_mul_f32 v[78:79],v[78:79],v[6:7]
v_pk_mul_f32 v[10:11],v[114:115],v[114:115]
v_pk_add_f32 v[8:9],v[8:9],v[250:251] op_sel_hi:[1,0]
v_pk_add_f32 v[226:227],v[226:227],v[78:79]
v_pk_fma_f32 v[10:11],v[10:11],v[248:249],v[248:249] op_sel:[0,0,1] op_sel_hi:[1,0,1]
v_rcp_f32 v8,v8
v_pk_fma_f32 v[234:235],v[78:79],v[78:79],v[234:235]
v_pk_mul_f32 v[10:11],v[10:11],v[114:115]
v_rcp_f32 v9,v9
v_pk_mul_f32 v[80:81],v[80:81],v[210:211]
v_exp_f32 v10,v10
v_pk_mul_f32 v[112:113],v[112:113],v[8:9]
v_pk_mul_f32 v[240:241],v[80:81],v[80:81]
v_exp_f32 v11,v11
v_pk_add_f32 v[228:229],v[228:229],v[112:113]
v_pk_fma_f32 v[240:241],v[240:241],v[248:249],v[248:249] op_sel:[0,0,1] op_sel_hi:[1,0,1]
v_pk_add_f32 v[10:11],v[10:11],v[250:251] op_sel_hi:[1,0]
v_pk_fma_f32 v[236:237],v[112:113],v[112:113],v[236:237]
v_pk_mul_f32 v[240:241],v[240:241],v[80:81]
s_add_u32 m0,s49,131072
s_nop 0
buffer_load_dwordx4 v255,s[8:11],s20 offen sc1 lds
v_rcp_f32 v10,v10
v_pk_fma_f32 v[82:83],v[204:205],v[200:201],v[82:83] op_sel_hi:[1,0,1]
v_exp_f32 v240,v240
v_pk_fma_f32 v[116:117],v[206:207],v[200:201],v[116:117] op_sel_hi:[1,0,1]
v_rcp_f32 v11,v11
v_pk_mul_f32 v[82:83],v[82:83],v[212:213]
v_exp_f32 v241,v241
v_pk_mul_f32 v[114:115],v[114:115],v[10:11]
v_pk_mul_f32 v[242:243],v[82:83],v[82:83]
v_pk_add_f32 v[240:241],v[240:241],v[250:251] op_sel_hi:[1,0]
v_pk_add_f32 v[230:231],v[230:231],v[114:115]
v_pk_fma_f32 v[242:243],v[242:243],v[248:249],v[248:249] op_sel:[0,0,1] op_sel_hi:[1,0,1]
v_rcp_f32 v240,v240
v_pk_fma_f32 v[238:239],v[114:115],v[114:115],v[238:239]
v_pk_mul_f32 v[242:243],v[242:243],v[82:83]
v_rcp_f32 v241,v241
v_pk_mul_f32 v[116:117],v[116:117],v[214:215]
v_exp_f32 v242,v242
v_pk_mul_f32 v[80:81],v[80:81],v[240:241]
v_pk_mul_f32 v[244:245],v[116:117],v[116:117]
v_exp_f32 v243,v243
v_pk_add_f32 v[224:225],v[224:225],v[80:81]
v_pk_fma_f32 v[244:245],v[244:245],v[248:249],v[248:249] op_sel:[0,0,1] op_sel_hi:[1,0,1]
v_pk_add_f32 v[242:243],v[242:243],v[250:251] op_sel_hi:[1,0]
v_pk_fma_f32 v[232:233],v[80:81],v[80:81],v[232:233]
v_pk_mul_f32 v[244:245],v[244:245],v[116:117]
v_rcp_f32 v242,v242
v_pk_fma_f32 v[118:119],v[208:209],v[200:201],v[118:119] op_sel_hi:[1,0,1]
v_exp_f32 v244,v244
v_rcp_f32 v243,v243
v_pk_mul_f32 v[118:119],v[118:119],v[216:217]
v_exp_f32 v245,v245
v_pk_mul_f32 v[82:83],v[82:83],v[242:243]
v_pk_mul_f32 v[246:247],v[118:119],v[118:119]
v_pk_add_f32 v[244:245],v[244:245],v[250:251] op_sel_hi:[1,0]
v_pk_add_f32 v[226:227],v[226:227],v[82:83]
v_pk_fma_f32 v[246:247],v[246:247],v[248:249],v[248:249] op_sel:[0,0,1] op_sel_hi:[1,0,1]
v_rcp_f32 v244,v244
v_pk_fma_f32 v[234:235],v[82:83],v[82:83],v[234:235]
v_pk_mul_f32 v[246:247],v[246:247],v[118:119]
v_rcp_f32 v245,v245
s_nop 0
v_pk_mul_f32 v[116:117],v[116:117],v[244:245]
v_exp_f32 v246,v246
v_pk_add_f32 v[228:229],v[228:229],v[116:117]
v_exp_f32 v247,v247
v_pk_fma_f32 v[236:237],v[116:117],v[116:117],v[236:237]
v_pk_add_f32 v[246:247],v[246:247],v[250:251] op_sel_hi:[1,0]
v_rcp_f32 v246,v246
v_rcp_f32 v247,v247
s_nop 0
v_pk_mul_f32 v[118:119],v[118:119],v[246:247]
v_pk_add_f32 v[230:231],v[230:231],v[118:119]
v_pk_fma_f32 v[238:239],v[118:119],v[118:119],v[238:239]
v_add_f32_dpp v224,v224,v224 row_ror:8 row_mask:0xf bank_mask:0xf
v_add_f32_dpp v225,v225,v225 row_ror:8 row_mask:0xf bank_mask:0xf
v_add_f32_dpp v226,v226,v226 row_ror:8 row_mask:0xf bank_mask:0xf
v_add_f32_dpp v227,v227,v227 row_ror:8 row_mask:0xf bank_mask:0xf
v_add_f32_dpp v228,v228,v228 row_ror:8 row_mask:0xf bank_mask:0xf
v_add_f32_dpp v229,v229,v229 row_ror:8 row_mask:0xf bank_mask:0xf
v_add_f32_dpp v230,v230,v230 row_ror:8 row_mask:0xf bank_mask:0xf
v_add_f32_dpp v231,v231,v231 row_ror:8 row_mask:0xf bank_mask:0xf
v_add_f32_dpp v232,v232,v232 row_ror:8 row_mask:0xf bank_mask:0xf
v_add_f32_dpp v233,v233,v233 row_ror:8 row_mask:0xf bank_mask:0xf
v_add_f32_dpp v234,v234,v234 row_ror:8 row_mask:0xf bank_mask:0xf
v_add_f32_dpp v235,v235,v235 row_ror:8 row_mask:0xf bank_mask:0xf
v_add_f32_dpp v236,v236,v236 row_ror:8 row_mask:0xf bank_mask:0xf
v_add_f32_dpp v237,v237,v237 row_ror:8 row_mask:0xf bank_mask:0xf
v_add_f32_dpp v238,v238,v238 row_ror:8 row_mask:0xf bank_mask:0xf
v_add_f32_dpp v239,v239,v239 row_ror:8 row_mask:0xf bank_mask:0xf
v_add_f32_dpp v224,v224,v224 row_ror:4 row_mask:0xf bank_mask:0xf
v_add_f32_dpp v225,v225,v225 row_ror:4 row_mask:0xf bank_mask:0xf
v_add_f32_dpp v226,v226,v226 row_ror:4 row_mask:0xf bank_mask:0xf
v_add_f32_dpp v227,v227,v227 row_ror:4 row_mask:0xf bank_mask:0xf
v_add_f32_dpp v228,v228,v228 row_ror:4 row_mask:0xf bank_mask:0xf
v_add_f32_dpp v229,v229,v229 row_ror:4 row_mask:0xf bank_mask:0xf
v_add_f32_dpp v230,v230,v230 row_ror:4 row_mask:0xf bank_mask:0xf
v_add_f32_dpp v231,v231,v231 row_ror:4 row_mask:0xf bank_mask:0xf
v_add_f32_dpp v232,v232,v232 row_ror:4 row_mask:0xf bank_mask:0xf
v_add_f32_dpp v233,v233,v233 row_ror:4 row_mask:0xf bank_mask:0xf
v_add_f32_dpp v234,v234,v234 row_ror:4 row_mask:0xf bank_mask:0xf
v_add_f32_dpp v235,v235,v235 row_ror:4 row_mask:0xf bank_mask:0xf
v_add_f32_dpp v236,v236,v236 row_ror:4 row_mask:0xf bank_mask:0xf
v_add_f32_dpp v237,v237,v237 row_ror:4 row_mask:0xf bank_mask:0xf
v_add_f32_dpp v238,v238,v238 row_ror:4 row_mask:0xf bank_mask:0xf
v_add_f32_dpp v239,v239,v239 row_ror:4 row_mask:0xf bank_mask:0xf
v_add_f32_dpp v224,v224,v224 row_ror:2 row_mask:0xf bank_mask:0xf
v_add_f32_dpp v225,v225,v225 row_ror:2 row_mask:0xf bank_mask:0xf
v_add_f32_dpp v226,v226,v226 row_ror:2 row_mask:0xf bank_mask:0xf
v_add_f32_dpp v227,v227,v227 row_ror:2 row_mask:0xf bank_mask:0xf
v_add_f32_dpp v228,v228,v228 row_ror:2 row_mask:0xf bank_mask:0xf
v_add_f32_dpp v229,v229,v229 row_ror:2 row_mask:0xf bank_mask:0xf
v_add_f32_dpp v230,v230,v230 row_ror:2 row_mask:0xf bank_mask:0xf
v_add_f32_dpp v231,v231,v231 row_ror:2 row_mask:0xf bank_mask:0xf
v_add_f32_dpp v232,v232,v232 row_ror:2 row_mask:0xf bank_mask:0xf
v_add_f32_dpp v233,v233,v233 row_ror:2 row_mask:0xf bank_mask:0xf
v_add_f32_dpp v234,v234,v234 row_ror:2 row_mask:0xf bank_mask:0xf
v_add_f32_dpp v235,v235,v235 row_ror:2 row_mask:0xf bank_mask:0xf
v_add_f32_dpp v236,v236,v236 row_ror:2 row_mask:0xf bank_mask:0xf
v_add_f32_dpp v237,v237,v237 row_ror:2 row_mask:0xf bank_mask:0xf
v_add_f32_dpp v238,v238,v238 row_ror:2 row_mask:0xf bank_mask:0xf
v_add_f32_dpp v239,v239,v239 row_ror:2 row_mask:0xf bank_mask:0xf
v_add_f32_dpp v224,v224,v224 row_ror:1 row_mask:0xf bank_mask:0xf
v_add_f32_dpp v225,v225,v225 row_ror:1 row_mask:0xf bank_mask:0xf
v_add_f32_dpp v226,v226,v226 row_ror:1 row_mask:0xf bank_mask:0xf
v_add_f32_dpp v227,v227,v227 row_ror:1 row_mask:0xf bank_mask:0xf
v_add_f32_dpp v228,v228,v228 row_ror:1 row_mask:0xf bank_mask:0xf
v_add_f32_dpp v229,v229,v229 row_ror:1 row_mask:0xf bank_mask:0xf
v_add_f32_dpp v230,v230,v230 row_ror:1 row_mask:0xf bank_mask:0xf
v_add_f32_dpp v231,v231,v231 row_ror:1 row_mask:0xf bank_mask:0xf
v_add_f32_dpp v232,v232,v232 row_ror:1 row_mask:0xf bank_mask:0xf
v_add_f32_dpp v233,v233,v233 row_ror:1 row_mask:0xf bank_mask:0xf
v_add_f32_dpp v234,v234,v234 row_ror:1 row_mask:0xf bank_mask:0xf
v_add_f32_dpp v235,v235,v235 row_ror:1 row_mask:0xf bank_mask:0xf
v_add_f32_dpp v236,v236,v236 row_ror:1 row_mask:0xf bank_mask:0xf
v_add_f32_dpp v237,v237,v237 row_ror:1 row_mask:0xf bank_mask:0xf
v_add_f32_dpp v238,v238,v238 row_ror:1 row_mask:0xf bank_mask:0xf
v_add_f32_dpp v239,v239,v239 row_ror:1 row_mask:0xf bank_mask:0xf
s_mov_b32 exec_lo,0x00010001
s_mov_b32 exec_hi,0x00010001
ds_write_b128 v252,v[224:227] offset:0
ds_write_b128 v252,v[232:235] offset:128
ds_write_b128 v252,v[228:231] offset:64
ds_write_b128 v252,v[236:239] offset:192
s_mov_b64 exec,-1
ds_read_b32 v6,v223
v_lshlrev_b32 v5,2,v0
s_waitcnt lgkmcnt(0)
buffer_store_dword v6,v5,s[8:11],s52 offen sc0 sc1
ds_read_b128 v[16:19],v1 offset:12288
MF v[120:123],v[24:27],a[0:3],0
s_lshl_b32 s24,s44,19
s_lshl_b32 s27,s22,14
MF v[156:159],v[24:27],a[4:7],0
ds_read_b128 v[20:23],v1 offset:13312
s_add_u32 s24,s24,s27
s_add_u32 s24,s24,0x880000
MF v[124:127],v[28:31],a[0:3],0
s_lshl_b32 s27,s22,1
s_mul_i32 s29,s22,10240
MF v[160:163],v[28:31],a[4:7],0
ds_read_b128 v[24:27],v1 offset:14336
s_lshl_b32 s21,s22,13
MF v[128:131],v[32:35],a[0:3],0
s_add_u32 s84,s27,0
s_and_b32 s84,s84,7
MF v[164:167],v[32:35],a[4:7],0
ds_read_b128 v[28:31],v1 offset:15360
s_lshl_b32 s84,s84,16
s_add_u32 s84,s84,s24
MF v[132:135],v[36:39],a[0:3],0
s_add_u32 s85,s27,1
s_and_b32 s85,s85,7
MF v[168:171],v[36:39],a[4:7],0
ds_read_b128 v[32:35],v1 offset:16384
s_lshl_b32 s85,s85,16
s_add_u32 s85,s85,s24
MF v[136:139],v[40:43],a[0:3],0
s_add_u32 s86,s27,2
s_and_b32 s86,s86,7
MF v[172:175],v[40:43],a[4:7],0
ds_read_b128 v[36:39],v1 offset:17408
s_lshl_b32 s86,s86,16
s_add_u32 s86,s86,s24
MF v[140:143],v[44:47],a[0:3],0
s_add_u32 s87,s27,3
s_and_b32 s87,s87,7
MF v[176:179],v[44:47],a[4:7],0
ds_read_b128 v[40:43],v1 offset:18432
s_waitcnt lgkmcnt(5)
MF v[144:147],v[16:19],a[0:3],0
s_lshl_b32 s87,s87,16
s_add_u32 s87,s87,s24
MF v[180:183],v[16:19],a[4:7],0
ds_read_b128 v[44:47],v1 offset:19456
s_add_u32 s88,s27,4
s_and_b32 s88,s88,7
MF v[148:151],v[20:23],a[0:3],0
s_lshl_b32 s88,s88,16
s_add_u32 s88,s88,s24
MF v[184:187],v[20:23],a[4:7],0
ds_read_b128 v[16:19],v1 offset:20480
s_waitcnt lgkmcnt(5)
MF v[152:155],v[24:27],a[0:3],0
s_add_u32 s89,s27,5
s_and_b32 s89,s89,7
MF v[188:191],v[24:27],a[4:7],0
ds_read_b128 v[20:23],v1 offset:21504
s_lshl_b32 s89,s89,16
s_add_u32 s89,s89,s24
MF v[120:123],v[28:31],a[8:11],v[120:123]
s_add_u32 s90,s27,6
s_and_b32 s90,s90,7
MF v[156:159],v[28:31],a[12:15],v[156:159]
ds_read_b128 v[24:27],v1 offset:22528
s_waitcnt lgkmcnt(5)
MF v[124:127],v[32:35],a[8:11],v[124:127]
s_lshl_b32 s90,s90,16
s_add_u32 s90,s90,s24
MF v[160:163],v[32:35],a[12:15],v[160:163]
ds_read_b128 v[28:31],v1 offset:23552
s_add_u32 s91,s27,7
s_and_b32 s91,s91,7
MF v[128:131],v[36:39],a[8:11],v[128:131]
s_lshl_b32 s91,s91,16
s_add_u32 s91,s91,s24
MF v[164:167],v[36:39],a[12:15],v[164:167]
s_waitcnt vmcnt(19)
s_barrier
ds_read_b128 v[32:35],v1 offset:24576
s_waitcnt lgkmcnt(5)
s_add_u32 m0,s49,135168
s_add_u32 s20,s48,294912
MF v[132:135],v[40:43],a[8:11],v[132:135]
buffer_load_dwordx4 v1,s[8:11],s20 offen sc1 lds
MF v[168:171],v[40:43],a[12:15],v[168:171]
ds_read_b128 v[36:39],v1 offset:25600
MF v[136:139],v[44:47],a[8:11],v[136:139]
MF v[172:175],v[44:47],a[12:15],v[172:175]
ds_read_b128 v[40:43],v1 offset:26624
s_waitcnt lgkmcnt(5)
MF v[140:143],v[16:19],a[8:11],v[140:143]
MF v[176:179],v[16:19],a[12:15],v[176:179]
ds_read_b128 v[44:47],v1 offset:27648
s_add_u32 m0,s49,139264
MF v[144:147],v[20:23],a[8:11],v[144:147]
buffer_load_dwordx4 v253,s[8:11],s20 offen sc1 lds
MF v[180:183],v[20:23],a[12:15],v[180:183]
ds_read_b128 v[16:19],v1 offset:28672
s_waitcnt lgkmcnt(5)
MF v[148:151],v[24:27],a[8:11],v[148:151]
MF v[184:187],v[24:27],a[12:15],v[184:187]
ds_read_b128 v[20:23],v1 offset:29696
MF v[152:155],v[28:31],a[8:11],v[152:155]
MF v[188:191],v[28:31],a[12:15],v[188:191]
ds_read_b128 v[24:27],v1 offset:30720
s_waitcnt lgkmcnt(5)
s_add_u32 m0,s49,143360
MF v[120:123],v[32:35],a[16:19],v[120:123]
buffer_load_dwordx4 v254,s[8:11],s20 offen sc1 lds
MF v[156:159],v[32:35],a[20:23],v[156:159]
ds_read_b128 v[28:31],v1 offset:31744
MF v[124:127],v[36:39],a[16:19],v[124:127]
MF v[160:163],v[36:39],a[20:23],v[160:163]
ds_read_b128 v[32:35],v1 offset:32768
s_waitcnt lgkmcnt(5)
MF v[128:131],v[40:43],a[16:19],v[128:131]
MF v[164:167],v[40:43],a[20:23],v[164:167]
ds_read_b128 v[36:39],v1 offset:33792
s_add_u32 m0,s49,147456
MF v[132:135],v[44:47],a[16:19],v[132:135]
buffer_load_dwordx4 v255,s[8:11],s20 offen sc1 lds
MF v[168:171],v[44:47],a[20:23],v[168:171]
ds_read_b128 v[40:43],v1 offset:34816
s_waitcnt lgkmcnt(5)
MF v[136:139],v[16:19],a[16:19],v[136:139]
MF v[172:175],v[16:19],a[20:23],v[172:175]
ds_read_b128 v[44:47],v1 offset:35840
MF v[140:143],v[20:23],a[16:19],v[140:143]
MF v[176:179],v[20:23],a[20:23],v[176:179]
ds_read_b128 v[16:19],v1 offset:36864
s_waitcnt lgkmcnt(5)
s_add_u32 m0,s49,151552
s_add_u32 s20,s48,311296
MF v[144:147],v[24:27],a[16:19],v[144:147]
buffer_load_dwordx4 v1,s[8:11],s20 offen sc1 lds
MF v[180:183],v[24:27],a[20:23],v[180:183]
ds_read_b128 v[20:23],v1 offset:37888
MF v[148:151],v[28:31],a[16:19],v[148:151]
MF v[184:187],v[28:31],a[20:23],v[184:187]
ds_read_b128 v[24:27],v1 offset:38912
s_waitcnt lgkmcnt(5)
MF v[152:155],v[32:35],a[16:19],v[152:155]
MF v[188:191],v[32:35],a[20:23],v[188:191]
ds_read_b128 v[28:31],v1 offset:39936
s_add_u32 m0,s49,155648
MF v[120:123],v[36:39],a[24:27],v[120:123]
buffer_load_dwordx4 v253,s[8:11],s20 offen sc1 lds
MF v[156:159],v[36:39],a[28:31],v[156:159]
ds_read_b128 v[32:35],v1 offset:40960
s_waitcnt lgkmcnt(5)
MF v[124:127],v[40:43],a[24:27],v[124:127]
MF v[160:163],v[40:43],a[28:31],v[160:163]
ds_read_b128 v[36:39],v1 offset:41984
MF v[128:131],v[44:47],a[24:27],v[128:131]
MF v[164:167],v[44:47],a[28:31],v[164:167]
ds_read_b128 v[40:43],v1 offset:43008
s_waitcnt lgkmcnt(5)
s_add_u32 m0,s49,0
MF v[132:135],v[16:19],a[24:27],v[132:135]
buffer_load_dwordx4 v254,s[8:11],s20 offen sc1 lds
MF v[168:171],v[16:19],a[28:31],v[168:171]
ds_read_b128 v[44:47],v1 offset:44032
MF v[136:139],v[20:23],a[24:27],v[136:139]
MF v[172:175],v[20:23],a[28:31],v[172:175]
ds_read_b128 v[16:19],v1 offset:45056
s_waitcnt lgkmcnt(5)
MF v[140:143],v[24:27],a[24:27],v[140:143]
MF v[176:179],v[24:27],a[28:31],v[176:179]
ds_read_b128 v[20:23],v1 offset:46080
s_add_u32 m0,s49,4096
MF v[144:147],v[28:31],a[24:27],v[144:147]
buffer_load_dwordx4 v255,s[8:11],s20 offen sc1 lds
MF v[180:183],v[28:31],a[28:31],v[180:183]
ds_read_b128 v[24:27],v1 offset:47104
s_waitcnt lgkmcnt(5)
MF v[148:151],v[32:35],a[24:27],v[148:151]
MF v[184:187],v[32:35],a[28:31],v[184:187]
ds_read_b128 v[28:31],v1 offset:48128
MF v[152:155],v[36:39],a[24:27],v[152:155]
MF v[188:191],v[36:39],a[28:31],v[188:191]
ds_read_b128 v[32:35],v1 offset:49152
s_waitcnt lgkmcnt(5)
s_add_u32 m0,s49,8192
s_add_u32 s20,s48,327680
MF v[120:123],v[40:43],a[32:35],v[120:123]
buffer_load_dwordx4 v1,s[8:11],s20 offen sc1 lds
MF v[156:159],v[40:43],a[36:39],v[156:159]
ds_read_b128 v[36:39],v1 offset:50176
MF v[124:127],v[44:47],a[32:35],v[124:127]
MF v[160:163],v[44:47],a[36:39],v[160:163]
ds_read_b128 v[40:43],v1 offset:51200
s_waitcnt lgkmcnt(5)
MF v[128:131],v[16:19],a[32:35],v[128:131]
MF v[164:167],v[16:19],a[36:39],v[164:167]
ds_read_b128 v[44:47],v1 offset:52224
MF v[132:135],v[20:23],a[32:35],v[132:135]
MF v[168:171],v[20:23],a[36:39],v[168:171]
ds_read_b128 v[16:19],v1 offset:53248
s_waitcnt lgkmcnt(5)
MF v[136:139],v[24:27],a[32:35],v[136:139]
MF v[172:175],v[24:27],a[36:39],v[172:175]
ds_read_b128 v[20:23],v1 offset:54272
MF v[140:143],v[28:31],a[32:35],v[140:143]
MF v[176:179],v[28:31],a[36:39],v[176:179]
ds_read_b128 v[24:27],v1 offset:55296
s_waitcnt lgkmcnt(5)
MF v[144:147],v[32:35],a[32:35],v[144:147]
MF v[180:183],v[32:35],a[36:39],v[180:183]
ds_read_b128 v[28:31],v1 offset:56320
MF v[148:151],v[36:39],a[32:35],v[148:151]
MF v[184:187],v[36:39],a[36:39],v[184:187]
ds_read_b128 v[32:35],v1 offset:57344
s_waitcnt lgkmcnt(5)
MF v[152:155],v[40:43],a[32:35],v[152:155]
MF v[188:191],v[40:43],a[36:39],v[188:191]
ds_read_b128 v[36:39],v1 offset:58368
MF v[120:123],v[44:47],a[40:43],v[120:123]
MF v[156:159],v[44:47],a[44:47],v[156:159]
ds_read_b128 v[40:43],v1 offset:59392
s_waitcnt lgkmcnt(5)
MF v[124:127],v[16:19],a[40:43],v[124:127]
MF v[160:163],v[16:19],a[44:47],v[160:163]
ds_read_b128 v[44:47],v1 offset:60416
MF v[128:131],v[20:23],a[40:43],v[128:131]
MF v[164:167],v[20:23],a[44:47],v[164:167]
s_waitcnt vmcnt(19)
s_barrier
ds_read_b128 v[16:19],v1 offset:61440
s_waitcnt lgkmcnt(5)
MF v[132:135],v[24:27],a[40:43],v[132:135]
MF v[168:171],v[24:27],a[44:47],v[168:171]
ds_read_b128 v[20:23],v1 offset:62464
MF v[136:139],v[28:31],a[40:43],v[136:139]
buffer_load_dwordx4 v[224:227],v1,s[8:11],s51 offen offset:0 sc0 sc1
buffer_load_dwordx4 v[228:231],v1,s[8:11],s51 offen offset:1024 sc0 sc1
buffer_load_dwordx4 v[232:235],v1,s[8:11],s51 offen offset:2048 sc0 sc1
buffer_load_dwordx4 v[236:239],v1,s[8:11],s51 offen offset:3072 sc0 sc1
MF v[172:175],v[28:31],a[44:47],v[172:175]
ds_read_b128 v[24:27],v1 offset:63488
s_waitcnt lgkmcnt(5)
MF v[140:143],v[32:35],a[40:43],v[140:143]
s_add_u32 m0,s29,11264
s_nop 0
buffer_load_dwordx4 v1,s[8:11],s88 offen offset:1024 sc1 lds
MF v[176:179],v[32:35],a[44:47],v[176:179]
ds_read_b128 v[28:31],v1 offset:64512
MF v[144:147],v[36:39],a[40:43],v[144:147]
s_add_u32 m0,s29,12288
s_nop 0
buffer_load_dwordx4 v1,s[8:11],s89 offen offset:1024 sc1 lds
MF v[180:183],v[36:39],a[44:47],v[180:183]
ds_read_b128 v[32:35],v2 offset:0
s_waitcnt lgkmcnt(5)
MF v[148:151],v[40:43],a[40:43],v[148:151]
MF v[184:187],v[40:43],a[44:47],v[184:187]
ds_read_b128 v[36:39],v2 offset:1024
s_add_u32 m0,s29,13312
s_nop 0
buffer_load_dwordx4 v1,s[8:11],s90 offen offset:1024 sc1 lds
MF v[152:155],v[44:47],a[40:43],v[152:155]
MF v[188:191],v[44:47],a[44:47],v[188:191]
ds_read_b128 v[40:43],v2 offset:2048
s_waitcnt lgkmcnt(5)
MF v[120:123],v[16:19],a[48:51],v[120:123]
s_add_u32 m0,s29,14336
s_nop 0
buffer_load_dwordx4 v1,s[8:11],s91 offen offset:1024 sc1 lds
MF v[156:159],v[16:19],a[52:55],v[156:159]
ds_read_b128 v[44:47],v2 offset:3072
MF v[124:127],v[20:23],a[48:51],v[124:127]
s_add_u32 m0,s29,14336
s_nop 0
buffer_load_dwordx4 v1,s[8:11],s84 offen offset:2048 sc1 lds
MF v[160:163],v[20:23],a[52:55],v[160:163]
ds_read_b128 v[16:19],v2 offset:4096
s_waitcnt lgkmcnt(5)
MF v[128:131],v[24:27],a[48:51],v[128:131]
MF v[164:167],v[24:27],a[52:55],v[164:167]
ds_read_b128 v[20:23],v2 offset:5120
s_add_u32 m0,s29,15360
s_nop 0
buffer_load_dwordx4 v1,s[8:11],s85 offen offset:2048 sc1 lds
MF v[132:135],v[28:31],a[48:51],v[132:135]
MF v[168:171],v[28:31],a[52:55],v[168:171]
ds_read_b128 v[24:27],v2 offset:6144
s_waitcnt lgkmcnt(5)
MF v[136:139],v[32:35],a[48:51],v[136:139]
s_add_u32 m0,s29,16384
s_nop 0
buffer_load_dwordx4 v1,s[8:11],s86 offen offset:2048 sc1 lds
MF v[172:175],v[32:35],a[52:55],v[172:175]
ds_read_b128 v[28:31],v2 offset:7168
MF v[140:143],v[36:39],a[48:51],v[140:143]
s_add_u32 m0,s29,17408
s_nop 0
buffer_load_dwordx4 v1,s[8:11],s87 offen offset:2048 sc1 lds
MF v[176:179],v[36:39],a[52:55],v[176:179]
ds_read_b128 v[32:35],v2 offset:8192
s_waitcnt lgkmcnt(5)
MF v[144:147],v[40:43],a[48:51],v[144:147]
MF v[180:183],v[40:43],a[52:55],v[180:183]
ds_read_b128 v[36:39],v2 offset:9216
s_add_u32 m0,s29,18432
s_nop 0
buffer_load_dwordx4 v1,s[8:11],s88 offen offset:2048 sc1 lds
MF v[148:151],v[44:47],a[48:51],v[148:151]
MF v[184:187],v[44:47],a[52:55],v[184:187]
ds_read_b128 v[40:43],v2 offset:10240
s_waitcnt lgkmcnt(5)
MF v[152:155],v[16:19],a[48:51],v[152:155]
s_add_u32 m0,s29,19456
s_nop 0
buffer_load_dwordx4 v1,s[8:11],s89 offen offset:2048 sc1 lds
MF v[188:191],v[16:19],a[52:55],v[188:191]
ds_read_b128 v[44:47],v2 offset:11264
MF v[120:123],v[20:23],a[56:59],v[120:123]
MF v[156:159],v[20:23],a[60:63],v[156:159]
ds_read_b128 v[16:19],v2 offset:12288
s_waitcnt lgkmcnt(5)
MF v[124:127],v[24:27],a[56:59],v[124:127]
MF v[160:163],v[24:27],a[60:63],v[160:163]
ds_read_b128 v[20:23],v2 offset:13312
MF v[128:131],v[28:31],a[56:59],v[128:131]
MF v[164:167],v[28:31],a[60:63],v[164:167]
ds_read_b128 v[24:27],v2 offset:14336
s_waitcnt lgkmcnt(5)
MF v[132:135],v[32:35],a[56:59],v[132:135]
MF v[168:171],v[32:35],a[60:63],v[168:171]
ds_read_b128 v[28:31],v2 offset:15360
MF v[136:139],v[36:39],a[56:59],v[136:139]
MF v[172:175],v[36:39],a[60:63],v[172:175]
ds_read_b128 v[32:35],v2 offset:16384
s_waitcnt lgkmcnt(5)
MF v[140:143],v[40:43],a[56:59],v[140:143]
MF v[176:179],v[40:43],a[60:63],v[176:179]
ds_read_b128 v[36:39],v2 offset:17408
MF v[144:147],v[44:47],a[56:59],v[144:147]
MF v[180:183],v[44:47],a[60:63],v[180:183]
ds_read_b128 v[40:43],v2 offset:18432
s_waitcnt lgkmcnt(5)
MF v[148:151],v[16:19],a[56:59],v[148:151]
MF v[184:187],v[16:19],a[60:63],v[184:187]
ds_read_b128 v[44:47],v2 offset:19456
MF v[152:155],v[20:23],a[56:59],v[152:155]
s_waitcnt vmcnt(10)
v_max_u32 v240,v224,v225
v_max3_u32 v240,v240,v226,v227
v_max3_u32 v240,v240,v228,v229
v_max3_u32 v240,v240,v230,v231
v_max3_u32 v240,v240,v232,v233
v_max3_u32 v240,v240,v234,v235
v_max3_u32 v240,v240,v236,v237
v_max3_u32 v240,v240,v238,v239
v_cmp_eq_u32 vcc,-1,v240
s_cbranch_vccz k3_0_P3G
s_mov_b32 s53,0
k3_0_P3:
s_nop 7
s_nop 3
buffer_load_dwordx4 v[224:227],v1,s[8:11],s51 offen offset:0 sc0 sc1
buffer_load_dwordx4 v[228:231],v1,s[8:11],s51 offen offset:1024 sc0 sc1
buffer_load_dwordx4 v[232:235],v1,s[8:11],s51 offen offset:2048 sc0 sc1
buffer_load_dwordx4 v[236:239],v1,s[8:11],s51 offen offset:3072 sc0 sc1
s_add_u32 s53,s53,1
s_waitcnt vmcnt(0)
v_max_u32 v240,v224,v225
v_max3_u32 v240,v240,v226,v227
v_max3_u32 v240,v240,v228,v229
v_max3_u32 v240,v240,v230,v231
v_max3_u32 v240,v240,v232,v233
v_max3_u32 v240,v240,v234,v235
v_max3_u32 v240,v240,v236,v237
v_max3_u32 v240,v240,v238,v239
v_cmp_eq_u32 vcc,-1,v240
s_cbranch_vccz k3_0_P3G
s_cmp_lt_u32 s53,100000
s_cbranch_scc1 k3_0_P3
k3_0_P3G:
s_nop 7
s_nop 3
v_add_f32 v224,v224,v228
MF v[188:191],v[20:23],a[60:63],v[188:191]
ds_read_b128 v[16:19],v2 offset:20480
s_waitcnt lgkmcnt(5)
MF v[120:123],v[24:27],a[64:67],v[120:123]
v_add_f32 v225,v225,v229
v_add_f32 v226,v226,v230
MF v[156:159],v[24:27],a[68:71],v[156:159]
ds_read_b128 v[20:23],v2 offset:21504
v_add_f32 v227,v227,v231
MF v[124:127],v[28:31],a[64:67],v[124:127]
v_add_f32 v224,v224,v232
v_add_f32 v225,v225,v233
MF v[160:163],v[28:31],a[68:71],v[160:163]
ds_read_b128 v[24:27],v2 offset:22528
s_waitcnt lgkmcnt(5)
MF v[128:131],v[32:35],a[64:67],v[128:131]
v_add_f32 v226,v226,v234
v_add_f32 v227,v227,v235
MF v[164:167],v[32:35],a[68:71],v[164:167]
ds_read_b128 v[28:31],v2 offset:23552
v_add_f32 v224,v224,v236
MF v[132:135],v[36:39],a[64:67],v[132:135]
v_add_f32 v225,v225,v237
v_add_f32 v226,v226,v238
MF v[168:171],v[36:39],a[68:71],v[168:171]
ds_read_b128 v[32:35],v2 offset:24576
s_waitcnt lgkmcnt(5)
MF v[136:139],v[40:43],a[64:67],v[136:139]
v_add_f32 v227,v227,v239
v_mov_b32 v228,v224
MF v[172:175],v[40:43],a[68:71],v[172:175]
ds_read_b128 v[36:39],v2 offset:25600
v_mov_b32 v229,v225
MF v[140:143],v[44:47],a[64:67],v[140:143]
v_mov_b32 v230,v226
v_mov_b32 v231,v227
MF v[176:179],v[44:47],a[68:71],v[176:179]
ds_read_b128 v[40:43],v2 offset:26624
s_waitcnt lgkmcnt(5)
MF v[144:147],v[16:19],a[64:67],v[144:147]
v_permlane32_swap_b32 v224,v228
v_permlane32_swap_b32 v225,v229
MF v[180:183],v[16:19],a[68:71],v[180:183]
ds_read_b128 v[44:47],v2 offset:27648
v_permlane32_swap_b32 v226,v230
MF v[148:151],v[20:23],a[64:67],v[148:151]
v_permlane32_swap_b32 v227,v231
v_add_f32 v224,v224,v228
MF v[184:187],v[20:23],a[68:71],v[184:187]
ds_read_b128 v[16:19],v2 offset:28672
s_waitcnt lgkmcnt(5)
MF v[152:155],v[24:27],a[64:67],v[152:155]
v_add_f32 v225,v225,v229
v_add_f32 v226,v226,v230
MF v[188:191],v[24:27],a[68:71],v[188:191]
ds_read_b128 v[20:23],v2 offset:29696
v_add_f32 v227,v227,v231
MF v[120:123],v[28:31],a[72:75],v[120:123]
v_mov_b32 v228,v224
v_mov_b32 v229,v225
MF v[156:159],v[28:31],a[76:79],v[156:159]
ds_read_b128 v[24:27],v2 offset:30720
s_waitcnt lgkmcnt(5)
MF v[124:127],v[32:35],a[72:75],v[124:127]
v_mov_b32 v230,v226
v_mov_b32 v231,v227
MF v[160:163],v[32:35],a[76:79],v[160:163]
ds_read_b128 v[28:31],v2 offset:31744
v_permlane16_swap_b32 v224,v228
MF v[128:131],v[36:39],a[72:75],v[128:131]
v_permlane16_swap_b32 v225,v229
v_permlane16_swap_b32 v226,v230
MF v[164:167],v[36:39],a[76:79],v[164:167]
s_barrier
ds_read_b128 v[32:35],v2 offset:32768
s_waitcnt lgkmcnt(5)
MF v[132:135],v[40:43],a[72:75],v[132:135]
v_permlane16_swap_b32 v227,v231
v_add_f32 v224,v224,v228
MF v[168:171],v[40:43],a[76:79],v[168:171]
ds_read_b128 v[36:39],v2 offset:33792
v_add_f32 v225,v225,v229
MF v[136:139],v[44:47],a[72:75],v[136:139]
v_add_f32 v226,v226,v230
v_add_f32 v227,v227,v231
MF v[172:175],v[44:47],a[76:79],v[172:175]
ds_read_b128 v[40:43],v2 offset:34816
s_waitcnt lgkmcnt(5)
MF v[140:143],v[16:19],a[72:75],v[140:143]
v_mul_f32 v232,0xb9e38e39,v224
v_mul_f32 v233,0xb9e38e39,v226
MF v[176:179],v[16:19],a[76:79],v[176:179]
ds_read_b128 v[44:47],v2 offset:35840
v_mul_f32 v225,0x39e38e39,v225
MF v[144:147],v[20:23],a[72:75],v[144:147]
v_mul_f32 v227,0x39e38e39,v227
v_mul_f32 v224,v232,v232
MF v[180:183],v[20:23],a[76:79],v[180:183]
ds_read_b128 v[16:19],v2 offset:36864
s_waitcnt lgkmcnt(5)
MF v[148:151],v[24:27],a[72:75],v[148:151]
v_mul_f32 v226,v233,v233
v_sub_f32 v225,v225,v224
MF v[184:187],v[24:27],a[76:79],v[184:187]
ds_read_b128 v[20:23],v2 offset:37888
v_sub_f32 v227,v227,v226
MF v[152:155],v[28:31],a[72:75],v[152:155]
v_max_f32 v225,0,v225
v_max_f32 v227,0,v227
MF v[188:191],v[28:31],a[76:79],v[188:191]
ds_read_b128 v[24:27],v2 offset:38912
s_waitcnt lgkmcnt(5)
MF v[120:123],v[32:35],a[80:83],v[120:123]
v_add_f32 v225,0x3727c5ac,v225
v_add_f32 v227,0x3727c5ac,v227
MF v[156:159],v[32:35],a[84:87],v[156:159]
ds_read_b128 v[28:31],v2 offset:39936
v_rsq_f32 v234,v225
MF v[124:127],v[36:39],a[80:83],v[124:127]
v_rsq_f32 v235,v227
MF v[160:163],v[36:39],a[84:87],v[160:163]
ds_read_b128 v[32:35],v2 offset:40960
s_waitcnt lgkmcnt(5)
MF v[128:131],v[40:43],a[80:83],v[128:131]
v_mul_f32 v232,v232,v234
v_mul_f32 v233,v233,v235
MF v[164:167],v[40:43],a[84:87],v[164:167]
ds_read_b128 v[36:39],v2 offset:41984
v_lshlrev_b32 v4,3,v14
MF v[132:135],v[44:47],a[80:83],v[132:135]
v_add_u32 v4,s30,v4
s_mov_b64 exec,0xffff
ds_write_b64 v4,v[232:233]
ds_write_b64 v4,v[234:235] offset:128
s_mov_b64 exec,-1
MF v[168:171],v[44:47],a[84:87],v[168:171]
ds_read_b128 v[40:43],v2 offset:43008
s_waitcnt lgkmcnt(7)
MF v[136:139],v[16:19],a[80:83],v[136:139]
ds_read_b128 v[202:205],v252 offset:0
ds_read_b128 v[210:213],v252 offset:128
MF v[172:175],v[16:19],a[84:87],v[172:175]
ds_read_b128 v[44:47],v2 offset:44032
ds_read_b128 v[206:209],v252 offset:64
MF v[140:143],v[20:23],a[80:83],v[140:143]
ds_read_b128 v[214:217],v252 offset:192
s_add_u32 m0,s21,51200
s_nop 0
buffer_load_dwordx4 v1,s[8:11],s90 offen offset:2048 sc1 lds
MF v[176:179],v[20:23],a[84:87],v[176:179]
ds_read_b128 v[16:19],v2 offset:45056
s_waitcnt lgkmcnt(11)
MF v[144:147],v[24:27],a[80:83],v[144:147]
MF v[180:183],v[24:27],a[84:87],v[180:183]
ds_read_b128 v[20:23],v2 offset:46080
s_add_u32 m0,s21,52224
s_nop 0
buffer_load_dwordx4 v1,s[8:11],s91 offen offset:2048 sc1 lds
MF v[148:151],v[28:31],a[80:83],v[148:151]
MF v[184:187],v[28:31],a[84:87],v[184:187]
ds_read_b128 v[24:27],v2 offset:47104
s_waitcnt lgkmcnt(11)
MF v[152:155],v[32:35],a[80:83],v[152:155]
s_waitcnt lgkmcnt(3)
v_fma_f32 v48,v48,v210,v202
MF v[188:191],v[32:35],a[84:87],v[188:191]
ds_read_b128 v[28:31],v2 offset:48128
v_fma_f32 v49,v49,v211,v203
MF v[120:123],v[36:39],a[88:91],v[120:123]
v_fma_f32 v50,v50,v212,v204
v_fma_f32 v51,v51,v213,v205
MF v[156:159],v[36:39],a[92:95],v[156:159]
ds_read_b128 v[32:35],v2 offset:49152
v_cvt_pk_bf16_f32 v48,v48,v49
MF v[124:127],v[40:43],a[88:91],v[124:127]
v_cvt_pk_bf16_f32 v49,v50,v51
buffer_store_dwordx2 v[48:49],v222,s[8:11],s34 offen offset:0 sc1
MF v[160:163],v[40:43],a[92:95],v[160:163]
ds_read_b128 v[36:39],v2 offset:50176
v_fma_f32 v84,v84,v214,v206
MF v[128:131],v[44:47],a[88:91],v[128:131]
v_fma_f32 v85,v85,v215,v207
v_fma_f32 v86,v86,v216,v208
MF v[164:167],v[44:47],a[92:95],v[164:167]
ds_read_b128 v[40:43],v2 offset:51200
s_waitcnt lgkmcnt(5)
MF v[132:135],v[16:19],a[88:91],v[132:135]
v_fma_f32 v87,v87,v217,v209
v_cvt_pk_bf16_f32 v84,v84,v85
MF v[168:171],v[16:19],a[92:95],v[168:171]
ds_read_b128 v[44:47],v2 offset:52224
v_cvt_pk_bf16_f32 v85,v86,v87
MF v[136:139],v[20:23],a[88:91],v[136:139]
buffer_store_dwordx2 v[84:85],v222,s[8:11],s34 offen offset:512 sc1
v_fma_f32 v52,v52,v210,v202
MF v[172:175],v[20:23],a[92:95],v[172:175]
ds_read_b128 v[16:19],v2 offset:53248
s_waitcnt lgkmcnt(5)
MF v[140:143],v[24:27],a[88:91],v[140:143]
v_fma_f32 v53,v53,v211,v203
v_fma_f32 v54,v54,v212,v204
MF v[176:179],v[24:27],a[92:95],v[176:179]
ds_read_b128 v[20:23],v2 offset:54272
v_fma_f32 v55,v55,v213,v205
MF v[144:147],v[28:31],a[88:91],v[144:147]
v_cvt_pk_bf16_f32 v52,v52,v53
v_cvt_pk_bf16_f32 v53,v54,v55
MF v[180:183],v[28:31],a[92:95],v[180:183]
ds_read_b128 v[24:27],v2 offset:55296
s_waitcnt lgkmcnt(5)
MF v[148:151],v[32:35],a[88:91],v[148:151]
buffer_store_dwordx2 v[52:53],v222,s[8:11],s34 offen offset:1024 sc1
v_fma_f32 v88,v88,v214,v206
MF v[184:187],v[32:35],a[92:95],v[184:187]
ds_read_b128 v[28:31],v2 offset:56320
v_fma_f32 v89,v89,v215,v207
MF v[152:155],v[36:39],a[88:91],v[152:155]
v_fma_f32 v90,v90,v216,v208
v_fma_f32 v91,v91,v217,v209
MF v[188:191],v[36:39],a[92:95],v[188:191]
ds_read_b128 v[32:35],v2 offset:57344
s_waitcnt lgkmcnt(5)
MF v[120:123],v[40:43],a[96:99],v[120:123]
v_cvt_pk_bf16_f32 v88,v88,v89
v_cvt_pk_bf16_f32 v89,v90,v91
MF v[156:159],v[40:43],a[100:103],v[156:159]
ds_read_b128 v[36:39],v2 offset:58368
buffer_store_dwordx2 v[88:89],v222,s[8:11],s34 offen offset:1536 sc1
MF v[124:127],v[44:47],a[96:99],v[124:127]
v_fma_f32 v56,v56,v210,v202
v_fma_f32 v57,v57,v211,v203
MF v[160:163],v[44:47],a[100:103],v[160:163]
ds_read_b128 v[40:43],v2 offset:59392
s_waitcnt lgkmcnt(5)
MF v[128:131],v[16:19],a[96:99],v[128:131]
v_fma_f32 v58,v58,v212,v204
v_fma_f32 v59,v59,v213,v205
MF v[164:167],v[16:19],a[100:103],v[164:167]
ds_read_b128 v[44:47],v2 offset:60416
v_cvt_pk_bf16_f32 v56,v56,v57
MF v[132:135],v[20:23],a[96:99],v[132:135]
v_cvt_pk_bf16_f32 v57,v58,v59
buffer_store_dwordx2 v[56:57],v222,s[8:11],s34 offen offset:2048 sc1
MF v[168:171],v[20:23],a[100:103],v[168:171]
ds_read_b128 v[16:19],v2 offset:61440
s_waitcnt lgkmcnt(5)
MF v[136:139],v[24:27],a[96:99],v[136:139]
v_fma_f32 v92,v92,v214,v206
v_fma_f32 v93,v93,v215,v207
MF v[172:175],v[24:27],a[100:103],v[172:175]
ds_read_b128 v[20:23],v2 offset:62464
v_fma_f32 v94,v94,v216,v208
MF v[140:143],v[28:31],a[96:99],v[140:143]
v_fma_f32 v95,v95,v217,v209
v_cvt_pk_bf16_f32 v92,v92,v93
MF v[176:179],v[28:31],a[100:103],v[176:179]
ds_read_b128 v[24:27],v2 offset:63488
s_waitcnt lgkmcnt(5)
MF v[144:147],v[32:35],a[96:99],v[144:147]
v_cvt_pk_bf16_f32 v93,v94,v95
buffer_store_dwordx2 v[92:93],v222,s[8:11],s34 offen offset:2560 sc1
MF v[180:183],v[32:35],a[100:103],v[180:183]
ds_read_b128 v[28:31],v2 offset:64512
v_fma_f32 v60,v60,v210,v202
MF v[148:151],v[36:39],a[96:99],v[148:151]
v_fma_f32 v61,v61,v211,v203
v_fma_f32 v62,v62,v212,v204
MF v[184:187],v[36:39],a[100:103],v[184:187]
ds_read_b128 v[32:35],v3 offset:0
s_waitcnt lgkmcnt(5)
MF v[152:155],v[40:43],a[96:99],v[152:155]
v_fma_f32 v63,v63,v213,v205
v_cvt_pk_bf16_f32 v60,v60,v61
MF v[188:191],v[40:43],a[100:103],v[188:191]
ds_read_b128 v[36:39],v3 offset:1024
v_cvt_pk_bf16_f32 v61,v62,v63
MF v[120:123],v[44:47],a[104:107],v[120:123]
buffer_store_dwordx2 v[60:61],v222,s[8:11],s34 offen offset:3072 sc1
v_fma_f32 v96,v96,v214,v206
MF v[156:159],v[44:47],a[108:111],v[156:159]
ds_read_b128 v[40:43],v3 offset:2048
s_waitcnt lgkmcnt(5)
MF v[124:127],v[16:19],a[104:107],v[124:127]
v_fma_f32 v97,v97,v215,v207
v_fma_f32 v98,v98,v216,v208
MF v[160:163],v[16:19],a[108:111],v[160:163]
ds_read_b128 v[44:47],v3 offset:3072
v_fma_f32 v99,v99,v217,v209
MF v[128:131],v[20:23],a[104:107],v[128:131]
v_cvt_pk_bf16_f32 v96,v96,v97
v_cvt_pk_bf16_f32 v97,v98,v99
MF v[164:167],v[20:23],a[108:111],v[164:167]
s_barrier
ds_read_b128 v[16:19],v3 offset:4096
s_waitcnt lgkmcnt(5)
MF v[132:135],v[24:27],a[104:107],v[132:135]
buffer_store_dwordx2 v[96:97],v222,s[8:11],s34 offen offset:3584 sc1
v_fma_f32 v64,v64,v210,v202
MF v[168:171],v[24:27],a[108:111],v[168:171]
ds_read_b128 v[20:23],v3 offset:5120
v_fma_f32 v65,v65,v211,v203
MF v[136:139],v[28:31],a[104:107],v[136:139]
v_fma_f32 v66,v66,v212,v204
v_fma_f32 v67,v67,v213,v205
MF v[172:175],v[28:31],a[108:111],v[172:175]
ds_read_b128 v[24:27],v3 offset:6144
s_waitcnt lgkmcnt(5)
MF v[140:143],v[32:35],a[104:107],v[140:143]
v_cvt_pk_bf16_f32 v64,v64,v65
v_cvt_pk_bf16_f32 v65,v66,v67
MF v[176:179],v[32:35],a[108:111],v[176:179]
ds_read_b128 v[28:31],v3 offset:7168
buffer_store_dwordx2 v[64:65],v222,s[8:11],s35 offen offset:0 sc1
MF v[144:147],v[36:39],a[104:107],v[144:147]
v_fma_f32 v100,v100,v214,v206
v_fma_f32 v101,v101,v215,v207
MF v[180:183],v[36:39],a[108:111],v[180:183]
ds_read_b128 v[32:35],v3 offset:8192
s_waitcnt lgkmcnt(5)
MF v[148:151],v[40:43],a[104:107],v[148:151]
v_fma_f32 v102,v102,v216,v208
v_fma_f32 v103,v103,v217,v209
MF v[184:187],v[40:43],a[108:111],v[184:187]
ds_read_b128 v[36:39],v3 offset:9216
v_cvt_pk_bf16_f32 v100,v100,v101
MF v[152:155],v[44:47],a[104:107],v[152:155]
v_cvt_pk_bf16_f32 v101,v102,v103
buffer_store_dwordx2 v[100:101],v222,s[8:11],s35 offen offset:512 sc1
MF v[188:191],v[44:47],a[108:111],v[188:191]
ds_read_b128 v[40:43],v3 offset:10240
s_waitcnt lgkmcnt(5)
MF v[120:123],v[16:19],a[112:115],v[120:123]
v_fma_f32 v68,v68,v210,v202
v_fma_f32 v69,v69,v211,v203
MF v[156:159],v[16:19],a[116:119],v[156:159]
ds_read_b128 v[44:47],v3 offset:11264
v_fma_f32 v70,v70,v212,v204
MF v[124:127],v[20:23],a[112:115],v[124:127]
v_fma_f32 v71,v71,v213,v205
v_cvt_pk_bf16_f32 v68,v68,v69
MF v[160:163],v[20:23],a[116:119],v[160:163]
ds_read_b128 v[16:19],v3 offset:12288
s_waitcnt lgkmcnt(5)
MF v[128:131],v[24:27],a[112:115],v[128:131]
v_cvt_pk_bf16_f32 v69,v70,v71
buffer_store_dwordx2 v[68:69],v222,s[8:11],s35 offen offset:1024 sc1
MF v[164:167],v[24:27],a[116:119],v[164:167]
ds_read_b128 v[20:23],v3 offset:13312
v_fma_f32 v104,v104,v214,v206
MF v[132:135],v[28:31],a[112:115],v[132:135]
v_fma_f32 v105,v105,v215,v207
v_fma_f32 v106,v106,v216,v208
MF v[168:171],v[28:31],a[116:119],v[168:171]
ds_read_b128 v[24:27],v3 offset:14336
s_waitcnt lgkmcnt(5)
MF v[136:139],v[32:35],a[112:115],v[136:139]
v_fma_f32 v107,v107,v217,v209
v_cvt_pk_bf16_f32 v104,v104,v105
MF v[172:175],v[32:35],a[116:119],v[172:175]
ds_read_b128 v[28:31],v3 offset:15360
v_cvt_pk_bf16_f32 v105,v106,v107
MF v[140:143],v[36:39],a[112:115],v[140:143]
buffer_store_dwordx2 v[104:105],v222,s[8:11],s35 offen offset:1536 sc1
v_fma_f32 v72,v72,v210,v202
MF v[176:179],v[36:39],a[116:119],v[176:179]
ds_read_b128 v[32:35],v3 offset:16384
s_waitcnt lgkmcnt(5)
MF v[144:147],v[40:43],a[112:115],v[144:147]
v_fma_f32 v73,v73,v211,v203
v_fma_f32 v74,v74,v212,v204
MF v[180:183],v[40:43],a[116:119],v[180:183]
ds_read_b128 v[36:39],v3 offset:17408
v_fma_f32 v75,v75,v213,v205
MF v[148:151],v[44:47],a[112:115],v[148:151]
v_cvt_pk_bf16_f32 v72,v72,v73
v_cvt_pk_bf16_f32 v73,v74,v75
MF v[184:187],v[44:47],a[116:119],v[184:187]
ds_read_b128 v[40:43],v3 offset:18432
s_waitcnt lgkmcnt(5)
MF v[152:155],v[16:19],a[112:115],v[152:155]
buffer_store_dwordx2 v[72:73],v222,s[8:11],s35 offen offset:2048 sc1
v_fma_f32 v108,v108,v214,v206
MF v[188:191],v[16:19],a[116:119],v[188:191]
ds_read_b128 v[44:47],v3 offset:19456
v_fma_f32 v109,v109,v215,v207
MF v[120:123],v[20:23],a[120:123],v[120:123]
v_fma_f32 v110,v110,v216,v208
v_fma_f32 v111,v111,v217,v209
MF v[156:159],v[20:23],a[124:127],v[156:159]
ds_read_b128 v[16:19],v3 offset:20480
s_waitcnt lgkmcnt(5)
MF v[124:127],v[24:27],a[120:123],v[124:127]
v_cvt_pk_bf16_f32 v108,v108,v109
v_cvt_pk_bf16_f32 v109,v110,v111
MF v[160:163],v[24:27],a[124:127],v[160:163]
ds_read_b128 v[20:23],v3 offset:21504
buffer_store_dwordx2 v[108:109],v222,s[8:11],s35 offen offset:2560 sc1
MF v[128:131],v[28:31],a[120:123],v[128:131]
v_fma_f32 v76,v76,v210,v202
v_fma_f32 v77,v77,v211,v203
MF v[164:167],v[28:31],a[124:127],v[164:167]
ds_read_b128 v[24:27],v3 offset:22528
s_waitcnt lgkmcnt(5)
MF v[132:135],v[32:35],a[120:123],v[132:135]
v_fma_f32 v78,v78,v212,v204
v_fma_f32 v79,v79,v213,v205
MF v[168:171],v[32:35],a[124:127],v[168:171]
ds_read_b128 v[28:31],v3 offset:23552
v_cvt_pk_bf16_f32 v76,v76,v77
MF v[136:139],v[36:39],a[120:123],v[136:139]
v_cvt_pk_bf16_f32 v77,v78,v79
buffer_store_dwordx2 v[76:77],v222,s[8:11],s35 offen offset:3072 sc1
MF v[172:175],v[36:39],a[124:127],v[172:175]
ds_read_b128 v[32:35],v3 offset:24576
s_waitcnt lgkmcnt(5)
MF v[140:143],v[40:43],a[120:123],v[140:143]
v_fma_f32 v112,v112,v214,v206
v_fma_f32 v113,v113,v215,v207
MF v[176:179],v[40:43],a[124:127],v[176:179]
ds_read_b128 v[36:39],v3 offset:25600
v_fma_f32 v114,v114,v216,v208
MF v[144:147],v[44:47],a[120:123],v[144:147]
v_fma_f32 v115,v115,v217,v209
v_cvt_pk_bf16_f32 v112,v112,v113
MF v[180:183],v[44:47],a[124:127],v[180:183]
ds_read_b128 v[40:43],v3 offset:26624
s_waitcnt lgkmcnt(5)
MF v[148:151],v[16:19],a[120:123],v[148:151]
v_cvt_pk_bf16_f32 v113,v114,v115
buffer_store_dwordx2 v[112:113],v222,s[8:11],s35 offen offset:3584 sc1
MF v[184:187],v[16:19],a[124:127],v[184:187]
ds_read_b128 v[44:47],v3 offset:27648
v_fma_f32 v80,v80,v210,v202
MF v[152:155],v[20:23],a[120:123],v[152:155]
v_fma_f32 v81,v81,v211,v203
v_fma_f32 v82,v82,v212,v204
MF v[188:191],v[20:23],a[124:127],v[188:191]
ds_read_b128 v[16:19],v1 offset:0
s_waitcnt lgkmcnt(5)
MF v[120:123],v[24:27],a[128:131],v[120:123]
v_fma_f32 v83,v83,v213,v205
v_cvt_pk_bf16_f32 v80,v80,v81
MF v[156:159],v[24:27],a[132:135],v[156:159]
ds_read_b128 v[20:23],v1 offset:1024
v_cvt_pk_bf16_f32 v81,v82,v83
MF v[124:127],v[28:31],a[128:131],v[124:127]
buffer_store_dwordx2 v[80:81],v222,s[8:11],s36 offen offset:0 sc1
v_fma_f32 v116,v116,v214,v206
MF v[160:163],v[28:31],a[132:135],v[160:163]
ds_read_b128 v[24:27],v1 offset:2048
s_waitcnt lgkmcnt(5)
MF v[128:131],v[32:35],a[128:131],v[128:131]
v_fma_f32 v117,v117,v215,v207
v_fma_f32 v118,v118,v216,v208
MF v[164:167],v[32:35],a[132:135],v[164:167]
ds_read_b128 v[28:31],v1 offset:3072
v_fma_f32 v119,v119,v217,v209
MF v[132:135],v[36:39],a[128:131],v[132:135]
v_cvt_pk_bf16_f32 v116,v116,v117
v_cvt_pk_bf16_f32 v117,v118,v119
MF v[168:171],v[36:39],a[132:135],v[168:171]
ds_read_b128 v[32:35],v1 offset:4096
s_waitcnt lgkmcnt(5)
MF v[136:139],v[40:43],a[128:131],v[136:139]
buffer_store_dwordx2 v[116:117],v222,s[8:11],s36 offen offset:512 sc1
v_lshlrev_b32 v13,4,v15
v_add_u32 v13,161344,v13
MF v[172:175],v[40:43],a[132:135],v[172:175]
ds_read_b128 v[36:39],v1 offset:5120
ds_read_b128 v[48:51],v13 offset:0
MF v[140:143],v[44:47],a[128:131],v[140:143]
ds_read_b128 v[52:55],v13 offset:64
ds_read_b128 v[56:59],v13 offset:128
MF v[176:179],v[44:47],a[132:135],v[176:179]
ds_read_b128 v[40:43],v1 offset:6144
s_waitcnt lgkmcnt(8)
MF v[144:147],v[16:19],a[128:131],v[144:147]
ds_read_b128 v[60:63],v13 offset:192
ds_read_b128 v[64:67],v13 offset:256
MF v[180:183],v[16:19],a[132:135],v[180:183]
ds_read_b128 v[44:47],v1 offset:7168
ds_read_b128 v[68:71],v13 offset:320
MF v[148:151],v[20:23],a[128:131],v[148:151]
ds_read_b128 v[72:75],v13 offset:384
ds_read_b128 v[76:79],v13 offset:448
MF v[184:187],v[20:23],a[132:135],v[184:187]
ds_read_b128 v[16:19],v1 offset:8192
s_waitcnt lgkmcnt(13)
MF v[152:155],v[24:27],a[128:131],v[152:155]
ds_read_b128 v[80:83],v13 offset:512
s_add_u32 m0,s21,52224
s_nop 0
buffer_load_dwordx4 v1,s[8:11],s84 offen offset:3072 sc1 lds
MF v[188:191],v[24:27],a[132:135],v[188:191]
ds_read_b128 v[20:23],v1 offset:9216
MF v[120:123],v[28:31],a[136:139],v[120:123]
s_add_u32 m0,s21,53248
s_nop 0
buffer_load_dwordx4 v1,s[8:11],s85 offen offset:3072 sc1 lds
MF v[156:159],v[28:31],a[140:143],v[156:159]
s_waitcnt lgkmcnt(12)
ds_read_b128 v[24:27],v1 offset:10240
MF v[124:127],v[32:35],a[136:139],v[124:127]
MF v[160:163],v[32:35],a[140:143],v[160:163]
ds_read_b128 v[28:31],v1 offset:11264
s_add_u32 m0,s21,54272
s_nop 0
buffer_load_dwordx4 v1,s[8:11],s86 offen offset:3072 sc1 lds
MF v[128:131],v[36:39],a[136:139],v[128:131]
MF v[164:167],v[36:39],a[140:143],v[164:167]
s_waitcnt lgkmcnt(8)
s_add_u32 m0,s21,55296
s_nop 0
buffer_load_dwordx4 v1,s[8:11],s87 offen offset:3072 sc1 lds
MF v[132:135],v[40:43],a[136:139],v[132:135]
MF v[168:171],v[40:43],a[140:143],v[168:171]
s_add_u32 m0,s21,56320
s_nop 0
buffer_load_dwordx4 v1,s[8:11],s88 offen offset:3072 sc1 lds
MF v[136:139],v[44:47],a[136:139],v[136:139]
MF v[172:175],v[44:47],a[140:143],v[172:175]
s_waitcnt lgkmcnt(2)
s_add_u32 m0,s21,57344
s_nop 0
buffer_load_dwordx4 v1,s[8:11],s89 offen offset:3072 sc1 lds
MF v[140:143],v[16:19],a[136:139],v[140:143]
MF v[176:179],v[16:19],a[140:143],v[176:179]
MF v[144:147],v[20:23],a[136:139],v[144:147]
MF v[180:183],v[20:23],a[140:143],v[180:183]
s_waitcnt lgkmcnt(0)
MF v[148:151],v[24:27],a[136:139],v[148:151]
MF v[184:187],v[24:27],a[140:143],v[184:187]
MF v[152:155],v[28:31],a[136:139],v[152:155]
MF v[188:191],v[28:31],a[140:143],v[188:191]
v_mov_b32 v13,1
v_mov_b32 v12,0
s_waitcnt vmcnt(6)
s_mov_b32 exec_lo,0x1
s_mov_b32 exec_hi,0x0
buffer_atomic_or v13,v12,s[8:11],s78 offen sc1
s_mov_b64 exec,-1
s_lshl_b32 s46,s44,4
s_add_u32 s46,s46,s45
s_lshl_b32 s46,s46,3
s_lshl_b32 s47,s22,1
s_add_u32 s46,s46,s47
s_mul_i32 s46,s46,4608
s_add_u32 s34,s46,0x2d00000
s_add_u32 s35,s34,4096
s_add_u32 s36,s34,8192
v_lshlrev_b32 v9,3,v0
s_waitcnt lgkmcnt(0)
s_nop 7
v_pk_fma_f32 v[120:121],v[218:219],v[48:49],v[120:121] op_sel_hi:[0,1,1]
v_pk_fma_f32 v[122:123],v[218:219],v[50:51],v[122:123] op_sel_hi:[0,1,1]
v_pk_fma_f32 v[156:157],v[218:219],v[48:49],v[156:157] op_sel:[1,0,0]
v_pk_fma_f32 v[158:159],v[218:219],v[50:51],v[158:159] op_sel:[1,0,0]
v_pk_mul_f32 v[120:121],v[120:121],v[220:221] op_sel_hi:[1,0]
v_pk_mul_f32 v[122:123],v[122:123],v[220:221] op_sel_hi:[1,0]
v_pk_mul_f32 v[156:157],v[156:157],v[220:221] op_sel:[0,1]
v_pk_mul_f32 v[158:159],v[158:159],v[220:221] op_sel:[0,1]
v_cvt_pk_bf16_f32 v120,v120,v121
v_cvt_pk_bf16_f32 v121,v122,v123
v_accvgpr_write_b32 a216,v120
v_accvgpr_write_b32 a217,v121
v_cvt_pk_bf16_f32 v156,v156,v157
v_cvt_pk_bf16_f32 v157,v158,v159
v_accvgpr_write_b32 a234,v156
v_accvgpr_write_b32 a235,v157
v_pk_fma_f32 v[124:125],v[218:219],v[52:53],v[124:125] op_sel_hi:[0,1,1]
v_pk_fma_f32 v[126:127],v[218:219],v[54:55],v[126:127] op_sel_hi:[0,1,1]
v_pk_fma_f32 v[160:161],v[218:219],v[52:53],v[160:161] op_sel:[1,0,0]
v_pk_fma_f32 v[162:163],v[218:219],v[54:55],v[162:163] op_sel:[1,0,0]
v_pk_mul_f32 v[124:125],v[124:125],v[220:221] op_sel_hi:[1,0]
v_pk_mul_f32 v[126:127],v[126:127],v[220:221] op_sel_hi:[1,0]
v_pk_mul_f32 v[160:161],v[160:161],v[220:221] op_sel:[0,1]
v_pk_mul_f32 v[162:163],v[162:163],v[220:221] op_sel:[0,1]
v_cvt_pk_bf16_f32 v124,v124,v125
v_cvt_pk_bf16_f32 v125,v126,v127
v_accvgpr_write_b32 a218,v124
v_accvgpr_write_b32 a219,v125
v_cvt_pk_bf16_f32 v160,v160,v161
v_cvt_pk_bf16_f32 v161,v162,v163
v_accvgpr_write_b32 a236,v160
v_accvgpr_write_b32 a237,v161
v_pk_fma_f32 v[128:129],v[218:219],v[56:57],v[128:129] op_sel_hi:[0,1,1]
v_pk_fma_f32 v[130:131],v[218:219],v[58:59],v[130:131] op_sel_hi:[0,1,1]
v_pk_fma_f32 v[164:165],v[218:219],v[56:57],v[164:165] op_sel:[1,0,0]
v_pk_fma_f32 v[166:167],v[218:219],v[58:59],v[166:167] op_sel:[1,0,0]
v_pk_mul_f32 v[128:129],v[128:129],v[220:221] op_sel_hi:[1,0]
v_pk_mul_f32 v[130:131],v[130:131],v[220:221] op_sel_hi:[1,0]
v_pk_mul_f32 v[164:165],v[164:165],v[220:221] op_sel:[0,1]
v_pk_mul_f32 v[166:167],v[166:167],v[220:221] op_sel:[0,1]
v_cvt_pk_bf16_f32 v128,v128,v129
v_cvt_pk_bf16_f32 v129,v130,v131
v_accvgpr_write_b32 a220,v128
v_accvgpr_write_b32 a221,v129
v_cvt_pk_bf16_f32 v164,v164,v165
v_cvt_pk_bf16_f32 v165,v166,v167
v_accvgpr_write_b32 a238,v164
v_accvgpr_write_b32 a239,v165
v_pk_fma_f32 v[132:133],v[218:219],v[60:61],v[132:133] op_sel_hi:[0,1,1]
v_pk_fma_f32 v[134:135],v[218:219],v[62:63],v[134:135] op_sel_hi:[0,1,1]
v_pk_fma_f32 v[168:169],v[218:219],v[60:61],v[168:169] op_sel:[1,0,0]
v_pk_fma_f32 v[170:171],v[218:219],v[62:63],v[170:171] op_sel:[1,0,0]
v_pk_mul_f32 v[132:133],v[132:133],v[220:221] op_sel_hi:[1,0]
v_pk_mul_f32 v[134:135],v[134:135],v[220:221] op_sel_hi:[1,0]
v_pk_mul_f32 v[168:169],v[168:169],v[220:221] op_sel:[0,1]
v_pk_mul_f32 v[170:171],v[170:171],v[220:221] op_sel:[0,1]
v_cvt_pk_bf16_f32 v132,v132,v133
v_cvt_pk_bf16_f32 v133,v134,v135
v_accvgpr_write_b32 a222,v132
v_accvgpr_write_b32 a223,v133
v_cvt_pk_bf16_f32 v168,v168,v169
v_cvt_pk_bf16_f32 v169,v170,v171
v_accvgpr_write_b32 a240,v168
v_accvgpr_write_b32 a241,v169
v_pk_fma_f32 v[136:137],v[218:219],v[64:65],v[136:137] op_sel_hi:[0,1,1]
v_pk_fma_f32 v[138:139],v[218:219],v[66:67],v[138:139] op_sel_hi:[0,1,1]
v_pk_fma_f32 v[172:173],v[218:219],v[64:65],v[172:173] op_sel:[1,0,0]
v_pk_fma_f32 v[174:175],v[218:219],v[66:67],v[174:175] op_sel:[1,0,0]
v_pk_mul_f32 v[136:137],v[136:137],v[220:221] op_sel_hi:[1,0]
v_pk_mul_f32 v[138:139],v[138:139],v[220:221] op_sel_hi:[1,0]
v_pk_mul_f32 v[172:173],v[172:173],v[220:221] op_sel:[0,1]
v_pk_mul_f32 v[174:175],v[174:175],v[220:221] op_sel:[0,1]
v_cvt_pk_bf16_f32 v136,v136,v137
v_cvt_pk_bf16_f32 v137,v138,v139
v_accvgpr_write_b32 a224,v136
v_accvgpr_write_b32 a225,v137
v_cvt_pk_bf16_f32 v172,v172,v173
v_cvt_pk_bf16_f32 v173,v174,v175
v_accvgpr_write_b32 a242,v172
v_accvgpr_write_b32 a243,v173
v_pk_fma_f32 v[140:141],v[218:219],v[68:69],v[140:141] op_sel_hi:[0,1,1]
v_pk_fma_f32 v[142:143],v[218:219],v[70:71],v[142:143] op_sel_hi:[0,1,1]
v_pk_fma_f32 v[176:177],v[218:219],v[68:69],v[176:177] op_sel:[1,0,0]
v_pk_fma_f32 v[178:179],v[218:219],v[70:71],v[178:179] op_sel:[1,0,0]
v_pk_mul_f32 v[140:141],v[140:141],v[220:221] op_sel_hi:[1,0]
v_pk_mul_f32 v[142:143],v[142:143],v[220:221] op_sel_hi:[1,0]
v_pk_mul_f32 v[176:177],v[176:177],v[220:221] op_sel:[0,1]
v_pk_mul_f32 v[178:179],v[178:179],v[220:221] op_sel:[0,1]
v_cvt_pk_bf16_f32 v140,v140,v141
v_cvt_pk_bf16_f32 v141,v142,v143
v_accvgpr_write_b32 a226,v140
v_accvgpr_write_b32 a227,v141
v_cvt_pk_bf16_f32 v176,v176,v177
v_cvt_pk_bf16_f32 v177,v178,v179
v_accvgpr_write_b32 a244,v176
v_accvgpr_write_b32 a245,v177
v_pk_fma_f32 v[144:145],v[218:219],v[72:73],v[144:145] op_sel_hi:[0,1,1]
v_pk_fma_f32 v[146:147],v[218:219],v[74:75],v[146:147] op_sel_hi:[0,1,1]
v_pk_fma_f32 v[180:181],v[218:219],v[72:73],v[180:181] op_sel:[1,0,0]
v_pk_fma_f32 v[182:183],v[218:219],v[74:75],v[182:183] op_sel:[1,0,0]
v_pk_mul_f32 v[144:145],v[144:145],v[220:221] op_sel_hi:[1,0]
v_pk_mul_f32 v[146:147],v[146:147],v[220:221] op_sel_hi:[1,0]
v_pk_mul_f32 v[180:181],v[180:181],v[220:221] op_sel:[0,1]
v_pk_mul_f32 v[182:183],v[182:183],v[220:221] op_sel:[0,1]
v_cvt_pk_bf16_f32 v144,v144,v145
v_cvt_pk_bf16_f32 v145,v146,v147
v_accvgpr_write_b32 a228,v144
v_accvgpr_write_b32 a229,v145
v_cvt_pk_bf16_f32 v180,v180,v181
v_cvt_pk_bf16_f32 v181,v182,v183
v_accvgpr_write_b32 a246,v180
v_accvgpr_write_b32 a247,v181
v_pk_fma_f32 v[148:149],v[218:219],v[76:77],v[148:149] op_sel_hi:[0,1,1]
v_pk_fma_f32 v[150:151],v[218:219],v[78:79],v[150:151] op_sel_hi:[0,1,1]
v_pk_fma_f32 v[184:185],v[218:219],v[76:77],v[184:185] op_sel:[1,0,0]
v_pk_fma_f32 v[186:187],v[218:219],v[78:79],v[186:187] op_sel:[1,0,0]
v_pk_mul_f32 v[148:149],v[148:149],v[220:221] op_sel_hi:[1,0]
v_pk_mul_f32 v[150:151],v[150:151],v[220:221] op_sel_hi:[1,0]
v_pk_mul_f32 v[184:185],v[184:185],v[220:221] op_sel:[0,1]
v_pk_mul_f32 v[186:187],v[186:187],v[220:221] op_sel:[0,1]
v_cvt_pk_bf16_f32 v148,v148,v149
v_cvt_pk_bf16_f32 v149,v150,v151
v_accvgpr_write_b32 a230,v148
v_accvgpr_write_b32 a231,v149
v_cvt_pk_bf16_f32 v184,v184,v185
v_cvt_pk_bf16_f32 v185,v186,v187
v_accvgpr_write_b32 a248,v184
v_accvgpr_write_b32 a249,v185
v_pk_fma_f32 v[152:153],v[218:219],v[80:81],v[152:153] op_sel_hi:[0,1,1]
v_pk_fma_f32 v[154:155],v[218:219],v[82:83],v[154:155] op_sel_hi:[0,1,1]
v_pk_fma_f32 v[188:189],v[218:219],v[80:81],v[188:189] op_sel:[1,0,0]
v_pk_fma_f32 v[190:191],v[218:219],v[82:83],v[190:191] op_sel:[1,0,0]
v_pk_mul_f32 v[152:153],v[152:153],v[220:221] op_sel_hi:[1,0]
v_pk_mul_f32 v[154:155],v[154:155],v[220:221] op_sel_hi:[1,0]
v_pk_mul_f32 v[188:189],v[188:189],v[220:221] op_sel:[0,1]
v_pk_mul_f32 v[190:191],v[190:191],v[220:221] op_sel:[0,1]
v_cvt_pk_bf16_f32 v152,v152,v153
v_cvt_pk_bf16_f32 v153,v154,v155
v_accvgpr_write_b32 a232,v152
v_accvgpr_write_b32 a233,v153
v_cvt_pk_bf16_f32 v188,v188,v189
v_cvt_pk_bf16_f32 v189,v190,v191
v_accvgpr_write_b32 a250,v188
v_accvgpr_write_b32 a251,v189
PH_k4_0:
s_and_b32 s44,s3,1
s_lshl_b32 s44,s44,3
s_and_b32 s45,s23,7
s_add_u32 s44,s44,s45
s_lshr_b32 s45,s3,1
s_lshl_b32 s45,s45,2
s_lshr_b32 s46,s23,3
s_add_u32 s45,s45,s46
v_add_u32 v2,4096,v1
v_add_u32 v3,8192,v1
v_add_u32 v4,12288,v1
s_lshl_b32 s46,s22,1
s_add_u32 s46,s46,0
s_and_b32 s46,s46,7
s_lshl_b32 s47,s44,3
s_add_u32 s46,s46,s47
s_lshl_b32 s46,s46,16
s_lshl_b32 s47,s22,14
s_add_u32 s46,s46,s47
s_add_u32 s24,s46,0x880000
s_lshl_b32 s46,s22,1
s_add_u32 s46,s46,1
s_and_b32 s46,s46,7
s_lshl_b32 s47,s44,3
s_add_u32 s46,s46,s47
s_lshl_b32 s46,s46,16
s_lshl_b32 s47,s22,14
s_add_u32 s46,s46,s47
s_add_u32 s25,s46,0x880000
s_lshl_b32 s46,s22,1
s_add_u32 s46,s46,2
s_and_b32 s46,s46,7
s_lshl_b32 s47,s44,3
s_add_u32 s46,s46,s47
s_lshl_b32 s46,s46,16
s_lshl_b32 s47,s22,14
s_add_u32 s46,s46,s47
s_add_u32 s26,s46,0x880000
s_lshl_b32 s46,s22,1
s_add_u32 s46,s46,3
s_and_b32 s46,s46,7
s_lshl_b32 s47,s44,3
s_add_u32 s46,s46,s47
s_lshl_b32 s46,s46,16
s_lshl_b32 s47,s22,14
s_add_u32 s46,s46,s47
s_add_u32 s27,s46,0x880000
s_lshl_b32 s46,s22,1
s_add_u32 s46,s46,4
s_and_b32 s46,s46,7
s_lshl_b32 s47,s44,3
s_add_u32 s46,s46,s47
s_lshl_b32 s46,s46,16
s_lshl_b32 s47,s22,14
s_add_u32 s46,s46,s47
s_add_u32 s28,s46,0x880000
s_lshl_b32 s46,s22,1
s_add_u32 s46,s46,5
s_and_b32 s46,s46,7
s_lshl_b32 s47,s44,3
s_add_u32 s46,s46,s47
s_lshl_b32 s46,s46,16
s_lshl_b32 s47,s22,14
s_add_u32 s46,s46,s47
s_add_u32 s29,s46,0x880000
s_lshl_b32 s46,s22,1
s_add_u32 s46,s46,6
s_and_b32 s46,s46,7
s_lshl_b32 s47,s44,3
s_add_u32 s46,s46,s47
s_lshl_b32 s46,s46,16
s_lshl_b32 s47,s22,14
s_add_u32 s46,s46,s47
s_add_u32 s30,s46,0x880000
s_lshl_b32 s46,s22,1
s_add_u32 s46,s46,7
s_and_b32 s46,s46,7
s_lshl_b32 s47,s44,3
s_add_u32 s46,s46,s47
s_lshl_b32 s46,s46,16
s_lshl_b32 s47,s22,14
s_add_u32 s46,s46,s47
s_add_u32 s31,s46,0x880000
s_lshl_b32 s46,s45,6
s_lshl_b32 s47,s22,4
s_add_u32 s46,s46,s47
s_mul_i32 s32,s46,9216
s_add_u32 s32,s32,0x2400000
s_lshl_b32 s79,s45,11
s_add_u32 s79,s79,0x1320000
v_lshlrev_b32 v198,2,v0
s_cmp_eq_u32 s22,0
s_cselect_b32 s79,s79,0x40000000
v_mov_b32 v199,0
buffer_atomic_or v199,v198,s[8:11],s79 offen sc0 sc1
buffer_load_dwordx4 v[16:19],v1,s[8:11],s24 offen offset:0 sc1
buffer_load_dwordx4 v[20:23],v1,s[8:11],s25 offen offset:0 sc1
buffer_load_dwordx4 v[24:27],v1,s[8:11],s26 offen offset:0 sc1
buffer_load_dwordx4 v[28:31],v1,s[8:11],s27 offen offset:0 sc1
buffer_load_dwordx4 v[32:35],v1,s[8:11],s28 offen offset:0 sc1
buffer_load_dwordx4 v[36:39],v1,s[8:11],s29 offen offset:0 sc1
buffer_load_dwordx4 v[40:43],v1,s[8:11],s30 offen offset:0 sc1
buffer_load_dwordx4 v[44:47],v1,s[8:11],s31 offen offset:0 sc1
buffer_load_dwordx4 v[48:51],v1,s[8:11],s24 offen offset:1024 sc1
buffer_load_dwordx4 v[52:55],v1,s[8:11],s25 offen offset:1024 sc1
buffer_load_dwordx4 v[56:59],v1,s[8:11],s26 offen offset:1024 sc1
buffer_load_dwordx4 v[60:63],v1,s[8:11],s27 offen offset:1024 sc1
v_lshlrev_b32 v12,1,v14
s_lshl_b32 s46,s44,8
s_lshl_b32 s47,s22,6
s_add_u32 s46,s46,s47
buffer_load_ushort v10,v12,s[12:15],s46 offen offset:0
buffer_load_ushort v11,v12,s[12:15],s46 offen offset:32
s_add_u32 s46,s22,1
s_and_b32 s46,s46,3
s_mul_i32 s46,s46,18432
s_add_u32 s46,s46,0
v_add_u32 v5,s46,v1
s_add_u32 s46,s22,2
s_and_b32 s46,s46,3
s_mul_i32 s46,s46,18432
s_add_u32 s46,s46,73728
v_add_u32 v6,s46,v1
s_add_u32 s46,s22,3
s_and_b32 s46,s46,3
s_mul_i32 s46,s46,18432
s_add_u32 s46,s46,0
v_add_u32 v7,s46,v1
s_mul_i32 s46,s22,18432
v_add_u32 v8,s46,v1
v_add_u32 v9,73728,v8
s_getpc_b64 s[58:59]
PC_mega_kernel_7:
s_mul_i32 s46,s23,4
s_add_u32 s46,s46,s22
s_lshl_b32 s46,s46,10
v_add_u32 v13,s46,v1
v_add_u32 v13,PH_k5_0-PC_mega_kernel_7,v13
v_min_u32 v13,PH_k1_1-PC_mega_kernel_7-16,v13
v_and_b32 v13,-4,v13
global_load_dwordx4 a[252:255],v13,s[58:59]
s_waitcnt vmcnt(15)
v_cmp_eq_u32 vcc,0,v199
s_cbranch_vccz DW_mega_kernel_8G
s_mov_b32 s53,0
s_cmp_lg_u32 s22,0
s_cbranch_scc1 DW_mega_kernel_8G
DW_mega_kernel_8:
s_nop 7
s_nop 3
v_mov_b32 v199,0
buffer_atomic_or v199,v198,s[8:11],s79 offen sc0 sc1
s_add_u32 s53,s53,1
s_waitcnt vmcnt(0)
v_cmp_eq_u32 vcc,0,v199
s_cbranch_vccz DW_mega_kernel_8G
s_cmp_lt_u32 s53,100000
s_cbranch_scc1 DW_mega_kernel_8
DW_mega_kernel_8G:
s_nop 7
s_nop 3
s_barrier
s_add_u32 s33,s32,0
buffer_load_dwordx4 v[64:67],v1,s[8:11],s33 offen offset:0 sc1
buffer_load_dwordx4 v[68:71],v1,s[8:11],s33 offen offset:1024 sc1
buffer_load_dwordx4 v[72:75],v1,s[8:11],s33 offen offset:2048 sc1
buffer_load_dwordx4 v[76:79],v1,s[8:11],s33 offen offset:3072 sc1
s_add_u32 s33,s32,4096
buffer_load_dwordx4 v[80:83],v1,s[8:11],s33 offen offset:0 sc1
buffer_load_dwordx4 v[84:87],v1,s[8:11],s33 offen offset:1024 sc1
buffer_load_dwordx4 v[88:91],v1,s[8:11],s33 offen offset:2048 sc1
buffer_load_dwordx4 v[92:95],v1,s[8:11],s33 offen offset:3072 sc1
s_add_u32 s33,s32,8192
buffer_load_dwordx4 v[96:99],v1,s[8:11],s33 offen offset:0 sc1
s_mul_i32 s46,s22,10240
v_add_u32 v12,s46,v1
s_lshl_b32 s46,s22,13
v_add_u32 v177,s46,v1
s_add_u32 s33,s32,9216
buffer_load_dwordx4 v[100:103],v1,s[8:11],s33 offen offset:0 sc1
buffer_load_dwordx4 v[104:107],v1,s[8:11],s33 offen offset:1024 sc1
buffer_load_dwordx4 v[108:111],v1,s[8:11],s33 offen offset:2048 sc1
buffer_load_dwordx4 v[112:115],v1,s[8:11],s33 offen offset:3072 sc1
s_add_u32 s33,s32,13312
buffer_load_dwordx4 v[116:119],v1,s[8:11],s33 offen offset:0 sc1
buffer_load_dwordx4 v[120:123],v1,s[8:11],s33 offen offset:1024 sc1
buffer_load_dwordx4 v[124:127],v1,s[8:11],s33 offen offset:2048 sc1
buffer_load_dwordx4 v[128:131],v1,s[8:11],s33 offen offset:3072 sc1
s_add_u32 s33,s32,17408
buffer_load_dwordx4 v[132:135],v1,s[8:11],s33 offen offset:0 sc1
s_waitcnt vmcnt(32)
s_waitcnt vmcnt(17)
MF v[184:187],v[64:67],v[16:19],0
s_waitcnt vmcnt(16)
MF v[188:191],v[68:71],v[16:19],0
s_waitcnt vmcnt(15)
MF v[192:195],v[72:75],v[16:19],0
s_add_u32 s33,s32,18432
buffer_load_dwordx4 v[136:139],v1,s[8:11],s33 offen offset:0 sc1
s_waitcnt vmcnt(15)
MF v[196:199],v[76:79],v[16:19],0
s_waitcnt vmcnt(14)
MF v[200:203],v[80:83],v[16:19],0
s_waitcnt vmcnt(13)
MF v[204:207],v[84:87],v[16:19],0
s_waitcnt vmcnt(12)
MF v[208:211],v[88:91],v[16:19],0
buffer_load_dwordx4 v[140:143],v1,s[8:11],s33 offen offset:1024 sc1
s_waitcnt vmcnt(12)
MF v[212:215],v[92:95],v[16:19],0
s_waitcnt vmcnt(11)
MF v[216:219],v[96:99],v[16:19],0
ds_read_b128 v[16:19],v12 offset:12288
MF v[220:223],v[64:67],v[20:23],0
v_mov_b32 v13,0xbdd2d3e8
MF v[224:227],v[68:71],v[20:23],0
v_accvgpr_read_b32 v176,a216
v_accvgpr_read_b32 v182,a217
MF v[228:231],v[72:75],v[20:23],0
buffer_load_dwordx4 v[144:147],v1,s[8:11],s33 offen offset:2048 sc1
MF v[232:235],v[76:79],v[20:23],0
v_lshlrev_b32 v172,16,v176
MF v[236:239],v[80:83],v[20:23],0
v_lshlrev_b32 v178,16,v182
v_and_b32 v173,0xffff0000,v176
MF v[240:243],v[84:87],v[20:23],0
v_and_b32 v179,0xffff0000,v182
MF v[244:247],v[88:91],v[20:23],0
buffer_load_dwordx4 v[148:151],v1,s[8:11],s33 offen offset:3072 sc1
MF v[248:251],v[92:95],v[20:23],0
v_mul_f32 v174,v172,v172
MF v[252:255],v[96:99],v[20:23],0
ds_read_b128 v[20:23],v12 offset:13312
MF a[0:3],v[64:67],v[24:27],0
v_mul_f32 v180,v178,v178
MF a[4:7],v[68:71],v[24:27],0
v_mul_f32 v175,v173,v173
v_mul_f32 v181,v179,v179
MF a[8:11],v[72:75],v[24:27],0
s_add_u32 s33,s32,22528
buffer_load_dwordx4 v[152:155],v1,s[8:11],s33 offen offset:0 sc1
MF a[12:15],v[76:79],v[24:27],0
v_fmaak_f32 v174,v174,v13,0xc0135761
MF a[16:19],v[80:83],v[24:27],0
v_fmaak_f32 v180,v180,v13,0xc0135761
v_fmaak_f32 v175,v175,v13,0xc0135761
MF a[20:23],v[84:87],v[24:27],0
v_fmaak_f32 v181,v181,v13,0xc0135761
MF a[24:27],v[88:91],v[24:27],0
buffer_load_dwordx4 v[156:159],v1,s[8:11],s33 offen offset:1024 sc1
MF a[28:31],v[92:95],v[24:27],0
v_mul_f32 v174,v174,v172
MF a[32:35],v[96:99],v[24:27],0
ds_read_b128 v[24:27],v12 offset:14336
MF a[36:39],v[64:67],v[28:31],0
v_mul_f32 v180,v180,v178
MF a[40:43],v[68:71],v[28:31],0
v_mul_f32 v175,v175,v173
v_mul_f32 v181,v181,v179
MF a[44:47],v[72:75],v[28:31],0
buffer_load_dwordx4 v[160:163],v1,s[8:11],s33 offen offset:2048 sc1
MF a[48:51],v[76:79],v[28:31],0
v_exp_f32 v174,v174
MF a[52:55],v[80:83],v[28:31],0
v_exp_f32 v180,v180
MF a[56:59],v[84:87],v[28:31],0
v_exp_f32 v175,v175
MF a[60:63],v[88:91],v[28:31],0
buffer_load_dwordx4 v[164:167],v1,s[8:11],s33 offen offset:3072 sc1
MF a[64:67],v[92:95],v[28:31],0
v_exp_f32 v181,v181
MF a[68:71],v[96:99],v[28:31],0
ds_read_b128 v[28:31],v12 offset:15360
MF a[72:75],v[64:67],v[32:35],0
v_add_f32 v174,1.0,v174
MF a[76:79],v[68:71],v[32:35],0
v_add_f32 v180,1.0,v180
v_add_f32 v175,1.0,v175
MF a[80:83],v[72:75],v[32:35],0
s_add_u32 s33,s32,26624
buffer_load_dwordx4 v[168:171],v1,s[8:11],s33 offen offset:0 sc1
MF a[84:87],v[76:79],v[32:35],0
v_add_f32 v181,1.0,v181
MF a[88:91],v[80:83],v[32:35],0
v_rcp_f32 v174,v174
MF a[92:95],v[84:87],v[32:35],0
v_rcp_f32 v180,v180
MF a[96:99],v[88:91],v[32:35],0
MF a[100:103],v[92:95],v[32:35],0
v_rcp_f32 v175,v175
MF a[104:107],v[96:99],v[32:35],0
ds_read_b128 v[32:35],v12 offset:16384
MF a[108:111],v[64:67],v[36:39],0
v_rcp_f32 v181,v181
MF a[112:115],v[68:71],v[36:39],0
v_mul_f32 v172,v172,v174
v_mul_f32 v178,v178,v180
MF a[116:119],v[72:75],v[36:39],0
v_mul_f32 v173,v173,v175
MF a[120:123],v[76:79],v[36:39],0
v_mul_f32 v179,v179,v181
MF a[124:127],v[80:83],v[36:39],0
v_cvt_pk_bf16_f32 v176,v172,v173
v_cvt_pk_bf16_f32 v182,v178,v179
MF a[128:131],v[84:87],v[36:39],0
v_accvgpr_write_b32 a216,v176
MF a[132:135],v[88:91],v[36:39],0
v_accvgpr_write_b32 a217,v182
MF a[136:139],v[92:95],v[36:39],0
v_accvgpr_read_b32 v176,a218
MF a[140:143],v[96:99],v[36:39],0
ds_read_b128 v[36:39],v12 offset:17408
MF a[144:147],v[64:67],v[40:43],0
v_accvgpr_read_b32 v182,a219
MF a[148:151],v[68:71],v[40:43],0
v_lshlrev_b32 v172,16,v176
v_lshlrev_b32 v178,16,v182
MF a[152:155],v[72:75],v[40:43],0
v_and_b32 v173,0xffff0000,v176
MF a[156:159],v[76:79],v[40:43],0
v_and_b32 v179,0xffff0000,v182
MF a[160:163],v[80:83],v[40:43],0
v_mul_f32 v174,v172,v172
v_mul_f32 v180,v178,v178
MF a[164:167],v[84:87],v[40:43],0
v_mul_f32 v175,v173,v173
MF a[168:171],v[88:91],v[40:43],0
v_mul_f32 v181,v179,v179
MF a[172:175],v[92:95],v[40:43],0
v_fmaak_f32 v174,v174,v13,0xc0135761
MF a[176:179],v[96:99],v[40:43],0
ds_read_b128 v[40:43],v12 offset:18432
MF a[180:183],v[64:67],v[44:47],0
v_fmaak_f32 v180,v180,v13,0xc0135761
MF a[184:187],v[68:71],v[44:47],0
v_fmaak_f32 v175,v175,v13,0xc0135761
v_fmaak_f32 v181,v181,v13,0xc0135761
MF a[188:191],v[72:75],v[44:47],0
v_mul_f32 v174,v174,v172
MF a[192:195],v[76:79],v[44:47],0
v_mul_f32 v180,v180,v178
MF a[196:199],v[80:83],v[44:47],0
v_mul_f32 v175,v175,v173
v_mul_f32 v181,v181,v179
MF a[200:203],v[84:87],v[44:47],0
v_exp_f32 v174,v174
MF a[204:207],v[88:91],v[44:47],0
v_exp_f32 v180,v180
MF a[208:211],v[92:95],v[44:47],0
v_exp_f32 v175,v175
MF a[212:215],v[96:99],v[44:47],0
ds_read_b128 v[44:47],v12 offset:19456
s_waitcnt vmcnt(17)
MF v[184:187],v[100:103],v[48:51],v[184:187]
s_waitcnt vmcnt(16)
MF v[188:191],v[104:107],v[48:51],v[188:191]
s_waitcnt vmcnt(15)
MF v[192:195],v[108:111],v[48:51],v[192:195]
s_add_u32 s33,s32,27648
buffer_load_dwordx4 v[64:67],v1,s[8:11],s33 offen offset:0 sc1
s_waitcnt vmcnt(15)
MF v[196:199],v[112:115],v[48:51],v[196:199]
s_waitcnt vmcnt(14)
MF v[200:203],v[116:119],v[48:51],v[200:203]
s_waitcnt vmcnt(13)
MF v[204:207],v[120:123],v[48:51],v[204:207]
s_waitcnt vmcnt(12)
MF v[208:211],v[124:127],v[48:51],v[208:211]
buffer_load_dwordx4 v[68:71],v1,s[8:11],s33 offen offset:1024 sc1
s_waitcnt vmcnt(12)
MF v[212:215],v[128:131],v[48:51],v[212:215]
s_waitcnt vmcnt(11)
MF v[216:219],v[132:135],v[48:51],v[216:219]
ds_read_b128 v[48:51],v12 offset:20480
MF v[220:223],v[100:103],v[52:55],v[220:223]
v_exp_f32 v181,v181
MF v[224:227],v[104:107],v[52:55],v[224:227]
v_add_f32 v174,1.0,v174
v_add_f32 v180,1.0,v180
MF v[228:231],v[108:111],v[52:55],v[228:231]
buffer_load_dwordx4 v[72:75],v1,s[8:11],s33 offen offset:2048 sc1
MF v[232:235],v[112:115],v[52:55],v[232:235]
v_add_f32 v175,1.0,v175
MF v[236:239],v[116:119],v[52:55],v[236:239]
v_add_f32 v181,1.0,v181
v_rcp_f32 v174,v174
MF v[240:243],v[120:123],v[52:55],v[240:243]
v_rcp_f32 v180,v180
MF v[244:247],v[124:127],v[52:55],v[244:247]
buffer_load_dwordx4 v[76:79],v1,s[8:11],s33 offen offset:3072 sc1
MF v[248:251],v[128:131],v[52:55],v[248:251]
v_rcp_f32 v175,v175
MF v[252:255],v[132:135],v[52:55],v[252:255]
ds_read_b128 v[52:55],v12 offset:21504
MF a[0:3],v[100:103],v[56:59],a[0:3]
v_rcp_f32 v181,v181
MF a[4:7],v[104:107],v[56:59],a[4:7]
v_mul_f32 v172,v172,v174
v_mul_f32 v178,v178,v180
MF a[8:11],v[108:111],v[56:59],a[8:11]
s_add_u32 s33,s32,31744
buffer_load_dwordx4 v[80:83],v1,s[8:11],s33 offen offset:0 sc1
MF a[12:15],v[112:115],v[56:59],a[12:15]
v_mul_f32 v173,v173,v175
MF a[16:19],v[116:119],v[56:59],a[16:19]
v_mul_f32 v179,v179,v181
v_cvt_pk_bf16_f32 v176,v172,v173
MF a[20:23],v[120:123],v[56:59],a[20:23]
v_cvt_pk_bf16_f32 v182,v178,v179
MF a[24:27],v[124:127],v[56:59],a[24:27]
buffer_load_dwordx4 v[84:87],v1,s[8:11],s33 offen offset:1024 sc1
MF a[28:31],v[128:131],v[56:59],a[28:31]
v_accvgpr_write_b32 a218,v176
MF a[32:35],v[132:135],v[56:59],a[32:35]
ds_read_b128 v[56:59],v177 offset:53248
MF a[36:39],v[100:103],v[60:63],a[36:39]
v_accvgpr_write_b32 a219,v182
MF a[40:43],v[104:107],v[60:63],a[40:43]
v_accvgpr_read_b32 v176,a220
v_accvgpr_read_b32 v182,a221
MF a[44:47],v[108:111],v[60:63],a[44:47]
buffer_load_dwordx4 v[88:91],v1,s[8:11],s33 offen offset:2048 sc1
MF a[48:51],v[112:115],v[60:63],a[48:51]
v_lshlrev_b32 v172,16,v176
MF a[52:55],v[116:119],v[60:63],a[52:55]
v_lshlrev_b32 v178,16,v182
v_and_b32 v173,0xffff0000,v176
MF a[56:59],v[120:123],v[60:63],a[56:59]
v_and_b32 v179,0xffff0000,v182
MF a[60:63],v[124:127],v[60:63],a[60:63]
buffer_load_dwordx4 v[92:95],v1,s[8:11],s33 offen offset:3072 sc1
MF a[64:67],v[128:131],v[60:63],a[64:67]
v_mul_f32 v174,v172,v172
MF a[68:71],v[132:135],v[60:63],a[68:71]
ds_read_b128 v[60:63],v177 offset:54272
s_waitcnt lgkmcnt(11)
MF a[72:75],v[100:103],v[16:19],a[72:75]
v_mul_f32 v180,v178,v178
MF a[76:79],v[104:107],v[16:19],a[76:79]
v_mul_f32 v175,v173,v173
v_mul_f32 v181,v179,v179
MF a[80:83],v[108:111],v[16:19],a[80:83]
s_add_u32 s33,s32,35840
buffer_load_dwordx4 v[96:99],v1,s[8:11],s33 offen offset:0 sc1
MF a[84:87],v[112:115],v[16:19],a[84:87]
v_fmaak_f32 v174,v174,v13,0xc0135761
MF a[88:91],v[116:119],v[16:19],a[88:91]
v_fmaak_f32 v180,v180,v13,0xc0135761
v_fmaak_f32 v175,v175,v13,0xc0135761
MF a[92:95],v[120:123],v[16:19],a[92:95]
v_fmaak_f32 v181,v181,v13,0xc0135761
MF a[96:99],v[124:127],v[16:19],a[96:99]
MF a[100:103],v[128:131],v[16:19],a[100:103]
v_mul_f32 v174,v174,v172
MF a[104:107],v[132:135],v[16:19],a[104:107]
ds_read_b128 v[16:19],v177 offset:55296
s_waitcnt lgkmcnt(11)
MF a[108:111],v[100:103],v[20:23],a[108:111]
v_mul_f32 v180,v180,v178
MF a[112:115],v[104:107],v[20:23],a[112:115]
v_mul_f32 v175,v175,v173
v_mul_f32 v181,v181,v179
MF a[116:119],v[108:111],v[20:23],a[116:119]
v_exp_f32 v174,v174
MF a[120:123],v[112:115],v[20:23],a[120:123]
v_exp_f32 v180,v180
MF a[124:127],v[116:119],v[20:23],a[124:127]
v_exp_f32 v175,v175
MF a[128:131],v[120:123],v[20:23],a[128:131]
v_exp_f32 v181,v181
MF a[132:135],v[124:127],v[20:23],a[132:135]
v_add_f32 v174,1.0,v174
MF a[136:139],v[128:131],v[20:23],a[136:139]
v_add_f32 v180,1.0,v180
MF a[140:143],v[132:135],v[20:23],a[140:143]
ds_read_b128 v[20:23],v177 offset:56320
s_waitcnt lgkmcnt(11)
MF a[144:147],v[100:103],v[24:27],a[144:147]
v_add_f32 v175,1.0,v175
MF a[148:151],v[104:107],v[24:27],a[148:151]
v_add_f32 v181,1.0,v181
v_rcp_f32 v174,v174
MF a[152:155],v[108:111],v[24:27],a[152:155]
v_rcp_f32 v180,v180
MF a[156:159],v[112:115],v[24:27],a[156:159]
v_rcp_f32 v175,v175
MF a[160:163],v[116:119],v[24:27],a[160:163]
v_rcp_f32 v181,v181
MF a[164:167],v[120:123],v[24:27],a[164:167]
v_mul_f32 v172,v172,v174
MF a[168:171],v[124:127],v[24:27],a[168:171]
v_mul_f32 v178,v178,v180
MF a[172:175],v[128:131],v[24:27],a[172:175]
v_mul_f32 v173,v173,v175
MF a[176:179],v[132:135],v[24:27],a[176:179]
ds_read_b128 v[24:27],v177 offset:57344
s_waitcnt lgkmcnt(11)
MF a[180:183],v[100:103],v[28:31],a[180:183]
v_mul_f32 v179,v179,v181
MF a[184:187],v[104:107],v[28:31],a[184:187]
v_cvt_pk_bf16_f32 v176,v172,v173
v_cvt_pk_bf16_f32 v182,v178,v179
MF a[188:191],v[108:111],v[28:31],a[188:191]
v_accvgpr_write_b32 a220,v176
MF a[192:195],v[112:115],v[28:31],a[192:195]
v_accvgpr_write_b32 a221,v182
MF a[196:199],v[116:119],v[28:31],a[196:199]
v_accvgpr_read_b32 v176,a222
v_accvgpr_read_b32 v182,a223
MF a[200:203],v[120:123],v[28:31],a[200:203]
v_lshlrev_b32 v172,16,v176
MF a[204:207],v[124:127],v[28:31],a[204:207]
v_lshlrev_b32 v178,16,v182
MF a[208:211],v[128:131],v[28:31],a[208:211]
v_and_b32 v173,0xffff0000,v176
MF a[212:215],v[132:135],v[28:31],a[212:215]
ds_read_b128 v[28:31],v177 offset:58368
s_waitcnt vmcnt(17)
s_waitcnt lgkmcnt(11)
MF v[184:187],v[136:139],v[32:35],v[184:187]
s_waitcnt vmcnt(16)
MF v[188:191],v[140:143],v[32:35],v[188:191]
s_waitcnt vmcnt(15)
MF v[192:195],v[144:147],v[32:35],v[192:195]
s_add_u32 s33,s32,36864
buffer_load_dwordx4 v[100:103],v1,s[8:11],s33 offen offset:0 sc1
s_waitcnt vmcnt(15)
MF v[196:199],v[148:151],v[32:35],v[196:199]
s_waitcnt vmcnt(14)
MF v[200:203],v[152:155],v[32:35],v[200:203]
s_waitcnt vmcnt(13)
MF v[204:207],v[156:159],v[32:35],v[204:207]
s_waitcnt vmcnt(12)
MF v[208:211],v[160:163],v[32:35],v[208:211]
buffer_load_dwordx4 v[104:107],v1,s[8:11],s33 offen offset:1024 sc1
s_waitcnt vmcnt(12)
MF v[212:215],v[164:167],v[32:35],v[212:215]
s_waitcnt vmcnt(11)
MF v[216:219],v[168:171],v[32:35],v[216:219]
ds_read_b128 v[32:35],v177 offset:59392
s_waitcnt lgkmcnt(11)
MF v[220:223],v[136:139],v[36:39],v[220:223]
v_and_b32 v179,0xffff0000,v182
MF v[224:227],v[140:143],v[36:39],v[224:227]
v_mul_f32 v174,v172,v172
v_mul_f32 v180,v178,v178
MF v[228:231],v[144:147],v[36:39],v[228:231]
buffer_load_dwordx4 v[108:111],v1,s[8:11],s33 offen offset:2048 sc1
MF v[232:235],v[148:151],v[36:39],v[232:235]
v_mul_f32 v175,v173,v173
MF v[236:239],v[152:155],v[36:39],v[236:239]
v_mul_f32 v181,v179,v179
v_fmaak_f32 v174,v174,v13,0xc0135761
MF v[240:243],v[156:159],v[36:39],v[240:243]
v_fmaak_f32 v180,v180,v13,0xc0135761
MF v[244:247],v[160:163],v[36:39],v[244:247]
buffer_load_dwordx4 v[112:115],v1,s[8:11],s33 offen offset:3072 sc1
MF v[248:251],v[164:167],v[36:39],v[248:251]
v_fmaak_f32 v175,v175,v13,0xc0135761
MF v[252:255],v[168:171],v[36:39],v[252:255]
ds_read_b128 v[36:39],v177 offset:60416
s_waitcnt lgkmcnt(11)
MF a[0:3],v[136:139],v[40:43],a[0:3]
v_fmaak_f32 v181,v181,v13,0xc0135761
MF a[4:7],v[140:143],v[40:43],a[4:7]
v_mul_f32 v174,v174,v172
v_mul_f32 v180,v180,v178
MF a[8:11],v[144:147],v[40:43],a[8:11]
s_add_u32 s33,s32,40960
buffer_load_dwordx4 v[116:119],v1,s[8:11],s33 offen offset:0 sc1
MF a[12:15],v[148:151],v[40:43],a[12:15]
v_mul_f32 v175,v175,v173
MF a[16:19],v[152:155],v[40:43],a[16:19]
v_mul_f32 v181,v181,v179
v_exp_f32 v174,v174
MF a[20:23],v[156:159],v[40:43],a[20:23]
v_exp_f32 v180,v180
MF a[24:27],v[160:163],v[40:43],a[24:27]
buffer_load_dwordx4 v[120:123],v1,s[8:11],s33 offen offset:1024 sc1
MF a[28:31],v[164:167],v[40:43],a[28:31]
v_exp_f32 v175,v175
MF a[32:35],v[168:171],v[40:43],a[32:35]
buffer_load_dwordx4 v[40:43],v1,s[8:11],s30 offen offset:3072 sc1
s_waitcnt lgkmcnt(10)
MF a[36:39],v[136:139],v[44:47],a[36:39]
v_exp_f32 v181,v181
MF a[40:43],v[140:143],v[44:47],a[40:43]
v_add_f32 v174,1.0,v174
v_add_f32 v180,1.0,v180
MF a[44:47],v[144:147],v[44:47],a[44:47]
buffer_load_dwordx4 v[124:127],v1,s[8:11],s33 offen offset:2048 sc1
MF a[48:51],v[148:151],v[44:47],a[48:51]
v_add_f32 v175,1.0,v175
MF a[52:55],v[152:155],v[44:47],a[52:55]
v_add_f32 v181,1.0,v181
v_rcp_f32 v174,v174
MF a[56:59],v[156:159],v[44:47],a[56:59]
v_rcp_f32 v180,v180
MF a[60:63],v[160:163],v[44:47],a[60:63]
buffer_load_dwordx4 v[128:131],v1,s[8:11],s33 offen offset:3072 sc1
MF a[64:67],v[164:167],v[44:47],a[64:67]
v_rcp_f32 v175,v175
MF a[68:71],v[168:171],v[44:47],a[68:71]
buffer_load_dwordx4 v[44:47],v1,s[8:11],s31 offen offset:3072 sc1
s_waitcnt lgkmcnt(9)
MF a[72:75],v[136:139],v[48:51],a[72:75]
v_rcp_f32 v181,v181
MF a[76:79],v[140:143],v[48:51],a[76:79]
v_mul_f32 v172,v172,v174
v_mul_f32 v178,v178,v180
MF a[80:83],v[144:147],v[48:51],a[80:83]
s_add_u32 s33,s32,45056
buffer_load_dwordx4 v[132:135],v1,s[8:11],s33 offen offset:0 sc1
MF a[84:87],v[148:151],v[48:51],a[84:87]
v_mul_f32 v173,v173,v175
MF a[88:91],v[152:155],v[48:51],a[88:91]
v_mul_f32 v179,v179,v181
v_cvt_pk_bf16_f32 v176,v172,v173
MF a[92:95],v[156:159],v[48:51],a[92:95]
v_cvt_pk_bf16_f32 v182,v178,v179
MF a[96:99],v[160:163],v[48:51],a[96:99]
MF a[100:103],v[164:167],v[48:51],a[100:103]
v_accvgpr_write_b32 a222,v176
MF a[104:107],v[168:171],v[48:51],a[104:107]
buffer_load_dwordx4 v[48:51],v2,s[8:11],s24 offen offset:0 sc1
s_waitcnt lgkmcnt(8)
MF a[108:111],v[136:139],v[52:55],a[108:111]
v_accvgpr_write_b32 a223,v182
MF a[112:115],v[140:143],v[52:55],a[112:115]
v_accvgpr_read_b32 v176,a224
v_accvgpr_read_b32 v182,a225
MF a[116:119],v[144:147],v[52:55],a[116:119]
v_lshlrev_b32 v172,16,v176
MF a[120:123],v[148:151],v[52:55],a[120:123]
v_lshlrev_b32 v178,16,v182
MF a[124:127],v[152:155],v[52:55],a[124:127]
v_and_b32 v173,0xffff0000,v176
v_and_b32 v179,0xffff0000,v182
MF a[128:131],v[156:159],v[52:55],a[128:131]
v_mul_f32 v174,v172,v172
MF a[132:135],v[160:163],v[52:55],a[132:135]
v_mul_f32 v180,v178,v178
MF a[136:139],v[164:167],v[52:55],a[136:139]
v_mul_f32 v175,v173,v173
MF a[140:143],v[168:171],v[52:55],a[140:143]
buffer_load_dwordx4 v[52:55],v2,s[8:11],s25 offen offset:0 sc1
s_waitcnt lgkmcnt(7)
MF a[144:147],v[136:139],v[56:59],a[144:147]
v_mul_f32 v181,v179,v179
MF a[148:151],v[140:143],v[56:59],a[148:151]
v_fmaak_f32 v174,v174,v13,0xc0135761
v_fmaak_f32 v180,v180,v13,0xc0135761
MF a[152:155],v[144:147],v[56:59],a[152:155]
v_fmaak_f32 v175,v175,v13,0xc0135761
MF a[156:159],v[148:151],v[56:59],a[156:159]
v_fmaak_f32 v181,v181,v13,0xc0135761
MF a[160:163],v[152:155],v[56:59],a[160:163]
v_mul_f32 v174,v174,v172
v_mul_f32 v180,v180,v178
MF a[164:167],v[156:159],v[56:59],a[164:167]
v_mul_f32 v175,v175,v173
MF a[168:171],v[160:163],v[56:59],a[168:171]
v_mul_f32 v181,v181,v179
MF a[172:175],v[164:167],v[56:59],a[172:175]
v_exp_f32 v174,v174
MF a[176:179],v[168:171],v[56:59],a[176:179]
buffer_load_dwordx4 v[56:59],v2,s[8:11],s26 offen offset:0 sc1
s_waitcnt lgkmcnt(6)
MF a[180:183],v[136:139],v[60:63],a[180:183]
v_exp_f32 v180,v180
MF a[184:187],v[140:143],v[60:63],a[184:187]
v_exp_f32 v175,v175
MF a[188:191],v[144:147],v[60:63],a[188:191]
v_exp_f32 v181,v181
MF a[192:195],v[148:151],v[60:63],a[192:195]
v_add_f32 v174,1.0,v174
MF a[196:199],v[152:155],v[60:63],a[196:199]
v_add_f32 v180,1.0,v180
v_add_f32 v175,1.0,v175
MF a[200:203],v[156:159],v[60:63],a[200:203]
v_add_f32 v181,1.0,v181
MF a[204:207],v[160:163],v[60:63],a[204:207]
v_rcp_f32 v174,v174
MF a[208:211],v[164:167],v[60:63],a[208:211]
v_rcp_f32 v180,v180
MF a[212:215],v[168:171],v[60:63],a[212:215]
buffer_load_dwordx4 v[60:63],v2,s[8:11],s27 offen offset:0 sc1
s_waitcnt vmcnt(23)
s_waitcnt lgkmcnt(5)
MF v[184:187],v[64:67],v[16:19],v[184:187]
s_waitcnt vmcnt(22)
MF v[188:191],v[68:71],v[16:19],v[188:191]
s_waitcnt vmcnt(21)
MF v[192:195],v[72:75],v[16:19],v[192:195]
s_add_u32 s33,s32,46080
buffer_load_dwordx4 v[136:139],v1,s[8:11],s33 offen offset:0 sc1
s_waitcnt vmcnt(21)
MF v[196:199],v[76:79],v[16:19],v[196:199]
s_waitcnt vmcnt(20)
MF v[200:203],v[80:83],v[16:19],v[200:203]
s_waitcnt vmcnt(19)
MF v[204:207],v[84:87],v[16:19],v[204:207]
s_waitcnt vmcnt(18)
MF v[208:211],v[88:91],v[16:19],v[208:211]
buffer_load_dwordx4 v[140:143],v1,s[8:11],s33 offen offset:1024 sc1
s_waitcnt vmcnt(18)
MF v[212:215],v[92:95],v[16:19],v[212:215]
s_waitcnt vmcnt(17)
MF v[216:219],v[96:99],v[16:19],v[216:219]
buffer_load_dwordx4 v[16:19],v2,s[8:11],s28 offen offset:0 sc1
s_waitcnt lgkmcnt(4)
MF v[220:223],v[64:67],v[20:23],v[220:223]
v_rcp_f32 v175,v175
MF v[224:227],v[68:71],v[20:23],v[224:227]
v_rcp_f32 v181,v181
MF v[228:231],v[72:75],v[20:23],v[228:231]
buffer_load_dwordx4 v[144:147],v1,s[8:11],s33 offen offset:2048 sc1
MF v[232:235],v[76:79],v[20:23],v[232:235]
v_mul_f32 v172,v172,v174
MF v[236:239],v[80:83],v[20:23],v[236:239]
v_mul_f32 v178,v178,v180
v_mul_f32 v173,v173,v175
MF v[240:243],v[84:87],v[20:23],v[240:243]
v_mul_f32 v179,v179,v181
MF v[244:247],v[88:91],v[20:23],v[244:247]
buffer_load_dwordx4 v[148:151],v1,s[8:11],s33 offen offset:3072 sc1
MF v[248:251],v[92:95],v[20:23],v[248:251]
v_cvt_pk_bf16_f32 v176,v172,v173
MF v[252:255],v[96:99],v[20:23],v[252:255]
buffer_load_dwordx4 v[20:23],v2,s[8:11],s29 offen offset:0 sc1
s_waitcnt lgkmcnt(3)
MF a[0:3],v[64:67],v[24:27],a[0:3]
v_cvt_pk_bf16_f32 v182,v178,v179
MF a[4:7],v[68:71],v[24:27],a[4:7]
v_accvgpr_write_b32 a224,v176
v_accvgpr_write_b32 a225,v182
MF a[8:11],v[72:75],v[24:27],a[8:11]
s_add_u32 s33,s32,50176
buffer_load_dwordx4 v[152:155],v1,s[8:11],s33 offen offset:0 sc1
MF a[12:15],v[76:79],v[24:27],a[12:15]
v_accvgpr_read_b32 v176,a226
MF a[16:19],v[80:83],v[24:27],a[16:19]
v_accvgpr_read_b32 v182,a227
v_lshlrev_b32 v172,16,v176
MF a[20:23],v[84:87],v[24:27],a[20:23]
v_lshlrev_b32 v178,16,v182
MF a[24:27],v[88:91],v[24:27],a[24:27]
buffer_load_dwordx4 v[156:159],v1,s[8:11],s33 offen offset:1024 sc1
MF a[28:31],v[92:95],v[24:27],a[28:31]
v_and_b32 v173,0xffff0000,v176
MF a[32:35],v[96:99],v[24:27],a[32:35]
buffer_load_dwordx4 v[24:27],v2,s[8:11],s30 offen offset:0 sc1
s_waitcnt lgkmcnt(2)
MF a[36:39],v[64:67],v[28:31],a[36:39]
v_and_b32 v179,0xffff0000,v182
MF a[40:43],v[68:71],v[28:31],a[40:43]
v_mul_f32 v174,v172,v172
v_mul_f32 v180,v178,v178
MF a[44:47],v[72:75],v[28:31],a[44:47]
buffer_load_dwordx4 v[160:163],v1,s[8:11],s33 offen offset:2048 sc1
MF a[48:51],v[76:79],v[28:31],a[48:51]
v_mul_f32 v175,v173,v173
MF a[52:55],v[80:83],v[28:31],a[52:55]
v_mul_f32 v181,v179,v179
v_fmaak_f32 v174,v174,v13,0xc0135761
MF a[56:59],v[84:87],v[28:31],a[56:59]
v_fmaak_f32 v180,v180,v13,0xc0135761
MF a[60:63],v[88:91],v[28:31],a[60:63]
buffer_load_dwordx4 v[164:167],v1,s[8:11],s33 offen offset:3072 sc1
MF a[64:67],v[92:95],v[28:31],a[64:67]
v_fmaak_f32 v175,v175,v13,0xc0135761
MF a[68:71],v[96:99],v[28:31],a[68:71]
buffer_load_dwordx4 v[28:31],v2,s[8:11],s31 offen offset:0 sc1
s_waitcnt lgkmcnt(1)
MF a[72:75],v[64:67],v[32:35],a[72:75]
v_fmaak_f32 v181,v181,v13,0xc0135761
MF a[76:79],v[68:71],v[32:35],a[76:79]
v_mul_f32 v174,v174,v172
v_mul_f32 v180,v180,v178
MF a[80:83],v[72:75],v[32:35],a[80:83]
s_add_u32 s33,s32,54272
buffer_load_dwordx4 v[168:171],v1,s[8:11],s33 offen offset:0 sc1
MF a[84:87],v[76:79],v[32:35],a[84:87]
v_mul_f32 v175,v175,v173
MF a[88:91],v[80:83],v[32:35],a[88:91]
v_mul_f32 v181,v181,v179
v_exp_f32 v174,v174
MF a[92:95],v[84:87],v[32:35],a[92:95]
v_exp_f32 v180,v180
MF a[96:99],v[88:91],v[32:35],a[96:99]
MF a[100:103],v[92:95],v[32:35],a[100:103]
v_exp_f32 v175,v175
MF a[104:107],v[96:99],v[32:35],a[104:107]
buffer_load_dwordx4 v[32:35],v2,s[8:11],s24 offen offset:1024 sc1
s_waitcnt lgkmcnt(0)
MF a[108:111],v[64:67],v[36:39],a[108:111]
v_exp_f32 v181,v181
MF a[112:115],v[68:71],v[36:39],a[112:115]
v_add_f32 v174,1.0,v174
v_add_f32 v180,1.0,v180
MF a[116:119],v[72:75],v[36:39],a[116:119]
v_add_f32 v175,1.0,v175
MF a[120:123],v[76:79],v[36:39],a[120:123]
v_add_f32 v181,1.0,v181
MF a[124:127],v[80:83],v[36:39],a[124:127]
v_rcp_f32 v174,v174
MF a[128:131],v[84:87],v[36:39],a[128:131]
v_rcp_f32 v180,v180
MF a[132:135],v[88:91],v[36:39],a[132:135]
v_rcp_f32 v175,v175
MF a[136:139],v[92:95],v[36:39],a[136:139]
v_rcp_f32 v181,v181
MF a[140:143],v[96:99],v[36:39],a[140:143]
buffer_load_dwordx4 v[36:39],v2,s[8:11],s25 offen offset:1024 sc1
s_waitcnt vmcnt(23)
MF a[144:147],v[64:67],v[40:43],a[144:147]
v_mul_f32 v172,v172,v174
MF a[148:151],v[68:71],v[40:43],a[148:151]
v_mul_f32 v178,v178,v180
v_mul_f32 v173,v173,v175
MF a[152:155],v[72:75],v[40:43],a[152:155]
v_mul_f32 v179,v179,v181
MF a[156:159],v[76:79],v[40:43],a[156:159]
v_cvt_pk_bf16_f32 v176,v172,v173
MF a[160:163],v[80:83],v[40:43],a[160:163]
v_cvt_pk_bf16_f32 v182,v178,v179
v_accvgpr_write_b32 a226,v176
MF a[164:167],v[84:87],v[40:43],a[164:167]
v_accvgpr_write_b32 a227,v182
MF a[168:171],v[88:91],v[40:43],a[168:171]
v_accvgpr_read_b32 v176,a228
MF a[172:175],v[92:95],v[40:43],a[172:175]
v_accvgpr_read_b32 v182,a229
MF a[176:179],v[96:99],v[40:43],a[176:179]
buffer_load_dwordx4 v[40:43],v2,s[8:11],s26 offen offset:1024 sc1
s_waitcnt vmcnt(21)
MF a[180:183],v[64:67],v[44:47],a[180:183]
v_lshlrev_b32 v172,16,v176
MF a[184:187],v[68:71],v[44:47],a[184:187]
v_lshlrev_b32 v178,16,v182
v_and_b32 v173,0xffff0000,v176
MF a[188:191],v[72:75],v[44:47],a[188:191]
v_and_b32 v179,0xffff0000,v182
MF a[192:195],v[76:79],v[44:47],a[192:195]
v_mul_f32 v174,v172,v172
MF a[196:199],v[80:83],v[44:47],a[196:199]
v_mul_f32 v180,v178,v178
v_mul_f32 v175,v173,v173
MF a[200:203],v[84:87],v[44:47],a[200:203]
v_mul_f32 v181,v179,v179
MF a[204:207],v[88:91],v[44:47],a[204:207]
v_fmaak_f32 v174,v174,v13,0xc0135761
MF a[208:211],v[92:95],v[44:47],a[208:211]
v_fmaak_f32 v180,v180,v13,0xc0135761
MF a[212:215],v[96:99],v[44:47],a[212:215]
buffer_load_dwordx4 v[44:47],v2,s[8:11],s27 offen offset:1024 sc1
s_waitcnt vmcnt(20)
MF v[184:187],v[100:103],v[48:51],v[184:187]
MF v[188:191],v[104:107],v[48:51],v[188:191]
MF v[192:195],v[108:111],v[48:51],v[192:195]
s_add_u32 s33,s32,55296
buffer_load_dwordx4 v[64:67],v1,s[8:11],s33 offen offset:0 sc1
MF v[196:199],v[112:115],v[48:51],v[196:199]
MF v[200:203],v[116:119],v[48:51],v[200:203]
MF v[204:207],v[120:123],v[48:51],v[204:207]
MF v[208:211],v[124:127],v[48:51],v[208:211]
buffer_load_dwordx4 v[68:71],v1,s[8:11],s33 offen offset:1024 sc1
MF v[212:215],v[128:131],v[48:51],v[212:215]
MF v[216:219],v[132:135],v[48:51],v[216:219]
buffer_load_dwordx4 v[48:51],v2,s[8:11],s28 offen offset:1024 sc1
s_waitcnt vmcnt(22)
MF v[220:223],v[100:103],v[52:55],v[220:223]
v_fmaak_f32 v175,v175,v13,0xc0135761
MF v[224:227],v[104:107],v[52:55],v[224:227]
v_fmaak_f32 v181,v181,v13,0xc0135761
v_mul_f32 v174,v174,v172
MF v[228:231],v[108:111],v[52:55],v[228:231]
buffer_load_dwordx4 v[72:75],v1,s[8:11],s33 offen offset:2048 sc1
MF v[232:235],v[112:115],v[52:55],v[232:235]
v_mul_f32 v180,v180,v178
MF v[236:239],v[116:119],v[52:55],v[236:239]
v_mul_f32 v175,v175,v173
v_mul_f32 v181,v181,v179
MF v[240:243],v[120:123],v[52:55],v[240:243]
v_exp_f32 v174,v174
MF v[244:247],v[124:127],v[52:55],v[244:247]
buffer_load_dwordx4 v[76:79],v1,s[8:11],s33 offen offset:3072 sc1
MF v[248:251],v[128:131],v[52:55],v[248:251]
v_exp_f32 v180,v180
MF v[252:255],v[132:135],v[52:55],v[252:255]
buffer_load_dwordx4 v[52:55],v2,s[8:11],s29 offen offset:1024 sc1
s_waitcnt vmcnt(24)
MF a[0:3],v[100:103],v[56:59],a[0:3]
v_exp_f32 v175,v175
MF a[4:7],v[104:107],v[56:59],a[4:7]
v_exp_f32 v181,v181
MF a[8:11],v[108:111],v[56:59],a[8:11]
s_add_u32 s33,s32,59392
buffer_load_dwordx4 v[80:83],v1,s[8:11],s33 offen offset:0 sc1
MF a[12:15],v[112:115],v[56:59],a[12:15]
v_add_f32 v174,1.0,v174
MF a[16:19],v[116:119],v[56:59],a[16:19]
v_add_f32 v180,1.0,v180
v_add_f32 v175,1.0,v175
MF a[20:23],v[120:123],v[56:59],a[20:23]
v_add_f32 v181,1.0,v181
MF a[24:27],v[124:127],v[56:59],a[24:27]
buffer_load_dwordx4 v[84:87],v1,s[8:11],s33 offen offset:1024 sc1
MF a[28:31],v[128:131],v[56:59],a[28:31]
v_rcp_f32 v174,v174
MF a[32:35],v[132:135],v[56:59],a[32:35]
buffer_load_dwordx4 v[56:59],v2,s[8:11],s30 offen offset:1024 sc1
s_waitcnt vmcnt(26)
MF a[36:39],v[100:103],v[60:63],a[36:39]
v_rcp_f32 v180,v180
MF a[40:43],v[104:107],v[60:63],a[40:43]
v_rcp_f32 v175,v175
MF a[44:47],v[108:111],v[60:63],a[44:47]
buffer_load_dwordx4 v[88:91],v1,s[8:11],s33 offen offset:2048 sc1
MF a[48:51],v[112:115],v[60:63],a[48:51]
v_rcp_f32 v181,v181
MF a[52:55],v[116:119],v[60:63],a[52:55]
v_mul_f32 v172,v172,v174
v_mul_f32 v178,v178,v180
MF a[56:59],v[120:123],v[60:63],a[56:59]
v_mul_f32 v173,v173,v175
MF a[60:63],v[124:127],v[60:63],a[60:63]
buffer_load_dwordx4 v[92:95],v1,s[8:11],s33 offen offset:3072 sc1
MF a[64:67],v[128:131],v[60:63],a[64:67]
v_mul_f32 v179,v179,v181
MF a[68:71],v[132:135],v[60:63],a[68:71]
buffer_load_dwordx4 v[60:63],v2,s[8:11],s31 offen offset:1024 sc1
s_waitcnt vmcnt(26)
MF a[72:75],v[100:103],v[16:19],a[72:75]
v_cvt_pk_bf16_f32 v176,v172,v173
MF a[76:79],v[104:107],v[16:19],a[76:79]
v_cvt_pk_bf16_f32 v182,v178,v179
v_accvgpr_write_b32 a228,v176
MF a[80:83],v[108:111],v[16:19],a[80:83]
s_add_u32 s33,s32,63488
buffer_load_dwordx4 v[96:99],v1,s[8:11],s33 offen offset:0 sc1
MF a[84:87],v[112:115],v[16:19],a[84:87]
v_accvgpr_write_b32 a229,v182
MF a[88:91],v[116:119],v[16:19],a[88:91]
v_accvgpr_read_b32 v176,a230
v_accvgpr_read_b32 v182,a231
MF a[92:95],v[120:123],v[16:19],a[92:95]
v_lshlrev_b32 v172,16,v176
MF a[96:99],v[124:127],v[16:19],a[96:99]
MF a[100:103],v[128:131],v[16:19],a[100:103]
v_lshlrev_b32 v178,16,v182
MF a[104:107],v[132:135],v[16:19],a[104:107]
buffer_load_dwordx4 v[16:19],v2,s[8:11],s24 offen offset:2048 sc1
s_waitcnt vmcnt(25)
MF a[108:111],v[100:103],v[20:23],a[108:111]
v_and_b32 v173,0xffff0000,v176
MF a[112:115],v[104:107],v[20:23],a[112:115]
v_and_b32 v179,0xffff0000,v182
v_mul_f32 v174,v172,v172
MF a[116:119],v[108:111],v[20:23],a[116:119]
v_mul_f32 v180,v178,v178
MF a[120:123],v[112:115],v[20:23],a[120:123]
v_mul_f32 v175,v173,v173
MF a[124:127],v[116:119],v[20:23],a[124:127]
v_mul_f32 v181,v179,v179
v_fmaak_f32 v174,v174,v13,0xc0135761
MF a[128:131],v[120:123],v[20:23],a[128:131]
v_fmaak_f32 v180,v180,v13,0xc0135761
MF a[132:135],v[124:127],v[20:23],a[132:135]
v_fmaak_f32 v175,v175,v13,0xc0135761
MF a[136:139],v[128:131],v[20:23],a[136:139]
v_fmaak_f32 v181,v181,v13,0xc0135761
MF a[140:143],v[132:135],v[20:23],a[140:143]
buffer_load_dwordx4 v[20:23],v2,s[8:11],s25 offen offset:2048 sc1
s_waitcnt vmcnt(23)
MF a[144:147],v[100:103],v[24:27],a[144:147]
v_mul_f32 v174,v174,v172
MF a[148:151],v[104:107],v[24:27],a[148:151]
v_mul_f32 v180,v180,v178
v_mul_f32 v175,v175,v173
MF a[152:155],v[108:111],v[24:27],a[152:155]
v_mul_f32 v181,v181,v179
MF a[156:159],v[112:115],v[24:27],a[156:159]
v_exp_f32 v174,v174
MF a[160:163],v[116:119],v[24:27],a[160:163]
v_exp_f32 v180,v180
MF a[164:167],v[120:123],v[24:27],a[164:167]
v_exp_f32 v175,v175
MF a[168:171],v[124:127],v[24:27],a[168:171]
v_exp_f32 v181,v181
MF a[172:175],v[128:131],v[24:27],a[172:175]
v_add_f32 v174,1.0,v174
MF a[176:179],v[132:135],v[24:27],a[176:179]
buffer_load_dwordx4 v[24:27],v2,s[8:11],s26 offen offset:2048 sc1
s_waitcnt vmcnt(21)
MF a[180:183],v[100:103],v[28:31],a[180:183]
v_add_f32 v180,1.0,v180
MF a[184:187],v[104:107],v[28:31],a[184:187]
v_add_f32 v175,1.0,v175
v_add_f32 v181,1.0,v181
MF a[188:191],v[108:111],v[28:31],a[188:191]
v_rcp_f32 v174,v174
MF a[192:195],v[112:115],v[28:31],a[192:195]
v_rcp_f32 v180,v180
MF a[196:199],v[116:119],v[28:31],a[196:199]
v_rcp_f32 v175,v175
MF a[200:203],v[120:123],v[28:31],a[200:203]
v_rcp_f32 v181,v181
MF a[204:207],v[124:127],v[28:31],a[204:207]
v_mul_f32 v172,v172,v174
MF a[208:211],v[128:131],v[28:31],a[208:211]
v_mul_f32 v178,v178,v180
MF a[212:215],v[132:135],v[28:31],a[212:215]
buffer_load_dwordx4 v[28:31],v2,s[8:11],s27 offen offset:2048 sc1
s_waitcnt vmcnt(20)
MF v[184:187],v[136:139],v[32:35],v[184:187]
MF v[188:191],v[140:143],v[32:35],v[188:191]
MF v[192:195],v[144:147],v[32:35],v[192:195]
s_add_u32 s33,s32,64512
buffer_load_dwordx4 v[100:103],v1,s[8:11],s33 offen offset:0 sc1
MF v[196:199],v[148:151],v[32:35],v[196:199]
MF v[200:203],v[152:155],v[32:35],v[200:203]
MF v[204:207],v[156:159],v[32:35],v[204:207]
MF v[208:211],v[160:163],v[32:35],v[208:211]
buffer_load_dwordx4 v[104:107],v1,s[8:11],s33 offen offset:1024 sc1
MF v[212:215],v[164:167],v[32:35],v[212:215]
MF v[216:219],v[168:171],v[32:35],v[216:219]
buffer_load_dwordx4 v[32:35],v2,s[8:11],s28 offen offset:2048 sc1
s_waitcnt vmcnt(22)
MF v[220:223],v[136:139],v[36:39],v[220:223]
v_mul_f32 v173,v173,v175
MF v[224:227],v[140:143],v[36:39],v[224:227]
v_mul_f32 v179,v179,v181
v_cvt_pk_bf16_f32 v176,v172,v173
MF v[228:231],v[144:147],v[36:39],v[228:231]
buffer_load_dwordx4 v[108:111],v1,s[8:11],s33 offen offset:2048 sc1
MF v[232:235],v[148:151],v[36:39],v[232:235]
v_cvt_pk_bf16_f32 v182,v178,v179
MF v[236:239],v[152:155],v[36:39],v[236:239]
v_accvgpr_write_b32 a230,v176
v_accvgpr_write_b32 a231,v182
MF v[240:243],v[156:159],v[36:39],v[240:243]
v_accvgpr_read_b32 v176,a232
MF v[244:247],v[160:163],v[36:39],v[244:247]
buffer_load_dwordx4 v[112:115],v1,s[8:11],s33 offen offset:3072 sc1
MF v[248:251],v[164:167],v[36:39],v[248:251]
v_accvgpr_read_b32 v182,a233
MF v[252:255],v[168:171],v[36:39],v[252:255]
buffer_load_dwordx4 v[36:39],v2,s[8:11],s29 offen offset:2048 sc1
s_waitcnt vmcnt(24)
MF a[0:3],v[136:139],v[40:43],a[0:3]
v_lshlrev_b32 v172,16,v176
MF a[4:7],v[140:143],v[40:43],a[4:7]
v_lshlrev_b32 v178,16,v182
v_and_b32 v173,0xffff0000,v176
MF a[8:11],v[144:147],v[40:43],a[8:11]
s_add_u32 s33,s32,68608
buffer_load_dwordx4 v[116:119],v1,s[8:11],s33 offen offset:0 sc1
MF a[12:15],v[148:151],v[40:43],a[12:15]
v_and_b32 v179,0xffff0000,v182
MF a[16:19],v[152:155],v[40:43],a[16:19]
v_mul_f32 v174,v172,v172
v_mul_f32 v180,v178,v178
MF a[20:23],v[156:159],v[40:43],a[20:23]
v_mul_f32 v175,v173,v173
MF a[24:27],v[160:163],v[40:43],a[24:27]
buffer_load_dwordx4 v[120:123],v1,s[8:11],s33 offen offset:1024 sc1
MF a[28:31],v[164:167],v[40:43],a[28:31]
v_mul_f32 v181,v179,v179
MF a[32:35],v[168:171],v[40:43],a[32:35]
buffer_load_dwordx4 v[40:43],v2,s[8:11],s30 offen offset:2048 sc1
s_waitcnt vmcnt(26)
MF a[36:39],v[136:139],v[44:47],a[36:39]
v_fmaak_f32 v174,v174,v13,0xc0135761
MF a[40:43],v[140:143],v[44:47],a[40:43]
v_fmaak_f32 v180,v180,v13,0xc0135761
v_fmaak_f32 v175,v175,v13,0xc0135761
MF a[44:47],v[144:147],v[44:47],a[44:47]
buffer_load_dwordx4 v[124:127],v1,s[8:11],s33 offen offset:2048 sc1
MF a[48:51],v[148:151],v[44:47],a[48:51]
v_fmaak_f32 v181,v181,v13,0xc0135761
MF a[52:55],v[152:155],v[44:47],a[52:55]
v_mul_f32 v174,v174,v172
v_mul_f32 v180,v180,v178
MF a[56:59],v[156:159],v[44:47],a[56:59]
v_mul_f32 v175,v175,v173
MF a[60:63],v[160:163],v[44:47],a[60:63]
buffer_load_dwordx4 v[128:131],v1,s[8:11],s33 offen offset:3072 sc1
MF a[64:67],v[164:167],v[44:47],a[64:67]
v_mul_f32 v181,v181,v179
MF a[68:71],v[168:171],v[44:47],a[68:71]
buffer_load_dwordx4 v[44:47],v2,s[8:11],s31 offen offset:2048 sc1
s_waitcnt vmcnt(26)
MF a[72:75],v[136:139],v[48:51],a[72:75]
v_exp_f32 v174,v174
MF a[76:79],v[140:143],v[48:51],a[76:79]
v_exp_f32 v180,v180
MF a[80:83],v[144:147],v[48:51],a[80:83]
s_add_u32 s33,s32,72704
buffer_load_dwordx4 v[132:135],v1,s[8:11],s33 offen offset:0 sc1
MF a[84:87],v[148:151],v[48:51],a[84:87]
v_exp_f32 v175,v175
MF a[88:91],v[152:155],v[48:51],a[88:91]
v_exp_f32 v181,v181
MF a[92:95],v[156:159],v[48:51],a[92:95]
v_add_f32 v174,1.0,v174
MF a[96:99],v[160:163],v[48:51],a[96:99]
MF a[100:103],v[164:167],v[48:51],a[100:103]
v_add_f32 v180,1.0,v180
MF a[104:107],v[168:171],v[48:51],a[104:107]
buffer_load_dwordx4 v[48:51],v2,s[8:11],s24 offen offset:3072 sc1
s_waitcnt vmcnt(25)
MF a[108:111],v[136:139],v[52:55],a[108:111]
v_add_f32 v175,1.0,v175
MF a[112:115],v[140:143],v[52:55],a[112:115]
v_add_f32 v181,1.0,v181
v_rcp_f32 v174,v174
MF a[116:119],v[144:147],v[52:55],a[116:119]
v_rcp_f32 v180,v180
MF a[120:123],v[148:151],v[52:55],a[120:123]
v_rcp_f32 v175,v175
MF a[124:127],v[152:155],v[52:55],a[124:127]
v_rcp_f32 v181,v181
MF a[128:131],v[156:159],v[52:55],a[128:131]
v_mul_f32 v172,v172,v174
MF a[132:135],v[160:163],v[52:55],a[132:135]
v_mul_f32 v178,v178,v180
MF a[136:139],v[164:167],v[52:55],a[136:139]
v_mul_f32 v173,v173,v175
MF a[140:143],v[168:171],v[52:55],a[140:143]
buffer_load_dwordx4 v[52:55],v2,s[8:11],s25 offen offset:3072 sc1
s_waitcnt vmcnt(23)
MF a[144:147],v[136:139],v[56:59],a[144:147]
v_mul_f32 v179,v179,v181
MF a[148:151],v[140:143],v[56:59],a[148:151]
v_cvt_pk_bf16_f32 v176,v172,v173
v_cvt_pk_bf16_f32 v182,v178,v179
MF a[152:155],v[144:147],v[56:59],a[152:155]
v_accvgpr_write_b32 a232,v176
MF a[156:159],v[148:151],v[56:59],a[156:159]
v_accvgpr_write_b32 a233,v182
MF a[160:163],v[152:155],v[56:59],a[160:163]
v_accvgpr_read_b32 v176,a234
v_accvgpr_read_b32 v182,a235
MF a[164:167],v[156:159],v[56:59],a[164:167]
v_lshlrev_b32 v172,16,v176
MF a[168:171],v[160:163],v[56:59],a[168:171]
v_lshlrev_b32 v178,16,v182
MF a[172:175],v[164:167],v[56:59],a[172:175]
v_and_b32 v173,0xffff0000,v176
MF a[176:179],v[168:171],v[56:59],a[176:179]
buffer_load_dwordx4 v[56:59],v2,s[8:11],s26 offen offset:3072 sc1
s_waitcnt vmcnt(21)
MF a[180:183],v[136:139],v[60:63],a[180:183]
v_and_b32 v179,0xffff0000,v182
MF a[184:187],v[140:143],v[60:63],a[184:187]
v_mul_f32 v174,v172,v172
v_mul_f32 v180,v178,v178
MF a[188:191],v[144:147],v[60:63],a[188:191]
v_mul_f32 v175,v173,v173
MF a[192:195],v[148:151],v[60:63],a[192:195]
v_mul_f32 v181,v179,v179
MF a[196:199],v[152:155],v[60:63],a[196:199]
v_fmaak_f32 v174,v174,v13,0xc0135761
v_fmaak_f32 v180,v180,v13,0xc0135761
MF a[200:203],v[156:159],v[60:63],a[200:203]
v_fmaak_f32 v175,v175,v13,0xc0135761
MF a[204:207],v[160:163],v[60:63],a[204:207]
v_fmaak_f32 v181,v181,v13,0xc0135761
MF a[208:211],v[164:167],v[60:63],a[208:211]
v_mul_f32 v174,v174,v172
MF a[212:215],v[168:171],v[60:63],a[212:215]
buffer_load_dwordx4 v[60:63],v2,s[8:11],s27 offen offset:3072 sc1
s_waitcnt vmcnt(20)
MF v[184:187],v[64:67],v[16:19],v[184:187]
MF v[188:191],v[68:71],v[16:19],v[188:191]
MF v[192:195],v[72:75],v[16:19],v[192:195]
s_add_u32 s33,s32,73728
buffer_load_dwordx4 v[136:139],v1,s[8:11],s33 offen offset:0 sc1
MF v[196:199],v[76:79],v[16:19],v[196:199]
MF v[200:203],v[80:83],v[16:19],v[200:203]
MF v[204:207],v[84:87],v[16:19],v[204:207]
MF v[208:211],v[88:91],v[16:19],v[208:211]
buffer_load_dwordx4 v[140:143],v1,s[8:11],s33 offen offset:1024 sc1
MF v[212:215],v[92:95],v[16:19],v[212:215]
MF v[216:219],v[96:99],v[16:19],v[216:219]
buffer_load_dwordx4 v[16:19],v2,s[8:11],s28 offen offset:3072 sc1
s_waitcnt vmcnt(22)
MF v[220:223],v[64:67],v[20:23],v[220:223]
v_mul_f32 v180,v180,v178
MF v[224:227],v[68:71],v[20:23],v[224:227]
v_mul_f32 v175,v175,v173
v_mul_f32 v181,v181,v179
MF v[228:231],v[72:75],v[20:23],v[228:231]
buffer_load_dwordx4 v[144:147],v1,s[8:11],s33 offen offset:2048 sc1
MF v[232:235],v[76:79],v[20:23],v[232:235]
v_exp_f32 v174,v174
MF v[236:239],v[80:83],v[20:23],v[236:239]
v_exp_f32 v180,v180
MF v[240:243],v[84:87],v[20:23],v[240:243]
v_exp_f32 v175,v175
MF v[244:247],v[88:91],v[20:23],v[244:247]
buffer_load_dwordx4 v[148:151],v1,s[8:11],s33 offen offset:3072 sc1
MF v[248:251],v[92:95],v[20:23],v[248:251]
v_exp_f32 v181,v181
MF v[252:255],v[96:99],v[20:23],v[252:255]
buffer_load_dwordx4 v[20:23],v2,s[8:11],s29 offen offset:3072 sc1
s_waitcnt vmcnt(24)
MF a[0:3],v[64:67],v[24:27],a[0:3]
v_add_f32 v174,1.0,v174
MF a[4:7],v[68:71],v[24:27],a[4:7]
v_add_f32 v180,1.0,v180
v_add_f32 v175,1.0,v175
MF a[8:11],v[72:75],v[24:27],a[8:11]
s_add_u32 s33,s32,77824
buffer_load_dwordx4 v[152:155],v1,s[8:11],s33 offen offset:0 sc1
MF a[12:15],v[76:79],v[24:27],a[12:15]
v_add_f32 v181,1.0,v181
MF a[16:19],v[80:83],v[24:27],a[16:19]
v_rcp_f32 v174,v174
MF a[20:23],v[84:87],v[24:27],a[20:23]
v_rcp_f32 v180,v180
MF a[24:27],v[88:91],v[24:27],a[24:27]
buffer_load_dwordx4 v[156:159],v1,s[8:11],s33 offen offset:1024 sc1
MF a[28:31],v[92:95],v[24:27],a[28:31]
v_rcp_f32 v175,v175
MF a[32:35],v[96:99],v[24:27],a[32:35]
buffer_load_dwordx4 v[24:27],v2,s[8:11],s30 offen offset:3072 sc1
s_waitcnt vmcnt(26)
MF a[36:39],v[64:67],v[28:31],a[36:39]
v_rcp_f32 v181,v181
MF a[40:43],v[68:71],v[28:31],a[40:43]
v_mul_f32 v172,v172,v174
v_mul_f32 v178,v178,v180
MF a[44:47],v[72:75],v[28:31],a[44:47]
buffer_load_dwordx4 v[160:163],v1,s[8:11],s33 offen offset:2048 sc1
MF a[48:51],v[76:79],v[28:31],a[48:51]
v_mul_f32 v173,v173,v175
MF a[52:55],v[80:83],v[28:31],a[52:55]
v_mul_f32 v179,v179,v181
v_cvt_pk_bf16_f32 v176,v172,v173
MF a[56:59],v[84:87],v[28:31],a[56:59]
v_cvt_pk_bf16_f32 v182,v178,v179
MF a[60:63],v[88:91],v[28:31],a[60:63]
buffer_load_dwordx4 v[164:167],v1,s[8:11],s33 offen offset:3072 sc1
MF a[64:67],v[92:95],v[28:31],a[64:67]
v_accvgpr_write_b32 a234,v176
MF a[68:71],v[96:99],v[28:31],a[68:71]
buffer_load_dwordx4 v[28:31],v2,s[8:11],s31 offen offset:3072 sc1
s_waitcnt vmcnt(26)
MF a[72:75],v[64:67],v[32:35],a[72:75]
v_accvgpr_write_b32 a235,v182
MF a[76:79],v[68:71],v[32:35],a[76:79]
v_accvgpr_read_b32 v176,a236
v_accvgpr_read_b32 v182,a237
MF a[80:83],v[72:75],v[32:35],a[80:83]
s_add_u32 s33,s32,81920
buffer_load_dwordx4 v[168:171],v1,s[8:11],s33 offen offset:0 sc1
MF a[84:87],v[76:79],v[32:35],a[84:87]
v_lshlrev_b32 v172,16,v176
MF a[88:91],v[80:83],v[32:35],a[88:91]
v_lshlrev_b32 v178,16,v182
v_and_b32 v173,0xffff0000,v176
MF a[92:95],v[84:87],v[32:35],a[92:95]
v_and_b32 v179,0xffff0000,v182
MF a[96:99],v[88:91],v[32:35],a[96:99]
MF a[100:103],v[92:95],v[32:35],a[100:103]
v_mul_f32 v174,v172,v172
MF a[104:107],v[96:99],v[32:35],a[104:107]
buffer_load_dwordx4 v[32:35],v3,s[8:11],s24 offen offset:0 sc1
s_waitcnt vmcnt(25)
MF a[108:111],v[64:67],v[36:39],a[108:111]
v_mul_f32 v180,v178,v178
MF a[112:115],v[68:71],v[36:39],a[112:115]
v_mul_f32 v175,v173,v173
v_mul_f32 v181,v179,v179
MF a[116:119],v[72:75],v[36:39],a[116:119]
v_fmaak_f32 v174,v174,v13,0xc0135761
MF a[120:123],v[76:79],v[36:39],a[120:123]
v_fmaak_f32 v180,v180,v13,0xc0135761
MF a[124:127],v[80:83],v[36:39],a[124:127]
v_fmaak_f32 v175,v175,v13,0xc0135761
v_fmaak_f32 v181,v181,v13,0xc0135761
MF a[128:131],v[84:87],v[36:39],a[128:131]
v_mul_f32 v174,v174,v172
MF a[132:135],v[88:91],v[36:39],a[132:135]
v_mul_f32 v180,v180,v178
MF a[136:139],v[92:95],v[36:39],a[136:139]
v_mul_f32 v175,v175,v173
MF a[140:143],v[96:99],v[36:39],a[140:143]
buffer_load_dwordx4 v[36:39],v3,s[8:11],s25 offen offset:0 sc1
s_waitcnt vmcnt(23)
MF a[144:147],v[64:67],v[40:43],a[144:147]
v_mul_f32 v181,v181,v179
MF a[148:151],v[68:71],v[40:43],a[148:151]
v_exp_f32 v174,v174
MF a[152:155],v[72:75],v[40:43],a[152:155]
v_exp_f32 v180,v180
MF a[156:159],v[76:79],v[40:43],a[156:159]
v_exp_f32 v175,v175
MF a[160:163],v[80:83],v[40:43],a[160:163]
v_exp_f32 v181,v181
MF a[164:167],v[84:87],v[40:43],a[164:167]
v_add_f32 v174,1.0,v174
MF a[168:171],v[88:91],v[40:43],a[168:171]
v_add_f32 v180,1.0,v180
MF a[172:175],v[92:95],v[40:43],a[172:175]
v_add_f32 v175,1.0,v175
MF a[176:179],v[96:99],v[40:43],a[176:179]
buffer_load_dwordx4 v[40:43],v3,s[8:11],s26 offen offset:0 sc1
s_waitcnt vmcnt(21)
MF a[180:183],v[64:67],v[44:47],a[180:183]
v_add_f32 v181,1.0,v181
MF a[184:187],v[68:71],v[44:47],a[184:187]
v_rcp_f32 v174,v174
MF a[188:191],v[72:75],v[44:47],a[188:191]
v_rcp_f32 v180,v180
MF a[192:195],v[76:79],v[44:47],a[192:195]
v_rcp_f32 v175,v175
MF a[196:199],v[80:83],v[44:47],a[196:199]
v_rcp_f32 v181,v181
MF a[200:203],v[84:87],v[44:47],a[200:203]
v_mul_f32 v172,v172,v174
MF a[204:207],v[88:91],v[44:47],a[204:207]
v_mul_f32 v178,v178,v180
MF a[208:211],v[92:95],v[44:47],a[208:211]
v_mul_f32 v173,v173,v175
MF a[212:215],v[96:99],v[44:47],a[212:215]
buffer_load_dwordx4 v[44:47],v3,s[8:11],s27 offen offset:0 sc1
s_waitcnt vmcnt(20)
MF v[184:187],v[100:103],v[48:51],v[184:187]
MF v[188:191],v[104:107],v[48:51],v[188:191]
MF v[192:195],v[108:111],v[48:51],v[192:195]
s_add_u32 s33,s32,82944
buffer_load_dwordx4 v[64:67],v1,s[8:11],s33 offen offset:0 sc1
MF v[196:199],v[112:115],v[48:51],v[196:199]
MF v[200:203],v[116:119],v[48:51],v[200:203]
MF v[204:207],v[120:123],v[48:51],v[204:207]
MF v[208:211],v[124:127],v[48:51],v[208:211]
buffer_load_dwordx4 v[68:71],v1,s[8:11],s33 offen offset:1024 sc1
MF v[212:215],v[128:131],v[48:51],v[212:215]
MF v[216:219],v[132:135],v[48:51],v[216:219]
buffer_load_dwordx4 v[48:51],v3,s[8:11],s28 offen offset:0 sc1
s_waitcnt vmcnt(22)
MF v[220:223],v[100:103],v[52:55],v[220:223]
v_mul_f32 v179,v179,v181
MF v[224:227],v[104:107],v[52:55],v[224:227]
v_cvt_pk_bf16_f32 v176,v172,v173
v_cvt_pk_bf16_f32 v182,v178,v179
MF v[228:231],v[108:111],v[52:55],v[228:231]
buffer_load_dwordx4 v[72:75],v1,s[8:11],s33 offen offset:2048 sc1
MF v[232:235],v[112:115],v[52:55],v[232:235]
v_accvgpr_write_b32 a236,v176
MF v[236:239],v[116:119],v[52:55],v[236:239]
v_accvgpr_write_b32 a237,v182
v_accvgpr_read_b32 v176,a238
MF v[240:243],v[120:123],v[52:55],v[240:243]
v_accvgpr_read_b32 v182,a239
MF v[244:247],v[124:127],v[52:55],v[244:247]
buffer_load_dwordx4 v[76:79],v1,s[8:11],s33 offen offset:3072 sc1
MF v[248:251],v[128:131],v[52:55],v[248:251]
v_lshlrev_b32 v172,16,v176
MF v[252:255],v[132:135],v[52:55],v[252:255]
buffer_load_dwordx4 v[52:55],v3,s[8:11],s29 offen offset:0 sc1
s_waitcnt vmcnt(24)
MF a[0:3],v[100:103],v[56:59],a[0:3]
v_lshlrev_b32 v178,16,v182
MF a[4:7],v[104:107],v[56:59],a[4:7]
v_and_b32 v173,0xffff0000,v176
v_and_b32 v179,0xffff0000,v182
MF a[8:11],v[108:111],v[56:59],a[8:11]
s_add_u32 s33,s32,87040
buffer_load_dwordx4 v[80:83],v1,s[8:11],s33 offen offset:0 sc1
MF a[12:15],v[112:115],v[56:59],a[12:15]
v_mul_f32 v174,v172,v172
MF a[16:19],v[116:119],v[56:59],a[16:19]
v_mul_f32 v180,v178,v178
v_mul_f32 v175,v173,v173
MF a[20:23],v[120:123],v[56:59],a[20:23]
v_mul_f32 v181,v179,v179
MF a[24:27],v[124:127],v[56:59],a[24:27]
buffer_load_dwordx4 v[84:87],v1,s[8:11],s33 offen offset:1024 sc1
MF a[28:31],v[128:131],v[56:59],a[28:31]
v_fmaak_f32 v174,v174,v13,0xc0135761
MF a[32:35],v[132:135],v[56:59],a[32:35]
buffer_load_dwordx4 v[56:59],v3,s[8:11],s30 offen offset:0 sc1
s_waitcnt vmcnt(26)
MF a[36:39],v[100:103],v[60:63],a[36:39]
v_fmaak_f32 v180,v180,v13,0xc0135761
MF a[40:43],v[104:107],v[60:63],a[40:43]
v_fmaak_f32 v175,v175,v13,0xc0135761
v_fmaak_f32 v181,v181,v13,0xc0135761
MF a[44:47],v[108:111],v[60:63],a[44:47]
buffer_load_dwordx4 v[88:91],v1,s[8:11],s33 offen offset:2048 sc1
MF a[48:51],v[112:115],v[60:63],a[48:51]
v_mul_f32 v174,v174,v172
MF a[52:55],v[116:119],v[60:63],a[52:55]
v_mul_f32 v180,v180,v178
v_mul_f32 v175,v175,v173
MF a[56:59],v[120:123],v[60:63],a[56:59]
v_mul_f32 v181,v181,v179
MF a[60:63],v[124:127],v[60:63],a[60:63]
buffer_load_dwordx4 v[92:95],v1,s[8:11],s33 offen offset:3072 sc1
MF a[64:67],v[128:131],v[60:63],a[64:67]
v_exp_f32 v174,v174
MF a[68:71],v[132:135],v[60:63],a[68:71]
buffer_load_dwordx4 v[60:63],v3,s[8:11],s31 offen offset:0 sc1
s_waitcnt vmcnt(26)
MF a[72:75],v[100:103],v[16:19],a[72:75]
v_exp_f32 v180,v180
MF a[76:79],v[104:107],v[16:19],a[76:79]
v_exp_f32 v175,v175
MF a[80:83],v[108:111],v[16:19],a[80:83]
s_add_u32 s33,s32,91136
buffer_load_dwordx4 v[96:99],v1,s[8:11],s33 offen offset:0 sc1
MF a[84:87],v[112:115],v[16:19],a[84:87]
v_exp_f32 v181,v181
MF a[88:91],v[116:119],v[16:19],a[88:91]
v_add_f32 v174,1.0,v174
v_add_f32 v180,1.0,v180
MF a[92:95],v[120:123],v[16:19],a[92:95]
v_add_f32 v175,1.0,v175
MF a[96:99],v[124:127],v[16:19],a[96:99]
MF a[100:103],v[128:131],v[16:19],a[100:103]
v_add_f32 v181,1.0,v181
MF a[104:107],v[132:135],v[16:19],a[104:107]
buffer_load_dwordx4 v[16:19],v3,s[8:11],s24 offen offset:1024 sc1
s_waitcnt vmcnt(25)
MF a[108:111],v[100:103],v[20:23],a[108:111]
v_rcp_f32 v174,v174
MF a[112:115],v[104:107],v[20:23],a[112:115]
v_rcp_f32 v180,v180
MF a[116:119],v[108:111],v[20:23],a[116:119]
v_rcp_f32 v175,v175
MF a[120:123],v[112:115],v[20:23],a[120:123]
v_rcp_f32 v181,v181
MF a[124:127],v[116:119],v[20:23],a[124:127]
v_mul_f32 v172,v172,v174
v_mul_f32 v178,v178,v180
MF a[128:131],v[120:123],v[20:23],a[128:131]
v_mul_f32 v173,v173,v175
MF a[132:135],v[124:127],v[20:23],a[132:135]
v_mul_f32 v179,v179,v181
MF a[136:139],v[128:131],v[20:23],a[136:139]
v_cvt_pk_bf16_f32 v176,v172,v173
MF a[140:143],v[132:135],v[20:23],a[140:143]
buffer_load_dwordx4 v[20:23],v3,s[8:11],s25 offen offset:1024 sc1
s_waitcnt vmcnt(23)
MF a[144:147],v[100:103],v[24:27],a[144:147]
v_cvt_pk_bf16_f32 v182,v178,v179
MF a[148:151],v[104:107],v[24:27],a[148:151]
v_accvgpr_write_b32 a238,v176
v_accvgpr_write_b32 a239,v182
MF a[152:155],v[108:111],v[24:27],a[152:155]
v_accvgpr_read_b32 v176,a240
MF a[156:159],v[112:115],v[24:27],a[156:159]
v_accvgpr_read_b32 v182,a241
MF a[160:163],v[116:119],v[24:27],a[160:163]
v_lshlrev_b32 v172,16,v176
v_lshlrev_b32 v178,16,v182
MF a[164:167],v[120:123],v[24:27],a[164:167]
v_and_b32 v173,0xffff0000,v176
MF a[168:171],v[124:127],v[24:27],a[168:171]
v_and_b32 v179,0xffff0000,v182
MF a[172:175],v[128:131],v[24:27],a[172:175]
v_mul_f32 v174,v172,v172
MF a[176:179],v[132:135],v[24:27],a[176:179]
buffer_load_dwordx4 v[24:27],v3,s[8:11],s26 offen offset:1024 sc1
s_waitcnt vmcnt(21)
MF a[180:183],v[100:103],v[28:31],a[180:183]
v_mul_f32 v180,v178,v178
MF a[184:187],v[104:107],v[28:31],a[184:187]
v_mul_f32 v175,v173,v173
v_mul_f32 v181,v179,v179
MF a[188:191],v[108:111],v[28:31],a[188:191]
v_fmaak_f32 v174,v174,v13,0xc0135761
MF a[192:195],v[112:115],v[28:31],a[192:195]
v_fmaak_f32 v180,v180,v13,0xc0135761
MF a[196:199],v[116:119],v[28:31],a[196:199]
v_fmaak_f32 v175,v175,v13,0xc0135761
v_fmaak_f32 v181,v181,v13,0xc0135761
MF a[200:203],v[120:123],v[28:31],a[200:203]
v_mul_f32 v174,v174,v172
MF a[204:207],v[124:127],v[28:31],a[204:207]
v_mul_f32 v180,v180,v178
MF a[208:211],v[128:131],v[28:31],a[208:211]
v_mul_f32 v175,v175,v173
MF a[212:215],v[132:135],v[28:31],a[212:215]
buffer_load_dwordx4 v[28:31],v3,s[8:11],s27 offen offset:1024 sc1
s_waitcnt vmcnt(20)
MF v[184:187],v[136:139],v[32:35],v[184:187]
MF v[188:191],v[140:143],v[32:35],v[188:191]
MF v[192:195],v[144:147],v[32:35],v[192:195]
s_add_u32 s33,s32,92160
buffer_load_dwordx4 v[100:103],v1,s[8:11],s33 offen offset:0 sc1
MF v[196:199],v[148:151],v[32:35],v[196:199]
MF v[200:203],v[152:155],v[32:35],v[200:203]
MF v[204:207],v[156:159],v[32:35],v[204:207]
MF v[208:211],v[160:163],v[32:35],v[208:211]
buffer_load_dwordx4 v[104:107],v1,s[8:11],s33 offen offset:1024 sc1
MF v[212:215],v[164:167],v[32:35],v[212:215]
MF v[216:219],v[168:171],v[32:35],v[216:219]
buffer_load_dwordx4 v[32:35],v3,s[8:11],s28 offen offset:1024 sc1
s_waitcnt vmcnt(22)
MF v[220:223],v[136:139],v[36:39],v[220:223]
v_mul_f32 v181,v181,v179
MF v[224:227],v[140:143],v[36:39],v[224:227]
v_exp_f32 v174,v174
MF v[228:231],v[144:147],v[36:39],v[228:231]
buffer_load_dwordx4 v[108:111],v1,s[8:11],s33 offen offset:2048 sc1
MF v[232:235],v[148:151],v[36:39],v[232:235]
v_exp_f32 v180,v180
MF v[236:239],v[152:155],v[36:39],v[236:239]
v_exp_f32 v175,v175
MF v[240:243],v[156:159],v[36:39],v[240:243]
v_exp_f32 v181,v181
MF v[244:247],v[160:163],v[36:39],v[244:247]
buffer_load_dwordx4 v[112:115],v1,s[8:11],s33 offen offset:3072 sc1
MF v[248:251],v[164:167],v[36:39],v[248:251]
v_add_f32 v174,1.0,v174
MF v[252:255],v[168:171],v[36:39],v[252:255]
buffer_load_dwordx4 v[36:39],v3,s[8:11],s29 offen offset:1024 sc1
s_waitcnt vmcnt(24)
MF a[0:3],v[136:139],v[40:43],a[0:3]
v_add_f32 v180,1.0,v180
MF a[4:7],v[140:143],v[40:43],a[4:7]
v_add_f32 v175,1.0,v175
v_add_f32 v181,1.0,v181
MF a[8:11],v[144:147],v[40:43],a[8:11]
s_add_u32 s33,s32,96256
buffer_load_dwordx4 v[116:119],v1,s[8:11],s33 offen offset:0 sc1
MF a[12:15],v[148:151],v[40:43],a[12:15]
v_rcp_f32 v174,v174
MF a[16:19],v[152:155],v[40:43],a[16:19]
v_rcp_f32 v180,v180
MF a[20:23],v[156:159],v[40:43],a[20:23]
v_rcp_f32 v175,v175
MF a[24:27],v[160:163],v[40:43],a[24:27]
buffer_load_dwordx4 v[120:123],v1,s[8:11],s33 offen offset:1024 sc1
MF a[28:31],v[164:167],v[40:43],a[28:31]
v_rcp_f32 v181,v181
MF a[32:35],v[168:171],v[40:43],a[32:35]
buffer_load_dwordx4 v[40:43],v3,s[8:11],s30 offen offset:1024 sc1
s_waitcnt vmcnt(26)
MF a[36:39],v[136:139],v[44:47],a[36:39]
v_mul_f32 v172,v172,v174
MF a[40:43],v[140:143],v[44:47],a[40:43]
v_mul_f32 v178,v178,v180
v_mul_f32 v173,v173,v175
MF a[44:47],v[144:147],v[44:47],a[44:47]
buffer_load_dwordx4 v[124:127],v1,s[8:11],s33 offen offset:2048 sc1
MF a[48:51],v[148:151],v[44:47],a[48:51]
v_mul_f32 v179,v179,v181
MF a[52:55],v[152:155],v[44:47],a[52:55]
v_cvt_pk_bf16_f32 v176,v172,v173
v_cvt_pk_bf16_f32 v182,v178,v179
MF a[56:59],v[156:159],v[44:47],a[56:59]
v_accvgpr_write_b32 a240,v176
MF a[60:63],v[160:163],v[44:47],a[60:63]
buffer_load_dwordx4 v[128:131],v1,s[8:11],s33 offen offset:3072 sc1
MF a[64:67],v[164:167],v[44:47],a[64:67]
v_accvgpr_write_b32 a241,v182
MF a[68:71],v[168:171],v[44:47],a[68:71]
buffer_load_dwordx4 v[44:47],v3,s[8:11],s31 offen offset:1024 sc1
s_waitcnt vmcnt(26)
MF a[72:75],v[136:139],v[48:51],a[72:75]
v_accvgpr_read_b32 v176,a242
MF a[76:79],v[140:143],v[48:51],a[76:79]
v_accvgpr_read_b32 v182,a243
v_lshlrev_b32 v172,16,v176
MF a[80:83],v[144:147],v[48:51],a[80:83]
s_add_u32 s33,s32,100352
buffer_load_dwordx4 v[132:135],v1,s[8:11],s33 offen offset:0 sc1
MF a[84:87],v[148:151],v[48:51],a[84:87]
v_lshlrev_b32 v178,16,v182
MF a[88:91],v[152:155],v[48:51],a[88:91]
v_and_b32 v173,0xffff0000,v176
v_and_b32 v179,0xffff0000,v182
MF a[92:95],v[156:159],v[48:51],a[92:95]
v_mul_f32 v174,v172,v172
MF a[96:99],v[160:163],v[48:51],a[96:99]
MF a[100:103],v[164:167],v[48:51],a[100:103]
v_mul_f32 v180,v178,v178
MF a[104:107],v[168:171],v[48:51],a[104:107]
buffer_load_dwordx4 v[48:51],v3,s[8:11],s24 offen offset:2048 sc1
s_waitcnt vmcnt(25)
MF a[108:111],v[136:139],v[52:55],a[108:111]
v_mul_f32 v175,v173,v173
MF a[112:115],v[140:143],v[52:55],a[112:115]
v_mul_f32 v181,v179,v179
v_fmaak_f32 v174,v174,v13,0xc0135761
MF a[116:119],v[144:147],v[52:55],a[116:119]
v_fmaak_f32 v180,v180,v13,0xc0135761
MF a[120:123],v[148:151],v[52:55],a[120:123]
v_fmaak_f32 v175,v175,v13,0xc0135761
MF a[124:127],v[152:155],v[52:55],a[124:127]
v_fmaak_f32 v181,v181,v13,0xc0135761
v_mul_f32 v174,v174,v172
MF a[128:131],v[156:159],v[52:55],a[128:131]
v_mul_f32 v180,v180,v178
MF a[132:135],v[160:163],v[52:55],a[132:135]
v_mul_f32 v175,v175,v173
MF a[136:139],v[164:167],v[52:55],a[136:139]
v_mul_f32 v181,v181,v179
MF a[140:143],v[168:171],v[52:55],a[140:143]
buffer_load_dwordx4 v[52:55],v3,s[8:11],s25 offen offset:2048 sc1
s_waitcnt vmcnt(23)
MF a[144:147],v[136:139],v[56:59],a[144:147]
v_exp_f32 v174,v174
MF a[148:151],v[140:143],v[56:59],a[148:151]
v_exp_f32 v180,v180
MF a[152:155],v[144:147],v[56:59],a[152:155]
v_exp_f32 v175,v175
MF a[156:159],v[148:151],v[56:59],a[156:159]
v_exp_f32 v181,v181
MF a[160:163],v[152:155],v[56:59],a[160:163]
v_add_f32 v174,1.0,v174
v_add_f32 v180,1.0,v180
MF a[164:167],v[156:159],v[56:59],a[164:167]
v_add_f32 v175,1.0,v175
MF a[168:171],v[160:163],v[56:59],a[168:171]
v_add_f32 v181,1.0,v181
MF a[172:175],v[164:167],v[56:59],a[172:175]
v_rcp_f32 v174,v174
MF a[176:179],v[168:171],v[56:59],a[176:179]
buffer_load_dwordx4 v[56:59],v3,s[8:11],s26 offen offset:2048 sc1
s_waitcnt vmcnt(21)
MF a[180:183],v[136:139],v[60:63],a[180:183]
v_rcp_f32 v180,v180
MF a[184:187],v[140:143],v[60:63],a[184:187]
v_rcp_f32 v175,v175
MF a[188:191],v[144:147],v[60:63],a[188:191]
v_rcp_f32 v181,v181
MF a[192:195],v[148:151],v[60:63],a[192:195]
v_mul_f32 v172,v172,v174
MF a[196:199],v[152:155],v[60:63],a[196:199]
v_mul_f32 v178,v178,v180
v_mul_f32 v173,v173,v175
MF a[200:203],v[156:159],v[60:63],a[200:203]
v_mul_f32 v179,v179,v181
MF a[204:207],v[160:163],v[60:63],a[204:207]
v_cvt_pk_bf16_f32 v176,v172,v173
MF a[208:211],v[164:167],v[60:63],a[208:211]
v_cvt_pk_bf16_f32 v182,v178,v179
MF a[212:215],v[168:171],v[60:63],a[212:215]
buffer_load_dwordx4 v[60:63],v3,s[8:11],s27 offen offset:2048 sc1
s_waitcnt vmcnt(20)
MF v[184:187],v[64:67],v[16:19],v[184:187]
MF v[188:191],v[68:71],v[16:19],v[188:191]
MF v[192:195],v[72:75],v[16:19],v[192:195]
s_add_u32 s33,s32,101376
buffer_load_dwordx4 v[136:139],v1,s[8:11],s33 offen offset:0 sc1
MF v[196:199],v[76:79],v[16:19],v[196:199]
MF v[200:203],v[80:83],v[16:19],v[200:203]
MF v[204:207],v[84:87],v[16:19],v[204:207]
MF v[208:211],v[88:91],v[16:19],v[208:211]
buffer_load_dwordx4 v[140:143],v1,s[8:11],s33 offen offset:1024 sc1
MF v[212:215],v[92:95],v[16:19],v[212:215]
MF v[216:219],v[96:99],v[16:19],v[216:219]
buffer_load_dwordx4 v[16:19],v3,s[8:11],s28 offen offset:2048 sc1
s_waitcnt vmcnt(22)
MF v[220:223],v[64:67],v[20:23],v[220:223]
v_accvgpr_write_b32 a242,v176
MF v[224:227],v[68:71],v[20:23],v[224:227]
v_accvgpr_write_b32 a243,v182
v_accvgpr_read_b32 v176,a244
MF v[228:231],v[72:75],v[20:23],v[228:231]
buffer_load_dwordx4 v[144:147],v1,s[8:11],s33 offen offset:2048 sc1
MF v[232:235],v[76:79],v[20:23],v[232:235]
v_accvgpr_read_b32 v182,a245
MF v[236:239],v[80:83],v[20:23],v[236:239]
v_lshlrev_b32 v172,16,v176
v_lshlrev_b32 v178,16,v182
MF v[240:243],v[84:87],v[20:23],v[240:243]
v_and_b32 v173,0xffff0000,v176
MF v[244:247],v[88:91],v[20:23],v[244:247]
buffer_load_dwordx4 v[148:151],v1,s[8:11],s33 offen offset:3072 sc1
MF v[248:251],v[92:95],v[20:23],v[248:251]
v_and_b32 v179,0xffff0000,v182
MF v[252:255],v[96:99],v[20:23],v[252:255]
buffer_load_dwordx4 v[20:23],v3,s[8:11],s29 offen offset:2048 sc1
s_waitcnt vmcnt(24)
MF a[0:3],v[64:67],v[24:27],a[0:3]
v_mul_f32 v174,v172,v172
MF a[4:7],v[68:71],v[24:27],a[4:7]
v_mul_f32 v180,v178,v178
v_mul_f32 v175,v173,v173
MF a[8:11],v[72:75],v[24:27],a[8:11]
s_add_u32 s33,s32,105472
buffer_load_dwordx4 v[152:155],v1,s[8:11],s33 offen offset:0 sc1
MF a[12:15],v[76:79],v[24:27],a[12:15]
v_mul_f32 v181,v179,v179
MF a[16:19],v[80:83],v[24:27],a[16:19]
v_fmaak_f32 v174,v174,v13,0xc0135761
v_fmaak_f32 v180,v180,v13,0xc0135761
MF a[20:23],v[84:87],v[24:27],a[20:23]
v_fmaak_f32 v175,v175,v13,0xc0135761
MF a[24:27],v[88:91],v[24:27],a[24:27]
buffer_load_dwordx4 v[156:159],v1,s[8:11],s33 offen offset:1024 sc1
MF a[28:31],v[92:95],v[24:27],a[28:31]
v_fmaak_f32 v181,v181,v13,0xc0135761
MF a[32:35],v[96:99],v[24:27],a[32:35]
buffer_load_dwordx4 v[24:27],v3,s[8:11],s30 offen offset:2048 sc1
s_waitcnt vmcnt(26)
MF a[36:39],v[64:67],v[28:31],a[36:39]
v_mul_f32 v174,v174,v172
MF a[40:43],v[68:71],v[28:31],a[40:43]
v_mul_f32 v180,v180,v178
v_mul_f32 v175,v175,v173
MF a[44:47],v[72:75],v[28:31],a[44:47]
buffer_load_dwordx4 v[160:163],v1,s[8:11],s33 offen offset:2048 sc1
MF a[48:51],v[76:79],v[28:31],a[48:51]
v_mul_f32 v181,v181,v179
MF a[52:55],v[80:83],v[28:31],a[52:55]
v_exp_f32 v174,v174
MF a[56:59],v[84:87],v[28:31],a[56:59]
v_exp_f32 v180,v180
MF a[60:63],v[88:91],v[28:31],a[60:63]
buffer_load_dwordx4 v[164:167],v1,s[8:11],s33 offen offset:3072 sc1
MF a[64:67],v[92:95],v[28:31],a[64:67]
v_exp_f32 v175,v175
MF a[68:71],v[96:99],v[28:31],a[68:71]
buffer_load_dwordx4 v[28:31],v3,s[8:11],s31 offen offset:2048 sc1
s_waitcnt vmcnt(26)
MF a[72:75],v[64:67],v[32:35],a[72:75]
v_exp_f32 v181,v181
MF a[76:79],v[68:71],v[32:35],a[76:79]
v_add_f32 v174,1.0,v174
v_add_f32 v180,1.0,v180
MF a[80:83],v[72:75],v[32:35],a[80:83]
s_add_u32 s33,s32,109568
buffer_load_dwordx4 v[168:171],v1,s[8:11],s33 offen offset:0 sc1
MF a[84:87],v[76:79],v[32:35],a[84:87]
v_add_f32 v175,1.0,v175
MF a[88:91],v[80:83],v[32:35],a[88:91]
v_add_f32 v181,1.0,v181
v_rcp_f32 v174,v174
MF a[92:95],v[84:87],v[32:35],a[92:95]
v_rcp_f32 v180,v180
MF a[96:99],v[88:91],v[32:35],a[96:99]
MF a[100:103],v[92:95],v[32:35],a[100:103]
v_rcp_f32 v175,v175
MF a[104:107],v[96:99],v[32:35],a[104:107]
buffer_load_dwordx4 v[32:35],v3,s[8:11],s24 offen offset:3072 sc1
s_waitcnt vmcnt(25)
MF a[108:111],v[64:67],v[36:39],a[108:111]
v_rcp_f32 v181,v181
MF a[112:115],v[68:71],v[36:39],a[112:115]
v_mul_f32 v172,v172,v174
v_mul_f32 v178,v178,v180
MF a[116:119],v[72:75],v[36:39],a[116:119]
v_mul_f32 v173,v173,v175
MF a[120:123],v[76:79],v[36:39],a[120:123]
v_mul_f32 v179,v179,v181
MF a[124:127],v[80:83],v[36:39],a[124:127]
v_cvt_pk_bf16_f32 v176,v172,v173
v_cvt_pk_bf16_f32 v182,v178,v179
MF a[128:131],v[84:87],v[36:39],a[128:131]
v_accvgpr_write_b32 a244,v176
MF a[132:135],v[88:91],v[36:39],a[132:135]
v_accvgpr_write_b32 a245,v182
MF a[136:139],v[92:95],v[36:39],a[136:139]
v_accvgpr_read_b32 v176,a246
MF a[140:143],v[96:99],v[36:39],a[140:143]
buffer_load_dwordx4 v[36:39],v3,s[8:11],s25 offen offset:3072 sc1
s_waitcnt vmcnt(23)
MF a[144:147],v[64:67],v[40:43],a[144:147]
v_accvgpr_read_b32 v182,a247
MF a[148:151],v[68:71],v[40:43],a[148:151]
v_lshlrev_b32 v172,16,v176
v_lshlrev_b32 v178,16,v182
MF a[152:155],v[72:75],v[40:43],a[152:155]
v_and_b32 v173,0xffff0000,v176
MF a[156:159],v[76:79],v[40:43],a[156:159]
v_and_b32 v179,0xffff0000,v182
MF a[160:163],v[80:83],v[40:43],a[160:163]
v_mul_f32 v174,v172,v172
v_mul_f32 v180,v178,v178
MF a[164:167],v[84:87],v[40:43],a[164:167]
v_mul_f32 v175,v173,v173
MF a[168:171],v[88:91],v[40:43],a[168:171]
v_mul_f32 v181,v179,v179
MF a[172:175],v[92:95],v[40:43],a[172:175]
v_fmaak_f32 v174,v174,v13,0xc0135761
MF a[176:179],v[96:99],v[40:43],a[176:179]
buffer_load_dwordx4 v[40:43],v3,s[8:11],s26 offen offset:3072 sc1
s_waitcnt vmcnt(21)
MF a[180:183],v[64:67],v[44:47],a[180:183]
v_fmaak_f32 v180,v180,v13,0xc0135761
MF a[184:187],v[68:71],v[44:47],a[184:187]
v_fmaak_f32 v175,v175,v13,0xc0135761
v_fmaak_f32 v181,v181,v13,0xc0135761
MF a[188:191],v[72:75],v[44:47],a[188:191]
v_mul_f32 v174,v174,v172
MF a[192:195],v[76:79],v[44:47],a[192:195]
v_mul_f32 v180,v180,v178
MF a[196:199],v[80:83],v[44:47],a[196:199]
v_mul_f32 v175,v175,v173
v_mul_f32 v181,v181,v179
MF a[200:203],v[84:87],v[44:47],a[200:203]
v_exp_f32 v174,v174
MF a[204:207],v[88:91],v[44:47],a[204:207]
v_exp_f32 v180,v180
MF a[208:211],v[92:95],v[44:47],a[208:211]
v_exp_f32 v175,v175
MF a[212:215],v[96:99],v[44:47],a[212:215]
buffer_load_dwordx4 v[44:47],v3,s[8:11],s27 offen offset:3072 sc1
s_waitcnt vmcnt(20)
MF v[184:187],v[100:103],v[48:51],v[184:187]
MF v[188:191],v[104:107],v[48:51],v[188:191]
MF v[192:195],v[108:111],v[48:51],v[192:195]
s_add_u32 s33,s32,110592
buffer_load_dwordx4 v[64:67],v1,s[8:11],s33 offen offset:0 sc1
MF v[196:199],v[112:115],v[48:51],v[196:199]
MF v[200:203],v[116:119],v[48:51],v[200:203]
MF v[204:207],v[120:123],v[48:51],v[204:207]
MF v[208:211],v[124:127],v[48:51],v[208:211]
buffer_load_dwordx4 v[68:71],v1,s[8:11],s33 offen offset:1024 sc1
MF v[212:215],v[128:131],v[48:51],v[212:215]
MF v[216:219],v[132:135],v[48:51],v[216:219]
buffer_load_dwordx4 v[48:51],v3,s[8:11],s28 offen offset:3072 sc1
s_waitcnt vmcnt(22)
MF v[220:223],v[100:103],v[52:55],v[220:223]
v_exp_f32 v181,v181
MF v[224:227],v[104:107],v[52:55],v[224:227]
v_add_f32 v174,1.0,v174
v_add_f32 v180,1.0,v180
MF v[228:231],v[108:111],v[52:55],v[228:231]
buffer_load_dwordx4 v[72:75],v1,s[8:11],s33 offen offset:2048 sc1
MF v[232:235],v[112:115],v[52:55],v[232:235]
v_add_f32 v175,1.0,v175
MF v[236:239],v[116:119],v[52:55],v[236:239]
v_add_f32 v181,1.0,v181
v_rcp_f32 v174,v174
MF v[240:243],v[120:123],v[52:55],v[240:243]
v_rcp_f32 v180,v180
MF v[244:247],v[124:127],v[52:55],v[244:247]
buffer_load_dwordx4 v[76:79],v1,s[8:11],s33 offen offset:3072 sc1
MF v[248:251],v[128:131],v[52:55],v[248:251]
v_rcp_f32 v175,v175
MF v[252:255],v[132:135],v[52:55],v[252:255]
buffer_load_dwordx4 v[52:55],v3,s[8:11],s29 offen offset:3072 sc1
s_waitcnt vmcnt(24)
MF a[0:3],v[100:103],v[56:59],a[0:3]
v_rcp_f32 v181,v181
MF a[4:7],v[104:107],v[56:59],a[4:7]
v_mul_f32 v172,v172,v174
v_mul_f32 v178,v178,v180
MF a[8:11],v[108:111],v[56:59],a[8:11]
s_add_u32 s33,s32,114688
buffer_load_dwordx4 v[80:83],v1,s[8:11],s33 offen offset:0 sc1
MF a[12:15],v[112:115],v[56:59],a[12:15]
v_mul_f32 v173,v173,v175
MF a[16:19],v[116:119],v[56:59],a[16:19]
v_mul_f32 v179,v179,v181
v_cvt_pk_bf16_f32 v176,v172,v173
MF a[20:23],v[120:123],v[56:59],a[20:23]
v_cvt_pk_bf16_f32 v182,v178,v179
MF a[24:27],v[124:127],v[56:59],a[24:27]
buffer_load_dwordx4 v[84:87],v1,s[8:11],s33 offen offset:1024 sc1
MF a[28:31],v[128:131],v[56:59],a[28:31]
v_accvgpr_write_b32 a246,v176
MF a[32:35],v[132:135],v[56:59],a[32:35]
buffer_load_dwordx4 v[56:59],v3,s[8:11],s30 offen offset:3072 sc1
s_waitcnt vmcnt(26)
MF a[36:39],v[100:103],v[60:63],a[36:39]
v_accvgpr_write_b32 a247,v182
MF a[40:43],v[104:107],v[60:63],a[40:43]
v_accvgpr_read_b32 v176,a248
v_accvgpr_read_b32 v182,a249
MF a[44:47],v[108:111],v[60:63],a[44:47]
buffer_load_dwordx4 v[88:91],v1,s[8:11],s33 offen offset:2048 sc1
MF a[48:51],v[112:115],v[60:63],a[48:51]
v_lshlrev_b32 v172,16,v176
MF a[52:55],v[116:119],v[60:63],a[52:55]
v_lshlrev_b32 v178,16,v182
v_and_b32 v173,0xffff0000,v176
MF a[56:59],v[120:123],v[60:63],a[56:59]
v_and_b32 v179,0xffff0000,v182
MF a[60:63],v[124:127],v[60:63],a[60:63]
buffer_load_dwordx4 v[92:95],v1,s[8:11],s33 offen offset:3072 sc1
MF a[64:67],v[128:131],v[60:63],a[64:67]
v_mul_f32 v174,v172,v172
MF a[68:71],v[132:135],v[60:63],a[68:71]
buffer_load_dwordx4 v[60:63],v3,s[8:11],s31 offen offset:3072 sc1
s_waitcnt vmcnt(26)
MF a[72:75],v[100:103],v[16:19],a[72:75]
v_mul_f32 v180,v178,v178
MF a[76:79],v[104:107],v[16:19],a[76:79]
v_mul_f32 v175,v173,v173
v_mul_f32 v181,v179,v179
MF a[80:83],v[108:111],v[16:19],a[80:83]
s_add_u32 s33,s32,118784
buffer_load_dwordx4 v[96:99],v1,s[8:11],s33 offen offset:0 sc1
MF a[84:87],v[112:115],v[16:19],a[84:87]
v_fmaak_f32 v174,v174,v13,0xc0135761
MF a[88:91],v[116:119],v[16:19],a[88:91]
v_fmaak_f32 v180,v180,v13,0xc0135761
v_fmaak_f32 v175,v175,v13,0xc0135761
MF a[92:95],v[120:123],v[16:19],a[92:95]
v_fmaak_f32 v181,v181,v13,0xc0135761
MF a[96:99],v[124:127],v[16:19],a[96:99]
MF a[100:103],v[128:131],v[16:19],a[100:103]
v_mul_f32 v174,v174,v172
MF a[104:107],v[132:135],v[16:19],a[104:107]
buffer_load_dwordx4 v[16:19],v4,s[8:11],s26 offen offset:0 sc1
s_waitcnt vmcnt(25)
MF a[108:111],v[100:103],v[20:23],a[108:111]
v_mul_f32 v180,v180,v178
MF a[112:115],v[104:107],v[20:23],a[112:115]
v_mul_f32 v175,v175,v173
v_mul_f32 v181,v181,v179
MF a[116:119],v[108:111],v[20:23],a[116:119]
v_exp_f32 v174,v174
MF a[120:123],v[112:115],v[20:23],a[120:123]
v_exp_f32 v180,v180
MF a[124:127],v[116:119],v[20:23],a[124:127]
v_exp_f32 v175,v175
MF a[128:131],v[120:123],v[20:23],a[128:131]
v_exp_f32 v181,v181
MF a[132:135],v[124:127],v[20:23],a[132:135]
v_add_f32 v174,1.0,v174
MF a[136:139],v[128:131],v[20:23],a[136:139]
v_add_f32 v180,1.0,v180
MF a[140:143],v[132:135],v[20:23],a[140:143]
buffer_load_dwordx4 v[20:23],v4,s[8:11],s27 offen offset:0 sc1
s_waitcnt vmcnt(23)
MF a[144:147],v[100:103],v[24:27],a[144:147]
v_add_f32 v175,1.0,v175
MF a[148:151],v[104:107],v[24:27],a[148:151]
v_add_f32 v181,1.0,v181
v_rcp_f32 v174,v174
MF a[152:155],v[108:111],v[24:27],a[152:155]
v_rcp_f32 v180,v180
MF a[156:159],v[112:115],v[24:27],a[156:159]
v_rcp_f32 v175,v175
MF a[160:163],v[116:119],v[24:27],a[160:163]
v_rcp_f32 v181,v181
MF a[164:167],v[120:123],v[24:27],a[164:167]
v_mul_f32 v172,v172,v174
MF a[168:171],v[124:127],v[24:27],a[168:171]
v_mul_f32 v178,v178,v180
MF a[172:175],v[128:131],v[24:27],a[172:175]
v_mul_f32 v173,v173,v175
MF a[176:179],v[132:135],v[24:27],a[176:179]
buffer_load_dwordx4 v[24:27],v4,s[8:11],s28 offen offset:0 sc1
s_waitcnt vmcnt(21)
MF a[180:183],v[100:103],v[28:31],a[180:183]
v_mul_f32 v179,v179,v181
MF a[184:187],v[104:107],v[28:31],a[184:187]
v_cvt_pk_bf16_f32 v176,v172,v173
v_cvt_pk_bf16_f32 v182,v178,v179
MF a[188:191],v[108:111],v[28:31],a[188:191]
v_accvgpr_write_b32 a248,v176
MF a[192:195],v[112:115],v[28:31],a[192:195]
v_accvgpr_write_b32 a249,v182
MF a[196:199],v[116:119],v[28:31],a[196:199]
v_accvgpr_read_b32 v176,a250
v_accvgpr_read_b32 v182,a251
MF a[200:203],v[120:123],v[28:31],a[200:203]
v_lshlrev_b32 v172,16,v176
MF a[204:207],v[124:127],v[28:31],a[204:207]
v_lshlrev_b32 v178,16,v182
MF a[208:211],v[128:131],v[28:31],a[208:211]
v_and_b32 v173,0xffff0000,v176
MF a[212:215],v[132:135],v[28:31],a[212:215]
buffer_load_dwordx4 v[28:31],v4,s[8:11],s29 offen offset:0 sc1
s_waitcnt vmcnt(20)
MF v[184:187],v[136:139],v[32:35],v[184:187]
MF v[188:191],v[140:143],v[32:35],v[188:191]
MF v[192:195],v[144:147],v[32:35],v[192:195]
s_add_u32 s33,s32,119808
buffer_load_dwordx4 v[100:103],v1,s[8:11],s33 offen offset:0 sc1
MF v[196:199],v[148:151],v[32:35],v[196:199]
MF v[200:203],v[152:155],v[32:35],v[200:203]
MF v[204:207],v[156:159],v[32:35],v[204:207]
MF v[208:211],v[160:163],v[32:35],v[208:211]
buffer_load_dwordx4 v[104:107],v1,s[8:11],s33 offen offset:1024 sc1
MF v[212:215],v[164:167],v[32:35],v[212:215]
MF v[216:219],v[168:171],v[32:35],v[216:219]
buffer_load_dwordx4 v[32:35],v4,s[8:11],s30 offen offset:0 sc1
s_waitcnt vmcnt(22)
MF v[220:223],v[136:139],v[36:39],v[220:223]
v_and_b32 v179,0xffff0000,v182
MF v[224:227],v[140:143],v[36:39],v[224:227]
v_mul_f32 v174,v172,v172
v_mul_f32 v180,v178,v178
MF v[228:231],v[144:147],v[36:39],v[228:231]
buffer_load_dwordx4 v[108:111],v1,s[8:11],s33 offen offset:2048 sc1
MF v[232:235],v[148:151],v[36:39],v[232:235]
v_mul_f32 v175,v173,v173
MF v[236:239],v[152:155],v[36:39],v[236:239]
v_mul_f32 v181,v179,v179
v_fmaak_f32 v174,v174,v13,0xc0135761
MF v[240:243],v[156:159],v[36:39],v[240:243]
v_fmaak_f32 v180,v180,v13,0xc0135761
MF v[244:247],v[160:163],v[36:39],v[244:247]
buffer_load_dwordx4 v[112:115],v1,s[8:11],s33 offen offset:3072 sc1
MF v[248:251],v[164:167],v[36:39],v[248:251]
v_fmaak_f32 v175,v175,v13,0xc0135761
MF v[252:255],v[168:171],v[36:39],v[252:255]
buffer_load_dwordx4 v[36:39],v4,s[8:11],s31 offen offset:0 sc1
s_waitcnt vmcnt(24)
MF a[0:3],v[136:139],v[40:43],a[0:3]
v_fmaak_f32 v181,v181,v13,0xc0135761
MF a[4:7],v[140:143],v[40:43],a[4:7]
v_mul_f32 v174,v174,v172
v_mul_f32 v180,v180,v178
MF a[8:11],v[144:147],v[40:43],a[8:11]
s_add_u32 s33,s32,123904
buffer_load_dwordx4 v[116:119],v1,s[8:11],s33 offen offset:0 sc1
MF a[12:15],v[148:151],v[40:43],a[12:15]
v_mul_f32 v175,v175,v173
MF a[16:19],v[152:155],v[40:43],a[16:19]
v_mul_f32 v181,v181,v179
v_exp_f32 v174,v174
MF a[20:23],v[156:159],v[40:43],a[20:23]
v_exp_f32 v180,v180
MF a[24:27],v[160:163],v[40:43],a[24:27]
buffer_load_dwordx4 v[120:123],v1,s[8:11],s33 offen offset:1024 sc1
MF a[28:31],v[164:167],v[40:43],a[28:31]
v_exp_f32 v175,v175
MF a[32:35],v[168:171],v[40:43],a[32:35]
buffer_load_dwordx4 v[40:43],v4,s[8:11],s24 offen offset:0 sc1
s_waitcnt vmcnt(26)
MF a[36:39],v[136:139],v[44:47],a[36:39]
v_exp_f32 v181,v181
MF a[40:43],v[140:143],v[44:47],a[40:43]
v_add_f32 v174,1.0,v174
v_add_f32 v180,1.0,v180
MF a[44:47],v[144:147],v[44:47],a[44:47]
buffer_load_dwordx4 v[124:127],v1,s[8:11],s33 offen offset:2048 sc1
MF a[48:51],v[148:151],v[44:47],a[48:51]
v_add_f32 v175,1.0,v175
MF a[52:55],v[152:155],v[44:47],a[52:55]
v_add_f32 v181,1.0,v181
v_rcp_f32 v174,v174
MF a[56:59],v[156:159],v[44:47],a[56:59]
v_rcp_f32 v180,v180
MF a[60:63],v[160:163],v[44:47],a[60:63]
buffer_load_dwordx4 v[128:131],v1,s[8:11],s33 offen offset:3072 sc1
MF a[64:67],v[164:167],v[44:47],a[64:67]
v_rcp_f32 v175,v175
MF a[68:71],v[168:171],v[44:47],a[68:71]
buffer_load_dwordx4 v[44:47],v4,s[8:11],s25 offen offset:0 sc1
s_waitcnt vmcnt(26)
MF a[72:75],v[136:139],v[48:51],a[72:75]
v_rcp_f32 v181,v181
MF a[76:79],v[140:143],v[48:51],a[76:79]
v_mul_f32 v172,v172,v174
v_mul_f32 v178,v178,v180
MF a[80:83],v[144:147],v[48:51],a[80:83]
s_add_u32 s33,s32,128000
buffer_load_dwordx4 v[132:135],v1,s[8:11],s33 offen offset:0 sc1
MF a[84:87],v[148:151],v[48:51],a[84:87]
v_mul_f32 v173,v173,v175
MF a[88:91],v[152:155],v[48:51],a[88:91]
v_mul_f32 v179,v179,v181
v_cvt_pk_bf16_f32 v176,v172,v173
MF a[92:95],v[156:159],v[48:51],a[92:95]
v_cvt_pk_bf16_f32 v182,v178,v179
MF a[96:99],v[160:163],v[48:51],a[96:99]
MF a[100:103],v[164:167],v[48:51],a[100:103]
v_accvgpr_write_b32 a250,v176
MF a[104:107],v[168:171],v[48:51],a[104:107]
buffer_load_dwordx4 v[48:51],v4,s[8:11],s26 offen offset:1024 sc1
s_waitcnt vmcnt(25)
MF a[108:111],v[136:139],v[52:55],a[108:111]
v_accvgpr_write_b32 a251,v182
MF a[112:115],v[140:143],v[52:55],a[112:115]
MF a[116:119],v[144:147],v[52:55],a[116:119]
MF a[120:123],v[148:151],v[52:55],a[120:123]
MF a[124:127],v[152:155],v[52:55],a[124:127]
MF a[128:131],v[156:159],v[52:55],a[128:131]
MF a[132:135],v[160:163],v[52:55],a[132:135]
MF a[136:139],v[164:167],v[52:55],a[136:139]
MF a[140:143],v[168:171],v[52:55],a[140:143]
buffer_load_dwordx4 v[52:55],v4,s[8:11],s26 offen offset:2048 sc1
s_waitcnt vmcnt(23)
MF a[144:147],v[136:139],v[56:59],a[144:147]
MF a[148:151],v[140:143],v[56:59],a[148:151]
MF a[152:155],v[144:147],v[56:59],a[152:155]
MF a[156:159],v[148:151],v[56:59],a[156:159]
MF a[160:163],v[152:155],v[56:59],a[160:163]
MF a[164:167],v[156:159],v[56:59],a[164:167]
MF a[168:171],v[160:163],v[56:59],a[168:171]
MF a[172:175],v[164:167],v[56:59],a[172:175]
MF a[176:179],v[168:171],v[56:59],a[176:179]
buffer_load_dwordx4 v[56:59],v4,s[8:11],s26 offen offset:3072 sc1
s_waitcnt vmcnt(21)
MF a[180:183],v[136:139],v[60:63],a[180:183]
MF a[184:187],v[140:143],v[60:63],a[184:187]
MF a[188:191],v[144:147],v[60:63],a[188:191]
MF a[192:195],v[148:151],v[60:63],a[192:195]
MF a[196:199],v[152:155],v[60:63],a[196:199]
MF a[200:203],v[156:159],v[60:63],a[200:203]
MF a[204:207],v[160:163],v[60:63],a[204:207]
MF a[208:211],v[164:167],v[60:63],a[208:211]
MF a[212:215],v[168:171],v[60:63],a[212:215]
buffer_load_dwordx4 v[60:63],v4,s[8:11],s27 offen offset:1024 sc1
s_waitcnt vmcnt(20)
MF a[0:3],v[64:67],v[16:19],a[0:3]
s_add_u32 s33,s32,129024
buffer_load_dwordx4 v[136:139],v1,s[8:11],s33 offen offset:0 sc1
MF a[4:7],v[68:71],v[16:19],a[4:7]
MF a[8:11],v[72:75],v[16:19],a[8:11]
buffer_load_dwordx4 v[140:143],v1,s[8:11],s33 offen offset:1024 sc1
MF a[12:15],v[76:79],v[16:19],a[12:15]
MF a[16:19],v[80:83],v[16:19],a[16:19]
buffer_load_dwordx4 v[144:147],v1,s[8:11],s33 offen offset:2048 sc1
MF a[20:23],v[84:87],v[16:19],a[20:23]
MF a[24:27],v[88:91],v[16:19],a[24:27]
buffer_load_dwordx4 v[148:151],v1,s[8:11],s33 offen offset:3072 sc1
MF a[28:31],v[92:95],v[16:19],a[28:31]
MF a[32:35],v[96:99],v[16:19],a[32:35]
s_add_u32 s33,s32,133120
buffer_load_dwordx4 v[152:155],v1,s[8:11],s33 offen offset:0 sc1
buffer_load_dwordx4 v[16:19],v4,s[8:11],s27 offen offset:2048 sc1
s_waitcnt vmcnt(25)
MF a[36:39],v[64:67],v[20:23],a[36:39]
MF a[40:43],v[68:71],v[20:23],a[40:43]
buffer_load_dwordx4 v[156:159],v1,s[8:11],s33 offen offset:1024 sc1
MF a[44:47],v[72:75],v[20:23],a[44:47]
MF a[48:51],v[76:79],v[20:23],a[48:51]
buffer_load_dwordx4 v[160:163],v1,s[8:11],s33 offen offset:2048 sc1
MF a[52:55],v[80:83],v[20:23],a[52:55]
MF a[56:59],v[84:87],v[20:23],a[56:59]
buffer_load_dwordx4 v[164:167],v1,s[8:11],s33 offen offset:3072 sc1
MF a[60:63],v[88:91],v[20:23],a[60:63]
MF a[64:67],v[92:95],v[20:23],a[64:67]
s_add_u32 s33,s32,137216
buffer_load_dwordx4 v[168:171],v1,s[8:11],s33 offen offset:0 sc1
MF a[68:71],v[96:99],v[20:23],a[68:71]
buffer_load_dwordx4 v[20:23],v4,s[8:11],s27 offen offset:3072 sc1
s_waitcnt vmcnt(29)
MF a[72:75],v[64:67],v[24:27],a[72:75]
s_waitcnt vmcnt(28)
MF a[108:111],v[64:67],v[28:31],a[108:111]
s_waitcnt vmcnt(25)
MF a[144:147],v[64:67],v[32:35],a[144:147]
s_waitcnt vmcnt(22)
MF a[180:183],v[64:67],v[36:39],a[180:183]
s_waitcnt vmcnt(19)
MF v[184:187],v[64:67],v[40:43],v[184:187]
s_waitcnt vmcnt(16)
MF v[220:223],v[64:67],v[44:47],v[220:223]
s_add_u32 s33,s32,138240
buffer_load_dwordx4 v[64:67],v1,s[8:11],s33 offen offset:0 sc1
MF a[76:79],v[68:71],v[24:27],a[76:79]
MF a[112:115],v[68:71],v[28:31],a[112:115]
MF a[148:151],v[68:71],v[32:35],a[148:151]
MF a[184:187],v[68:71],v[36:39],a[184:187]
MF v[188:191],v[68:71],v[40:43],v[188:191]
MF v[224:227],v[68:71],v[44:47],v[224:227]
buffer_load_dwordx4 v[68:71],v1,s[8:11],s33 offen offset:1024 sc1
MF a[80:83],v[72:75],v[24:27],a[80:83]
MF a[116:119],v[72:75],v[28:31],a[116:119]
MF a[152:155],v[72:75],v[32:35],a[152:155]
MF a[188:191],v[72:75],v[36:39],a[188:191]
MF v[192:195],v[72:75],v[40:43],v[192:195]
MF v[228:231],v[72:75],v[44:47],v[228:231]
buffer_load_dwordx4 v[72:75],v1,s[8:11],s33 offen offset:2048 sc1
MF a[84:87],v[76:79],v[24:27],a[84:87]
MF a[120:123],v[76:79],v[28:31],a[120:123]
MF a[156:159],v[76:79],v[32:35],a[156:159]
MF a[192:195],v[76:79],v[36:39],a[192:195]
MF v[196:199],v[76:79],v[40:43],v[196:199]
MF v[232:235],v[76:79],v[44:47],v[232:235]
buffer_load_dwordx4 v[76:79],v1,s[8:11],s33 offen offset:3072 sc1
MF a[88:91],v[80:83],v[24:27],a[88:91]
MF a[124:127],v[80:83],v[28:31],a[124:127]
MF a[160:163],v[80:83],v[32:35],a[160:163]
MF a[196:199],v[80:83],v[36:39],a[196:199]
MF v[200:203],v[80:83],v[40:43],v[200:203]
MF v[236:239],v[80:83],v[44:47],v[236:239]
s_add_u32 s33,s32,142336
buffer_load_dwordx4 v[80:83],v1,s[8:11],s33 offen offset:0 sc1
MF a[92:95],v[84:87],v[24:27],a[92:95]
MF a[128:131],v[84:87],v[28:31],a[128:131]
MF a[164:167],v[84:87],v[32:35],a[164:167]
MF a[200:203],v[84:87],v[36:39],a[200:203]
MF v[204:207],v[84:87],v[40:43],v[204:207]
MF v[240:243],v[84:87],v[44:47],v[240:243]
buffer_load_dwordx4 v[84:87],v1,s[8:11],s33 offen offset:1024 sc1
MF a[96:99],v[88:91],v[24:27],a[96:99]
MF a[132:135],v[88:91],v[28:31],a[132:135]
MF a[168:171],v[88:91],v[32:35],a[168:171]
MF a[204:207],v[88:91],v[36:39],a[204:207]
MF v[208:211],v[88:91],v[40:43],v[208:211]
MF v[244:247],v[88:91],v[44:47],v[244:247]
buffer_load_dwordx4 v[88:91],v1,s[8:11],s33 offen offset:2048 sc1
MF a[100:103],v[92:95],v[24:27],a[100:103]
MF a[136:139],v[92:95],v[28:31],a[136:139]
MF a[172:175],v[92:95],v[32:35],a[172:175]
MF a[208:211],v[92:95],v[36:39],a[208:211]
MF v[212:215],v[92:95],v[40:43],v[212:215]
MF v[248:251],v[92:95],v[44:47],v[248:251]
buffer_load_dwordx4 v[92:95],v1,s[8:11],s33 offen offset:3072 sc1
MF a[104:107],v[96:99],v[24:27],a[104:107]
MF a[140:143],v[96:99],v[28:31],a[140:143]
MF a[176:179],v[96:99],v[32:35],a[176:179]
MF a[212:215],v[96:99],v[36:39],a[212:215]
MF v[216:219],v[96:99],v[40:43],v[216:219]
MF v[252:255],v[96:99],v[44:47],v[252:255]
s_add_u32 s33,s32,146432
buffer_load_dwordx4 v[96:99],v1,s[8:11],s33 offen offset:0 sc1
buffer_load_dwordx4 v[24:27],v4,s[8:11],s28 offen offset:1024 sc1
buffer_load_dwordx4 v[28:31],v4,s[8:11],s28 offen offset:2048 sc1
buffer_load_dwordx4 v[32:35],v4,s[8:11],s28 offen offset:3072 sc1
buffer_load_dwordx4 v[36:39],v4,s[8:11],s29 offen offset:1024 sc1
buffer_load_dwordx4 v[40:43],v4,s[8:11],s29 offen offset:2048 sc1
buffer_load_dwordx4 v[44:47],v4,s[8:11],s29 offen offset:3072 sc1
s_lshl_b32 s46,s44,4
s_add_u32 s46,s46,s45
s_lshl_b32 s46,s46,3
s_lshl_b32 s47,s22,1
s_add_u32 s46,s46,s47
s_mul_i32 s34,s46,4608
s_add_u32 s34,s34,0x2d00000
v_lshlrev_b32 v10,16,v10
v_lshlrev_b32 v11,16,v11
s_waitcnt vmcnt(29)
MF a[0:3],v[100:103],v[48:51],a[0:3]
v_add_f32 v184,v184,v10
v_add_f32 v185,v185,v10
s_waitcnt vmcnt(28)
s_waitcnt vmcnt(25)
MF a[0:3],v[136:139],v[52:55],a[0:3]
v_add_f32 v186,v186,v10
v_add_f32 v187,v187,v10
s_waitcnt vmcnt(14)
MF a[0:3],v[64:67],v[56:59],a[0:3]
v_add_f32 v188,v188,v10
v_add_f32 v189,v189,v10
MF a[4:7],v[104:107],v[48:51],a[4:7]
v_add_f32 v190,v190,v10
v_add_f32 v191,v191,v10
MF a[4:7],v[140:143],v[52:55],a[4:7]
s_nop 1
ds_write_b128 v5,a[0:3] offset:0
v_add_f32 v192,v192,v10
s_waitcnt vmcnt(13)
MF a[4:7],v[68:71],v[56:59],a[4:7]
v_add_f32 v193,v193,v10
v_add_f32 v194,v194,v10
MF a[8:11],v[108:111],v[48:51],a[8:11]
v_add_f32 v195,v195,v10
v_add_f32 v196,v196,v10
MF a[8:11],v[144:147],v[52:55],a[8:11]
s_nop 1
ds_write_b128 v5,a[4:7] offset:1024
v_add_f32 v197,v197,v10
s_waitcnt vmcnt(12)
MF a[8:11],v[72:75],v[56:59],a[8:11]
v_add_f32 v198,v198,v10
v_add_f32 v199,v199,v10
MF a[12:15],v[112:115],v[48:51],a[12:15]
v_add_f32 v200,v200,v10
v_add_f32 v201,v201,v10
MF a[12:15],v[148:151],v[52:55],a[12:15]
s_nop 1
ds_write_b128 v5,a[8:11] offset:2048
v_add_f32 v202,v202,v10
s_waitcnt vmcnt(11)
MF a[12:15],v[76:79],v[56:59],a[12:15]
v_add_f32 v203,v203,v10
v_add_f32 v204,v204,v10
MF a[16:19],v[116:119],v[48:51],a[16:19]
v_add_f32 v205,v205,v10
v_add_f32 v206,v206,v10
MF a[16:19],v[152:155],v[52:55],a[16:19]
s_nop 1
ds_write_b128 v5,a[12:15] offset:3072
v_add_f32 v207,v207,v10
s_waitcnt vmcnt(10)
MF a[16:19],v[80:83],v[56:59],a[16:19]
v_add_f32 v208,v208,v10
v_add_f32 v209,v209,v10
MF a[20:23],v[120:123],v[48:51],a[20:23]
v_add_f32 v210,v210,v10
v_add_f32 v211,v211,v10
MF a[20:23],v[156:159],v[52:55],a[20:23]
s_nop 1
ds_write_b128 v5,a[16:19] offset:4096
v_add_f32 v212,v212,v10
s_waitcnt vmcnt(9)
MF a[20:23],v[84:87],v[56:59],a[20:23]
v_add_f32 v213,v213,v10
v_add_f32 v214,v214,v10
MF a[24:27],v[124:127],v[48:51],a[24:27]
v_add_f32 v215,v215,v10
v_add_f32 v216,v216,v10
MF a[24:27],v[160:163],v[52:55],a[24:27]
s_nop 1
ds_write_b128 v5,a[20:23] offset:5120
v_add_f32 v217,v217,v10
s_waitcnt vmcnt(8)
MF a[24:27],v[88:91],v[56:59],a[24:27]
v_add_f32 v218,v218,v10
v_add_f32 v219,v219,v10
MF a[28:31],v[128:131],v[48:51],a[28:31]
v_add_f32 v220,v220,v11
v_add_f32 v221,v221,v11
MF a[28:31],v[164:167],v[52:55],a[28:31]
s_nop 1
ds_write_b128 v5,a[24:27] offset:6144
v_add_f32 v222,v222,v11
s_waitcnt vmcnt(7)
MF a[28:31],v[92:95],v[56:59],a[28:31]
v_add_f32 v223,v223,v11
v_add_f32 v224,v224,v11
MF a[32:35],v[132:135],v[48:51],a[32:35]
v_add_f32 v225,v225,v11
v_add_f32 v226,v226,v11
MF a[32:35],v[168:171],v[52:55],a[32:35]
s_nop 1
ds_write_b128 v5,a[28:31] offset:7168
v_add_f32 v227,v227,v11
s_waitcnt vmcnt(6)
MF a[32:35],v[96:99],v[56:59],a[32:35]
v_add_f32 v228,v228,v11
v_add_f32 v229,v229,v11
buffer_load_dwordx4 v[48:51],v4,s[8:11],s30 offen offset:1024 sc1
buffer_load_dwordx4 v[52:55],v4,s[8:11],s30 offen offset:2048 sc1
buffer_load_dwordx4 v[56:59],v4,s[8:11],s30 offen offset:3072 sc1
MF a[36:39],v[100:103],v[60:63],a[36:39]
v_add_f32 v230,v230,v11
v_add_f32 v231,v231,v11
MF a[36:39],v[136:139],v[16:19],a[36:39]
ds_write_b128 v5,a[32:35] offset:8192
v_add_f32 v232,v232,v11
MF a[36:39],v[64:67],v[20:23],a[36:39]
v_add_f32 v233,v233,v11
v_add_f32 v234,v234,v11
MF a[40:43],v[104:107],v[60:63],a[40:43]
v_add_f32 v235,v235,v11
v_add_f32 v236,v236,v11
MF a[40:43],v[140:143],v[16:19],a[40:43]
s_nop 1
ds_write_b128 v5,a[36:39] offset:9216
v_add_f32 v237,v237,v11
MF a[40:43],v[68:71],v[20:23],a[40:43]
v_add_f32 v238,v238,v11
v_add_f32 v239,v239,v11
MF a[44:47],v[108:111],v[60:63],a[44:47]
v_add_f32 v240,v240,v11
v_add_f32 v241,v241,v11
MF a[44:47],v[144:147],v[16:19],a[44:47]
s_nop 1
ds_write_b128 v5,a[40:43] offset:10240
v_add_f32 v242,v242,v11
MF a[44:47],v[72:75],v[20:23],a[44:47]
v_add_f32 v243,v243,v11
v_add_f32 v244,v244,v11
MF a[48:51],v[112:115],v[60:63],a[48:51]
v_add_f32 v245,v245,v11
v_add_f32 v246,v246,v11
MF a[48:51],v[148:151],v[16:19],a[48:51]
s_nop 1
ds_write_b128 v5,a[44:47] offset:11264
v_add_f32 v247,v247,v11
MF a[48:51],v[76:79],v[20:23],a[48:51]
v_add_f32 v248,v248,v11
v_add_f32 v249,v249,v11
MF a[52:55],v[116:119],v[60:63],a[52:55]
v_add_f32 v250,v250,v11
v_add_f32 v251,v251,v11
MF a[52:55],v[152:155],v[16:19],a[52:55]
s_nop 1
ds_write_b128 v5,a[48:51] offset:12288
v_add_f32 v252,v252,v11
MF a[52:55],v[80:83],v[20:23],a[52:55]
v_add_f32 v253,v253,v11
v_add_f32 v254,v254,v11
MF a[56:59],v[120:123],v[60:63],a[56:59]
v_add_f32 v255,v255,v11
MF a[56:59],v[156:159],v[16:19],a[56:59]
s_nop 2
ds_write_b128 v5,a[52:55] offset:13312
MF a[56:59],v[84:87],v[20:23],a[56:59]
MF a[60:63],v[124:127],v[60:63],a[60:63]
MF a[60:63],v[160:163],v[16:19],a[60:63]
s_nop 5
ds_write_b128 v5,a[56:59] offset:14336
MF a[60:63],v[88:91],v[20:23],a[60:63]
MF a[64:67],v[128:131],v[60:63],a[64:67]
MF a[64:67],v[164:167],v[16:19],a[64:67]
s_waitcnt lgkmcnt(12)
s_nop 4
ds_write_b128 v5,a[60:63] offset:15360
MF a[64:67],v[92:95],v[20:23],a[64:67]
MF a[68:71],v[132:135],v[60:63],a[68:71]
MF a[68:71],v[168:171],v[16:19],a[68:71]
s_nop 5
ds_write_b128 v5,a[64:67] offset:16384
MF a[68:71],v[96:99],v[20:23],a[68:71]
buffer_load_dwordx4 v[60:63],v4,s[8:11],s31 offen offset:1024 sc1
buffer_load_dwordx4 v[16:19],v4,s[8:11],s31 offen offset:2048 sc1
buffer_load_dwordx4 v[20:23],v4,s[8:11],s31 offen offset:3072 sc1
s_nop 4
ds_write_b128 v5,a[68:71] offset:17408
s_waitcnt lgkmcnt(0)
s_barrier
s_waitcnt vmcnt(11)
MF a[72:75],v[100:103],v[24:27],a[72:75]
ds_read_b128 v[172:175],v8 offset:0
ds_read_b128 v[176:179],v8 offset:1024
s_waitcnt vmcnt(10)
MF a[72:75],v[136:139],v[28:31],a[72:75]
ds_read_b128 v[180:183],v8 offset:2048
v_and_b32 v2,7,v0
v_lshl_add_u32 v2,v15,3,v2
v_lshlrev_b32 v2,4,v2
v_add_u32 v2,4096,v2
s_mul_i32 s48,s22,18
s_mov_b32 s49,0
s_lshr_b32 s20,s23,2
s_mul_i32 s20,s20,72
s_add_u32 s48,s48,s20
s_mul_i32 s48,s48,4608
s_add_u32 s48,s48,0x1080000
buffer_load_dwordx4 a[0:3],v1,s[8:11],s48 offen offset:0 sc1
s_waitcnt vmcnt(10)
MF a[72:75],v[64:67],v[32:35],a[72:75]
s_waitcnt lgkmcnt(2)
v_add_f32 v184,v184,v172
v_add_f32 v185,v185,v173
MF a[76:79],v[104:107],v[24:27],a[76:79]
v_add_f32 v186,v186,v174
v_add_f32 v187,v187,v175
MF a[76:79],v[140:143],v[28:31],a[76:79]
s_nop 0
ds_write_b128 v6,a[72:75] offset:0
ds_read_b128 v[172:175],v8 offset:3072
MF a[76:79],v[68:71],v[32:35],a[76:79]
buffer_load_dwordx4 a[4:7],v1,s[8:11],s48 offen offset:1024 sc1
s_waitcnt lgkmcnt(3)
v_add_f32 v188,v188,v176
v_add_f32 v189,v189,v177
MF a[80:83],v[108:111],v[24:27],a[80:83]
v_add_f32 v190,v190,v178
v_add_f32 v191,v191,v179
MF a[80:83],v[144:147],v[28:31],a[80:83]
ds_write_b128 v6,a[76:79] offset:1024
ds_read_b128 v[176:179],v8 offset:4096
MF a[80:83],v[72:75],v[32:35],a[80:83]
buffer_load_dwordx4 a[8:11],v1,s[8:11],s48 offen offset:2048 sc1
s_waitcnt lgkmcnt(4)
v_add_f32 v192,v192,v180
v_add_f32 v193,v193,v181
MF a[84:87],v[112:115],v[24:27],a[84:87]
v_add_f32 v194,v194,v182
v_add_f32 v195,v195,v183
MF a[84:87],v[148:151],v[28:31],a[84:87]
ds_write_b128 v6,a[80:83] offset:2048
ds_read_b128 v[180:183],v8 offset:5120
MF a[84:87],v[76:79],v[32:35],a[84:87]
buffer_load_dwordx4 a[12:15],v1,s[8:11],s48 offen offset:3072 sc1
s_waitcnt lgkmcnt(4)
v_add_f32 v196,v196,v172
v_add_f32 v197,v197,v173
MF a[88:91],v[116:119],v[24:27],a[88:91]
v_add_f32 v198,v198,v174
v_add_f32 v199,v199,v175
MF a[88:91],v[152:155],v[28:31],a[88:91]
ds_write_b128 v6,a[84:87] offset:3072
ds_read_b128 v[172:175],v8 offset:6144
MF a[88:91],v[80:83],v[32:35],a[88:91]
buffer_load_dwordx4 a[16:19],v2,s[8:11],s48 offen sc1
s_waitcnt lgkmcnt(4)
v_add_f32 v200,v200,v176
v_add_f32 v201,v201,v177
MF a[92:95],v[120:123],v[24:27],a[92:95]
v_add_f32 v202,v202,v178
v_add_f32 v203,v203,v179
MF a[92:95],v[156:159],v[28:31],a[92:95]
ds_write_b128 v6,a[88:91] offset:4096
ds_read_b128 v[176:179],v8 offset:7168
MF a[92:95],v[84:87],v[32:35],a[92:95]
s_add_u32 s48,s48,4608
buffer_load_dwordx4 a[20:23],v1,s[8:11],s48 offen offset:0 sc1
s_waitcnt lgkmcnt(4)
v_add_f32 v204,v204,v180
v_add_f32 v205,v205,v181
MF a[96:99],v[124:127],v[24:27],a[96:99]
v_add_f32 v206,v206,v182
v_add_f32 v207,v207,v183
MF a[96:99],v[160:163],v[28:31],a[96:99]
ds_write_b128 v6,a[92:95] offset:5120
ds_read_b128 v[180:183],v8 offset:8192
MF a[96:99],v[88:91],v[32:35],a[96:99]
buffer_load_dwordx4 a[24:27],v1,s[8:11],s48 offen offset:1024 sc1
s_waitcnt lgkmcnt(4)
v_add_f32 v208,v208,v172
v_add_f32 v209,v209,v173
MF a[100:103],v[128:131],v[24:27],a[100:103]
v_add_f32 v210,v210,v174
v_add_f32 v211,v211,v175
MF a[100:103],v[164:167],v[28:31],a[100:103]
ds_write_b128 v6,a[96:99] offset:6144
ds_read_b128 v[172:175],v8 offset:9216
MF a[100:103],v[92:95],v[32:35],a[100:103]
buffer_load_dwordx4 a[28:31],v1,s[8:11],s48 offen offset:2048 sc1
s_waitcnt lgkmcnt(4)
v_add_f32 v212,v212,v176
v_add_f32 v213,v213,v177
MF a[104:107],v[132:135],v[24:27],a[104:107]
v_add_f32 v214,v214,v178
v_add_f32 v215,v215,v179
MF a[104:107],v[168:171],v[28:31],a[104:107]
ds_write_b128 v6,a[100:103] offset:7168
ds_read_b128 v[176:179],v8 offset:10240
MF a[104:107],v[96:99],v[32:35],a[104:107]
buffer_load_dwordx4 a[32:35],v1,s[8:11],s48 offen offset:3072 sc1
s_waitcnt lgkmcnt(4)
v_add_f32 v216,v216,v180
v_add_f32 v217,v217,v181
buffer_load_dwordx4 v[24:27],v4,s[8:11],s24 offen offset:1024 sc1
buffer_load_dwordx4 v[28:31],v4,s[8:11],s24 offen offset:2048 sc1
buffer_load_dwordx4 v[32:35],v4,s[8:11],s24 offen offset:3072 sc1
s_waitcnt vmcnt(20)
MF a[108:111],v[100:103],v[36:39],a[108:111]
v_add_f32 v218,v218,v182
v_add_f32 v219,v219,v183
s_waitcnt vmcnt(19)
MF a[108:111],v[136:139],v[40:43],a[108:111]
ds_write_b128 v6,a[104:107] offset:8192
ds_read_b128 v[180:183],v8 offset:11264
s_waitcnt vmcnt(18)
MF a[108:111],v[64:67],v[44:47],a[108:111]
buffer_load_dwordx4 a[36:39],v2,s[8:11],s48 offen sc1
s_waitcnt lgkmcnt(4)
v_add_f32 v220,v220,v172
v_add_f32 v221,v221,v173
MF a[112:115],v[104:107],v[36:39],a[112:115]
v_add_f32 v222,v222,v174
v_add_f32 v223,v223,v175
MF a[112:115],v[140:143],v[40:43],a[112:115]
ds_write_b128 v6,a[108:111] offset:9216
ds_read_b128 v[172:175],v8 offset:12288
MF a[112:115],v[68:71],v[44:47],a[112:115]
s_add_u32 s48,s48,4608
buffer_load_dwordx4 a[40:43],v1,s[8:11],s48 offen offset:0 sc1
s_waitcnt lgkmcnt(4)
v_add_f32 v224,v224,v176
v_add_f32 v225,v225,v177
MF a[116:119],v[108:111],v[36:39],a[116:119]
v_add_f32 v226,v226,v178
v_add_f32 v227,v227,v179
MF a[116:119],v[144:147],v[40:43],a[116:119]
ds_write_b128 v6,a[112:115] offset:10240
ds_read_b128 v[176:179],v8 offset:13312
MF a[116:119],v[72:75],v[44:47],a[116:119]
buffer_load_dwordx4 a[44:47],v1,s[8:11],s48 offen offset:1024 sc1
s_waitcnt lgkmcnt(4)
v_add_f32 v228,v228,v180
v_add_f32 v229,v229,v181
MF a[120:123],v[112:115],v[36:39],a[120:123]
v_add_f32 v230,v230,v182
v_add_f32 v231,v231,v183
MF a[120:123],v[148:151],v[40:43],a[120:123]
ds_write_b128 v6,a[116:119] offset:11264
ds_read_b128 v[180:183],v8 offset:14336
MF a[120:123],v[76:79],v[44:47],a[120:123]
buffer_load_dwordx4 a[48:51],v1,s[8:11],s48 offen offset:2048 sc1
s_waitcnt lgkmcnt(4)
v_add_f32 v232,v232,v172
v_add_f32 v233,v233,v173
MF a[124:127],v[116:119],v[36:39],a[124:127]
v_add_f32 v234,v234,v174
v_add_f32 v235,v235,v175
MF a[124:127],v[152:155],v[40:43],a[124:127]
ds_write_b128 v6,a[120:123] offset:12288
ds_read_b128 v[172:175],v8 offset:15360
MF a[124:127],v[80:83],v[44:47],a[124:127]
buffer_load_dwordx4 a[52:55],v1,s[8:11],s48 offen offset:3072 sc1
s_waitcnt lgkmcnt(4)
v_add_f32 v236,v236,v176
v_add_f32 v237,v237,v177
MF a[128:131],v[120:123],v[36:39],a[128:131]
v_add_f32 v238,v238,v178
v_add_f32 v239,v239,v179
MF a[128:131],v[156:159],v[40:43],a[128:131]
ds_write_b128 v6,a[124:127] offset:13312
ds_read_b128 v[176:179],v8 offset:16384
MF a[128:131],v[84:87],v[44:47],a[128:131]
buffer_load_dwordx4 a[56:59],v2,s[8:11],s48 offen sc1
s_waitcnt lgkmcnt(4)
v_add_f32 v240,v240,v180
v_add_f32 v241,v241,v181
MF a[132:135],v[124:127],v[36:39],a[132:135]
v_add_f32 v242,v242,v182
v_add_f32 v243,v243,v183
MF a[132:135],v[160:163],v[40:43],a[132:135]
ds_write_b128 v6,a[128:131] offset:14336
ds_read_b128 v[180:183],v8 offset:17408
MF a[132:135],v[88:91],v[44:47],a[132:135]
s_add_u32 s48,s48,4608
buffer_load_dwordx4 a[60:63],v1,s[8:11],s48 offen offset:0 sc1
s_waitcnt lgkmcnt(4)
v_add_f32 v244,v244,v172
v_add_f32 v245,v245,v173
MF a[136:139],v[128:131],v[36:39],a[136:139]
v_add_f32 v246,v246,v174
v_add_f32 v247,v247,v175
MF a[136:139],v[164:167],v[40:43],a[136:139]
ds_write_b128 v6,a[132:135] offset:15360
buffer_load_dwordx4 a[64:67],v1,s[8:11],s48 offen offset:1024 sc1
MF a[136:139],v[92:95],v[44:47],a[136:139]
s_waitcnt lgkmcnt(3)
v_add_f32 v248,v248,v176
v_add_f32 v249,v249,v177
v_add_f32 v250,v250,v178
MF a[140:143],v[132:135],v[36:39],a[140:143]
v_add_f32 v251,v251,v179
buffer_load_dwordx4 a[68:71],v1,s[8:11],s48 offen offset:2048 sc1
MF a[140:143],v[168:171],v[40:43],a[140:143]
ds_write_b128 v6,a[136:139] offset:16384
s_waitcnt lgkmcnt(2)
v_add_f32 v252,v252,v180
MF a[140:143],v[96:99],v[44:47],a[140:143]
v_add_f32 v253,v253,v181
v_add_f32 v254,v254,v182
v_add_f32 v255,v255,v183
buffer_load_dwordx4 v[36:39],v4,s[8:11],s25 offen offset:1024 sc1
buffer_load_dwordx4 v[40:43],v4,s[8:11],s25 offen offset:2048 sc1
buffer_load_dwordx4 v[44:47],v4,s[8:11],s25 offen offset:3072 sc1
s_nop 1
ds_write_b128 v6,a[140:143] offset:17408
s_mul_i32 s46,s45,144
v_lshlrev_b32 v13,2,v15
v_add_u32 v13,s46,v13
v_lshrrev_b32 v12,3,v13
v_lshlrev_b32 v12,8,v12
v_lshl_add_u32 v12,v14,4,v12
v_and_b32 v10,4,v13
v_lshl_add_u32 v12,v10,1,v12
s_lshl_b32 s46,s44,3
s_lshl_b32 s47,s22,1
s_add_u32 s46,s46,s47
s_mul_i32 s46,s46,73728
s_add_u32 s36,s46,0x3600000
s_add_u32 s37,s36,4096
s_add_u32 s38,s36,73728
s_add_u32 s39,s38,4096
s_waitcnt lgkmcnt(0)
s_barrier
s_waitcnt vmcnt(29)
MF a[144:147],v[100:103],v[48:51],a[144:147]
ds_read_b128 v[172:175],v9 offset:0
ds_read_b128 v[176:179],v9 offset:1024
s_waitcnt vmcnt(28)
MF a[144:147],v[136:139],v[52:55],a[144:147]
ds_read_b128 v[180:183],v9 offset:2048
buffer_load_dwordx4 a[72:75],v1,s[8:11],s48 offen offset:3072 sc1
s_waitcnt vmcnt(28)
MF a[144:147],v[64:67],v[56:59],a[144:147]
s_waitcnt lgkmcnt(2)
v_add_f32 v184,v184,v172
v_add_f32 v185,v185,v173
MF a[148:151],v[104:107],v[48:51],a[148:151]
v_add_f32 v186,v186,v174
v_add_f32 v187,v187,v175
MF a[148:151],v[140:143],v[52:55],a[148:151]
s_nop 0
ds_write_b128 v7,a[144:147] offset:0
ds_read_b128 v[172:175],v9 offset:3072
MF a[148:151],v[68:71],v[56:59],a[148:151]
buffer_load_dwordx4 a[76:79],v2,s[8:11],s48 offen sc1
s_waitcnt lgkmcnt(3)
v_add_f32 v188,v188,v176
v_add_f32 v189,v189,v177
MF a[152:155],v[108:111],v[48:51],a[152:155]
v_add_f32 v190,v190,v178
v_add_f32 v191,v191,v179
MF a[152:155],v[144:147],v[52:55],a[152:155]
ds_write_b128 v7,a[148:151] offset:1024
ds_read_b128 v[176:179],v9 offset:4096
MF a[152:155],v[72:75],v[56:59],a[152:155]
s_add_u32 s48,s48,4608
buffer_load_dwordx4 a[80:83],v1,s[8:11],s48 offen offset:0 sc1
s_waitcnt lgkmcnt(4)
v_add_f32 v192,v192,v180
v_add_f32 v193,v193,v181
MF a[156:159],v[112:115],v[48:51],a[156:159]
v_add_f32 v194,v194,v182
v_add_f32 v195,v195,v183
MF a[156:159],v[148:151],v[52:55],a[156:159]
ds_write_b128 v7,a[152:155] offset:2048
ds_read_b128 v[180:183],v9 offset:5120
MF a[156:159],v[76:79],v[56:59],a[156:159]
buffer_load_dwordx4 a[84:87],v1,s[8:11],s48 offen offset:1024 sc1
s_waitcnt lgkmcnt(4)
v_add_f32 v196,v196,v172
v_add_f32 v197,v197,v173
MF a[160:163],v[116:119],v[48:51],a[160:163]
v_add_f32 v198,v198,v174
v_add_f32 v199,v199,v175
MF a[160:163],v[152:155],v[52:55],a[160:163]
ds_write_b128 v7,a[156:159] offset:3072
ds_read_b128 v[172:175],v9 offset:6144
MF a[160:163],v[80:83],v[56:59],a[160:163]
buffer_load_dwordx4 a[88:91],v1,s[8:11],s48 offen offset:2048 sc1
s_waitcnt lgkmcnt(4)
v_add_f32 v200,v200,v176
v_add_f32 v201,v201,v177
MF a[164:167],v[120:123],v[48:51],a[164:167]
v_add_f32 v202,v202,v178
v_add_f32 v203,v203,v179
MF a[164:167],v[156:159],v[52:55],a[164:167]
ds_write_b128 v7,a[160:163] offset:4096
ds_read_b128 v[176:179],v9 offset:7168
MF a[164:167],v[84:87],v[56:59],a[164:167]
buffer_load_dwordx4 a[92:95],v1,s[8:11],s48 offen offset:3072 sc1
s_waitcnt lgkmcnt(4)
v_add_f32 v204,v204,v180
v_add_f32 v205,v205,v181
MF a[168:171],v[124:127],v[48:51],a[168:171]
v_add_f32 v206,v206,v182
v_add_f32 v207,v207,v183
MF a[168:171],v[160:163],v[52:55],a[168:171]
ds_write_b128 v7,a[164:167] offset:5120
ds_read_b128 v[180:183],v9 offset:8192
MF a[168:171],v[88:91],v[56:59],a[168:171]
buffer_load_dwordx4 a[96:99],v2,s[8:11],s48 offen sc1
s_waitcnt lgkmcnt(4)
v_add_f32 v208,v208,v172
v_add_f32 v209,v209,v173
MF a[172:175],v[128:131],v[48:51],a[172:175]
v_add_f32 v210,v210,v174
v_add_f32 v211,v211,v175
MF a[172:175],v[164:167],v[52:55],a[172:175]
ds_write_b128 v7,a[168:171] offset:6144
ds_read_b128 v[172:175],v9 offset:9216
MF a[172:175],v[92:95],v[56:59],a[172:175]
s_add_u32 s48,s48,4608
buffer_load_dwordx4 a[100:103],v1,s[8:11],s48 offen offset:0 sc1
s_waitcnt lgkmcnt(4)
v_add_f32 v212,v212,v176
v_add_f32 v213,v213,v177
MF a[176:179],v[132:135],v[48:51],a[176:179]
v_add_f32 v214,v214,v178
v_add_f32 v215,v215,v179
MF a[176:179],v[168:171],v[52:55],a[176:179]
ds_write_b128 v7,a[172:175] offset:7168
ds_read_b128 v[176:179],v9 offset:10240
MF a[176:179],v[96:99],v[56:59],a[176:179]
buffer_load_dwordx4 a[104:107],v1,s[8:11],s48 offen offset:1024 sc1
s_waitcnt lgkmcnt(4)
v_add_f32 v216,v216,v180
v_add_f32 v217,v217,v181
s_waitcnt vmcnt(35)
MF a[180:183],v[100:103],v[60:63],a[180:183]
v_add_f32 v218,v218,v182
v_add_f32 v219,v219,v183
s_waitcnt vmcnt(34)
MF a[180:183],v[136:139],v[16:19],a[180:183]
ds_write_b128 v7,a[176:179] offset:8192
ds_read_b128 v[180:183],v9 offset:11264
s_waitcnt vmcnt(33)
MF a[180:183],v[64:67],v[20:23],a[180:183]
buffer_load_dwordx4 a[108:111],v1,s[8:11],s48 offen offset:2048 sc1
s_waitcnt lgkmcnt(4)
v_add_f32 v220,v220,v172
v_add_f32 v221,v221,v173
MF a[184:187],v[104:107],v[60:63],a[184:187]
v_add_f32 v222,v222,v174
v_add_f32 v223,v223,v175
MF a[184:187],v[140:143],v[16:19],a[184:187]
ds_write_b128 v7,a[180:183] offset:9216
ds_read_b128 v[172:175],v9 offset:12288
MF a[184:187],v[68:71],v[20:23],a[184:187]
buffer_load_dwordx4 a[112:115],v1,s[8:11],s48 offen offset:3072 sc1
s_waitcnt lgkmcnt(4)
v_add_f32 v224,v224,v176
v_add_f32 v225,v225,v177
MF a[188:191],v[108:111],v[60:63],a[188:191]
v_add_f32 v226,v226,v178
v_add_f32 v227,v227,v179
MF a[188:191],v[144:147],v[16:19],a[188:191]
ds_write_b128 v7,a[184:187] offset:10240
ds_read_b128 v[176:179],v9 offset:13312
MF a[188:191],v[72:75],v[20:23],a[188:191]
buffer_load_dwordx4 a[116:119],v2,s[8:11],s48 offen sc1
s_waitcnt lgkmcnt(4)
v_add_f32 v228,v228,v180
v_add_f32 v229,v229,v181
MF a[192:195],v[112:115],v[60:63],a[192:195]
v_add_f32 v230,v230,v182
v_add_f32 v231,v231,v183
MF a[192:195],v[148:151],v[16:19],a[192:195]
ds_write_b128 v7,a[188:191] offset:11264
ds_read_b128 v[180:183],v9 offset:14336
MF a[192:195],v[76:79],v[20:23],a[192:195]
s_add_u32 s48,s48,4608
buffer_load_dwordx4 a[120:123],v1,s[8:11],s48 offen offset:0 sc1
s_waitcnt lgkmcnt(4)
v_add_f32 v232,v232,v172
v_add_f32 v233,v233,v173
MF a[196:199],v[116:119],v[60:63],a[196:199]
v_add_f32 v234,v234,v174
v_add_f32 v235,v235,v175
MF a[196:199],v[152:155],v[16:19],a[196:199]
ds_write_b128 v7,a[192:195] offset:12288
ds_read_b128 v[172:175],v9 offset:15360
MF a[196:199],v[80:83],v[20:23],a[196:199]
buffer_load_dwordx4 a[124:127],v1,s[8:11],s48 offen offset:1024 sc1
s_waitcnt lgkmcnt(4)
v_add_f32 v236,v236,v176
v_add_f32 v237,v237,v177
MF a[200:203],v[120:123],v[60:63],a[200:203]
v_add_f32 v238,v238,v178
v_add_f32 v239,v239,v179
MF a[200:203],v[156:159],v[16:19],a[200:203]
ds_write_b128 v7,a[196:199] offset:13312
ds_read_b128 v[176:179],v9 offset:16384
MF a[200:203],v[84:87],v[20:23],a[200:203]
buffer_load_dwordx4 a[128:131],v1,s[8:11],s48 offen offset:2048 sc1
s_waitcnt lgkmcnt(4)
v_add_f32 v240,v240,v180
v_add_f32 v241,v241,v181
MF a[204:207],v[124:127],v[60:63],a[204:207]
v_add_f32 v242,v242,v182
v_add_f32 v243,v243,v183
MF a[204:207],v[160:163],v[16:19],a[204:207]
ds_write_b128 v7,a[200:203] offset:14336
ds_read_b128 v[180:183],v9 offset:17408
MF a[204:207],v[88:91],v[20:23],a[204:207]
buffer_load_dwordx4 a[132:135],v1,s[8:11],s48 offen offset:3072 sc1
s_waitcnt lgkmcnt(4)
v_add_f32 v244,v244,v172
v_add_f32 v245,v245,v173
MF a[208:211],v[128:131],v[60:63],a[208:211]
v_add_f32 v246,v246,v174
v_add_f32 v247,v247,v175
MF a[208:211],v[164:167],v[16:19],a[208:211]
ds_write_b128 v7,a[204:207] offset:15360
buffer_load_dwordx4 a[136:139],v2,s[8:11],s48 offen sc1
MF a[208:211],v[92:95],v[20:23],a[208:211]
s_waitcnt lgkmcnt(3)
v_add_f32 v248,v248,v176
v_add_f32 v249,v249,v177
v_add_f32 v250,v250,v178
MF a[212:215],v[132:135],v[60:63],a[212:215]
v_add_f32 v251,v251,v179
s_add_u32 s48,s48,4608
buffer_load_dwordx4 a[140:143],v1,s[8:11],s48 offen offset:0 sc1
MF a[212:215],v[168:171],v[16:19],a[212:215]
ds_write_b128 v7,a[208:211] offset:16384
s_waitcnt lgkmcnt(2)
v_add_f32 v252,v252,v180
MF a[212:215],v[96:99],v[20:23],a[212:215]
v_add_f32 v253,v253,v181
v_add_f32 v254,v254,v182
v_add_f32 v255,v255,v183
s_nop 4
ds_write_b128 v7,a[212:215] offset:17408
s_waitcnt lgkmcnt(0)
s_barrier
ds_read_b128 v[172:175],v8 offset:0
ds_read_b128 v[176:179],v8 offset:1024
ds_read_b128 v[180:183],v8 offset:2048
s_waitcnt lgkmcnt(2)
v_add_f32 v184,v184,v172
v_add_f32 v185,v185,v173
v_add_f32 v186,v186,v174
v_add_f32 v187,v187,v175
s_waitcnt vmcnt(32)
s_nop 0
MF v[184:187],v[100:103],v[24:27],v[184:187]
s_waitcnt vmcnt(31)
MF v[184:187],v[136:139],v[28:31],v[184:187]
s_waitcnt vmcnt(30)
MF v[184:187],v[64:67],v[32:35],v[184:187]
ds_read_b128 v[172:175],v8 offset:3072
s_waitcnt lgkmcnt(2)
v_add_f32 v188,v188,v176
v_add_f32 v189,v189,v177
v_add_f32 v190,v190,v178
v_add_f32 v191,v191,v179
s_nop 1
MF v[188:191],v[104:107],v[24:27],v[188:191]
v_accvgpr_read_b32 v48,a216
v_accvgpr_read_b32 v49,a217
v_lshlrev_b32 v16,16,v48
v_and_b32 v17,0xffff0000,v48
v_lshlrev_b32 v18,16,v49
MF v[188:191],v[140:143],v[28:31],v[188:191]
v_and_b32 v19,0xffff0000,v49
v_mul_f32 v184,v184,v16
v_mul_f32 v185,v185,v17
v_mul_f32 v186,v186,v18
v_mul_f32 v187,v187,v19
MF v[188:191],v[68:71],v[32:35],v[188:191]
v_cvt_pk_bf16_f32 v184,v184,v185
v_cvt_pk_bf16_f32 v185,v186,v187
buffer_store_dwordx2 v[184:185],v12,s[8:11],s36 offen offset:0 sc1
buffer_load_dwordx4 a[144:147],v1,s[8:11],s48 offen offset:1024 sc1
ds_read_b128 v[176:179],v8 offset:4096
s_waitcnt lgkmcnt(2)
v_add_f32 v192,v192,v180
v_add_f32 v193,v193,v181
v_add_f32 v194,v194,v182
v_add_f32 v195,v195,v183
s_nop 1
MF v[192:195],v[108:111],v[24:27],v[192:195]
v_accvgpr_read_b32 v50,a218
v_accvgpr_read_b32 v51,a219
v_lshlrev_b32 v20,16,v50
v_and_b32 v21,0xffff0000,v50
v_lshlrev_b32 v22,16,v51
MF v[192:195],v[144:147],v[28:31],v[192:195]
v_and_b32 v23,0xffff0000,v51
v_mul_f32 v188,v188,v20
v_mul_f32 v189,v189,v21
v_mul_f32 v190,v190,v22
v_mul_f32 v191,v191,v23
MF v[192:195],v[72:75],v[32:35],v[192:195]
v_cvt_pk_bf16_f32 v188,v188,v189
v_cvt_pk_bf16_f32 v189,v190,v191
buffer_store_dwordx2 v[188:189],v12,s[8:11],s36 offen offset:512 sc1
ds_read_b128 v[180:183],v8 offset:5120
s_waitcnt lgkmcnt(2)
v_add_f32 v196,v196,v172
v_add_f32 v197,v197,v173
v_add_f32 v198,v198,v174
v_add_f32 v199,v199,v175
s_nop 1
MF v[196:199],v[112:115],v[24:27],v[196:199]
v_accvgpr_read_b32 v48,a220
v_accvgpr_read_b32 v49,a221
v_lshlrev_b32 v16,16,v48
v_and_b32 v17,0xffff0000,v48
v_lshlrev_b32 v18,16,v49
MF v[196:199],v[148:151],v[28:31],v[196:199]
v_and_b32 v19,0xffff0000,v49
v_mul_f32 v192,v192,v16
v_mul_f32 v193,v193,v17
v_mul_f32 v194,v194,v18
v_mul_f32 v195,v195,v19
MF v[196:199],v[76:79],v[32:35],v[196:199]
v_cvt_pk_bf16_f32 v192,v192,v193
v_cvt_pk_bf16_f32 v193,v194,v195
buffer_store_dwordx2 v[192:193],v12,s[8:11],s36 offen offset:1024 sc1
buffer_load_dwordx4 a[148:151],v1,s[8:11],s48 offen offset:2048 sc1
ds_read_b128 v[172:175],v8 offset:6144
s_waitcnt lgkmcnt(2)
v_add_f32 v200,v200,v176
v_add_f32 v201,v201,v177
v_add_f32 v202,v202,v178
v_add_f32 v203,v203,v179
s_nop 1
MF v[200:203],v[116:119],v[24:27],v[200:203]
v_accvgpr_read_b32 v50,a222
v_accvgpr_read_b32 v51,a223
v_lshlrev_b32 v20,16,v50
v_and_b32 v21,0xffff0000,v50
v_lshlrev_b32 v22,16,v51
MF v[200:203],v[152:155],v[28:31],v[200:203]
v_and_b32 v23,0xffff0000,v51
v_mul_f32 v196,v196,v20
v_mul_f32 v197,v197,v21
v_mul_f32 v198,v198,v22
v_mul_f32 v199,v199,v23
MF v[200:203],v[80:83],v[32:35],v[200:203]
v_cvt_pk_bf16_f32 v196,v196,v197
v_cvt_pk_bf16_f32 v197,v198,v199
buffer_store_dwordx2 v[196:197],v12,s[8:11],s36 offen offset:1536 sc1
ds_read_b128 v[176:179],v8 offset:7168
s_waitcnt lgkmcnt(2)
v_add_f32 v204,v204,v180
v_add_f32 v205,v205,v181
v_add_f32 v206,v206,v182
v_add_f32 v207,v207,v183
s_nop 1
MF v[204:207],v[120:123],v[24:27],v[204:207]
v_accvgpr_read_b32 v48,a224
v_accvgpr_read_b32 v49,a225
v_lshlrev_b32 v16,16,v48
v_and_b32 v17,0xffff0000,v48
v_lshlrev_b32 v18,16,v49
MF v[204:207],v[156:159],v[28:31],v[204:207]
v_and_b32 v19,0xffff0000,v49
v_mul_f32 v200,v200,v16
v_mul_f32 v201,v201,v17
v_mul_f32 v202,v202,v18
v_mul_f32 v203,v203,v19
MF v[204:207],v[84:87],v[32:35],v[204:207]
v_cvt_pk_bf16_f32 v200,v200,v201
v_cvt_pk_bf16_f32 v201,v202,v203
buffer_store_dwordx2 v[200:201],v12,s[8:11],s36 offen offset:2048 sc1
buffer_load_dwordx4 a[152:155],v1,s[8:11],s48 offen offset:3072 sc1
ds_read_b128 v[180:183],v8 offset:8192
s_waitcnt lgkmcnt(2)
v_add_f32 v208,v208,v172
v_add_f32 v209,v209,v173
v_add_f32 v210,v210,v174
v_add_f32 v211,v211,v175
s_nop 1
MF v[208:211],v[124:127],v[24:27],v[208:211]
v_accvgpr_read_b32 v50,a226
v_accvgpr_read_b32 v51,a227
v_lshlrev_b32 v20,16,v50
v_and_b32 v21,0xffff0000,v50
v_lshlrev_b32 v22,16,v51
MF v[208:211],v[160:163],v[28:31],v[208:211]
v_and_b32 v23,0xffff0000,v51
v_mul_f32 v204,v204,v20
v_mul_f32 v205,v205,v21
v_mul_f32 v206,v206,v22
v_mul_f32 v207,v207,v23
MF v[208:211],v[88:91],v[32:35],v[208:211]
v_cvt_pk_bf16_f32 v204,v204,v205
v_cvt_pk_bf16_f32 v205,v206,v207
buffer_store_dwordx2 v[204:205],v12,s[8:11],s36 offen offset:2560 sc1
ds_read_b128 v[172:175],v8 offset:9216
s_waitcnt lgkmcnt(2)
v_add_f32 v212,v212,v176
v_add_f32 v213,v213,v177
v_add_f32 v214,v214,v178
v_add_f32 v215,v215,v179
s_nop 1
MF v[212:215],v[128:131],v[24:27],v[212:215]
v_accvgpr_read_b32 v48,a228
v_accvgpr_read_b32 v49,a229
v_lshlrev_b32 v16,16,v48
v_and_b32 v17,0xffff0000,v48
v_lshlrev_b32 v18,16,v49
MF v[212:215],v[164:167],v[28:31],v[212:215]
v_and_b32 v19,0xffff0000,v49
v_mul_f32 v208,v208,v16
v_mul_f32 v209,v209,v17
v_mul_f32 v210,v210,v18
v_mul_f32 v211,v211,v19
MF v[212:215],v[92:95],v[32:35],v[212:215]
v_cvt_pk_bf16_f32 v208,v208,v209
v_cvt_pk_bf16_f32 v209,v210,v211
buffer_store_dwordx2 v[208:209],v12,s[8:11],s36 offen offset:3072 sc1
buffer_load_dwordx4 a[156:159],v2,s[8:11],s48 offen sc1
ds_read_b128 v[176:179],v8 offset:10240
s_waitcnt lgkmcnt(2)
v_add_f32 v216,v216,v180
v_add_f32 v217,v217,v181
v_add_f32 v218,v218,v182
v_add_f32 v219,v219,v183
s_nop 1
MF v[216:219],v[132:135],v[24:27],v[216:219]
v_accvgpr_read_b32 v50,a230
v_accvgpr_read_b32 v51,a231
v_lshlrev_b32 v20,16,v50
v_and_b32 v21,0xffff0000,v50
v_lshlrev_b32 v22,16,v51
MF v[216:219],v[168:171],v[28:31],v[216:219]
v_and_b32 v23,0xffff0000,v51
v_mul_f32 v212,v212,v20
v_mul_f32 v213,v213,v21
v_mul_f32 v214,v214,v22
v_mul_f32 v215,v215,v23
MF v[216:219],v[96:99],v[32:35],v[216:219]
v_cvt_pk_bf16_f32 v212,v212,v213
v_cvt_pk_bf16_f32 v213,v214,v215
buffer_store_dwordx2 v[212:213],v12,s[8:11],s36 offen offset:3584 sc1
ds_read_b128 v[180:183],v8 offset:11264
s_waitcnt lgkmcnt(2)
v_add_f32 v220,v220,v172
v_add_f32 v221,v221,v173
v_add_f32 v222,v222,v174
v_add_f32 v223,v223,v175
s_waitcnt vmcnt(32)
s_nop 0
MF v[220:223],v[100:103],v[36:39],v[220:223]
v_accvgpr_read_b32 v48,a232
v_accvgpr_read_b32 v49,a233
v_lshlrev_b32 v16,16,v48
v_and_b32 v17,0xffff0000,v48
v_lshlrev_b32 v18,16,v49
s_waitcnt vmcnt(31)
MF v[220:223],v[136:139],v[40:43],v[220:223]
v_and_b32 v19,0xffff0000,v49
v_mul_f32 v216,v216,v16
v_mul_f32 v217,v217,v17
v_mul_f32 v218,v218,v18
v_mul_f32 v219,v219,v19
s_waitcnt vmcnt(30)
MF v[220:223],v[64:67],v[44:47],v[220:223]
v_cvt_pk_bf16_f32 v216,v216,v217
v_cvt_pk_bf16_f32 v217,v218,v219
buffer_store_dwordx2 v[216:217],v12,s[8:11],s37 offen offset:0 sc1
s_add_u32 s48,s48,4608
buffer_load_dwordx4 a[160:163],v1,s[8:11],s48 offen offset:0 sc1
ds_read_b128 v[172:175],v8 offset:12288
s_waitcnt lgkmcnt(2)
v_add_f32 v224,v224,v176
v_add_f32 v225,v225,v177
v_add_f32 v226,v226,v178
v_add_f32 v227,v227,v179
s_nop 1
MF v[224:227],v[104:107],v[36:39],v[224:227]
v_accvgpr_read_b32 v50,a234
v_accvgpr_read_b32 v51,a235
v_lshlrev_b32 v20,16,v50
v_and_b32 v21,0xffff0000,v50
v_lshlrev_b32 v22,16,v51
MF v[224:227],v[140:143],v[40:43],v[224:227]
v_and_b32 v23,0xffff0000,v51
v_mul_f32 v220,v220,v20
v_mul_f32 v221,v221,v21
v_mul_f32 v222,v222,v22
v_mul_f32 v223,v223,v23
MF v[224:227],v[68:71],v[44:47],v[224:227]
v_cvt_pk_bf16_f32 v220,v220,v221
v_cvt_pk_bf16_f32 v221,v222,v223
buffer_store_dwordx2 v[220:221],v12,s[8:11],s38 offen offset:0 sc1
ds_read_b128 v[176:179],v8 offset:13312
s_waitcnt lgkmcnt(2)
v_add_f32 v228,v228,v180
v_add_f32 v229,v229,v181
v_add_f32 v230,v230,v182
v_add_f32 v231,v231,v183
s_nop 1
MF v[228:231],v[108:111],v[36:39],v[228:231]
v_accvgpr_read_b32 v48,a236
v_accvgpr_read_b32 v49,a237
v_lshlrev_b32 v16,16,v48
v_and_b32 v17,0xffff0000,v48
v_lshlrev_b32 v18,16,v49
MF v[228:231],v[144:147],v[40:43],v[228:231]
v_and_b32 v19,0xffff0000,v49
v_mul_f32 v224,v224,v16
v_mul_f32 v225,v225,v17
v_mul_f32 v226,v226,v18
v_mul_f32 v227,v227,v19
MF v[228:231],v[72:75],v[44:47],v[228:231]
v_cvt_pk_bf16_f32 v224,v224,v225
v_cvt_pk_bf16_f32 v225,v226,v227
buffer_store_dwordx2 v[224:225],v12,s[8:11],s38 offen offset:512 sc1
buffer_load_dwordx4 a[164:167],v1,s[8:11],s48 offen offset:1024 sc1
ds_read_b128 v[180:183],v8 offset:14336
s_waitcnt lgkmcnt(2)
v_add_f32 v232,v232,v172
v_add_f32 v233,v233,v173
v_add_f32 v234,v234,v174
v_add_f32 v235,v235,v175
s_nop 1
MF v[232:235],v[112:115],v[36:39],v[232:235]
v_accvgpr_read_b32 v50,a238
v_accvgpr_read_b32 v51,a239
v_lshlrev_b32 v20,16,v50
v_and_b32 v21,0xffff0000,v50
v_lshlrev_b32 v22,16,v51
MF v[232:235],v[148:151],v[40:43],v[232:235]
v_and_b32 v23,0xffff0000,v51
v_mul_f32 v228,v228,v20
v_mul_f32 v229,v229,v21
v_mul_f32 v230,v230,v22
v_mul_f32 v231,v231,v23
MF v[232:235],v[76:79],v[44:47],v[232:235]
v_cvt_pk_bf16_f32 v228,v228,v229
v_cvt_pk_bf16_f32 v229,v230,v231
buffer_store_dwordx2 v[228:229],v12,s[8:11],s38 offen offset:1024 sc1
ds_read_b128 v[172:175],v8 offset:15360
s_waitcnt lgkmcnt(2)
v_add_f32 v236,v236,v176
v_add_f32 v237,v237,v177
v_add_f32 v238,v238,v178
v_add_f32 v239,v239,v179
s_nop 1
MF v[236:239],v[116:119],v[36:39],v[236:239]
v_accvgpr_read_b32 v48,a240
v_accvgpr_read_b32 v49,a241
v_lshlrev_b32 v16,16,v48
v_and_b32 v17,0xffff0000,v48
v_lshlrev_b32 v18,16,v49
MF v[236:239],v[152:155],v[40:43],v[236:239]
v_and_b32 v19,0xffff0000,v49
v_mul_f32 v232,v232,v16
v_mul_f32 v233,v233,v17
v_mul_f32 v234,v234,v18
v_mul_f32 v235,v235,v19
MF v[236:239],v[80:83],v[44:47],v[236:239]
v_cvt_pk_bf16_f32 v232,v232,v233
v_cvt_pk_bf16_f32 v233,v234,v235
buffer_store_dwordx2 v[232:233],v12,s[8:11],s38 offen offset:1536 sc1
buffer_load_dwordx4 a[168:171],v1,s[8:11],s48 offen offset:2048 sc1
ds_read_b128 v[176:179],v8 offset:16384
s_waitcnt lgkmcnt(2)
v_add_f32 v240,v240,v180
v_add_f32 v241,v241,v181
v_add_f32 v242,v242,v182
v_add_f32 v243,v243,v183
s_nop 1
MF v[240:243],v[120:123],v[36:39],v[240:243]
v_accvgpr_read_b32 v50,a242
v_accvgpr_read_b32 v51,a243
v_lshlrev_b32 v20,16,v50
v_and_b32 v21,0xffff0000,v50
v_lshlrev_b32 v22,16,v51
MF v[240:243],v[156:159],v[40:43],v[240:243]
v_and_b32 v23,0xffff0000,v51
v_mul_f32 v236,v236,v20
v_mul_f32 v237,v237,v21
v_mul_f32 v238,v238,v22
v_mul_f32 v239,v239,v23
MF v[240:243],v[84:87],v[44:47],v[240:243]
v_cvt_pk_bf16_f32 v236,v236,v237
v_cvt_pk_bf16_f32 v237,v238,v239
buffer_store_dwordx2 v[236:237],v12,s[8:11],s38 offen offset:2048 sc1
ds_read_b128 v[180:183],v8 offset:17408
s_waitcnt lgkmcnt(2)
v_add_f32 v244,v244,v172
v_add_f32 v245,v245,v173
v_add_f32 v246,v246,v174
v_add_f32 v247,v247,v175
s_nop 1
MF v[244:247],v[124:127],v[36:39],v[244:247]
v_accvgpr_read_b32 v48,a244
v_accvgpr_read_b32 v49,a245
v_lshlrev_b32 v16,16,v48
v_and_b32 v17,0xffff0000,v48
v_lshlrev_b32 v18,16,v49
MF v[244:247],v[160:163],v[40:43],v[244:247]
v_and_b32 v19,0xffff0000,v49
v_mul_f32 v240,v240,v16
v_mul_f32 v241,v241,v17
v_mul_f32 v242,v242,v18
v_mul_f32 v243,v243,v19
MF v[244:247],v[88:91],v[44:47],v[244:247]
v_cvt_pk_bf16_f32 v240,v240,v241
v_cvt_pk_bf16_f32 v241,v242,v243
buffer_store_dwordx2 v[240:241],v12,s[8:11],s38 offen offset:2560 sc1
buffer_load_dwordx4 a[172:175],v1,s[8:11],s48 offen offset:3072 sc1
s_waitcnt lgkmcnt(1)
v_add_f32 v248,v248,v176
v_add_f32 v249,v249,v177
v_add_f32 v250,v250,v178
v_add_f32 v251,v251,v179
s_nop 1
MF v[248:251],v[128:131],v[36:39],v[248:251]
v_accvgpr_read_b32 v50,a246
v_accvgpr_read_b32 v51,a247
v_lshlrev_b32 v20,16,v50
v_and_b32 v21,0xffff0000,v50
v_lshlrev_b32 v22,16,v51
MF v[248:251],v[164:167],v[40:43],v[248:251]
v_and_b32 v23,0xffff0000,v51
v_mul_f32 v244,v244,v20
v_mul_f32 v245,v245,v21
v_mul_f32 v246,v246,v22
v_mul_f32 v247,v247,v23
MF v[248:251],v[92:95],v[44:47],v[248:251]
v_cvt_pk_bf16_f32 v244,v244,v245
v_cvt_pk_bf16_f32 v245,v246,v247
buffer_store_dwordx2 v[244:245],v12,s[8:11],s38 offen offset:3072 sc1
s_waitcnt lgkmcnt(0)
v_add_f32 v252,v252,v180
v_add_f32 v253,v253,v181
v_add_f32 v254,v254,v182
v_add_f32 v255,v255,v183
s_nop 1
MF v[252:255],v[132:135],v[36:39],v[252:255]
v_accvgpr_read_b32 v48,a248
v_accvgpr_read_b32 v49,a249
v_lshlrev_b32 v16,16,v48
v_and_b32 v17,0xffff0000,v48
v_lshlrev_b32 v18,16,v49
MF v[252:255],v[168:171],v[40:43],v[252:255]
v_and_b32 v19,0xffff0000,v49
v_mul_f32 v248,v248,v16
v_mul_f32 v249,v249,v17
v_mul_f32 v250,v250,v18
v_mul_f32 v251,v251,v19
MF v[252:255],v[96:99],v[44:47],v[252:255]
v_cvt_pk_bf16_f32 v248,v248,v249
v_cvt_pk_bf16_f32 v249,v250,v251
buffer_store_dwordx2 v[248:249],v12,s[8:11],s38 offen offset:3584 sc1
buffer_load_dwordx4 a[176:179],v2,s[8:11],s48 offen sc1
v_accvgpr_read_b32 v50,a250
v_accvgpr_read_b32 v51,a251
v_lshlrev_b32 v20,16,v50
v_and_b32 v21,0xffff0000,v50
v_lshlrev_b32 v22,16,v51
v_and_b32 v23,0xffff0000,v51
v_mul_f32 v252,v252,v20
v_mul_f32 v253,v253,v21
v_mul_f32 v254,v254,v22
v_mul_f32 v255,v255,v23
v_cvt_pk_bf16_f32 v252,v252,v253
v_cvt_pk_bf16_f32 v253,v254,v255
buffer_store_dwordx2 v[252:253],v12,s[8:11],s39 offen offset:0 sc1
s_lshl_b32 s78,s44,11
s_lshl_b32 s47,s45,4
s_add_u32 s78,s78,s47
s_lshl_b32 s47,s22,2
s_add_u32 s78,s78,s47
s_add_u32 s78,s78,0x1328000
PH_k5_0:
s_lshl_b32 s44,s3,2
s_and_b32 s45,s23,3
s_add_u32 s44,s44,s45
s_lshr_b32 s45,s23,2
v_and_b32 v2,7,v0
v_lshl_add_u32 v2,v15,3,v2
v_lshlrev_b32 v2,4,v2
v_add_u32 v2,4096,v2
s_mul_i32 s55,s22,18
s_mov_b32 s56,0
s_add_u32 s46,s22,0
s_and_b32 s46,s46,3
s_lshl_b32 s47,s44,2
s_add_u32 s46,s46,s47
s_mul_i32 s46,s46,72
s_add_u32 s46,s46,s55
s_lshl_b32 s46,s46,10
s_add_u32 s24,s46,0x3600000
s_add_u32 s46,s22,1
s_and_b32 s46,s46,3
s_lshl_b32 s47,s44,2
s_add_u32 s46,s46,s47
s_mul_i32 s46,s46,72
s_add_u32 s46,s46,s55
s_lshl_b32 s46,s46,10
s_add_u32 s25,s46,0x3600000
s_add_u32 s46,s22,2
s_and_b32 s46,s46,3
s_lshl_b32 s47,s44,2
s_add_u32 s46,s46,s47
s_mul_i32 s46,s46,72
s_add_u32 s46,s46,s55
s_lshl_b32 s46,s46,10
s_add_u32 s26,s46,0x3600000
s_add_u32 s46,s22,3
s_and_b32 s46,s46,3
s_lshl_b32 s47,s44,2
s_add_u32 s46,s46,s47
s_mul_i32 s46,s46,72
s_add_u32 s46,s46,s55
s_lshl_b32 s46,s46,10
s_add_u32 s27,s46,0x3600000
s_mul_i32 s46,s45,72
s_add_u32 s46,s46,s55
s_mul_i32 s28,s46,4608
s_add_u32 s28,s28,0x1080000
s_add_u32 s28,s28,36864
s_lshr_b32 s51,s44,1
s_lshl_b32 s79,s51,11
s_add_u32 s79,s79,0x1328000
s_add_u32 s28,s28,4608
buffer_load_dwordx4 v[176:179],v1,s[8:11],s28 offen offset:0 sc1
buffer_load_dwordx4 v[180:183],v1,s[8:11],s28 offen offset:1024 sc1
buffer_load_dwordx4 v[184:187],v1,s[8:11],s28 offen offset:2048 sc1
buffer_load_dwordx4 v[188:191],v1,s[8:11],s28 offen offset:3072 sc1
buffer_load_dwordx4 v[192:195],v2,s[8:11],s28 offen sc1
v_mov_b32 v13,1
v_mov_b32 v12,0
s_waitcnt vmcnt(5)
s_mov_b32 exec_lo,0x1
s_mov_b32 exec_hi,0x0
buffer_atomic_or v13,v12,s[8:11],s78 offen sc1
s_mov_b64 exec,-1
v_lshlrev_b32 v198,2,v0
s_cmp_eq_u32 s22,0
s_cselect_b32 s79,s79,0x40000000
v_mov_b32 v199,0
buffer_atomic_or v199,v198,s[8:11],s79 offen sc0 sc1
s_mul_i32 s46,s45,72
v_lshlrev_b32 v4,2,v15
v_add_u32 v4,s46,v4
v_lshrrev_b32 v5,3,v4
v_lshlrev_b32 v5,8,v5
v_lshl_add_u32 v5,v14,4,v5
v_and_b32 v10,4,v4
v_lshl_add_u32 v5,v10,1,v5
v_add_u32 v4,16,v4
v_lshrrev_b32 v6,3,v4
v_lshlrev_b32 v6,8,v6
v_lshl_add_u32 v6,v14,4,v6
v_and_b32 v10,4,v4
v_lshl_add_u32 v6,v10,1,v6
v_add_u32 v4,16,v4
v_lshrrev_b32 v7,3,v4
v_lshlrev_b32 v7,8,v7
v_lshl_add_u32 v7,v14,4,v7
v_and_b32 v10,4,v4
v_lshl_add_u32 v7,v10,1,v7
v_add_u32 v4,16,v4
v_lshrrev_b32 v8,3,v4
v_lshlrev_b32 v8,8,v8
v_lshl_add_u32 v8,v14,4,v8
v_and_b32 v10,4,v4
v_lshl_add_u32 v8,v10,1,v8
v_add_u32 v4,16,v4
v_lshrrev_b32 v9,3,v4
v_lshlrev_b32 v9,8,v9
v_lshl_add_u32 v9,v14,4,v9
v_and_b32 v10,4,v4
v_lshl_add_u32 v9,v10,1,v9
v_cmp_gt_u32 vcc,2,v15
v_mov_b32 v10,0x7ff00000
s_nop 0
v_cndmask_b32 v9,v10,v9,vcc
s_lshl_b32 s50,s44,2
s_add_u32 s50,s50,s22
s_mul_i32 s52,s50,18432
s_add_u32 s54,s52,0x1680000
s_add_u32 s57,s52,0x1900000
buffer_load_dwordx2 v[206:207],v5,s[8:11],s54 offen sc1
buffer_load_dwordx2 v[208:209],v6,s[8:11],s54 offen sc1
buffer_load_dwordx2 v[210:211],v7,s[8:11],s54 offen sc1
buffer_load_dwordx2 v[212:213],v8,s[8:11],s54 offen sc1
buffer_load_dwordx2 v[214:215],v9,s[8:11],s54 offen sc1
s_add_u32 s28,s28,4608
buffer_load_dwordx4 v[32:35],v1,s[8:11],s28 offen offset:0 sc1
buffer_load_dwordx4 v[36:39],v1,s[8:11],s28 offen offset:1024 sc1
buffer_load_dwordx4 v[40:43],v1,s[8:11],s28 offen offset:2048 sc1
buffer_load_dwordx4 v[44:47],v1,s[8:11],s28 offen offset:3072 sc1
buffer_load_dwordx4 v[48:51],v2,s[8:11],s28 offen sc1
s_add_u32 s46,s22,1
s_and_b32 s46,s46,3
s_mul_i32 s46,s46,3
s_add_u32 s46,s46,0
s_mul_i32 s46,s46,5120
s_add_u32 s46,s46,98304
v_add_u32 v241,s46,v1
s_add_u32 s46,s22,2
s_and_b32 s46,s46,3
s_mul_i32 s46,s46,3
s_add_u32 s46,s46,1
s_mul_i32 s46,s46,5120
s_add_u32 s46,s46,98304
v_add_u32 v242,s46,v1
s_add_u32 s46,s22,3
s_and_b32 s46,s46,3
s_mul_i32 s46,s46,3
s_add_u32 s46,s46,2
s_mul_i32 s46,s46,5120
s_add_u32 s46,s46,98304
v_add_u32 v243,s46,v1
s_mul_i32 s46,s22,15360
s_add_u32 s46,s46,98304
v_add_u32 v240,s46,v1
v_mov_b32 v244,0
v_mov_b32 v245,0
v_mov_b32 v246,0
v_mov_b32 v247,0
s_lshl_b32 s46,s50,7
s_lshl_b32 s47,s45,14
s_add_u32 s46,s46,s47
s_add_u32 s29,s46,0x1e40000
v_lshlrev_b32 v248,3,v14
s_waitcnt vmcnt(5)
v_lshlrev_b32 v216,16,v206
v_and_b32 v217,0xffff0000,v206
v_lshlrev_b32 v218,16,v207
v_and_b32 v219,0xffff0000,v207
v_lshlrev_b32 v220,16,v208
v_and_b32 v221,0xffff0000,v208
v_lshlrev_b32 v222,16,v209
v_and_b32 v223,0xffff0000,v209
v_lshlrev_b32 v224,16,v210
v_and_b32 v225,0xffff0000,v210
v_lshlrev_b32 v226,16,v211
v_and_b32 v227,0xffff0000,v211
v_lshlrev_b32 v228,16,v212
v_and_b32 v229,0xffff0000,v212
v_lshlrev_b32 v230,16,v213
v_and_b32 v231,0xffff0000,v213
v_lshlrev_b32 v232,16,v214
v_and_b32 v233,0xffff0000,v214
v_lshlrev_b32 v234,16,v215
v_and_b32 v235,0xffff0000,v215
s_getpc_b64 s[58:59]
PC_mega_kernel_9:
s_mul_i32 s46,s23,4
s_add_u32 s46,s46,s22
s_lshl_b32 s46,s46,10
v_add_u32 v13,s46,v1
v_add_u32 v13,PH_k1_1-PC_mega_kernel_9,v13
v_min_u32 v13,PH_k2_1-PC_mega_kernel_9-16,v13
v_and_b32 v13,-4,v13
global_load_dwordx4 a[252:255],v13,s[58:59]
v_cmp_eq_u32 vcc,0,v199
s_cbranch_vccz DW_mega_kernel_10G
s_mov_b32 s53,0
s_cmp_lg_u32 s22,0
s_cbranch_scc1 DW_mega_kernel_10G
DW_mega_kernel_10:
s_nop 7
s_nop 3
v_mov_b32 v199,0
buffer_atomic_or v199,v198,s[8:11],s79 offen sc0 sc1
s_add_u32 s53,s53,1
s_waitcnt vmcnt(0)
v_cmp_eq_u32 vcc,0,v199
s_cbranch_vccz DW_mega_kernel_10G
s_cmp_lt_u32 s53,100000
s_cbranch_scc1 DW_mega_kernel_10
DW_mega_kernel_10G:
s_nop 7
s_nop 3
s_barrier
buffer_load_dwordx4 v[16:19],v1,s[8:11],s24 offen offset:0 sc1
buffer_load_dwordx4 v[20:23],v1,s[8:11],s25 offen offset:0 sc1
buffer_load_dwordx4 v[24:27],v1,s[8:11],s26 offen offset:0 sc1
buffer_load_dwordx4 v[28:31],v1,s[8:11],s27 offen offset:0 sc1
buffer_load_dwordx4 v[52:55],v1,s[8:11],s24 offen offset:1024 sc1
buffer_load_dwordx4 v[56:59],v1,s[8:11],s25 offen offset:1024 sc1
buffer_load_dwordx4 v[60:63],v1,s[8:11],s26 offen offset:1024 sc1
buffer_load_dwordx4 v[64:67],v1,s[8:11],s27 offen offset:1024 sc1
buffer_load_dwordx4 v[88:91],v1,s[8:11],s24 offen offset:2048 sc1
buffer_load_dwordx4 v[92:95],v1,s[8:11],s25 offen offset:2048 sc1
buffer_load_dwordx4 v[96:99],v1,s[8:11],s26 offen offset:2048 sc1
buffer_load_dwordx4 v[100:103],v1,s[8:11],s27 offen offset:2048 sc1
buffer_load_dwordx4 v[124:127],v1,s[8:11],s24 offen offset:3072 sc1
buffer_load_dwordx4 v[128:131],v1,s[8:11],s25 offen offset:3072 sc1
buffer_load_dwordx4 v[132:135],v1,s[8:11],s26 offen offset:3072 sc1
buffer_load_dwordx4 v[136:139],v1,s[8:11],s27 offen offset:3072 sc1
s_add_u32 s24,s24,4096
s_add_u32 s25,s25,4096
s_add_u32 s26,s26,4096
s_add_u32 s27,s27,4096
buffer_load_dwordx4 v[160:163],v1,s[8:11],s24 offen offset:0 sc1
buffer_load_dwordx4 v[164:167],v1,s[8:11],s25 offen offset:0 sc1
buffer_load_dwordx4 v[168:171],v1,s[8:11],s26 offen offset:0 sc1
buffer_load_dwordx4 v[172:175],v1,s[8:11],s27 offen offset:0 sc1
s_waitcnt vmcnt(19)
MF v[216:219],a[0:3],v[16:19],v[216:219]
s_add_u32 s28,s28,4608
buffer_load_dwordx4 v[68:71],v1,s[8:11],s28 offen offset:0 sc1
MF v[220:223],a[4:7],v[16:19],v[220:223]
MF v[224:227],a[8:11],v[16:19],v[224:227]
buffer_load_dwordx4 v[72:75],v1,s[8:11],s28 offen offset:1024 sc1
MF v[228:231],a[12:15],v[16:19],v[228:231]
MF v[232:235],a[16:19],v[16:19],v[232:235]
buffer_load_dwordx4 v[76:79],v1,s[8:11],s28 offen offset:2048 sc1
s_waitcnt vmcnt(21)
MF a[192:195],a[0:3],v[20:23],0
MF a[196:199],a[4:7],v[20:23],0
buffer_load_dwordx4 v[80:83],v1,s[8:11],s28 offen offset:3072 sc1
MF a[200:203],a[8:11],v[20:23],0
MF a[204:207],a[12:15],v[20:23],0
buffer_load_dwordx4 v[84:87],v2,s[8:11],s28 offen sc1
MF a[208:211],a[16:19],v[20:23],0
s_waitcnt vmcnt(22)
MF a[212:215],a[0:3],v[24:27],0
MF a[216:219],a[4:7],v[24:27],0
MF a[220:223],a[8:11],v[24:27],0
MF a[224:227],a[12:15],v[24:27],0
MF a[228:231],a[16:19],v[24:27],0
s_waitcnt vmcnt(21)
MF a[232:235],a[0:3],v[28:31],0
MF a[236:239],a[4:7],v[28:31],0
MF a[240:243],a[8:11],v[28:31],0
MF a[244:247],a[12:15],v[28:31],0
MF a[248:251],a[16:19],v[28:31],0
s_waitcnt vmcnt(20)
MF v[216:219],a[20:23],v[52:55],v[216:219]
buffer_load_dwordx4 v[16:19],v1,s[8:11],s24 offen offset:1024 sc1
MF v[220:223],a[24:27],v[52:55],v[220:223]
MF v[224:227],a[28:31],v[52:55],v[224:227]
buffer_load_dwordx4 v[20:23],v1,s[8:11],s25 offen offset:1024 sc1
MF v[228:231],a[32:35],v[52:55],v[228:231]
MF v[232:235],a[36:39],v[52:55],v[232:235]
buffer_load_dwordx4 v[24:27],v1,s[8:11],s26 offen offset:1024 sc1
s_waitcnt vmcnt(22)
MF a[192:195],a[20:23],v[56:59],a[192:195]
MF a[196:199],a[24:27],v[56:59],a[196:199]
buffer_load_dwordx4 v[28:31],v1,s[8:11],s27 offen offset:1024 sc1
MF a[200:203],a[28:31],v[56:59],a[200:203]
MF a[204:207],a[32:35],v[56:59],a[204:207]
s_add_u32 s28,s28,4608
buffer_load_dwordx4 v[104:107],v1,s[8:11],s28 offen offset:0 sc1
MF a[208:211],a[36:39],v[56:59],a[208:211]
s_waitcnt vmcnt(23)
MF a[212:215],a[20:23],v[60:63],a[212:215]
buffer_load_dwordx4 v[108:111],v1,s[8:11],s28 offen offset:1024 sc1
MF a[216:219],a[24:27],v[60:63],a[216:219]
MF a[220:223],a[28:31],v[60:63],a[220:223]
buffer_load_dwordx4 v[112:115],v1,s[8:11],s28 offen offset:2048 sc1
MF a[224:227],a[32:35],v[60:63],a[224:227]
MF a[228:231],a[36:39],v[60:63],a[228:231]
buffer_load_dwordx4 v[116:119],v1,s[8:11],s28 offen offset:3072 sc1
s_waitcnt vmcnt(25)
MF a[232:235],a[20:23],v[64:67],a[232:235]
MF a[236:239],a[24:27],v[64:67],a[236:239]
buffer_load_dwordx4 v[120:123],v2,s[8:11],s28 offen sc1
MF a[240:243],a[28:31],v[64:67],a[240:243]
MF a[244:247],a[32:35],v[64:67],a[244:247]
MF a[248:251],a[36:39],v[64:67],a[248:251]
s_waitcnt vmcnt(25)
MF v[216:219],a[40:43],v[88:91],v[216:219]
buffer_load_dwordx4 v[52:55],v1,s[8:11],s24 offen offset:2048 sc1
MF v[220:223],a[44:47],v[88:91],v[220:223]
MF v[224:227],a[48:51],v[88:91],v[224:227]
buffer_load_dwordx4 v[56:59],v1,s[8:11],s25 offen offset:2048 sc1
MF v[228:231],a[52:55],v[88:91],v[228:231]
MF v[232:235],a[56:59],v[88:91],v[232:235]
buffer_load_dwordx4 v[60:63],v1,s[8:11],s26 offen offset:2048 sc1
s_waitcnt vmcnt(27)
MF a[192:195],a[40:43],v[92:95],a[192:195]
MF a[196:199],a[44:47],v[92:95],a[196:199]
buffer_load_dwordx4 v[64:67],v1,s[8:11],s27 offen offset:2048 sc1
MF a[200:203],a[48:51],v[92:95],a[200:203]
MF a[204:207],a[52:55],v[92:95],a[204:207]
s_add_u32 s28,s28,4608
buffer_load_dwordx4 v[140:143],v1,s[8:11],s28 offen offset:0 sc1
MF a[208:211],a[56:59],v[92:95],a[208:211]
s_waitcnt vmcnt(28)
MF a[212:215],a[40:43],v[96:99],a[212:215]
buffer_load_dwordx4 v[144:147],v1,s[8:11],s28 offen offset:1024 sc1
MF a[216:219],a[44:47],v[96:99],a[216:219]
MF a[220:223],a[48:51],v[96:99],a[220:223]
buffer_load_dwordx4 v[148:151],v1,s[8:11],s28 offen offset:2048 sc1
MF a[224:227],a[52:55],v[96:99],a[224:227]
MF a[228:231],a[56:59],v[96:99],a[228:231]
buffer_load_dwordx4 v[152:155],v1,s[8:11],s28 offen offset:3072 sc1
s_waitcnt vmcnt(30)
MF a[232:235],a[40:43],v[100:103],a[232:235]
MF a[236:239],a[44:47],v[100:103],a[236:239]
buffer_load_dwordx4 v[156:159],v2,s[8:11],s28 offen sc1
MF a[240:243],a[48:51],v[100:103],a[240:243]
MF a[244:247],a[52:55],v[100:103],a[244:247]
MF a[248:251],a[56:59],v[100:103],a[248:251]
s_waitcnt vmcnt(30)
MF v[216:219],a[60:63],v[124:127],v[216:219]
buffer_load_dwordx4 v[88:91],v1,s[8:11],s24 offen offset:3072 sc1
MF v[220:223],a[64:67],v[124:127],v[220:223]
MF v[224:227],a[68:71],v[124:127],v[224:227]
buffer_load_dwordx4 v[92:95],v1,s[8:11],s25 offen offset:3072 sc1
MF v[228:231],a[72:75],v[124:127],v[228:231]
MF v[232:235],a[76:79],v[124:127],v[232:235]
buffer_load_dwordx4 v[96:99],v1,s[8:11],s26 offen offset:3072 sc1
s_waitcnt vmcnt(32)
MF a[192:195],a[60:63],v[128:131],a[192:195]
MF a[196:199],a[64:67],v[128:131],a[196:199]
buffer_load_dwordx4 v[100:103],v1,s[8:11],s27 offen offset:3072 sc1
MF a[200:203],a[68:71],v[128:131],a[200:203]
MF a[204:207],a[72:75],v[128:131],a[204:207]
MF a[208:211],a[76:79],v[128:131],a[208:211]
s_waitcnt vmcnt(32)
MF a[212:215],a[60:63],v[132:135],a[212:215]
MF a[216:219],a[64:67],v[132:135],a[216:219]
MF a[220:223],a[68:71],v[132:135],a[220:223]
MF a[224:227],a[72:75],v[132:135],a[224:227]
MF a[228:231],a[76:79],v[132:135],a[228:231]
s_waitcnt vmcnt(31)
MF a[232:235],a[60:63],v[136:139],a[232:235]
MF a[236:239],a[64:67],v[136:139],a[236:239]
MF a[240:243],a[68:71],v[136:139],a[240:243]
MF a[244:247],a[72:75],v[136:139],a[244:247]
MF a[248:251],a[76:79],v[136:139],a[248:251]
s_waitcnt vmcnt(30)
MF v[216:219],a[80:83],v[160:163],v[216:219]
s_add_u32 s24,s24,4096
s_add_u32 s25,s25,4096
s_add_u32 s26,s26,4096
s_add_u32 s27,s27,4096
buffer_load_dwordx4 v[124:127],v1,s[8:11],s24 offen offset:0 sc1
MF v[220:223],a[84:87],v[160:163],v[220:223]
MF v[224:227],a[88:91],v[160:163],v[224:227]
buffer_load_dwordx4 v[128:131],v1,s[8:11],s25 offen offset:0 sc1
MF v[228:231],a[92:95],v[160:163],v[228:231]
MF v[232:235],a[96:99],v[160:163],v[232:235]
buffer_load_dwordx4 v[132:135],v1,s[8:11],s26 offen offset:0 sc1
s_waitcnt vmcnt(32)
MF a[192:195],a[80:83],v[164:167],a[192:195]
MF a[196:199],a[84:87],v[164:167],a[196:199]
buffer_load_dwordx4 v[136:139],v1,s[8:11],s27 offen offset:0 sc1
MF a[200:203],a[88:91],v[164:167],a[200:203]
MF a[204:207],a[92:95],v[164:167],a[204:207]
MF a[208:211],a[96:99],v[164:167],a[208:211]
s_waitcnt vmcnt(32)
MF a[212:215],a[80:83],v[168:171],a[212:215]
MF a[216:219],a[84:87],v[168:171],a[216:219]
MF a[220:223],a[88:91],v[168:171],a[220:223]
MF a[224:227],a[92:95],v[168:171],a[224:227]
MF a[228:231],a[96:99],v[168:171],a[228:231]
s_waitcnt vmcnt(31)
MF a[232:235],a[80:83],v[172:175],a[232:235]
MF a[236:239],a[84:87],v[172:175],a[236:239]
MF a[240:243],a[88:91],v[172:175],a[240:243]
MF a[244:247],a[92:95],v[172:175],a[244:247]
MF a[248:251],a[96:99],v[172:175],a[248:251]
s_waitcnt vmcnt(25)
MF v[216:219],a[100:103],v[16:19],v[216:219]
buffer_load_dwordx4 v[160:163],v1,s[8:11],s24 offen offset:1024 sc1
MF v[220:223],a[104:107],v[16:19],v[220:223]
MF v[224:227],a[108:111],v[16:19],v[224:227]
buffer_load_dwordx4 v[164:167],v1,s[8:11],s25 offen offset:1024 sc1
MF v[228:231],a[112:115],v[16:19],v[228:231]
MF v[232:235],a[116:119],v[16:19],v[232:235]
buffer_load_dwordx4 v[168:171],v1,s[8:11],s26 offen offset:1024 sc1
s_waitcnt vmcnt(27)
MF a[192:195],a[100:103],v[20:23],a[192:195]
MF a[196:199],a[104:107],v[20:23],a[196:199]
buffer_load_dwordx4 v[172:175],v1,s[8:11],s27 offen offset:1024 sc1
MF a[200:203],a[108:111],v[20:23],a[200:203]
MF a[204:207],a[112:115],v[20:23],a[204:207]
MF a[208:211],a[116:119],v[20:23],a[208:211]
s_waitcnt vmcnt(27)
MF a[212:215],a[100:103],v[24:27],a[212:215]
MF a[216:219],a[104:107],v[24:27],a[216:219]
MF a[220:223],a[108:111],v[24:27],a[220:223]
MF a[224:227],a[112:115],v[24:27],a[224:227]
MF a[228:231],a[116:119],v[24:27],a[228:231]
s_waitcnt vmcnt(26)
MF a[232:235],a[100:103],v[28:31],a[232:235]
MF a[236:239],a[104:107],v[28:31],a[236:239]
MF a[240:243],a[108:111],v[28:31],a[240:243]
MF a[244:247],a[112:115],v[28:31],a[244:247]
MF a[248:251],a[116:119],v[28:31],a[248:251]
s_waitcnt vmcnt(20)
MF v[216:219],a[120:123],v[52:55],v[216:219]
buffer_load_dwordx4 v[16:19],v1,s[8:11],s24 offen offset:2048 sc1
MF v[220:223],a[124:127],v[52:55],v[220:223]
MF v[224:227],a[128:131],v[52:55],v[224:227]
buffer_load_dwordx4 v[20:23],v1,s[8:11],s25 offen offset:2048 sc1
MF v[228:231],a[132:135],v[52:55],v[228:231]
MF v[232:235],a[136:139],v[52:55],v[232:235]
buffer_load_dwordx4 v[24:27],v1,s[8:11],s26 offen offset:2048 sc1
s_waitcnt vmcnt(22)
MF a[192:195],a[120:123],v[56:59],a[192:195]
MF a[196:199],a[124:127],v[56:59],a[196:199]
buffer_load_dwordx4 v[28:31],v1,s[8:11],s27 offen offset:2048 sc1
MF a[200:203],a[128:131],v[56:59],a[200:203]
MF a[204:207],a[132:135],v[56:59],a[204:207]
MF a[208:211],a[136:139],v[56:59],a[208:211]
s_waitcnt vmcnt(22)
MF a[212:215],a[120:123],v[60:63],a[212:215]
MF a[216:219],a[124:127],v[60:63],a[216:219]
MF a[220:223],a[128:131],v[60:63],a[220:223]
MF a[224:227],a[132:135],v[60:63],a[224:227]
MF a[228:231],a[136:139],v[60:63],a[228:231]
s_waitcnt vmcnt(21)
MF a[232:235],a[120:123],v[64:67],a[232:235]
MF a[236:239],a[124:127],v[64:67],a[236:239]
MF a[240:243],a[128:131],v[64:67],a[240:243]
MF a[244:247],a[132:135],v[64:67],a[244:247]
MF a[248:251],a[136:139],v[64:67],a[248:251]
s_waitcnt vmcnt(15)
MF v[216:219],a[140:143],v[88:91],v[216:219]
buffer_load_dwordx4 v[52:55],v1,s[8:11],s24 offen offset:3072 sc1
MF v[220:223],a[144:147],v[88:91],v[220:223]
MF v[224:227],a[148:151],v[88:91],v[224:227]
buffer_load_dwordx4 v[56:59],v1,s[8:11],s25 offen offset:3072 sc1
MF v[228:231],a[152:155],v[88:91],v[228:231]
MF v[232:235],a[156:159],v[88:91],v[232:235]
buffer_load_dwordx4 v[60:63],v1,s[8:11],s26 offen offset:3072 sc1
s_waitcnt vmcnt(17)
MF a[192:195],a[140:143],v[92:95],a[192:195]
MF a[196:199],a[144:147],v[92:95],a[196:199]
buffer_load_dwordx4 v[64:67],v1,s[8:11],s27 offen offset:3072 sc1
MF a[200:203],a[148:151],v[92:95],a[200:203]
MF a[204:207],a[152:155],v[92:95],a[204:207]
MF a[208:211],a[156:159],v[92:95],a[208:211]
s_waitcnt vmcnt(17)
MF a[212:215],a[140:143],v[96:99],a[212:215]
MF a[216:219],a[144:147],v[96:99],a[216:219]
MF a[220:223],a[148:151],v[96:99],a[220:223]
MF a[224:227],a[152:155],v[96:99],a[224:227]
MF a[228:231],a[156:159],v[96:99],a[228:231]
s_waitcnt vmcnt(16)
MF a[232:235],a[140:143],v[100:103],a[232:235]
MF a[236:239],a[144:147],v[100:103],a[236:239]
MF a[240:243],a[148:151],v[100:103],a[240:243]
MF a[244:247],a[152:155],v[100:103],a[244:247]
MF a[248:251],a[156:159],v[100:103],a[248:251]
s_waitcnt vmcnt(15)
MF v[216:219],a[160:163],v[124:127],v[216:219]
s_add_u32 s24,s24,4096
s_add_u32 s25,s25,4096
s_add_u32 s26,s26,4096
s_add_u32 s27,s27,4096
buffer_load_dwordx4 v[88:91],v1,s[8:11],s24 offen offset:0 sc1
MF v[220:223],a[164:167],v[124:127],v[220:223]
MF v[224:227],a[168:171],v[124:127],v[224:227]
buffer_load_dwordx4 v[92:95],v1,s[8:11],s25 offen offset:0 sc1
MF v[228:231],a[172:175],v[124:127],v[228:231]
MF v[232:235],a[176:179],v[124:127],v[232:235]
buffer_load_dwordx4 v[96:99],v1,s[8:11],s26 offen offset:0 sc1
s_waitcnt vmcnt(17)
MF a[192:195],a[160:163],v[128:131],a[192:195]
MF a[196:199],a[164:167],v[128:131],a[196:199]
buffer_load_dwordx4 v[100:103],v1,s[8:11],s27 offen offset:0 sc1
MF a[200:203],a[168:171],v[128:131],a[200:203]
MF a[204:207],a[172:175],v[128:131],a[204:207]
MF a[208:211],a[176:179],v[128:131],a[208:211]
s_waitcnt vmcnt(17)
MF a[212:215],a[160:163],v[132:135],a[212:215]
MF a[216:219],a[164:167],v[132:135],a[216:219]
MF a[220:223],a[168:171],v[132:135],a[220:223]
MF a[224:227],a[172:175],v[132:135],a[224:227]
MF a[228:231],a[176:179],v[132:135],a[228:231]
s_waitcnt vmcnt(16)
MF a[232:235],a[160:163],v[136:139],a[232:235]
MF a[236:239],a[164:167],v[136:139],a[236:239]
MF a[240:243],a[168:171],v[136:139],a[240:243]
MF a[244:247],a[172:175],v[136:139],a[244:247]
MF a[248:251],a[176:179],v[136:139],a[248:251]
s_waitcnt vmcnt(15)
MF v[216:219],v[176:179],v[160:163],v[216:219]
buffer_load_dwordx4 v[124:127],v1,s[8:11],s24 offen offset:1024 sc1
MF v[220:223],v[180:183],v[160:163],v[220:223]
MF v[224:227],v[184:187],v[160:163],v[224:227]
buffer_load_dwordx4 v[128:131],v1,s[8:11],s25 offen offset:1024 sc1
MF v[228:231],v[188:191],v[160:163],v[228:231]
MF v[232:235],v[192:195],v[160:163],v[232:235]
buffer_load_dwordx4 v[132:135],v1,s[8:11],s26 offen offset:1024 sc1
s_waitcnt vmcnt(17)
MF a[192:195],v[176:179],v[164:167],a[192:195]
MF a[196:199],v[180:183],v[164:167],a[196:199]
buffer_load_dwordx4 v[136:139],v1,s[8:11],s27 offen offset:1024 sc1
MF a[200:203],v[184:187],v[164:167],a[200:203]
MF a[204:207],v[188:191],v[164:167],a[204:207]
MF a[208:211],v[192:195],v[164:167],a[208:211]
s_waitcnt vmcnt(17)
MF a[212:215],v[176:179],v[168:171],a[212:215]
MF a[216:219],v[180:183],v[168:171],a[216:219]
MF a[220:223],v[184:187],v[168:171],a[220:223]
MF a[224:227],v[188:191],v[168:171],a[224:227]
MF a[228:231],v[192:195],v[168:171],a[228:231]
s_waitcnt vmcnt(16)
MF a[232:235],v[176:179],v[172:175],a[232:235]
MF a[236:239],v[180:183],v[172:175],a[236:239]
MF a[240:243],v[184:187],v[172:175],a[240:243]
MF a[244:247],v[188:191],v[172:175],a[244:247]
MF a[248:251],v[192:195],v[172:175],a[248:251]
s_waitcnt vmcnt(15)
MF v[216:219],v[32:35],v[16:19],v[216:219]
buffer_load_dwordx4 v[160:163],v1,s[8:11],s24 offen offset:2048 sc1
MF v[220:223],v[36:39],v[16:19],v[220:223]
MF v[224:227],v[40:43],v[16:19],v[224:227]
buffer_load_dwordx4 v[164:167],v1,s[8:11],s25 offen offset:2048 sc1
MF v[228:231],v[44:47],v[16:19],v[228:231]
MF v[232:235],v[48:51],v[16:19],v[232:235]
buffer_load_dwordx4 v[168:171],v1,s[8:11],s26 offen offset:2048 sc1
s_waitcnt vmcnt(17)
MF a[192:195],v[32:35],v[20:23],a[192:195]
MF a[196:199],v[36:39],v[20:23],a[196:199]
buffer_load_dwordx4 v[172:175],v1,s[8:11],s27 offen offset:2048 sc1
MF a[200:203],v[40:43],v[20:23],a[200:203]
MF a[204:207],v[44:47],v[20:23],a[204:207]
s_add_u32 s28,s28,4608
buffer_load_dwordx4 v[176:179],v1,s[8:11],s28 offen offset:0 sc1
MF a[208:211],v[48:51],v[20:23],a[208:211]
s_waitcnt vmcnt(18)
MF a[212:215],v[32:35],v[24:27],a[212:215]
buffer_load_dwordx4 v[180:183],v1,s[8:11],s28 offen offset:1024 sc1
MF a[216:219],v[36:39],v[24:27],a[216:219]
MF a[220:223],v[40:43],v[24:27],a[220:223]
buffer_load_dwordx4 v[184:187],v1,s[8:11],s28 offen offset:2048 sc1
MF a[224:227],v[44:47],v[24:27],a[224:227]
MF a[228:231],v[48:51],v[24:27],a[228:231]
buffer_load_dwordx4 v[188:191],v1,s[8:11],s28 offen offset:3072 sc1
s_waitcnt vmcnt(20)
MF a[232:235],v[32:35],v[28:31],a[232:235]
MF a[236:239],v[36:39],v[28:31],a[236:239]
buffer_load_dwordx4 v[192:195],v2,s[8:11],s28 offen sc1
MF a[240:243],v[40:43],v[28:31],a[240:243]
MF a[244:247],v[44:47],v[28:31],a[244:247]
MF a[248:251],v[48:51],v[28:31],a[248:251]
s_waitcnt vmcnt(20)
MF v[216:219],v[68:71],v[52:55],v[216:219]
buffer_load_dwordx4 v[16:19],v1,s[8:11],s24 offen offset:3072 sc1
MF v[220:223],v[72:75],v[52:55],v[220:223]
MF v[224:227],v[76:79],v[52:55],v[224:227]
buffer_load_dwordx4 v[20:23],v1,s[8:11],s25 offen offset:3072 sc1
MF v[228:231],v[80:83],v[52:55],v[228:231]
MF v[232:235],v[84:87],v[52:55],v[232:235]
buffer_load_dwordx4 v[24:27],v1,s[8:11],s26 offen offset:3072 sc1
s_waitcnt vmcnt(22)
MF a[192:195],v[68:71],v[56:59],a[192:195]
MF a[196:199],v[72:75],v[56:59],a[196:199]
buffer_load_dwordx4 v[28:31],v1,s[8:11],s27 offen offset:3072 sc1
MF a[200:203],v[76:79],v[56:59],a[200:203]
MF a[204:207],v[80:83],v[56:59],a[204:207]
s_add_u32 s28,s28,4608
buffer_load_dwordx4 v[32:35],v1,s[8:11],s28 offen offset:0 sc1
MF a[208:211],v[84:87],v[56:59],a[208:211]
s_waitcnt vmcnt(23)
MF a[212:215],v[68:71],v[60:63],a[212:215]
buffer_load_dwordx4 v[36:39],v1,s[8:11],s28 offen offset:1024 sc1
MF a[216:219],v[72:75],v[60:63],a[216:219]
MF a[220:223],v[76:79],v[60:63],a[220:223]
buffer_load_dwordx4 v[40:43],v1,s[8:11],s28 offen offset:2048 sc1
MF a[224:227],v[80:83],v[60:63],a[224:227]
MF a[228:231],v[84:87],v[60:63],a[228:231]
buffer_load_dwordx4 v[44:47],v1,s[8:11],s28 offen offset:3072 sc1
s_waitcnt vmcnt(25)
MF a[232:235],v[68:71],v[64:67],a[232:235]
MF a[236:239],v[72:75],v[64:67],a[236:239]
buffer_load_dwordx4 v[48:51],v2,s[8:11],s28 offen sc1
MF a[240:243],v[76:79],v[64:67],a[240:243]
MF a[244:247],v[80:83],v[64:67],a[244:247]
MF a[248:251],v[84:87],v[64:67],a[248:251]
s_waitcnt vmcnt(25)
MF v[216:219],v[104:107],v[88:91],v[216:219]
s_add_u32 s24,s24,4096
s_add_u32 s25,s25,4096
s_add_u32 s26,s26,4096
s_add_u32 s27,s27,4096
buffer_load_dwordx4 v[52:55],v1,s[8:11],s24 offen offset:0 sc1
MF v[220:223],v[108:111],v[88:91],v[220:223]
MF v[224:227],v[112:115],v[88:91],v[224:227]
buffer_load_dwordx4 v[56:59],v1,s[8:11],s25 offen offset:0 sc1
MF v[228:231],v[116:119],v[88:91],v[228:231]
MF v[232:235],v[120:123],v[88:91],v[232:235]
buffer_load_dwordx4 v[60:63],v1,s[8:11],s26 offen offset:0 sc1
s_waitcnt vmcnt(27)
MF a[192:195],v[104:107],v[92:95],a[192:195]
MF a[196:199],v[108:111],v[92:95],a[196:199]
buffer_load_dwordx4 v[64:67],v1,s[8:11],s27 offen offset:0 sc1
MF a[200:203],v[112:115],v[92:95],a[200:203]
MF a[204:207],v[116:119],v[92:95],a[204:207]
s_add_u32 s28,s28,4608
buffer_load_dwordx4 v[68:71],v1,s[8:11],s28 offen offset:0 sc1
MF a[208:211],v[120:123],v[92:95],a[208:211]
s_waitcnt vmcnt(28)
MF a[212:215],v[104:107],v[96:99],a[212:215]
buffer_load_dwordx4 v[72:75],v1,s[8:11],s28 offen offset:1024 sc1
MF a[216:219],v[108:111],v[96:99],a[216:219]
MF a[220:223],v[112:115],v[96:99],a[220:223]
buffer_load_dwordx4 v[76:79],v1,s[8:11],s28 offen offset:2048 sc1
MF a[224:227],v[116:119],v[96:99],a[224:227]
MF a[228:231],v[120:123],v[96:99],a[228:231]
buffer_load_dwordx4 v[80:83],v1,s[8:11],s28 offen offset:3072 sc1
s_waitcnt vmcnt(30)
MF a[232:235],v[104:107],v[100:103],a[232:235]
MF a[236:239],v[108:111],v[100:103],a[236:239]
buffer_load_dwordx4 v[84:87],v2,s[8:11],s28 offen sc1
MF a[240:243],v[112:115],v[100:103],a[240:243]
MF a[244:247],v[116:119],v[100:103],a[244:247]
MF a[248:251],v[120:123],v[100:103],a[248:251]
s_waitcnt vmcnt(30)
MF v[216:219],v[140:143],v[124:127],v[216:219]
buffer_load_dwordx4 v[88:91],v1,s[8:11],s24 offen offset:1024 sc1
MF v[220:223],v[144:147],v[124:127],v[220:223]
MF v[224:227],v[148:151],v[124:127],v[224:227]
buffer_load_dwordx4 v[92:95],v1,s[8:11],s25 offen offset:1024 sc1
MF v[228:231],v[152:155],v[124:127],v[228:231]
MF v[232:235],v[156:159],v[124:127],v[232:235]
buffer_load_dwordx4 v[96:99],v1,s[8:11],s26 offen offset:1024 sc1
s_waitcnt vmcnt(32)
MF a[192:195],v[140:143],v[128:131],a[192:195]
MF a[196:199],v[144:147],v[128:131],a[196:199]
buffer_load_dwordx4 v[100:103],v1,s[8:11],s27 offen offset:1024 sc1
MF a[200:203],v[148:151],v[128:131],a[200:203]
MF a[204:207],v[152:155],v[128:131],a[204:207]
s_add_u32 s28,s28,4608
buffer_load_dwordx4 v[104:107],v1,s[8:11],s28 offen offset:0 sc1
MF a[208:211],v[156:159],v[128:131],a[208:211]
s_waitcnt vmcnt(33)
MF a[212:215],v[140:143],v[132:135],a[212:215]
buffer_load_dwordx4 v[108:111],v1,s[8:11],s28 offen offset:1024 sc1
MF a[216:219],v[144:147],v[132:135],a[216:219]
MF a[220:223],v[148:151],v[132:135],a[220:223]
buffer_load_dwordx4 v[112:115],v1,s[8:11],s28 offen offset:2048 sc1
MF a[224:227],v[152:155],v[132:135],a[224:227]
MF a[228:231],v[156:159],v[132:135],a[228:231]
buffer_load_dwordx4 v[116:119],v1,s[8:11],s28 offen offset:3072 sc1
s_waitcnt vmcnt(35)
MF a[232:235],v[140:143],v[136:139],a[232:235]
MF a[236:239],v[144:147],v[136:139],a[236:239]
buffer_load_dwordx4 v[120:123],v2,s[8:11],s28 offen sc1
MF a[240:243],v[148:151],v[136:139],a[240:243]
MF a[244:247],v[152:155],v[136:139],a[244:247]
MF a[248:251],v[156:159],v[136:139],a[248:251]
s_waitcnt vmcnt(35)
s_waitcnt vmcnt(31)
MF v[216:219],v[176:179],v[160:163],v[216:219]
s_lshl_b32 s49,s22,10
s_lshr_b32 s48,s3,1
s_lshl_b32 s48,s48,2
s_lshr_b32 s20,s23,3
s_add_u32 s48,s48,s20
s_mul_i32 s48,s48,165888
s_add_u32 s48,s48,0x0
s_add_u32 s48,s48,s49
v_add_u32 v253,4096,v1
v_add_u32 v254,8192,v1
v_add_u32 v255,12288,v1
s_add_u32 m0,s49,0
s_add_u32 s20,s48,0
buffer_load_dwordx4 v1,s[8:11],s20 offen sc1 lds
s_waitcnt vmcnt(31)
MF v[220:223],v[180:183],v[160:163],v[220:223]
s_waitcnt vmcnt(30)
MF v[224:227],v[184:187],v[160:163],v[224:227]
s_add_u32 m0,s49,4096
s_nop 0
buffer_load_dwordx4 v253,s[8:11],s20 offen sc1 lds
s_waitcnt vmcnt(30)
MF v[228:231],v[188:191],v[160:163],v[228:231]
s_waitcnt vmcnt(29)
MF v[232:235],v[192:195],v[160:163],v[232:235]
s_add_u32 m0,s49,8192
s_nop 0
buffer_load_dwordx4 v254,s[8:11],s20 offen sc1 lds
MF a[192:195],v[176:179],v[164:167],a[192:195]
MF a[196:199],v[180:183],v[164:167],a[196:199]
s_add_u32 m0,s49,12288
s_nop 0
buffer_load_dwordx4 v255,s[8:11],s20 offen sc1 lds
MF a[200:203],v[184:187],v[164:167],a[200:203]
MF a[204:207],v[188:191],v[164:167],a[204:207]
s_add_u32 m0,s49,16384
s_add_u32 s20,s48,16384
buffer_load_dwordx4 v1,s[8:11],s20 offen sc1 lds
MF a[208:211],v[192:195],v[164:167],a[208:211]
MF a[212:215],v[176:179],v[168:171],a[212:215]
s_add_u32 m0,s49,20480
s_nop 0
buffer_load_dwordx4 v253,s[8:11],s20 offen sc1 lds
MF a[216:219],v[180:183],v[168:171],a[216:219]
MF a[220:223],v[184:187],v[168:171],a[220:223]
s_add_u32 m0,s49,24576
s_nop 0
buffer_load_dwordx4 v254,s[8:11],s20 offen sc1 lds
MF a[224:227],v[188:191],v[168:171],a[224:227]
MF a[228:231],v[192:195],v[168:171],a[228:231]
s_add_u32 m0,s49,28672
s_nop 0
buffer_load_dwordx4 v255,s[8:11],s20 offen sc1 lds
MF a[232:235],v[176:179],v[172:175],a[232:235]
MF a[236:239],v[180:183],v[172:175],a[236:239]
MF a[240:243],v[184:187],v[172:175],a[240:243]
MF a[244:247],v[188:191],v[172:175],a[244:247]
MF a[248:251],v[192:195],v[172:175],a[248:251]
s_waitcnt vmcnt(34)
s_waitcnt vmcnt(30)
MF v[216:219],v[32:35],v[16:19],v[216:219]
s_add_u32 m0,s49,32768
s_add_u32 s20,s48,32768
buffer_load_dwordx4 v1,s[8:11],s20 offen sc1 lds
s_waitcnt vmcnt(30)
MF v[220:223],v[36:39],v[16:19],v[220:223]
s_waitcnt vmcnt(29)
MF v[224:227],v[40:43],v[16:19],v[224:227]
s_add_u32 m0,s49,36864
s_nop 0
buffer_load_dwordx4 v253,s[8:11],s20 offen sc1 lds
s_waitcnt vmcnt(29)
MF v[228:231],v[44:47],v[16:19],v[228:231]
s_waitcnt vmcnt(28)
MF v[232:235],v[48:51],v[16:19],v[232:235]
s_add_u32 m0,s49,40960
s_nop 0
buffer_load_dwordx4 v254,s[8:11],s20 offen sc1 lds
MF a[192:195],v[32:35],v[20:23],a[192:195]
MF a[196:199],v[36:39],v[20:23],a[196:199]
s_add_u32 m0,s49,45056
s_nop 0
buffer_load_dwordx4 v255,s[8:11],s20 offen sc1 lds
MF a[200:203],v[40:43],v[20:23],a[200:203]
MF a[204:207],v[44:47],v[20:23],a[204:207]
s_add_u32 m0,s49,49152
s_add_u32 s20,s48,49152
buffer_load_dwordx4 v1,s[8:11],s20 offen sc1 lds
MF a[208:211],v[48:51],v[20:23],a[208:211]
MF a[212:215],v[32:35],v[24:27],a[212:215]
s_add_u32 m0,s49,53248
s_nop 0
buffer_load_dwordx4 v253,s[8:11],s20 offen sc1 lds
MF a[216:219],v[36:39],v[24:27],a[216:219]
MF a[220:223],v[40:43],v[24:27],a[220:223]
s_add_u32 m0,s49,57344
s_nop 0
buffer_load_dwordx4 v254,s[8:11],s20 offen sc1 lds
MF a[224:227],v[44:47],v[24:27],a[224:227]
MF a[228:231],v[48:51],v[24:27],a[228:231]
s_add_u32 m0,s49,61440
s_nop 0
buffer_load_dwordx4 v255,s[8:11],s20 offen sc1 lds
MF a[232:235],v[32:35],v[28:31],a[232:235]
MF a[236:239],v[36:39],v[28:31],a[236:239]
MF a[240:243],v[40:43],v[28:31],a[240:243]
MF a[244:247],v[44:47],v[28:31],a[244:247]
MF a[248:251],v[48:51],v[28:31],a[248:251]
s_waitcnt vmcnt(33)
s_waitcnt vmcnt(29)
MF v[216:219],v[68:71],v[52:55],v[216:219]
s_add_u32 m0,s49,65536
s_add_u32 s20,s48,65536
buffer_load_dwordx4 v1,s[8:11],s20 offen sc1 lds
s_waitcnt vmcnt(29)
MF v[220:223],v[72:75],v[52:55],v[220:223]
s_waitcnt vmcnt(28)
MF v[224:227],v[76:79],v[52:55],v[224:227]
s_add_u32 m0,s49,69632
s_nop 0
buffer_load_dwordx4 v253,s[8:11],s20 offen sc1 lds
s_waitcnt vmcnt(28)
MF v[228:231],v[80:83],v[52:55],v[228:231]
s_waitcnt vmcnt(27)
MF v[232:235],v[84:87],v[52:55],v[232:235]
s_add_u32 m0,s49,73728
s_nop 0
buffer_load_dwordx4 v254,s[8:11],s20 offen sc1 lds
MF a[192:195],v[68:71],v[56:59],a[192:195]
MF a[196:199],v[72:75],v[56:59],a[196:199]
s_add_u32 m0,s49,77824
s_nop 0
buffer_load_dwordx4 v255,s[8:11],s20 offen sc1 lds
MF a[200:203],v[76:79],v[56:59],a[200:203]
MF a[204:207],v[80:83],v[56:59],a[204:207]
s_add_u32 m0,s49,81920
s_add_u32 s20,s48,81920
buffer_load_dwordx4 v1,s[8:11],s20 offen sc1 lds
MF a[208:211],v[84:87],v[56:59],a[208:211]
MF a[212:215],v[68:71],v[60:63],a[212:215]
s_add_u32 m0,s49,86016
s_nop 0
buffer_load_dwordx4 v253,s[8:11],s20 offen sc1 lds
MF a[216:219],v[72:75],v[60:63],a[216:219]
MF a[220:223],v[76:79],v[60:63],a[220:223]
s_add_u32 m0,s49,90112
s_nop 0
buffer_load_dwordx4 v254,s[8:11],s20 offen sc1 lds
MF a[224:227],v[80:83],v[60:63],a[224:227]
MF a[228:231],v[84:87],v[60:63],a[228:231]
s_add_u32 m0,s49,94208
s_nop 0
buffer_load_dwordx4 v255,s[8:11],s20 offen sc1 lds
MF a[232:235],v[68:71],v[64:67],a[232:235]
MF a[236:239],v[72:75],v[64:67],a[236:239]
MF a[240:243],v[76:79],v[64:67],a[240:243]
MF a[244:247],v[80:83],v[64:67],a[244:247]
MF a[248:251],v[84:87],v[64:67],a[248:251]
s_waitcnt vmcnt(31)
s_waitcnt vmcnt(28)
MF a[192:195],v[104:107],v[92:95],a[192:195]
s_waitcnt vmcnt(27)
MF a[196:199],v[108:111],v[92:95],a[196:199]
s_waitcnt vmcnt(26)
MF a[200:203],v[112:115],v[92:95],a[200:203]
s_waitcnt vmcnt(25)
MF a[204:207],v[116:119],v[92:95],a[204:207]
s_waitcnt vmcnt(24)
MF a[208:211],v[120:123],v[92:95],a[208:211]
MF a[212:215],v[104:107],v[96:99],a[212:215]
MF a[216:219],v[108:111],v[96:99],a[216:219]
MF a[220:223],v[112:115],v[96:99],a[220:223]
ds_write_b128 v241,a[192:195] offset:0
MF a[224:227],v[116:119],v[96:99],a[224:227]
ds_write_b128 v241,a[196:199] offset:1024
MF a[228:231],v[120:123],v[96:99],a[228:231]
ds_write_b128 v241,a[200:203] offset:2048
MF a[232:235],v[104:107],v[100:103],a[232:235]
ds_write_b128 v241,a[204:207] offset:3072
MF a[236:239],v[108:111],v[100:103],a[236:239]
ds_write_b128 v241,a[208:211] offset:4096
MF a[240:243],v[112:115],v[100:103],a[240:243]
ds_write_b128 v242,a[212:215] offset:0
MF a[244:247],v[116:119],v[100:103],a[244:247]
ds_write_b128 v242,a[216:219] offset:1024
MF a[248:251],v[120:123],v[100:103],a[248:251]
ds_write_b128 v242,a[220:223] offset:2048
MF v[216:219],v[104:107],v[88:91],v[216:219]
ds_write_b128 v242,a[224:227] offset:3072
MF v[220:223],v[108:111],v[88:91],v[220:223]
ds_write_b128 v242,a[228:231] offset:4096
MF v[224:227],v[112:115],v[88:91],v[224:227]
ds_write_b128 v243,a[232:235] offset:0
MF v[228:231],v[116:119],v[88:91],v[228:231]
ds_write_b128 v243,a[236:239] offset:1024
MF v[232:235],v[120:123],v[88:91],v[232:235]
ds_write_b128 v243,a[240:243] offset:2048
ds_write_b128 v243,a[244:247] offset:3072
ds_write_b128 v243,a[248:251] offset:4096
s_waitcnt lgkmcnt(0)
s_barrier
ds_read_b128 v[16:19],v240 offset:0
ds_read_b128 v[20:23],v240 offset:5120
ds_read_b128 v[24:27],v240 offset:10240
ds_read_b128 v[28:31],v240 offset:1024
ds_read_b128 v[32:35],v240 offset:6144
ds_read_b128 v[36:39],v240 offset:11264
ds_read_b128 v[40:43],v240 offset:2048
ds_read_b128 v[44:47],v240 offset:7168
ds_read_b128 v[48:51],v240 offset:12288
ds_read_b128 v[52:55],v240 offset:3072
ds_read_b128 v[56:59],v240 offset:8192
ds_read_b128 v[60:63],v240 offset:13312
ds_read_b128 v[64:67],v240 offset:4096
ds_read_b128 v[68:71],v240 offset:9216
ds_read_b128 v[72:75],v240 offset:14336
s_waitcnt lgkmcnt(12)
v_pk_add_f32 v[16:17],v[16:17],v[20:21]
v_pk_add_f32 v[216:217],v[216:217],v[24:25]
v_pk_add_f32 v[18:19],v[18:19],v[22:23]
v_pk_add_f32 v[218:219],v[218:219],v[26:27]
v_pk_add_f32 v[216:217],v[216:217],v[16:17]
v_pk_add_f32 v[218:219],v[218:219],v[18:19]
v_cvt_pk_bf16_f32 v16,v216,v217
v_cvt_pk_bf16_f32 v17,v218,v219
buffer_store_dwordx2 v[16:17],v5,s[8:11],s57 offen sc1
v_pk_add_f32 v[244:245],v[244:245],v[216:217]
v_pk_fma_f32 v[246:247],v[216:217],v[216:217],v[246:247]
v_pk_add_f32 v[244:245],v[244:245],v[218:219]
v_pk_fma_f32 v[246:247],v[218:219],v[218:219],v[246:247]
s_waitcnt lgkmcnt(9)
v_pk_add_f32 v[28:29],v[28:29],v[32:33]
v_pk_add_f32 v[220:221],v[220:221],v[36:37]
v_pk_add_f32 v[30:31],v[30:31],v[34:35]
v_pk_add_f32 v[222:223],v[222:223],v[38:39]
v_pk_add_f32 v[220:221],v[220:221],v[28:29]
v_pk_add_f32 v[222:223],v[222:223],v[30:31]
v_cvt_pk_bf16_f32 v28,v220,v221
v_cvt_pk_bf16_f32 v29,v222,v223
buffer_store_dwordx2 v[28:29],v6,s[8:11],s57 offen sc1
v_pk_add_f32 v[244:245],v[244:245],v[220:221]
v_pk_fma_f32 v[246:247],v[220:221],v[220:221],v[246:247]
v_pk_add_f32 v[244:245],v[244:245],v[222:223]
v_pk_fma_f32 v[246:247],v[222:223],v[222:223],v[246:247]
s_waitcnt lgkmcnt(6)
v_pk_add_f32 v[40:41],v[40:41],v[44:45]
v_pk_add_f32 v[224:225],v[224:225],v[48:49]
v_pk_add_f32 v[42:43],v[42:43],v[46:47]
v_pk_add_f32 v[226:227],v[226:227],v[50:51]
v_pk_add_f32 v[224:225],v[224:225],v[40:41]
v_pk_add_f32 v[226:227],v[226:227],v[42:43]
v_cvt_pk_bf16_f32 v40,v224,v225
v_cvt_pk_bf16_f32 v41,v226,v227
buffer_store_dwordx2 v[40:41],v7,s[8:11],s57 offen sc1
v_pk_add_f32 v[244:245],v[244:245],v[224:225]
v_pk_fma_f32 v[246:247],v[224:225],v[224:225],v[246:247]
v_pk_add_f32 v[244:245],v[244:245],v[226:227]
v_pk_fma_f32 v[246:247],v[226:227],v[226:227],v[246:247]
s_waitcnt lgkmcnt(3)
v_pk_add_f32 v[52:53],v[52:53],v[56:57]
v_pk_add_f32 v[228:229],v[228:229],v[60:61]
v_pk_add_f32 v[54:55],v[54:55],v[58:59]
v_pk_add_f32 v[230:231],v[230:231],v[62:63]
v_pk_add_f32 v[228:229],v[228:229],v[52:53]
v_pk_add_f32 v[230:231],v[230:231],v[54:55]
v_cvt_pk_bf16_f32 v52,v228,v229
v_cvt_pk_bf16_f32 v53,v230,v231
buffer_store_dwordx2 v[52:53],v8,s[8:11],s57 offen sc1
v_pk_add_f32 v[244:245],v[244:245],v[228:229]
v_pk_fma_f32 v[246:247],v[228:229],v[228:229],v[246:247]
v_pk_add_f32 v[244:245],v[244:245],v[230:231]
v_pk_fma_f32 v[246:247],v[230:231],v[230:231],v[246:247]
s_waitcnt lgkmcnt(0)
s_mov_b32 exec_lo,0xffffffff
s_mov_b32 exec_hi,0x0
v_pk_add_f32 v[64:65],v[64:65],v[68:69]
v_pk_add_f32 v[232:233],v[232:233],v[72:73]
v_pk_add_f32 v[66:67],v[66:67],v[70:71]
v_pk_add_f32 v[234:235],v[234:235],v[74:75]
v_pk_add_f32 v[232:233],v[232:233],v[64:65]
v_pk_add_f32 v[234:235],v[234:235],v[66:67]
v_cvt_pk_bf16_f32 v64,v232,v233
v_cvt_pk_bf16_f32 v65,v234,v235
buffer_store_dwordx2 v[64:65],v9,s[8:11],s57 offen sc1
v_pk_add_f32 v[244:245],v[244:245],v[232:233]
v_pk_fma_f32 v[246:247],v[232:233],v[232:233],v[246:247]
v_pk_add_f32 v[244:245],v[244:245],v[234:235]
v_pk_fma_f32 v[246:247],v[234:235],v[234:235],v[246:247]
s_mov_b64 exec,-1
v_add_f32 v12,v244,v245
v_add_f32 v13,v246,v247
v_mov_b32 v10,v12
v_mov_b32 v11,v13
s_nop 0
v_permlane32_swap_b32 v12,v10
v_permlane32_swap_b32 v13,v11
v_add_f32 v12,v12,v10
v_add_f32 v13,v13,v11
v_mov_b32 v10,v12
v_mov_b32 v11,v13
s_nop 0
v_permlane16_swap_b32 v12,v10
v_permlane16_swap_b32 v13,v11
v_add_f32 v12,v12,v10
v_add_f32 v13,v13,v11
s_mov_b64 exec,0xffff
buffer_store_dwordx2 v[12:13],v248,s[8:11],s29 offen sc1
s_mov_b64 exec,-1
s_barrier
s_mov_b64 exec,-1
s_and_b32 s46,s44,1
s_lshl_b32 s46,s46,3
s_add_u32 s46,s46,s45
s_lshl_b32 s78,s51,11
s_lshl_b32 s47,s46,4
s_add_u32 s78,s78,s47
s_lshl_b32 s47,s22,2
s_add_u32 s78,s78,s47
s_add_u32 s78,s78,0x1330000
s_mov_b64 exec,-1
PH_k1_1:
s_and_b32 s44,s3,1
s_lshl_b32 s44,s44,3
s_and_b32 s45,s23,7
s_add_u32 s44,s44,s45
s_lshr_b32 s45,s3,1
s_lshl_b32 s45,s45,2
s_lshr_b32 s46,s23,3
s_add_u32 s45,s45,s46
v_add_u32 v2,65536,v1
v_add_u32 v3,131072,v1
s_lshl_b32 s46,s44,3
s_lshl_b32 s47,s22,1
s_add_u32 s46,s46,s47
s_mul_i32 s24,s46,18432
s_add_u32 s24,s24,0x1900000
s_add_u32 s27,s24,18432
s_add_u32 s29,s24,16384
s_add_u32 s21,s27,16384
s_lshl_b32 s79,s44,11
s_add_u32 s79,s79,0x1330000
v_mov_b32 v13,1
v_mov_b32 v12,0
s_waitcnt vmcnt(0)
s_mov_b32 exec_lo,0x1
s_mov_b32 exec_hi,0x0
buffer_atomic_or v13,v12,s[8:11],s78 offen sc1
s_mov_b64 exec,-1
v_lshlrev_b32 v198,2,v0
s_cmp_eq_u32 s22,0
s_cselect_b32 s79,s79,0x40000000
v_mov_b32 v199,0
buffer_atomic_or v199,v198,s[8:11],s79 offen sc0 sc1
s_add_u32 m0,s49,98304
s_add_u32 s20,s48,98304
buffer_load_dwordx4 v1,s[8:11],s20 offen sc1 lds
s_add_u32 m0,s49,102400
s_nop 0
buffer_load_dwordx4 v253,s[8:11],s20 offen sc1 lds
s_add_u32 m0,s49,106496
s_nop 0
buffer_load_dwordx4 v254,s[8:11],s20 offen sc1 lds
s_add_u32 m0,s49,110592
s_nop 0
buffer_load_dwordx4 v255,s[8:11],s20 offen sc1 lds
s_add_u32 m0,s49,114688
s_add_u32 s20,s48,114688
buffer_load_dwordx4 v1,s[8:11],s20 offen sc1 lds
s_add_u32 m0,s49,118784
s_nop 0
buffer_load_dwordx4 v253,s[8:11],s20 offen sc1 lds
s_mul_i32 s31,s45,576
s_add_u32 s31,s31,0x290000
s_lshl_b32 s46,s22,8
v_lshlrev_b32 v12,2,v0
v_add_u32 v238,s46,v12
v_min_u32 v238,572,v238
buffer_load_dword v192,v238,s[8:11],s31 offen
s_add_u32 s31,s31,9216
buffer_load_dword v193,v238,s[8:11],s31 offen
s_lshl_b32 s46,s22,8
s_mul_i32 s50,s45,49152
s_add_u32 s50,s50,0x4240000
s_mul_i32 s51,s44,3072
s_add_u32 s51,s51,s50
v_lshlrev_b32 v4,2,v0
v_add_u32 v4,s46,v4
v_lshlrev_b32 v5,2,v4
v_cmp_gt_u32 vcc,684,v4
v_mov_b32 v6,0x7ff00000
s_nop 0
v_cndmask_b32 v237,v6,v5,vcc
v_min_u32 v4,680,v4
s_mov_b32 s41,3641
v_add_u32 v48,0,v4
v_add_u32 v64,1,v4
v_add_u32 v80,2,v4
v_add_u32 v96,3,v4
v_mul_u32_u24 v49,s41,v48
v_mul_u32_u24 v65,s41,v64
v_mul_u32_u24 v81,s41,v80
v_mul_u32_u24 v97,s41,v96
v_lshrrev_b32 v49,16,v49
v_lshrrev_b32 v65,16,v65
v_lshrrev_b32 v81,16,v81
v_lshrrev_b32 v97,16,v97
v_mul_u32_u24 v50,18,v49
v_mul_u32_u24 v66,18,v65
v_mul_u32_u24 v82,18,v81
v_mul_u32_u24 v98,18,v97
v_sub_u32 v50,v48,v50
v_sub_u32 v66,v64,v66
v_sub_u32 v82,v80,v82
v_sub_u32 v98,v96,v98
v_cmp_le_u32 s[32:33],19,v49
v_cmp_le_u32 s[34:35],19,v65
v_cmp_le_u32 s[36:37],19,v81
v_cmp_le_u32 s[38:39],19,v97
v_cndmask_b32 v51,0,1,s[32:33]
v_cndmask_b32 v67,0,1,s[34:35]
v_cndmask_b32 v83,0,1,s[36:37]
v_cndmask_b32 v99,0,1,s[38:39]
v_mul_u32_u24 v52,19,v51
v_mul_u32_u24 v68,19,v67
v_mul_u32_u24 v84,19,v83
v_mul_u32_u24 v100,19,v99
v_sub_u32 v52,v49,v52
v_sub_u32 v68,v65,v68
v_sub_u32 v84,v81,v84
v_sub_u32 v100,v97,v100
v_mad_u32_u24 v53,v51,18,v50
v_mad_u32_u24 v69,v67,18,v66
v_mad_u32_u24 v85,v83,18,v82
v_mad_u32_u24 v101,v99,18,v98
v_mad_u32_u24 v54,v51,18,v52
v_mad_u32_u24 v70,v67,18,v68
v_mad_u32_u24 v86,v83,18,v84
v_mad_u32_u24 v102,v99,18,v100
v_cmp_eq_u32 s[32:33],18,v52
v_cmp_eq_u32 s[34:35],18,v68
v_cmp_eq_u32 s[36:37],18,v84
v_cmp_eq_u32 s[38:39],18,v100
v_lshrrev_b32 v55,4,v53
v_lshrrev_b32 v71,4,v69
v_lshrrev_b32 v87,4,v85
v_lshrrev_b32 v103,4,v101
v_lshrrev_b32 v56,4,v54
v_lshrrev_b32 v72,4,v70
v_lshrrev_b32 v88,4,v86
v_lshrrev_b32 v104,4,v102
v_mad_u32_u24 v56,v55,3,v56
v_mad_u32_u24 v72,v71,3,v72
v_mad_u32_u24 v88,v87,3,v88
v_mad_u32_u24 v104,v103,3,v104
v_add_u32 v55,9,v55
v_add_u32 v71,9,v71
v_add_u32 v87,9,v87
v_add_u32 v103,9,v103
v_cndmask_b32 v55,v56,v55,s[32:33]
v_cndmask_b32 v71,v72,v71,s[34:35]
v_cndmask_b32 v87,v88,v87,s[36:37]
v_cndmask_b32 v103,v104,v103,s[38:39]
v_and_b32 v56,15,v54
v_and_b32 v72,15,v70
v_and_b32 v88,15,v86
v_and_b32 v104,15,v102
v_lshlrev_b32 v55,10,v55
v_lshlrev_b32 v71,10,v71
v_lshlrev_b32 v87,10,v87
v_lshlrev_b32 v103,10,v103
v_lshl_add_u32 v55,v56,4,v55
v_lshl_add_u32 v71,v72,4,v71
v_lshl_add_u32 v87,v88,4,v87
v_lshl_add_u32 v103,v104,4,v103
v_bfe_u32 v49,v53,2,2
v_bfe_u32 v65,v69,2,2
v_bfe_u32 v81,v85,2,2
v_bfe_u32 v97,v101,2,2
v_lshl_add_u32 v55,v49,8,v55
v_lshl_add_u32 v71,v65,8,v71
v_lshl_add_u32 v87,v81,8,v87
v_lshl_add_u32 v103,v97,8,v103
v_and_b32 v50,3,v53
v_and_b32 v66,3,v69
v_and_b32 v82,3,v85
v_and_b32 v98,3,v101
v_lshl_add_u32 v55,v50,2,v55
v_lshl_add_u32 v71,v66,2,v71
v_lshl_add_u32 v87,v82,2,v87
v_lshl_add_u32 v103,v98,2,v103
v_add_u32 v248,8192,v55
v_add_u32 v249,8192,v71
v_add_u32 v250,8192,v87
v_add_u32 v251,8192,v103
v_bfe_u32 v52,v53,4,1
v_bfe_u32 v68,v69,4,1
v_bfe_u32 v84,v85,4,1
v_bfe_u32 v100,v101,4,1
v_lshl_add_u32 v50,v52,2,v50
v_lshl_add_u32 v66,v68,2,v66
v_lshl_add_u32 v82,v84,2,v82
v_lshl_add_u32 v98,v100,2,v98
v_lshlrev_b32 v50,1,v50
v_lshlrev_b32 v66,1,v66
v_lshlrev_b32 v82,1,v82
v_lshlrev_b32 v98,1,v98
v_lshrrev_b32 v52,5,v53
v_lshrrev_b32 v68,5,v69
v_lshrrev_b32 v84,5,v85
v_lshrrev_b32 v100,5,v101
v_lshrrev_b32 v54,4,v54
v_lshrrev_b32 v70,4,v70
v_lshrrev_b32 v86,4,v86
v_lshrrev_b32 v102,4,v102
v_lshl_add_u32 v54,v54,1,v52
v_lshl_add_u32 v70,v70,1,v68
v_lshl_add_u32 v86,v86,1,v84
v_lshl_add_u32 v102,v102,1,v100
v_lshlrev_b32 v54,10,v54
v_lshlrev_b32 v70,10,v70
v_lshlrev_b32 v86,10,v86
v_lshlrev_b32 v102,10,v102
v_lshl_add_u32 v54,v49,8,v54
v_lshl_add_u32 v70,v65,8,v70
v_lshl_add_u32 v86,v81,8,v86
v_lshl_add_u32 v102,v97,8,v102
v_lshl_add_u32 v54,v56,4,v54
v_lshl_add_u32 v70,v72,4,v70
v_lshl_add_u32 v86,v88,4,v86
v_lshl_add_u32 v102,v104,4,v102
v_lshl_add_u32 v51,v51,1,v52
v_lshl_add_u32 v67,v67,1,v68
v_lshl_add_u32 v83,v83,1,v84
v_lshl_add_u32 v99,v99,1,v100
v_lshlrev_b32 v51,6,v51
v_lshlrev_b32 v67,6,v67
v_lshlrev_b32 v83,6,v83
v_lshlrev_b32 v99,6,v99
v_lshl_add_u32 v51,v49,4,v51
v_lshl_add_u32 v67,v65,4,v67
v_lshl_add_u32 v83,v81,4,v83
v_lshl_add_u32 v99,v97,4,v99
v_add_u32 v51,6144,v51
v_add_u32 v67,6144,v67
v_add_u32 v83,6144,v83
v_add_u32 v99,6144,v99
v_cndmask_b32 v54,v54,v51,s[32:33]
v_cndmask_b32 v70,v70,v67,s[34:35]
v_cndmask_b32 v86,v86,v83,s[36:37]
v_cndmask_b32 v102,v102,v99,s[38:39]
v_add_u32 v54,v54,v50
v_add_u32 v70,v70,v66
v_add_u32 v86,v86,v82
v_add_u32 v102,v102,v98
v_mov_b32 v56,7168
v_mov_b32 v72,7168
v_mov_b32 v88,7168
v_mov_b32 v104,7168
v_cndmask_b32 v54,v56,v54,vcc
v_cndmask_b32 v70,v72,v70,vcc
v_cndmask_b32 v86,v88,v86,vcc
v_cndmask_b32 v102,v104,v102,vcc
v_add_u32 v240,57344,v54
v_add_u32 v241,57344,v70
v_add_u32 v242,57344,v86
v_add_u32 v243,57344,v102
s_mul_i32 s46,s45,36
v_lshlrev_b32 v13,2,v15
v_add_u32 v13,s46,v13
v_lshrrev_b32 v244,3,v13
v_lshlrev_b32 v244,8,v244
v_lshl_add_u32 v244,v14,4,v244
v_and_b32 v8,4,v13
v_lshl_add_u32 v244,v8,1,v244
v_add_u32 v13,16,v13
v_lshrrev_b32 v245,3,v13
v_lshlrev_b32 v245,8,v245
v_lshl_add_u32 v245,v14,4,v245
v_and_b32 v8,4,v13
v_lshl_add_u32 v245,v8,1,v245
v_add_u32 v13,16,v13
v_lshrrev_b32 v246,3,v13
v_lshlrev_b32 v246,8,v246
v_lshl_add_u32 v246,v14,4,v246
v_and_b32 v8,4,v13
v_lshl_add_u32 v246,v8,1,v246
v_cmp_eq_u32 vcc,0,v15
v_mov_b32 v8,0x7ff00000
s_nop 0
v_cndmask_b32 v246,v8,v246,vcc
v_mov_b32 v232,0x3f803f80
v_mov_b32 v233,0x3f803f80
v_mov_b32 v234,0x3f803f80
v_mov_b32 v235,0x3f803f80
v_mov_b32 v184,0x3fb8aa3b
v_mov_b32 v185,0x358637bd
s_mul_i32 s46,s22,12288
s_add_u32 s46,s46,8192
v_add_u32 v236,s46,v1
s_lshl_b32 s46,s44,3
s_lshl_b32 s47,s22,1
s_add_u32 s46,s46,s47
s_mul_i32 s46,s46,18432
s_add_u32 s54,s46,0x4000000
s_add_u32 s55,s54,18432
s_getpc_b64 s[58:59]
PC_mega_kernel_11:
s_mul_i32 s46,s23,4
s_add_u32 s46,s46,s22
s_lshl_b32 s46,s46,10
v_add_u32 v13,s46,v1
v_add_u32 v13,PH_k2_1-PC_mega_kernel_11,v13
v_min_u32 v13,PH_k3_1-PC_mega_kernel_11-16,v13
v_and_b32 v13,-4,v13
global_load_dwordx4 a[252:255],v13,s[58:59]
s_waitcnt vmcnt(9)
v_cmp_eq_u32 vcc,0,v199
s_cbranch_vccz DW_mega_kernel_12G
s_mov_b32 s53,0
s_cmp_lg_u32 s22,0
s_cbranch_scc1 DW_mega_kernel_12G
DW_mega_kernel_12:
s_nop 7
s_nop 3
v_mov_b32 v199,0
buffer_atomic_or v199,v198,s[8:11],s79 offen sc0 sc1
s_add_u32 s53,s53,1
s_waitcnt vmcnt(0)
v_cmp_eq_u32 vcc,0,v199
s_cbranch_vccz DW_mega_kernel_12G
s_cmp_lt_u32 s53,100000
s_cbranch_scc1 DW_mega_kernel_12
DW_mega_kernel_12G:
s_nop 7
s_nop 3
s_barrier
v_and_b32 v12,31,v0
v_lshlrev_b32 v12,3,v12
v_lshrrev_b32 v13,5,v0
v_lshl_add_u32 v12,v13,16,v12
s_lshl_b32 s46,s44,10
s_lshl_b32 s47,s22,8
s_add_u32 s46,s46,s47
s_add_u32 s46,s46,0x1e40000
buffer_load_dwordx2 v[4:5],v12,s[8:11],s46 offen sc1
s_add_u32 s46,s46,16384
buffer_load_dwordx2 v[6:7],v12,s[8:11],s46 offen sc1
s_add_u32 s46,s46,16384
buffer_load_dwordx2 v[8:9],v12,s[8:11],s46 offen sc1
s_add_u32 s46,s46,16384
buffer_load_dwordx2 v[10:11],v12,s[8:11],s46 offen sc1
buffer_load_dwordx4 a[0:3],v1,s[8:11],s24 offen offset:0 sc1
buffer_load_dwordx4 a[4:7],v1,s[8:11],s27 offen offset:0 sc1
buffer_load_dwordx4 a[8:11],v1,s[8:11],s24 offen offset:1024 sc1
buffer_load_dwordx4 a[12:15],v1,s[8:11],s27 offen offset:1024 sc1
buffer_load_dwordx4 a[16:19],v1,s[8:11],s24 offen offset:2048 sc1
buffer_load_dwordx4 a[20:23],v1,s[8:11],s27 offen offset:2048 sc1
buffer_load_dwordx4 a[24:27],v1,s[8:11],s24 offen offset:3072 sc1
buffer_load_dwordx4 a[28:31],v1,s[8:11],s27 offen offset:3072 sc1
s_waitcnt lgkmcnt(0)
s_barrier
ds_read_b128 v[16:19],v1 offset:0
ds_read_b128 v[20:23],v1 offset:1024
ds_read_b128 v[24:27],v1 offset:2048
ds_read_b128 v[28:31],v1 offset:3072
ds_read_b128 v[32:35],v1 offset:4096
ds_read_b128 v[36:39],v1 offset:5120
ds_read_b128 v[40:43],v1 offset:6144
s_waitcnt vmcnt(6)
s_waitcnt lgkmcnt(5)
MF v[48:51],a[0:3],v[16:19],0
buffer_load_dwordx4 a[32:35],v253,s[8:11],s24 offen offset:0 sc1
MF v[72:75],a[4:7],v[16:19],0
ds_read_b128 v[44:47],v1 offset:7168
MF v[52:55],a[0:3],v[20:23],0
MF v[76:79],a[4:7],v[20:23],0
ds_read_b128 v[16:19],v1 offset:8192
s_waitcnt lgkmcnt(5)
MF v[56:59],a[0:3],v[24:27],0
buffer_load_dwordx4 a[36:39],v253,s[8:11],s27 offen offset:0 sc1
MF v[80:83],a[4:7],v[24:27],0
ds_read_b128 v[20:23],v1 offset:9216
MF v[60:63],a[0:3],v[28:31],0
MF v[84:87],a[4:7],v[28:31],0
ds_read_b128 v[24:27],v1 offset:10240
s_waitcnt lgkmcnt(5)
MF v[64:67],a[0:3],v[32:35],0
buffer_load_dwordx4 a[40:43],v253,s[8:11],s24 offen offset:1024 sc1
MF v[88:91],a[4:7],v[32:35],0
ds_read_b128 v[28:31],v1 offset:11264
MF v[68:71],a[0:3],v[36:39],0
MF v[92:95],a[4:7],v[36:39],0
s_barrier
ds_read_b128 v[32:35],v1 offset:12288
s_waitcnt vmcnt(7)
s_waitcnt lgkmcnt(5)
MF v[48:51],a[8:11],v[40:43],v[48:51]
buffer_load_dwordx4 a[44:47],v253,s[8:11],s27 offen offset:1024 sc1
MF v[72:75],a[12:15],v[40:43],v[72:75]
ds_read_b128 v[36:39],v1 offset:13312
MF v[52:55],a[8:11],v[44:47],v[52:55]
v_add_f32 v192,v192,v193
v_add_u32 v238,160768,v238
ds_write_b32 v238,v192
MF v[76:79],a[12:15],v[44:47],v[76:79]
ds_read_b128 v[40:43],v1 offset:14336
s_waitcnt lgkmcnt(6)
MF v[56:59],a[8:11],v[16:19],v[56:59]
buffer_load_dwordx4 a[48:51],v253,s[8:11],s24 offen offset:2048 sc1
MF v[80:83],a[12:15],v[16:19],v[80:83]
ds_read_b128 v[44:47],v1 offset:15360
MF v[60:63],a[8:11],v[20:23],v[60:63]
MF v[84:87],a[12:15],v[20:23],v[84:87]
ds_read_b128 v[16:19],v1 offset:16384
s_waitcnt lgkmcnt(6)
MF v[64:67],a[8:11],v[24:27],v[64:67]
buffer_load_dwordx4 a[52:55],v253,s[8:11],s27 offen offset:2048 sc1
MF v[88:91],a[12:15],v[24:27],v[88:91]
ds_read_b128 v[20:23],v1 offset:17408
MF v[68:71],a[8:11],v[28:31],v[68:71]
MF v[92:95],a[12:15],v[28:31],v[92:95]
ds_read_b128 v[24:27],v1 offset:18432
s_waitcnt vmcnt(8)
s_waitcnt lgkmcnt(6)
MF v[48:51],a[16:19],v[32:35],v[48:51]
buffer_load_dwordx4 a[56:59],v253,s[8:11],s24 offen offset:3072 sc1
MF v[72:75],a[20:23],v[32:35],v[72:75]
ds_read_b128 v[28:31],v1 offset:19456
MF v[52:55],a[16:19],v[36:39],v[52:55]
MF v[76:79],a[20:23],v[36:39],v[76:79]
ds_read_b128 v[32:35],v1 offset:20480
s_waitcnt lgkmcnt(5)
MF v[56:59],a[16:19],v[40:43],v[56:59]
buffer_load_dwordx4 a[60:63],v253,s[8:11],s27 offen offset:3072 sc1
MF v[80:83],a[20:23],v[40:43],v[80:83]
ds_read_b128 v[36:39],v1 offset:21504
MF v[60:63],a[16:19],v[44:47],v[60:63]
MF v[84:87],a[20:23],v[44:47],v[84:87]
ds_read_b128 v[40:43],v1 offset:22528
s_waitcnt lgkmcnt(5)
MF v[64:67],a[16:19],v[16:19],v[64:67]
buffer_load_dwordx4 a[64:67],v254,s[8:11],s24 offen offset:0 sc1
MF v[88:91],a[20:23],v[16:19],v[88:91]
ds_read_b128 v[44:47],v1 offset:23552
MF v[68:71],a[16:19],v[20:23],v[68:71]
MF v[92:95],a[20:23],v[20:23],v[92:95]
ds_read_b128 v[16:19],v1 offset:24576
s_waitcnt vmcnt(9)
s_waitcnt lgkmcnt(5)
MF v[48:51],a[24:27],v[24:27],v[48:51]
buffer_load_dwordx4 a[68:71],v254,s[8:11],s27 offen offset:0 sc1
MF v[72:75],a[28:31],v[24:27],v[72:75]
ds_read_b128 v[20:23],v1 offset:25600
MF v[52:55],a[24:27],v[28:31],v[52:55]
MF v[76:79],a[28:31],v[28:31],v[76:79]
ds_read_b128 v[24:27],v1 offset:26624
s_waitcnt lgkmcnt(5)
MF v[56:59],a[24:27],v[32:35],v[56:59]
buffer_load_dwordx4 a[72:75],v254,s[8:11],s24 offen offset:1024 sc1
MF v[80:83],a[28:31],v[32:35],v[80:83]
ds_read_b128 v[28:31],v1 offset:27648
MF v[60:63],a[24:27],v[36:39],v[60:63]
MF v[84:87],a[28:31],v[36:39],v[84:87]
ds_read_b128 v[32:35],v1 offset:28672
s_waitcnt lgkmcnt(5)
MF v[64:67],a[24:27],v[40:43],v[64:67]
buffer_load_dwordx4 a[76:79],v254,s[8:11],s27 offen offset:1024 sc1
MF v[88:91],a[28:31],v[40:43],v[88:91]
ds_read_b128 v[36:39],v1 offset:29696
MF v[68:71],a[24:27],v[44:47],v[68:71]
MF v[92:95],a[28:31],v[44:47],v[92:95]
ds_read_b128 v[40:43],v1 offset:30720
s_waitcnt vmcnt(10)
s_waitcnt lgkmcnt(5)
MF v[48:51],a[32:35],v[16:19],v[48:51]
buffer_load_dwordx4 a[80:83],v254,s[8:11],s24 offen offset:2048 sc1
MF v[72:75],a[36:39],v[16:19],v[72:75]
ds_read_b128 v[44:47],v1 offset:31744
MF v[52:55],a[32:35],v[20:23],v[52:55]
MF v[76:79],a[36:39],v[20:23],v[76:79]
ds_read_b128 v[16:19],v1 offset:32768
s_waitcnt lgkmcnt(5)
MF v[56:59],a[32:35],v[24:27],v[56:59]
buffer_load_dwordx4 a[84:87],v254,s[8:11],s27 offen offset:2048 sc1
MF v[80:83],a[36:39],v[24:27],v[80:83]
ds_read_b128 v[20:23],v1 offset:33792
MF v[60:63],a[32:35],v[28:31],v[60:63]
MF v[84:87],a[36:39],v[28:31],v[84:87]
ds_read_b128 v[24:27],v1 offset:34816
s_waitcnt lgkmcnt(5)
MF v[64:67],a[32:35],v[32:35],v[64:67]
buffer_load_dwordx4 a[88:91],v254,s[8:11],s24 offen offset:3072 sc1
MF v[88:91],a[36:39],v[32:35],v[88:91]
ds_read_b128 v[28:31],v1 offset:35840
MF v[68:71],a[32:35],v[36:39],v[68:71]
MF v[92:95],a[36:39],v[36:39],v[92:95]
s_barrier
ds_read_b128 v[32:35],v1 offset:36864
s_waitcnt vmcnt(11)
s_waitcnt lgkmcnt(5)
MF v[48:51],a[40:43],v[40:43],v[48:51]
buffer_load_dwordx4 a[92:95],v254,s[8:11],s27 offen offset:3072 sc1
MF v[72:75],a[44:47],v[40:43],v[72:75]
ds_read_b128 v[36:39],v1 offset:37888
MF v[52:55],a[40:43],v[44:47],v[52:55]
MF v[76:79],a[44:47],v[44:47],v[76:79]
ds_read_b128 v[40:43],v1 offset:38912
s_waitcnt lgkmcnt(5)
MF v[56:59],a[40:43],v[16:19],v[56:59]
buffer_load_dwordx4 a[96:99],v255,s[8:11],s24 offen offset:0 sc1
MF v[80:83],a[44:47],v[16:19],v[80:83]
ds_read_b128 v[44:47],v1 offset:39936
MF v[60:63],a[40:43],v[20:23],v[60:63]
MF v[84:87],a[44:47],v[20:23],v[84:87]
ds_read_b128 v[16:19],v1 offset:40960
s_waitcnt lgkmcnt(5)
MF v[64:67],a[40:43],v[24:27],v[64:67]
buffer_load_dwordx4 a[100:103],v255,s[8:11],s27 offen offset:0 sc1
MF v[88:91],a[44:47],v[24:27],v[88:91]
ds_read_b128 v[20:23],v1 offset:41984
MF v[68:71],a[40:43],v[28:31],v[68:71]
MF v[92:95],a[44:47],v[28:31],v[92:95]
ds_read_b128 v[24:27],v1 offset:43008
s_waitcnt vmcnt(12)
s_waitcnt lgkmcnt(5)
MF v[48:51],a[48:51],v[32:35],v[48:51]
buffer_load_dwordx4 a[104:107],v255,s[8:11],s24 offen offset:1024 sc1
MF v[72:75],a[52:55],v[32:35],v[72:75]
ds_read_b128 v[28:31],v1 offset:44032
MF v[52:55],a[48:51],v[36:39],v[52:55]
MF v[76:79],a[52:55],v[36:39],v[76:79]
ds_read_b128 v[32:35],v1 offset:45056
s_waitcnt lgkmcnt(5)
MF v[56:59],a[48:51],v[40:43],v[56:59]
buffer_load_dwordx4 a[108:111],v255,s[8:11],s27 offen offset:1024 sc1
MF v[80:83],a[52:55],v[40:43],v[80:83]
ds_read_b128 v[36:39],v1 offset:46080
MF v[60:63],a[48:51],v[44:47],v[60:63]
MF v[84:87],a[52:55],v[44:47],v[84:87]
ds_read_b128 v[40:43],v1 offset:47104
s_waitcnt lgkmcnt(5)
MF v[64:67],a[48:51],v[16:19],v[64:67]
buffer_load_dwordx4 a[112:115],v255,s[8:11],s24 offen offset:2048 sc1
MF v[88:91],a[52:55],v[16:19],v[88:91]
ds_read_b128 v[44:47],v1 offset:48128
MF v[68:71],a[48:51],v[20:23],v[68:71]
MF v[92:95],a[52:55],v[20:23],v[92:95]
ds_read_b128 v[16:19],v1 offset:49152
s_waitcnt vmcnt(13)
s_waitcnt lgkmcnt(5)
MF v[48:51],a[56:59],v[24:27],v[48:51]
buffer_load_dwordx4 a[116:119],v255,s[8:11],s27 offen offset:2048 sc1
MF v[72:75],a[60:63],v[24:27],v[72:75]
ds_read_b128 v[20:23],v1 offset:50176
MF v[52:55],a[56:59],v[28:31],v[52:55]
v_add_f32 v4,v4,v6
v_add_f32 v8,v8,v10
v_add_f32 v4,v4,v8
v_add_f32 v5,v5,v7
v_add_f32 v9,v9,v11
v_add_f32 v5,v5,v9
v_mov_b32 v6,v4
s_nop 1
v_permlane32_swap_b32 v4,v6
v_add_f32 v4,v4,v6
v_mov_b32 v6,v5
s_nop 1
v_permlane32_swap_b32 v5,v6
v_add_f32 v5,v5,v6
v_mul_f32 v4,0xbae38e39,v4
v_mul_f32 v5,0x3ae38e39,v5
v_mul_f32 v6,v4,v4
v_sub_f32 v5,v5,v6
v_max_f32 v5,0,v5
v_add_f32 v5,0x3727c5ac,v5
v_rsq_f32 v5,v5
v_cmp_gt_u32 vcc,32,v0
s_nop 1
v_cndmask_b32 v4,v5,v4,vcc
s_lshl_b32 s30,s22,8
s_add_u32 s30,s30,159744
v_lshlrev_b32 v6,2,v0
v_add_u32 v6,s30,v6
ds_write_b32 v6,v4
MF v[76:79],a[60:63],v[28:31],v[76:79]
ds_read_b128 v[24:27],v1 offset:51200
s_waitcnt lgkmcnt(6)
MF v[56:59],a[56:59],v[32:35],v[56:59]
buffer_load_dwordx4 a[120:123],v255,s[8:11],s24 offen offset:3072 sc1
v_lshlrev_b32 v12,4,v15
v_add_u32 v12,s30,v12
v_lshlrev_b32 v13,2,v14
v_add_u32 v13,s30,v13
MF v[80:83],a[60:63],v[32:35],v[80:83]
ds_read_b128 v[28:31],v1 offset:52224
ds_read_b128 v[212:215],v12 offset:0
MF v[60:63],a[56:59],v[36:39],v[60:63]
ds_read_b128 v[220:223],v12 offset:128
ds_read_b32 v228,v13 offset:0
MF v[84:87],a[60:63],v[36:39],v[84:87]
ds_read_b128 v[32:35],v1 offset:53248
s_waitcnt lgkmcnt(9)
MF v[64:67],a[56:59],v[40:43],v[64:67]
buffer_load_dwordx4 a[124:127],v255,s[8:11],s27 offen offset:3072 sc1
ds_read_b32 v230,v13 offset:128
MF v[88:91],a[60:63],v[40:43],v[88:91]
ds_read_b128 v[36:39],v1 offset:54272
ds_read_b128 v[216:219],v12 offset:64
MF v[68:71],a[56:59],v[44:47],v[68:71]
ds_read_b128 v[224:227],v12 offset:192
ds_read_b32 v229,v13 offset:64
MF v[92:95],a[60:63],v[44:47],v[92:95]
ds_read_b128 v[40:43],v1 offset:55296
s_waitcnt vmcnt(14)
s_waitcnt lgkmcnt(13)
MF v[48:51],a[64:67],v[16:19],v[48:51]
buffer_load_dwordx4 a[128:131],v1,s[8:11],s29 offen offset:0 sc1
ds_read_b32 v231,v13 offset:192
MF v[72:75],a[68:71],v[16:19],v[72:75]
ds_read_b128 v[44:47],v1 offset:56320
v_lshlrev_b32 v12,4,v15
v_add_u32 v12,160768,v12
v_lshlrev_b32 v13,2,v14
v_add_u32 v13,160768,v13
MF v[52:55],a[64:67],v[20:23],v[52:55]
s_waitcnt lgkmcnt(12)
ds_read_b32 v192,v13 offset:192
MF v[76:79],a[68:71],v[20:23],v[76:79]
ds_read_b128 v[16:19],v1 offset:57344
ds_read_b32 v193,v13 offset:256
MF v[56:59],a[64:67],v[24:27],v[56:59]
buffer_load_dwordx4 a[132:135],v1,s[8:11],s21 offen offset:0 sc1
s_waitcnt lgkmcnt(12)
ds_read_b32 v194,v13 offset:320
MF v[80:83],a[68:71],v[24:27],v[80:83]
ds_read_b128 v[20:23],v1 offset:58368
ds_read_b32 v195,v13 offset:384
MF v[60:63],a[64:67],v[28:31],v[60:63]
s_waitcnt lgkmcnt(12)
ds_read_b32 v196,v13 offset:448
MF v[84:87],a[68:71],v[28:31],v[84:87]
ds_read_b128 v[24:27],v1 offset:59392
ds_read_b32 v197,v13 offset:512
s_add_u32 m0,s49,122880
MF v[64:67],a[64:67],v[32:35],v[64:67]
buffer_load_dwordx4 v254,s[8:11],s20 offen sc1 lds
s_waitcnt lgkmcnt(12)
ds_read_b128 v[200:203],v12 offset:0
MF v[88:91],a[68:71],v[32:35],v[88:91]
ds_read_b128 v[28:31],v1 offset:60416
ds_read_b128 v[204:207],v12 offset:64
MF v[68:71],a[64:67],v[36:39],v[68:71]
s_waitcnt lgkmcnt(12)
ds_read_b128 v[208:211],v12 offset:128
MF v[92:95],a[68:71],v[36:39],v[92:95]
ds_read_b128 v[32:35],v1 offset:61440
s_waitcnt vmcnt(15)
s_add_u32 m0,s49,126976
MF v[48:51],a[72:75],v[40:43],v[48:51]
buffer_load_dwordx4 v255,s[8:11],s20 offen sc1 lds
MF v[72:75],a[76:79],v[40:43],v[72:75]
ds_read_b128 v[36:39],v1 offset:62464
MF v[52:55],a[72:75],v[44:47],v[52:55]
MF v[76:79],a[76:79],v[44:47],v[76:79]
s_waitcnt lgkmcnt(12)
ds_read_b128 v[40:43],v1 offset:63488
s_waitcnt lgkmcnt(11)
s_add_u32 m0,s49,131072
s_add_u32 s20,s48,131072
MF v[56:59],a[72:75],v[16:19],v[56:59]
buffer_load_dwordx4 v1,s[8:11],s20 offen sc1 lds
MF v[80:83],a[76:79],v[16:19],v[80:83]
ds_read_b128 v[44:47],v1 offset:64512
MF v[60:63],a[72:75],v[20:23],v[60:63]
MF v[84:87],a[76:79],v[20:23],v[84:87]
ds_read_b128 v[16:19],v2 offset:0
s_waitcnt lgkmcnt(7)
s_add_u32 m0,s49,135168
MF v[64:67],a[72:75],v[24:27],v[64:67]
buffer_load_dwordx4 v253,s[8:11],s20 offen sc1 lds
MF v[88:91],a[76:79],v[24:27],v[88:91]
ds_read_b128 v[20:23],v2 offset:1024
MF v[68:71],a[72:75],v[28:31],v[68:71]
MF v[92:95],a[76:79],v[28:31],v[92:95]
ds_read_b128 v[24:27],v2 offset:2048
s_waitcnt vmcnt(16)
s_waitcnt lgkmcnt(5)
s_add_u32 m0,s49,139264
MF v[48:51],a[80:83],v[32:35],v[48:51]
buffer_load_dwordx4 v254,s[8:11],s20 offen sc1 lds
MF v[72:75],a[84:87],v[32:35],v[72:75]
ds_read_b128 v[28:31],v2 offset:3072
MF v[52:55],a[80:83],v[36:39],v[52:55]
MF v[76:79],a[84:87],v[36:39],v[76:79]
ds_read_b128 v[32:35],v2 offset:4096
s_waitcnt lgkmcnt(5)
s_add_u32 m0,s49,143360
MF v[56:59],a[80:83],v[40:43],v[56:59]
buffer_load_dwordx4 v255,s[8:11],s20 offen sc1 lds
MF v[80:83],a[84:87],v[40:43],v[80:83]
ds_read_b128 v[36:39],v2 offset:5120
MF v[60:63],a[80:83],v[44:47],v[60:63]
MF v[84:87],a[84:87],v[44:47],v[84:87]
ds_read_b128 v[40:43],v2 offset:6144
s_waitcnt lgkmcnt(5)
MF v[64:67],a[80:83],v[16:19],v[64:67]
buffer_load_dwordx4 a[136:139],v1,s[8:11],s29 offen offset:1024 sc1
MF v[88:91],a[84:87],v[16:19],v[88:91]
ds_read_b128 v[44:47],v2 offset:7168
MF v[68:71],a[80:83],v[20:23],v[68:71]
MF v[92:95],a[84:87],v[20:23],v[92:95]
s_barrier
ds_read_b128 v[16:19],v2 offset:8192
s_waitcnt vmcnt(17)
s_waitcnt lgkmcnt(5)
MF v[48:51],a[88:91],v[24:27],v[48:51]
buffer_load_dwordx4 a[140:143],v1,s[8:11],s21 offen offset:1024 sc1
MF v[72:75],a[92:95],v[24:27],v[72:75]
ds_read_b128 v[20:23],v2 offset:9216
MF v[52:55],a[88:91],v[28:31],v[52:55]
MF v[76:79],a[92:95],v[28:31],v[76:79]
ds_read_b128 v[24:27],v2 offset:10240
s_waitcnt lgkmcnt(5)
s_add_u32 m0,s49,147456
s_add_u32 s20,s48,147456
MF v[56:59],a[88:91],v[32:35],v[56:59]
buffer_load_dwordx4 v1,s[8:11],s20 offen sc1 lds
MF v[80:83],a[92:95],v[32:35],v[80:83]
ds_read_b128 v[28:31],v2 offset:11264
MF v[60:63],a[88:91],v[36:39],v[60:63]
MF v[84:87],a[92:95],v[36:39],v[84:87]
ds_read_b128 v[32:35],v2 offset:12288
s_waitcnt lgkmcnt(5)
s_add_u32 m0,s49,151552
MF v[64:67],a[88:91],v[40:43],v[64:67]
buffer_load_dwordx4 v253,s[8:11],s20 offen sc1 lds
MF v[88:91],a[92:95],v[40:43],v[88:91]
ds_read_b128 v[36:39],v2 offset:13312
MF v[68:71],a[88:91],v[44:47],v[68:71]
MF v[92:95],a[92:95],v[44:47],v[92:95]
ds_read_b128 v[40:43],v2 offset:14336
s_waitcnt vmcnt(18)
s_waitcnt lgkmcnt(5)
s_add_u32 m0,s49,155648
MF v[48:51],a[96:99],v[16:19],v[48:51]
buffer_load_dwordx4 v254,s[8:11],s20 offen sc1 lds
MF v[72:75],a[100:103],v[16:19],v[72:75]
ds_read_b128 v[44:47],v2 offset:15360
MF v[52:55],a[96:99],v[20:23],v[52:55]
MF v[76:79],a[100:103],v[20:23],v[76:79]
ds_read_b128 v[16:19],v2 offset:16384
s_waitcnt lgkmcnt(5)
s_add_u32 m0,s49,0
MF v[56:59],a[96:99],v[24:27],v[56:59]
buffer_load_dwordx4 v255,s[8:11],s20 offen sc1 lds
MF v[80:83],a[100:103],v[24:27],v[80:83]
ds_read_b128 v[20:23],v2 offset:17408
MF v[60:63],a[96:99],v[28:31],v[60:63]
MF v[84:87],a[100:103],v[28:31],v[84:87]
ds_read_b128 v[24:27],v2 offset:18432
s_waitcnt lgkmcnt(5)
s_add_u32 m0,s49,4096
s_add_u32 s20,s48,163840
MF v[64:67],a[96:99],v[32:35],v[64:67]
buffer_load_dwordx4 v1,s[8:11],s20 offen sc1 lds
MF v[88:91],a[100:103],v[32:35],v[88:91]
ds_read_b128 v[28:31],v2 offset:19456
MF v[68:71],a[96:99],v[36:39],v[68:71]
MF v[92:95],a[100:103],v[36:39],v[92:95]
ds_read_b128 v[32:35],v2 offset:20480
s_waitcnt vmcnt(19)
s_waitcnt lgkmcnt(5)
MF v[48:51],a[104:107],v[40:43],v[48:51]
MF v[72:75],a[108:111],v[40:43],v[72:75]
ds_read_b128 v[36:39],v2 offset:21504
MF v[52:55],a[104:107],v[44:47],v[52:55]
MF v[76:79],a[108:111],v[44:47],v[76:79]
ds_read_b128 v[40:43],v2 offset:22528
s_waitcnt lgkmcnt(5)
MF v[56:59],a[104:107],v[16:19],v[56:59]
MF v[80:83],a[108:111],v[16:19],v[80:83]
ds_read_b128 v[44:47],v2 offset:23552
MF v[60:63],a[104:107],v[20:23],v[60:63]
MF v[84:87],a[108:111],v[20:23],v[84:87]
ds_read_b128 v[16:19],v2 offset:24576
s_waitcnt lgkmcnt(5)
MF v[64:67],a[104:107],v[24:27],v[64:67]
MF v[88:91],a[108:111],v[24:27],v[88:91]
ds_read_b128 v[20:23],v2 offset:25600
MF v[68:71],a[104:107],v[28:31],v[68:71]
MF v[92:95],a[108:111],v[28:31],v[92:95]
ds_read_b128 v[24:27],v2 offset:26624
s_waitcnt vmcnt(17)
s_waitcnt lgkmcnt(5)
MF v[48:51],a[112:115],v[32:35],v[48:51]
MF v[72:75],a[116:119],v[32:35],v[72:75]
ds_read_b128 v[28:31],v2 offset:27648
MF v[52:55],a[112:115],v[36:39],v[52:55]
MF v[76:79],a[116:119],v[36:39],v[76:79]
ds_read_b128 v[32:35],v2 offset:28672
s_waitcnt lgkmcnt(5)
MF v[56:59],a[112:115],v[40:43],v[56:59]
MF v[80:83],a[116:119],v[40:43],v[80:83]
ds_read_b128 v[36:39],v2 offset:29696
MF v[60:63],a[112:115],v[44:47],v[60:63]
MF v[84:87],a[116:119],v[44:47],v[84:87]
ds_read_b128 v[40:43],v2 offset:30720
s_waitcnt lgkmcnt(5)
MF v[64:67],a[112:115],v[16:19],v[64:67]
MF v[88:91],a[116:119],v[16:19],v[88:91]
ds_read_b128 v[44:47],v2 offset:31744
MF v[68:71],a[112:115],v[20:23],v[68:71]
MF v[92:95],a[116:119],v[20:23],v[92:95]
ds_read_b128 v[16:19],v2 offset:32768
s_waitcnt vmcnt(15)
s_waitcnt lgkmcnt(5)
MF v[48:51],a[120:123],v[24:27],v[48:51]
MF v[72:75],a[124:127],v[24:27],v[72:75]
ds_read_b128 v[20:23],v2 offset:33792
MF v[52:55],a[120:123],v[28:31],v[52:55]
MF v[76:79],a[124:127],v[28:31],v[76:79]
ds_read_b128 v[24:27],v2 offset:34816
s_waitcnt lgkmcnt(5)
MF v[56:59],a[120:123],v[32:35],v[56:59]
MF v[80:83],a[124:127],v[32:35],v[80:83]
ds_read_b128 v[28:31],v2 offset:35840
MF v[60:63],a[120:123],v[36:39],v[60:63]
MF v[84:87],a[124:127],v[36:39],v[84:87]
ds_read_b128 v[32:35],v2 offset:36864
s_waitcnt lgkmcnt(5)
MF v[64:67],a[120:123],v[40:43],v[64:67]
MF v[88:91],a[124:127],v[40:43],v[88:91]
ds_read_b128 v[36:39],v2 offset:37888
MF v[68:71],a[120:123],v[44:47],v[68:71]
MF v[92:95],a[124:127],v[44:47],v[92:95]
ds_read_b128 v[40:43],v2 offset:38912
s_waitcnt vmcnt(13)
s_waitcnt lgkmcnt(5)
MF v[48:51],a[128:131],v[16:19],v[48:51]
MF v[72:75],a[132:135],v[16:19],v[72:75]
ds_read_b128 v[44:47],v2 offset:39936
MF v[52:55],a[128:131],v[20:23],v[52:55]
MF v[76:79],a[132:135],v[20:23],v[76:79]
ds_read_b128 v[16:19],v2 offset:40960
s_waitcnt lgkmcnt(5)
MF v[56:59],a[128:131],v[24:27],v[56:59]
MF v[80:83],a[132:135],v[24:27],v[80:83]
ds_read_b128 v[20:23],v2 offset:41984
MF v[60:63],a[128:131],v[28:31],v[60:63]
MF v[84:87],a[132:135],v[28:31],v[84:87]
ds_read_b128 v[24:27],v2 offset:43008
s_waitcnt lgkmcnt(5)
MF v[64:67],a[128:131],v[32:35],v[64:67]
MF v[88:91],a[132:135],v[32:35],v[88:91]
ds_read_b128 v[28:31],v2 offset:44032
MF v[68:71],a[128:131],v[36:39],v[68:71]
MF v[92:95],a[132:135],v[36:39],v[92:95]
s_waitcnt vmcnt(7)
s_barrier
ds_read_b128 v[32:35],v2 offset:45056
s_waitcnt vmcnt(5)
s_waitcnt lgkmcnt(5)
MF v[48:51],a[136:139],v[40:43],v[48:51]
MF v[72:75],a[140:143],v[40:43],v[72:75]
ds_read_b128 v[36:39],v2 offset:46080
MF v[52:55],a[136:139],v[44:47],v[52:55]
MF v[76:79],a[140:143],v[44:47],v[76:79]
ds_read_b128 v[40:43],v2 offset:47104
s_waitcnt lgkmcnt(5)
MF v[56:59],a[136:139],v[16:19],v[56:59]
MF v[80:83],a[140:143],v[16:19],v[80:83]
ds_read_b128 v[44:47],v2 offset:48128
MF v[60:63],a[136:139],v[20:23],v[60:63]
MF v[84:87],a[140:143],v[20:23],v[84:87]
ds_read_b128 v[16:19],v2 offset:49152
s_waitcnt lgkmcnt(5)
MF v[64:67],a[136:139],v[24:27],v[64:67]
MF v[88:91],a[140:143],v[24:27],v[88:91]
ds_read_b128 v[20:23],v2 offset:50176
MF v[68:71],a[136:139],v[28:31],v[68:71]
MF v[92:95],a[140:143],v[28:31],v[92:95]
s_waitcnt lgkmcnt(0)
v_mov_b32 v8,0
v_mov_b32 v9,0
v_mov_b32 v10,0
v_mov_b32 v11,0
s_lshl_b32 s46,s22,11
s_add_u32 s46,s46,57344
v_add_u32 v12,s46,v1
ds_write_b128 v12,v[8:11]
ds_write_b128 v12,v[8:11] offset:1024
s_nop 7
v_pk_fma_f32 v[48:49],v[212:213],v[192:193],v[48:49] op_sel_hi:[1,0,1]
v_pk_fma_f32 v[50:51],v[214:215],v[192:193],v[50:51] op_sel_hi:[1,0,1]
v_pk_fma_f32 v[72:73],v[216:217],v[192:193],v[72:73] op_sel_hi:[1,0,1]
v_pk_fma_f32 v[74:75],v[218:219],v[192:193],v[74:75] op_sel_hi:[1,0,1]
v_pk_mul_f32 v[48:49],v[48:49],v[220:221]
v_pk_mul_f32 v[50:51],v[50:51],v[222:223]
v_pk_mul_f32 v[72:73],v[72:73],v[224:225]
v_pk_mul_f32 v[74:75],v[74:75],v[226:227]
v_pk_mul_f32 v[168:169],v[48:49],v[184:185] op_sel_hi:[1,0]
v_pk_mul_f32 v[170:171],v[50:51],v[184:185] op_sel_hi:[1,0]
v_pk_mul_f32 v[172:173],v[72:73],v[184:185] op_sel_hi:[1,0]
v_pk_mul_f32 v[174:175],v[74:75],v[184:185] op_sel_hi:[1,0]
v_pk_add_f32 v[48:49],v[48:49],v[184:185] op_sel:[0,1]
v_pk_add_f32 v[50:51],v[50:51],v[184:185] op_sel:[0,1]
v_pk_add_f32 v[72:73],v[72:73],v[184:185] op_sel:[0,1]
v_pk_add_f32 v[74:75],v[74:75],v[184:185] op_sel:[0,1]
v_min_f32 v168,0,v168
v_min_f32 v170,0,v170
v_min_f32 v172,0,v172
v_min_f32 v174,0,v174
v_min_f32 v169,0,v169
v_min_f32 v171,0,v171
v_min_f32 v173,0,v173
v_min_f32 v175,0,v175
v_exp_f32 v168,v168
v_exp_f32 v170,v170
v_exp_f32 v172,v172
v_exp_f32 v174,v174
v_exp_f32 v169,v169
v_exp_f32 v171,v171
v_exp_f32 v173,v173
v_exp_f32 v175,v175
v_max_f32 v48,v48,v185
v_max_f32 v50,v50,v185
v_max_f32 v72,v72,v185
v_max_f32 v74,v74,v185
v_max_f32 v49,v49,v185
v_max_f32 v51,v51,v185
v_max_f32 v73,v73,v185
v_max_f32 v75,v75,v185
v_pk_add_f32 v[48:49],v[48:49],v[168:169]
v_pk_add_f32 v[50:51],v[50:51],v[170:171]
v_pk_add_f32 v[72:73],v[72:73],v[172:173]
v_pk_add_f32 v[74:75],v[74:75],v[174:175]
v_cvt_pk_bf16_f32 v144,v48,v49
v_cvt_pk_bf16_f32 v145,v50,v51
v_cvt_pk_bf16_f32 v146,v72,v73
v_cvt_pk_bf16_f32 v147,v74,v75
v_pk_fma_f32 v[52:53],v[212:213],v[192:193],v[52:53] op_sel:[0,1,0]
v_pk_fma_f32 v[54:55],v[214:215],v[192:193],v[54:55] op_sel:[0,1,0]
v_pk_fma_f32 v[76:77],v[216:217],v[192:193],v[76:77] op_sel:[0,1,0]
v_pk_fma_f32 v[78:79],v[218:219],v[192:193],v[78:79] op_sel:[0,1,0]
v_pk_mul_f32 v[52:53],v[52:53],v[220:221]
v_pk_mul_f32 v[54:55],v[54:55],v[222:223]
v_pk_mul_f32 v[76:77],v[76:77],v[224:225]
v_pk_mul_f32 v[78:79],v[78:79],v[226:227]
v_pk_mul_f32 v[168:169],v[52:53],v[184:185] op_sel_hi:[1,0]
v_pk_mul_f32 v[170:171],v[54:55],v[184:185] op_sel_hi:[1,0]
v_pk_mul_f32 v[172:173],v[76:77],v[184:185] op_sel_hi:[1,0]
v_pk_mul_f32 v[174:175],v[78:79],v[184:185] op_sel_hi:[1,0]
v_pk_add_f32 v[52:53],v[52:53],v[184:185] op_sel:[0,1]
v_pk_add_f32 v[54:55],v[54:55],v[184:185] op_sel:[0,1]
v_pk_add_f32 v[76:77],v[76:77],v[184:185] op_sel:[0,1]
v_pk_add_f32 v[78:79],v[78:79],v[184:185] op_sel:[0,1]
v_min_f32 v168,0,v168
v_min_f32 v170,0,v170
v_min_f32 v172,0,v172
v_min_f32 v174,0,v174
v_min_f32 v169,0,v169
v_min_f32 v171,0,v171
v_min_f32 v173,0,v173
v_min_f32 v175,0,v175
v_exp_f32 v168,v168
v_exp_f32 v170,v170
v_exp_f32 v172,v172
v_exp_f32 v174,v174
v_exp_f32 v169,v169
v_exp_f32 v171,v171
v_exp_f32 v173,v173
v_exp_f32 v175,v175
v_max_f32 v52,v52,v185
v_max_f32 v54,v54,v185
v_max_f32 v76,v76,v185
v_max_f32 v78,v78,v185
v_max_f32 v53,v53,v185
v_max_f32 v55,v55,v185
v_max_f32 v77,v77,v185
v_max_f32 v79,v79,v185
v_pk_add_f32 v[52:53],v[52:53],v[168:169]
v_pk_add_f32 v[54:55],v[54:55],v[170:171]
v_pk_add_f32 v[76:77],v[76:77],v[172:173]
v_pk_add_f32 v[78:79],v[78:79],v[174:175]
v_cvt_pk_bf16_f32 v148,v52,v53
v_cvt_pk_bf16_f32 v149,v54,v55
v_cvt_pk_bf16_f32 v150,v76,v77
v_cvt_pk_bf16_f32 v151,v78,v79
v_pk_fma_f32 v[56:57],v[212:213],v[194:195],v[56:57] op_sel_hi:[1,0,1]
v_pk_fma_f32 v[58:59],v[214:215],v[194:195],v[58:59] op_sel_hi:[1,0,1]
v_pk_fma_f32 v[80:81],v[216:217],v[194:195],v[80:81] op_sel_hi:[1,0,1]
v_pk_fma_f32 v[82:83],v[218:219],v[194:195],v[82:83] op_sel_hi:[1,0,1]
v_pk_mul_f32 v[56:57],v[56:57],v[220:221]
v_pk_mul_f32 v[58:59],v[58:59],v[222:223]
v_pk_mul_f32 v[80:81],v[80:81],v[224:225]
v_pk_mul_f32 v[82:83],v[82:83],v[226:227]
v_pk_mul_f32 v[168:169],v[56:57],v[184:185] op_sel_hi:[1,0]
v_pk_mul_f32 v[170:171],v[58:59],v[184:185] op_sel_hi:[1,0]
v_pk_mul_f32 v[172:173],v[80:81],v[184:185] op_sel_hi:[1,0]
v_pk_mul_f32 v[174:175],v[82:83],v[184:185] op_sel_hi:[1,0]
v_pk_add_f32 v[56:57],v[56:57],v[184:185] op_sel:[0,1]
v_pk_add_f32 v[58:59],v[58:59],v[184:185] op_sel:[0,1]
v_pk_add_f32 v[80:81],v[80:81],v[184:185] op_sel:[0,1]
v_pk_add_f32 v[82:83],v[82:83],v[184:185] op_sel:[0,1]
v_min_f32 v168,0,v168
v_min_f32 v170,0,v170
v_min_f32 v172,0,v172
v_min_f32 v174,0,v174
v_min_f32 v169,0,v169
v_min_f32 v171,0,v171
v_min_f32 v173,0,v173
v_min_f32 v175,0,v175
v_exp_f32 v168,v168
v_exp_f32 v170,v170
v_exp_f32 v172,v172
v_exp_f32 v174,v174
v_exp_f32 v169,v169
v_exp_f32 v171,v171
v_exp_f32 v173,v173
v_exp_f32 v175,v175
v_max_f32 v56,v56,v185
v_max_f32 v58,v58,v185
v_max_f32 v80,v80,v185
v_max_f32 v82,v82,v185
v_max_f32 v57,v57,v185
v_max_f32 v59,v59,v185
v_max_f32 v81,v81,v185
v_max_f32 v83,v83,v185
v_pk_add_f32 v[56:57],v[56:57],v[168:169]
v_pk_add_f32 v[58:59],v[58:59],v[170:171]
v_pk_add_f32 v[80:81],v[80:81],v[172:173]
v_pk_add_f32 v[82:83],v[82:83],v[174:175]
v_cvt_pk_bf16_f32 v152,v56,v57
v_cvt_pk_bf16_f32 v153,v58,v59
v_cvt_pk_bf16_f32 v154,v80,v81
v_cvt_pk_bf16_f32 v155,v82,v83
v_pk_fma_f32 v[60:61],v[212:213],v[194:195],v[60:61] op_sel:[0,1,0]
v_pk_fma_f32 v[62:63],v[214:215],v[194:195],v[62:63] op_sel:[0,1,0]
v_pk_fma_f32 v[84:85],v[216:217],v[194:195],v[84:85] op_sel:[0,1,0]
v_pk_fma_f32 v[86:87],v[218:219],v[194:195],v[86:87] op_sel:[0,1,0]
v_pk_mul_f32 v[60:61],v[60:61],v[220:221]
v_pk_mul_f32 v[62:63],v[62:63],v[222:223]
v_pk_mul_f32 v[84:85],v[84:85],v[224:225]
v_pk_mul_f32 v[86:87],v[86:87],v[226:227]
v_cvt_pk_bf16_f32 v156,v60,v61
v_cvt_pk_bf16_f32 v157,v62,v63
v_cvt_pk_bf16_f32 v158,v84,v85
v_cvt_pk_bf16_f32 v159,v86,v87
v_pk_fma_f32 v[64:65],v[212:213],v[196:197],v[64:65] op_sel_hi:[1,0,1]
v_pk_fma_f32 v[66:67],v[214:215],v[196:197],v[66:67] op_sel_hi:[1,0,1]
v_pk_fma_f32 v[88:89],v[216:217],v[196:197],v[88:89] op_sel_hi:[1,0,1]
v_pk_fma_f32 v[90:91],v[218:219],v[196:197],v[90:91] op_sel_hi:[1,0,1]
v_pk_mul_f32 v[64:65],v[64:65],v[220:221]
v_pk_mul_f32 v[66:67],v[66:67],v[222:223]
v_pk_mul_f32 v[88:89],v[88:89],v[224:225]
v_pk_mul_f32 v[90:91],v[90:91],v[226:227]
v_cvt_pk_bf16_f32 v160,v64,v65
v_cvt_pk_bf16_f32 v161,v66,v67
v_cvt_pk_bf16_f32 v162,v88,v89
v_cvt_pk_bf16_f32 v163,v90,v91
v_pk_fma_f32 v[68:69],v[212:213],v[196:197],v[68:69] op_sel:[0,1,0]
v_pk_fma_f32 v[70:71],v[214:215],v[196:197],v[70:71] op_sel:[0,1,0]
v_pk_fma_f32 v[92:93],v[216:217],v[196:197],v[92:93] op_sel:[0,1,0]
v_pk_fma_f32 v[94:95],v[218:219],v[196:197],v[94:95] op_sel:[0,1,0]
v_pk_mul_f32 v[68:69],v[68:69],v[220:221]
v_pk_mul_f32 v[70:71],v[70:71],v[222:223]
v_pk_mul_f32 v[92:93],v[92:93],v[224:225]
v_pk_mul_f32 v[94:95],v[94:95],v[226:227]
v_cvt_pk_bf16_f32 v164,v68,v69
v_cvt_pk_bf16_f32 v165,v70,v71
v_cvt_pk_bf16_f32 v166,v92,v93
v_cvt_pk_bf16_f32 v167,v94,v95
MF v[48:51],v[144:147],v[156:159],0
MF v[52:55],v[144:147],v[160:163],0
MF v[56:59],v[144:147],v[164:167],0
MF v[84:87],v[144:147],v[232:235],0
MF v[60:63],v[148:151],v[156:159],0
MF v[64:67],v[148:151],v[160:163],0
MF v[68:71],v[148:151],v[164:167],0
MF v[88:91],v[148:151],v[232:235],0
MF v[72:75],v[152:155],v[156:159],0
MF v[76:79],v[152:155],v[160:163],0
MF v[80:83],v[152:155],v[164:167],0
MF v[92:95],v[152:155],v[232:235],0
ds_write_b128 v236,v[48:51] offset:0
ds_write_b128 v236,v[52:55] offset:1024
ds_write_b128 v236,v[56:59] offset:2048
ds_write_b128 v236,v[84:87] offset:9216
ds_write_b128 v236,v[60:63] offset:3072
ds_write_b128 v236,v[64:67] offset:4096
ds_write_b128 v236,v[68:71] offset:5120
ds_write_b128 v236,v[88:91] offset:10240
ds_write_b128 v236,v[72:75] offset:6144
ds_write_b128 v236,v[76:79] offset:7168
ds_write_b128 v236,v[80:83] offset:8192
ds_write_b128 v236,v[92:95] offset:11264
s_waitcnt lgkmcnt(0)
s_barrier
ds_read_b32 v168,v248 offset:0
ds_read_b32 v169,v248 offset:12288
ds_read_b32 v170,v248 offset:24576
ds_read_b32 v171,v248 offset:36864
ds_read_b32 v172,v249 offset:0
ds_read_b32 v173,v249 offset:12288
ds_read_b32 v174,v249 offset:24576
ds_read_b32 v175,v249 offset:36864
ds_read_b32 v176,v250 offset:0
ds_read_b32 v177,v250 offset:12288
ds_read_b32 v178,v250 offset:24576
ds_read_b32 v179,v250 offset:36864
ds_read_b32 v180,v251 offset:0
ds_read_b32 v181,v251 offset:12288
ds_read_b32 v182,v251 offset:24576
s_waitcnt lgkmcnt(12)
ds_read_b32 v183,v251 offset:36864
s_waitcnt lgkmcnt(0)
v_add_f32 v168,v168,v169
v_add_f32 v170,v170,v171
v_add_f32 v8,v168,v170
v_add_f32 v172,v172,v173
v_add_f32 v174,v174,v175
v_add_f32 v9,v172,v174
v_add_f32 v176,v176,v177
v_add_f32 v178,v178,v179
v_add_f32 v10,v176,v178
v_add_f32 v180,v180,v181
v_add_f32 v182,v182,v183
v_add_f32 v11,v180,v182
buffer_store_dwordx4 v[8:11],v237,s[8:11],s51 offen sc0 sc1
ds_read_b128 v[24:27],v2 offset:51200
MF v[120:123],v[32:35],a[0:3],0
MF v[132:135],v[32:35],a[4:7],0
ds_read_b128 v[28:31],v2 offset:52224
MF v[124:127],v[36:39],a[0:3],0
MF v[136:139],v[36:39],a[4:7],0
ds_read_b128 v[32:35],v2 offset:53248
MF v[128:131],v[40:43],a[0:3],0
MF v[140:143],v[40:43],a[4:7],0
ds_read_b128 v[36:39],v2 offset:54272
MF v[120:123],v[44:47],a[8:11],v[120:123]
MF v[132:135],v[44:47],a[12:15],v[132:135]
ds_read_b128 v[40:43],v2 offset:55296
MF v[124:127],v[16:19],a[8:11],v[124:127]
MF v[136:139],v[16:19],a[12:15],v[136:139]
ds_read_b128 v[44:47],v2 offset:56320
MF v[128:131],v[20:23],a[8:11],v[128:131]
MF v[140:143],v[20:23],a[12:15],v[140:143]
ds_read_b128 v[16:19],v2 offset:57344
s_waitcnt lgkmcnt(5)
MF v[120:123],v[24:27],a[16:19],v[120:123]
v_and_b32 v247,7,v0
v_lshl_add_u32 v247,v15,3,v247
v_lshlrev_b32 v247,4,v247
v_add_u32 v247,4096,v247
s_mul_i32 s48,s22,5
s_mov_b32 s49,0
s_cmp_eq_u32 s22,3
s_cselect_b32 s20,1,0
s_sub_u32 s48,s48,s20
s_cmp_ge_u32 s22,2
s_cselect_b32 s49,0x40000000,0
s_lshr_b32 s20,s23,2
s_mul_i32 s20,s20,18
s_add_u32 s48,s48,s20
s_mul_i32 s48,s48,4608
s_add_u32 s48,s48,0x2a0000
buffer_load_dwordx4 a[0:3],v1,s[8:11],s48 offen offset:0 sc1
MF v[132:135],v[24:27],a[20:23],v[132:135]
ds_read_b128 v[20:23],v2 offset:58368
MF v[124:127],v[28:31],a[16:19],v[124:127]
MF v[136:139],v[28:31],a[20:23],v[136:139]
ds_read_b128 v[24:27],v2 offset:59392
s_waitcnt lgkmcnt(5)
MF v[128:131],v[32:35],a[16:19],v[128:131]
buffer_load_dwordx4 a[4:7],v1,s[8:11],s48 offen offset:1024 sc1
MF v[140:143],v[32:35],a[20:23],v[140:143]
ds_read_b128 v[28:31],v2 offset:60416
MF v[120:123],v[36:39],a[24:27],v[120:123]
buffer_load_dwordx4 a[8:11],v1,s[8:11],s48 offen offset:2048 sc1
MF v[132:135],v[36:39],a[28:31],v[132:135]
ds_read_b128 v[32:35],v2 offset:61440
s_waitcnt lgkmcnt(5)
MF v[124:127],v[40:43],a[24:27],v[124:127]
MF v[136:139],v[40:43],a[28:31],v[136:139]
ds_read_b128 v[36:39],v2 offset:62464
MF v[128:131],v[44:47],a[24:27],v[128:131]
buffer_load_dwordx4 a[12:15],v1,s[8:11],s48 offen offset:3072 sc1
MF v[140:143],v[44:47],a[28:31],v[140:143]
ds_read_b128 v[40:43],v2 offset:63488
s_waitcnt lgkmcnt(5)
MF v[120:123],v[16:19],a[32:35],v[120:123]
MF v[132:135],v[16:19],a[36:39],v[132:135]
ds_read_b128 v[44:47],v2 offset:64512
buffer_load_dwordx4 a[16:19],v247,s[8:11],s48 offen sc1
MF v[124:127],v[20:23],a[32:35],v[124:127]
MF v[136:139],v[20:23],a[36:39],v[136:139]
ds_read_b128 v[16:19],v3 offset:0
s_waitcnt lgkmcnt(5)
MF v[128:131],v[24:27],a[32:35],v[128:131]
s_add_u32 s48,s48,4608
buffer_load_dwordx4 a[20:23],v1,s[8:11],s48 offen offset:0 sc1
MF v[140:143],v[24:27],a[36:39],v[140:143]
ds_read_b128 v[20:23],v3 offset:1024
MF v[120:123],v[28:31],a[40:43],v[120:123]
MF v[132:135],v[28:31],a[44:47],v[132:135]
ds_read_b128 v[24:27],v3 offset:2048
s_waitcnt lgkmcnt(5)
MF v[124:127],v[32:35],a[40:43],v[124:127]
buffer_load_dwordx4 a[24:27],v1,s[8:11],s48 offen offset:1024 sc1
MF v[136:139],v[32:35],a[44:47],v[136:139]
ds_read_b128 v[28:31],v3 offset:3072
MF v[128:131],v[36:39],a[40:43],v[128:131]
buffer_load_dwordx4 a[28:31],v1,s[8:11],s48 offen offset:2048 sc1
MF v[140:143],v[36:39],a[44:47],v[140:143]
ds_read_b128 v[32:35],v3 offset:4096
s_waitcnt lgkmcnt(5)
MF v[120:123],v[40:43],a[48:51],v[120:123]
MF v[132:135],v[40:43],a[52:55],v[132:135]
ds_read_b128 v[36:39],v3 offset:5120
MF v[124:127],v[44:47],a[48:51],v[124:127]
buffer_load_dwordx4 a[32:35],v1,s[8:11],s48 offen offset:3072 sc1
MF v[136:139],v[44:47],a[52:55],v[136:139]
ds_read_b128 v[40:43],v3 offset:6144
s_waitcnt lgkmcnt(5)
MF v[128:131],v[16:19],a[48:51],v[128:131]
MF v[140:143],v[16:19],a[52:55],v[140:143]
ds_read_b128 v[44:47],v3 offset:7168
buffer_load_dwordx4 a[36:39],v247,s[8:11],s48 offen sc1
MF v[120:123],v[20:23],a[56:59],v[120:123]
MF v[132:135],v[20:23],a[60:63],v[132:135]
ds_read_b128 v[16:19],v3 offset:8192
s_waitcnt lgkmcnt(5)
MF v[124:127],v[24:27],a[56:59],v[124:127]
s_add_u32 s48,s48,4608
buffer_load_dwordx4 a[40:43],v1,s[8:11],s48 offen offset:0 sc1
MF v[136:139],v[24:27],a[60:63],v[136:139]
ds_read_b128 v[20:23],v3 offset:9216
MF v[128:131],v[28:31],a[56:59],v[128:131]
MF v[140:143],v[28:31],a[60:63],v[140:143]
ds_read_b128 v[24:27],v3 offset:10240
s_waitcnt lgkmcnt(5)
MF v[120:123],v[32:35],a[64:67],v[120:123]
buffer_load_dwordx4 a[44:47],v1,s[8:11],s48 offen offset:1024 sc1
MF v[132:135],v[32:35],a[68:71],v[132:135]
ds_read_b128 v[28:31],v3 offset:11264
MF v[124:127],v[36:39],a[64:67],v[124:127]
buffer_load_dwordx4 a[48:51],v1,s[8:11],s48 offen offset:2048 sc1
MF v[136:139],v[36:39],a[68:71],v[136:139]
ds_read_b128 v[32:35],v3 offset:12288
s_waitcnt lgkmcnt(5)
MF v[128:131],v[40:43],a[64:67],v[128:131]
MF v[140:143],v[40:43],a[68:71],v[140:143]
ds_read_b128 v[36:39],v3 offset:13312
MF v[120:123],v[44:47],a[72:75],v[120:123]
buffer_load_dwordx4 a[52:55],v1,s[8:11],s48 offen offset:3072 sc1
MF v[132:135],v[44:47],a[76:79],v[132:135]
ds_read_b128 v[40:43],v3 offset:14336
s_waitcnt lgkmcnt(5)
MF v[124:127],v[16:19],a[72:75],v[124:127]
MF v[136:139],v[16:19],a[76:79],v[136:139]
ds_read_b128 v[44:47],v3 offset:15360
buffer_load_dwordx4 a[56:59],v247,s[8:11],s48 offen sc1
MF v[128:131],v[20:23],a[72:75],v[128:131]
MF v[140:143],v[20:23],a[76:79],v[140:143]
s_waitcnt vmcnt(16)
s_barrier
ds_read_b128 v[16:19],v3 offset:16384
s_waitcnt lgkmcnt(5)
MF v[120:123],v[24:27],a[80:83],v[120:123]
s_add_u32 s48,s48,4608
buffer_load_dwordx4 a[60:63],v1,s[8:11],s48 offen offset:0 sc1
MF v[132:135],v[24:27],a[84:87],v[132:135]
ds_read_b128 v[20:23],v3 offset:17408
MF v[124:127],v[28:31],a[80:83],v[124:127]
MF v[136:139],v[28:31],a[84:87],v[136:139]
ds_read_b128 v[24:27],v3 offset:18432
s_waitcnt lgkmcnt(5)
MF v[128:131],v[32:35],a[80:83],v[128:131]
buffer_load_dwordx4 a[64:67],v1,s[8:11],s48 offen offset:1024 sc1
MF v[140:143],v[32:35],a[84:87],v[140:143]
ds_read_b128 v[28:31],v3 offset:19456
MF v[120:123],v[36:39],a[88:91],v[120:123]
buffer_load_dwordx4 a[68:71],v1,s[8:11],s48 offen offset:2048 sc1
MF v[132:135],v[36:39],a[92:95],v[132:135]
ds_read_b128 v[32:35],v3 offset:20480
s_waitcnt lgkmcnt(5)
MF v[124:127],v[40:43],a[88:91],v[124:127]
MF v[136:139],v[40:43],a[92:95],v[136:139]
ds_read_b128 v[36:39],v3 offset:21504
MF v[128:131],v[44:47],a[88:91],v[128:131]
buffer_load_dwordx4 a[72:75],v1,s[8:11],s48 offen offset:3072 sc1
MF v[140:143],v[44:47],a[92:95],v[140:143]
ds_read_b128 v[40:43],v3 offset:22528
s_waitcnt lgkmcnt(5)
MF v[120:123],v[16:19],a[96:99],v[120:123]
MF v[132:135],v[16:19],a[100:103],v[132:135]
ds_read_b128 v[44:47],v3 offset:23552
buffer_load_dwordx4 a[76:79],v247,s[8:11],s48 offen sc1
MF v[124:127],v[20:23],a[96:99],v[124:127]
MF v[136:139],v[20:23],a[100:103],v[136:139]
ds_read_b128 v[16:19],v3 offset:24576
s_waitcnt lgkmcnt(5)
MF v[128:131],v[24:27],a[96:99],v[128:131]
s_add_u32 s48,s48,4608
s_add_u32 s48,s48,s49
buffer_load_dwordx4 a[80:83],v1,s[8:11],s48 offen offset:0 sc1
MF v[140:143],v[24:27],a[100:103],v[140:143]
ds_read_b128 v[20:23],v3 offset:25600
MF v[120:123],v[28:31],a[104:107],v[120:123]
MF v[132:135],v[28:31],a[108:111],v[132:135]
ds_read_b128 v[24:27],v3 offset:26624
s_waitcnt lgkmcnt(5)
MF v[124:127],v[32:35],a[104:107],v[124:127]
buffer_load_dwordx4 a[84:87],v1,s[8:11],s48 offen offset:1024 sc1
MF v[136:139],v[32:35],a[108:111],v[136:139]
ds_read_b128 v[28:31],v3 offset:27648
MF v[128:131],v[36:39],a[104:107],v[128:131]
s_add_u32 s52,s50,0
MF v[140:143],v[36:39],a[108:111],v[140:143]
ds_read_b128 v[32:35],v1 offset:0
s_waitcnt lgkmcnt(5)
MF v[120:123],v[40:43],a[112:115],v[120:123]
buffer_load_dwordx4 v[48:51],v237,s[8:11],s52 offen sc0 sc1
s_add_u32 s52,s50,3072
MF v[132:135],v[40:43],a[116:119],v[132:135]
ds_read_b128 v[36:39],v1 offset:1024
buffer_load_dwordx4 v[52:55],v237,s[8:11],s52 offen sc0 sc1
MF v[124:127],v[44:47],a[112:115],v[124:127]
s_add_u32 s52,s50,6144
buffer_load_dwordx4 v[56:59],v237,s[8:11],s52 offen sc0 sc1
MF v[136:139],v[44:47],a[116:119],v[136:139]
ds_read_b128 v[40:43],v1 offset:2048
s_waitcnt lgkmcnt(5)
MF v[128:131],v[16:19],a[112:115],v[128:131]
s_add_u32 s52,s50,9216
buffer_load_dwordx4 v[60:63],v237,s[8:11],s52 offen sc0 sc1
MF v[140:143],v[16:19],a[116:119],v[140:143]
ds_read_b128 v[44:47],v1 offset:3072
s_add_u32 s52,s50,12288
MF v[120:123],v[20:23],a[120:123],v[120:123]
buffer_load_dwordx4 v[64:67],v237,s[8:11],s52 offen sc0 sc1
s_add_u32 s52,s50,15360
MF v[132:135],v[20:23],a[124:127],v[132:135]
ds_read_b128 v[16:19],v1 offset:4096
s_waitcnt lgkmcnt(5)
MF v[124:127],v[24:27],a[120:123],v[124:127]
buffer_load_dwordx4 v[68:71],v237,s[8:11],s52 offen sc0 sc1
s_add_u32 s52,s50,18432
MF v[136:139],v[24:27],a[124:127],v[136:139]
ds_read_b128 v[20:23],v1 offset:5120
buffer_load_dwordx4 v[72:75],v237,s[8:11],s52 offen sc0 sc1
MF v[128:131],v[28:31],a[120:123],v[128:131]
s_add_u32 s52,s50,21504
buffer_load_dwordx4 v[76:79],v237,s[8:11],s52 offen sc0 sc1
MF v[140:143],v[28:31],a[124:127],v[140:143]
s_waitcnt lgkmcnt(4)
s_add_u32 s52,s50,24576
MF v[120:123],v[32:35],a[128:131],v[120:123]
buffer_load_dwordx4 v[80:83],v237,s[8:11],s52 offen sc0 sc1
s_add_u32 s52,s50,27648
MF v[132:135],v[32:35],a[132:135],v[132:135]
buffer_load_dwordx4 v[84:87],v237,s[8:11],s52 offen sc0 sc1
MF v[124:127],v[36:39],a[128:131],v[124:127]
s_add_u32 s52,s50,30720
buffer_load_dwordx4 v[88:91],v237,s[8:11],s52 offen sc0 sc1
MF v[136:139],v[36:39],a[132:135],v[136:139]
s_waitcnt lgkmcnt(2)
s_add_u32 s52,s50,33792
MF v[128:131],v[40:43],a[128:131],v[128:131]
buffer_load_dwordx4 v[92:95],v237,s[8:11],s52 offen sc0 sc1
s_add_u32 s52,s50,36864
MF v[140:143],v[40:43],a[132:135],v[140:143]
buffer_load_dwordx4 v[96:99],v237,s[8:11],s52 offen sc0 sc1
MF v[120:123],v[44:47],a[136:139],v[120:123]
s_add_u32 s52,s50,39936
buffer_load_dwordx4 v[100:103],v237,s[8:11],s52 offen sc0 sc1
MF v[132:135],v[44:47],a[140:143],v[132:135]
s_waitcnt lgkmcnt(0)
s_add_u32 s52,s50,43008
MF v[124:127],v[16:19],a[136:139],v[124:127]
buffer_load_dwordx4 v[104:107],v237,s[8:11],s52 offen sc0 sc1
s_add_u32 s52,s50,46080
MF v[136:139],v[16:19],a[140:143],v[136:139]
buffer_load_dwordx4 v[108:111],v237,s[8:11],s52 offen sc0 sc1
MF v[128:131],v[20:23],a[136:139],v[128:131]
MF v[140:143],v[20:23],a[140:143],v[140:143]
s_nop 7
v_pk_fma_f32 v[120:121],v[228:229],v[200:201],v[120:121] op_sel_hi:[0,1,1]
v_pk_fma_f32 v[122:123],v[228:229],v[202:203],v[122:123] op_sel_hi:[0,1,1]
v_pk_fma_f32 v[132:133],v[228:229],v[200:201],v[132:133] op_sel:[1,0,0]
v_pk_fma_f32 v[134:135],v[228:229],v[202:203],v[134:135] op_sel:[1,0,0]
v_pk_mul_f32 v[120:121],v[120:121],v[230:231] op_sel_hi:[1,0]
v_pk_mul_f32 v[122:123],v[122:123],v[230:231] op_sel_hi:[1,0]
v_pk_mul_f32 v[132:133],v[132:133],v[230:231] op_sel:[0,1]
v_pk_mul_f32 v[134:135],v[134:135],v[230:231] op_sel:[0,1]
v_pk_mul_f32 v[16:17],v[120:121],v[184:185] op_sel_hi:[1,0]
v_pk_mul_f32 v[18:19],v[122:123],v[184:185] op_sel_hi:[1,0]
v_pk_mul_f32 v[20:21],v[132:133],v[184:185] op_sel_hi:[1,0]
v_pk_mul_f32 v[22:23],v[134:135],v[184:185] op_sel_hi:[1,0]
v_pk_add_f32 v[120:121],v[120:121],v[184:185] op_sel:[0,1]
v_pk_add_f32 v[122:123],v[122:123],v[184:185] op_sel:[0,1]
v_pk_add_f32 v[132:133],v[132:133],v[184:185] op_sel:[0,1]
v_pk_add_f32 v[134:135],v[134:135],v[184:185] op_sel:[0,1]
v_min_f32 v16,0,v16
v_min_f32 v18,0,v18
v_min_f32 v20,0,v20
v_min_f32 v22,0,v22
v_min_f32 v17,0,v17
v_min_f32 v19,0,v19
v_min_f32 v21,0,v21
v_min_f32 v23,0,v23
v_exp_f32 v16,v16
v_exp_f32 v18,v18
v_exp_f32 v20,v20
v_exp_f32 v22,v22
v_exp_f32 v17,v17
v_exp_f32 v19,v19
v_exp_f32 v21,v21
v_exp_f32 v23,v23
v_max_f32 v120,v120,v185
v_max_f32 v122,v122,v185
v_max_f32 v132,v132,v185
v_max_f32 v134,v134,v185
v_max_f32 v121,v121,v185
v_max_f32 v123,v123,v185
v_max_f32 v133,v133,v185
v_max_f32 v135,v135,v185
v_pk_add_f32 v[120:121],v[120:121],v[16:17]
v_pk_add_f32 v[122:123],v[122:123],v[18:19]
v_pk_add_f32 v[132:133],v[132:133],v[20:21]
v_pk_add_f32 v[134:135],v[134:135],v[22:23]
v_cvt_pk_bf16_f32 v144,v120,v121
v_cvt_pk_bf16_f32 v145,v122,v123
v_cvt_pk_bf16_f32 v152,v132,v133
v_cvt_pk_bf16_f32 v153,v134,v135
buffer_load_dwordx4 a[88:91],v1,s[8:11],s48 offen offset:2048 sc1
buffer_load_dwordx4 a[92:95],v1,s[8:11],s48 offen offset:3072 sc1
buffer_load_dwordx4 a[96:99],v247,s[8:11],s48 offen sc1
v_pk_fma_f32 v[124:125],v[228:229],v[204:205],v[124:125] op_sel_hi:[0,1,1]
v_pk_fma_f32 v[126:127],v[228:229],v[206:207],v[126:127] op_sel_hi:[0,1,1]
v_pk_fma_f32 v[136:137],v[228:229],v[204:205],v[136:137] op_sel:[1,0,0]
v_pk_fma_f32 v[138:139],v[228:229],v[206:207],v[138:139] op_sel:[1,0,0]
v_pk_mul_f32 v[124:125],v[124:125],v[230:231] op_sel_hi:[1,0]
v_pk_mul_f32 v[126:127],v[126:127],v[230:231] op_sel_hi:[1,0]
v_pk_mul_f32 v[136:137],v[136:137],v[230:231] op_sel:[0,1]
v_pk_mul_f32 v[138:139],v[138:139],v[230:231] op_sel:[0,1]
v_pk_mul_f32 v[16:17],v[124:125],v[184:185] op_sel_hi:[1,0]
v_pk_mul_f32 v[18:19],v[126:127],v[184:185] op_sel_hi:[1,0]
v_pk_mul_f32 v[20:21],v[136:137],v[184:185] op_sel_hi:[1,0]
v_pk_mul_f32 v[22:23],v[138:139],v[184:185] op_sel_hi:[1,0]
v_pk_add_f32 v[124:125],v[124:125],v[184:185] op_sel:[0,1]
v_pk_add_f32 v[126:127],v[126:127],v[184:185] op_sel:[0,1]
v_pk_add_f32 v[136:137],v[136:137],v[184:185] op_sel:[0,1]
v_pk_add_f32 v[138:139],v[138:139],v[184:185] op_sel:[0,1]
v_min_f32 v16,0,v16
v_min_f32 v18,0,v18
v_min_f32 v20,0,v20
v_min_f32 v22,0,v22
v_min_f32 v17,0,v17
v_min_f32 v19,0,v19
v_min_f32 v21,0,v21
v_min_f32 v23,0,v23
v_exp_f32 v16,v16
v_exp_f32 v18,v18
v_exp_f32 v20,v20
v_exp_f32 v22,v22
v_exp_f32 v17,v17
v_exp_f32 v19,v19
v_exp_f32 v21,v21
v_exp_f32 v23,v23
v_max_f32 v124,v124,v185
v_max_f32 v126,v126,v185
v_max_f32 v136,v136,v185
v_max_f32 v138,v138,v185
v_max_f32 v125,v125,v185
v_max_f32 v127,v127,v185
v_max_f32 v137,v137,v185
v_max_f32 v139,v139,v185
v_pk_add_f32 v[124:125],v[124:125],v[16:17]
v_pk_add_f32 v[126:127],v[126:127],v[18:19]
v_pk_add_f32 v[136:137],v[136:137],v[20:21]
v_pk_add_f32 v[138:139],v[138:139],v[22:23]
v_cvt_pk_bf16_f32 v146,v124,v125
v_cvt_pk_bf16_f32 v147,v126,v127
v_cvt_pk_bf16_f32 v154,v136,v137
v_cvt_pk_bf16_f32 v155,v138,v139
v_pk_fma_f32 v[128:129],v[228:229],v[208:209],v[128:129] op_sel_hi:[0,1,1]
v_pk_fma_f32 v[130:131],v[228:229],v[210:211],v[130:131] op_sel_hi:[0,1,1]
v_pk_fma_f32 v[140:141],v[228:229],v[208:209],v[140:141] op_sel:[1,0,0]
v_pk_fma_f32 v[142:143],v[228:229],v[210:211],v[142:143] op_sel:[1,0,0]
v_pk_mul_f32 v[128:129],v[128:129],v[230:231] op_sel_hi:[1,0]
v_pk_mul_f32 v[130:131],v[130:131],v[230:231] op_sel_hi:[1,0]
v_pk_mul_f32 v[140:141],v[140:141],v[230:231] op_sel:[0,1]
v_pk_mul_f32 v[142:143],v[142:143],v[230:231] op_sel:[0,1]
v_pk_mul_f32 v[16:17],v[128:129],v[184:185] op_sel_hi:[1,0]
v_pk_mul_f32 v[18:19],v[130:131],v[184:185] op_sel_hi:[1,0]
v_pk_mul_f32 v[20:21],v[140:141],v[184:185] op_sel_hi:[1,0]
v_pk_mul_f32 v[22:23],v[142:143],v[184:185] op_sel_hi:[1,0]
v_pk_add_f32 v[128:129],v[128:129],v[184:185] op_sel:[0,1]
v_pk_add_f32 v[130:131],v[130:131],v[184:185] op_sel:[0,1]
v_pk_add_f32 v[140:141],v[140:141],v[184:185] op_sel:[0,1]
v_pk_add_f32 v[142:143],v[142:143],v[184:185] op_sel:[0,1]
v_min_f32 v16,0,v16
v_min_f32 v18,0,v18
v_min_f32 v20,0,v20
v_min_f32 v22,0,v22
v_min_f32 v17,0,v17
v_min_f32 v19,0,v19
v_min_f32 v21,0,v21
v_min_f32 v23,0,v23
v_exp_f32 v16,v16
v_exp_f32 v18,v18
v_exp_f32 v20,v20
v_exp_f32 v22,v22
v_exp_f32 v17,v17
v_exp_f32 v19,v19
v_exp_f32 v21,v21
v_exp_f32 v23,v23
v_max_f32 v128,v128,v185
v_max_f32 v130,v130,v185
v_max_f32 v140,v140,v185
v_max_f32 v142,v142,v185
v_max_f32 v129,v129,v185
v_max_f32 v131,v131,v185
v_max_f32 v141,v141,v185
v_max_f32 v143,v143,v185
v_pk_add_f32 v[128:129],v[128:129],v[16:17]
v_pk_add_f32 v[130:131],v[130:131],v[18:19]
v_pk_add_f32 v[140:141],v[140:141],v[20:21]
v_pk_add_f32 v[142:143],v[142:143],v[22:23]
v_cvt_pk_bf16_f32 v148,v128,v129
v_cvt_pk_bf16_f32 v149,v130,v131
v_cvt_pk_bf16_f32 v156,v140,v141
v_cvt_pk_bf16_f32 v157,v142,v143
v_mov_b32 v150,0
v_mov_b32 v151,0
v_mov_b32 v158,0
v_mov_b32 v159,0
s_waitcnt vmcnt(3)
v_max_u32 v8,v48,v49
v_max3_u32 v8,v8,v50,v51
v_max3_u32 v8,v8,v52,v53
v_max3_u32 v8,v8,v54,v55
v_max3_u32 v8,v8,v56,v57
v_max3_u32 v8,v8,v58,v59
v_max3_u32 v8,v8,v60,v61
v_max3_u32 v8,v8,v62,v63
v_max3_u32 v8,v8,v64,v65
v_max3_u32 v8,v8,v66,v67
v_max3_u32 v8,v8,v68,v69
v_max3_u32 v8,v8,v70,v71
v_max3_u32 v8,v8,v72,v73
v_max3_u32 v8,v8,v74,v75
v_max3_u32 v8,v8,v76,v77
v_max3_u32 v8,v8,v78,v79
v_max3_u32 v8,v8,v80,v81
v_max3_u32 v8,v8,v82,v83
v_max3_u32 v8,v8,v84,v85
v_max3_u32 v8,v8,v86,v87
v_max3_u32 v8,v8,v88,v89
v_max3_u32 v8,v8,v90,v91
v_max3_u32 v8,v8,v92,v93
v_max3_u32 v8,v8,v94,v95
v_max3_u32 v8,v8,v96,v97
v_max3_u32 v8,v8,v98,v99
v_max3_u32 v8,v8,v100,v101
v_max3_u32 v8,v8,v102,v103
v_max3_u32 v8,v8,v104,v105
v_max3_u32 v8,v8,v106,v107
v_max3_u32 v8,v8,v108,v109
v_max3_u32 v8,v8,v110,v111
v_cmp_eq_u32 vcc,-1,v8
s_cbranch_vccz k1_1_P1G
s_mov_b32 s53,0
k1_1_P1:
s_nop 7
s_nop 3
s_add_u32 s52,s50,0
buffer_load_dwordx4 v[48:51],v237,s[8:11],s52 offen sc0 sc1
s_add_u32 s52,s50,3072
buffer_load_dwordx4 v[52:55],v237,s[8:11],s52 offen sc0 sc1
s_add_u32 s52,s50,6144
buffer_load_dwordx4 v[56:59],v237,s[8:11],s52 offen sc0 sc1
s_add_u32 s52,s50,9216
buffer_load_dwordx4 v[60:63],v237,s[8:11],s52 offen sc0 sc1
s_add_u32 s52,s50,12288
buffer_load_dwordx4 v[64:67],v237,s[8:11],s52 offen sc0 sc1
s_add_u32 s52,s50,15360
buffer_load_dwordx4 v[68:71],v237,s[8:11],s52 offen sc0 sc1
s_add_u32 s52,s50,18432
buffer_load_dwordx4 v[72:75],v237,s[8:11],s52 offen sc0 sc1
s_add_u32 s52,s50,21504
buffer_load_dwordx4 v[76:79],v237,s[8:11],s52 offen sc0 sc1
s_add_u32 s52,s50,24576
buffer_load_dwordx4 v[80:83],v237,s[8:11],s52 offen sc0 sc1
s_add_u32 s52,s50,27648
buffer_load_dwordx4 v[84:87],v237,s[8:11],s52 offen sc0 sc1
s_add_u32 s52,s50,30720
buffer_load_dwordx4 v[88:91],v237,s[8:11],s52 offen sc0 sc1
s_add_u32 s52,s50,33792
buffer_load_dwordx4 v[92:95],v237,s[8:11],s52 offen sc0 sc1
s_add_u32 s52,s50,36864
buffer_load_dwordx4 v[96:99],v237,s[8:11],s52 offen sc0 sc1
s_add_u32 s52,s50,39936
buffer_load_dwordx4 v[100:103],v237,s[8:11],s52 offen sc0 sc1
s_add_u32 s52,s50,43008
buffer_load_dwordx4 v[104:107],v237,s[8:11],s52 offen sc0 sc1
s_add_u32 s52,s50,46080
buffer_load_dwordx4 v[108:111],v237,s[8:11],s52 offen sc0 sc1
s_add_u32 s53,s53,1
s_waitcnt vmcnt(0)
v_max_u32 v8,v48,v49
v_max3_u32 v8,v8,v50,v51
v_max3_u32 v8,v8,v52,v53
v_max3_u32 v8,v8,v54,v55
v_max3_u32 v8,v8,v56,v57
v_max3_u32 v8,v8,v58,v59
v_max3_u32 v8,v8,v60,v61
v_max3_u32 v8,v8,v62,v63
v_max3_u32 v8,v8,v64,v65
v_max3_u32 v8,v8,v66,v67
v_max3_u32 v8,v8,v68,v69
v_max3_u32 v8,v8,v70,v71
v_max3_u32 v8,v8,v72,v73
v_max3_u32 v8,v8,v74,v75
v_max3_u32 v8,v8,v76,v77
v_max3_u32 v8,v8,v78,v79
v_max3_u32 v8,v8,v80,v81
v_max3_u32 v8,v8,v82,v83
v_max3_u32 v8,v8,v84,v85
v_max3_u32 v8,v8,v86,v87
v_max3_u32 v8,v8,v88,v89
v_max3_u32 v8,v8,v90,v91
v_max3_u32 v8,v8,v92,v93
v_max3_u32 v8,v8,v94,v95
v_max3_u32 v8,v8,v96,v97
v_max3_u32 v8,v8,v98,v99
v_max3_u32 v8,v8,v100,v101
v_max3_u32 v8,v8,v102,v103
v_max3_u32 v8,v8,v104,v105
v_max3_u32 v8,v8,v106,v107
v_max3_u32 v8,v8,v108,v109
v_max3_u32 v8,v8,v110,v111
v_cmp_eq_u32 vcc,-1,v8
s_cbranch_vccz k1_1_P1G
s_cmp_lt_u32 s53,100000
s_cbranch_scc1 k1_1_P1
k1_1_P1G:
s_nop 7
s_nop 3
v_pk_add_f32 v[48:49],v[48:49],v[80:81]
v_pk_add_f32 v[50:51],v[50:51],v[82:83]
v_pk_add_f32 v[52:53],v[52:53],v[84:85]
v_pk_add_f32 v[54:55],v[54:55],v[86:87]
v_pk_add_f32 v[56:57],v[56:57],v[88:89]
v_pk_add_f32 v[58:59],v[58:59],v[90:91]
v_pk_add_f32 v[60:61],v[60:61],v[92:93]
v_pk_add_f32 v[62:63],v[62:63],v[94:95]
v_pk_add_f32 v[64:65],v[64:65],v[96:97]
v_pk_add_f32 v[66:67],v[66:67],v[98:99]
v_pk_add_f32 v[68:69],v[68:69],v[100:101]
v_pk_add_f32 v[70:71],v[70:71],v[102:103]
v_pk_add_f32 v[72:73],v[72:73],v[104:105]
v_pk_add_f32 v[74:75],v[74:75],v[106:107]
v_pk_add_f32 v[76:77],v[76:77],v[108:109]
v_pk_add_f32 v[78:79],v[78:79],v[110:111]
v_pk_add_f32 v[48:49],v[48:49],v[64:65]
v_pk_add_f32 v[50:51],v[50:51],v[66:67]
v_pk_add_f32 v[52:53],v[52:53],v[68:69]
v_pk_add_f32 v[54:55],v[54:55],v[70:71]
v_pk_add_f32 v[56:57],v[56:57],v[72:73]
v_pk_add_f32 v[58:59],v[58:59],v[74:75]
v_pk_add_f32 v[60:61],v[60:61],v[76:77]
v_pk_add_f32 v[62:63],v[62:63],v[78:79]
v_pk_add_f32 v[48:49],v[48:49],v[56:57]
v_pk_add_f32 v[50:51],v[50:51],v[58:59]
v_pk_add_f32 v[52:53],v[52:53],v[60:61]
v_pk_add_f32 v[54:55],v[54:55],v[62:63]
v_pk_add_f32 v[48:49],v[48:49],v[52:53]
v_pk_add_f32 v[50:51],v[50:51],v[54:55]
v_cvt_pk_bf16_f32 v48,v48,v48
ds_write_b16 v240,v48
v_cvt_pk_bf16_f32 v49,v49,v49
ds_write_b16 v241,v49
v_cvt_pk_bf16_f32 v50,v50,v50
ds_write_b16 v242,v50
v_cvt_pk_bf16_f32 v51,v51,v51
ds_write_b16 v243,v51
v_add_u32 v12,57344,v1
v_lshlrev_b32 v13,4,v15
v_add_u32 v13,63488,v13
s_mov_b32 s32,0xffff
s_mov_b32 s33,0
s_waitcnt lgkmcnt(0)
s_barrier
ds_read_b128 v[40:43],v13 offset:0
ds_read_b128 v[44:47],v13 offset:64
ds_read_b128 v[48:51],v13 offset:128
ds_read_b128 v[52:55],v13 offset:192
ds_read_b128 v[16:19],v12 offset:0
ds_read_b128 v[20:23],v12 offset:1024
ds_read_b128 v[24:27],v12 offset:2048
ds_read_b128 v[28:31],v12 offset:3072
ds_read_b128 v[32:35],v12 offset:4096
ds_read_b128 v[36:39],v12 offset:5120
s_waitcnt lgkmcnt(0)
MF v[60:63],v[40:43],v[144:147],0
MF v[64:67],v[48:51],v[144:147],0
MF v[68:71],v[40:43],v[152:155],0
MF v[72:75],v[48:51],v[152:155],0
MF v[60:63],v[44:47],v[148:151],v[60:63]
MF v[64:67],v[52:55],v[148:151],v[64:67]
MF v[68:71],v[44:47],v[156:159],v[68:71]
MF v[72:75],v[52:55],v[156:159],v[72:75]
MF v[80:83],v[16:19],v[144:147],0
MF v[84:87],v[24:27],v[144:147],0
MF v[88:91],v[32:35],v[144:147],0
MF v[92:95],v[16:19],v[152:155],0
MF v[96:99],v[24:27],v[152:155],0
MF v[100:103],v[32:35],v[152:155],0
MF v[80:83],v[20:23],v[148:151],v[80:83]
MF v[84:87],v[28:31],v[148:151],v[84:87]
MF v[88:91],v[36:39],v[148:151],v[88:91]
MF v[92:95],v[20:23],v[156:159],v[92:95]
MF v[96:99],v[28:31],v[156:159],v[96:99]
MF v[100:103],v[36:39],v[156:159],v[100:103]
v_add_f32 v60,0x358637bd,v60
v_rcp_f32 v60,v60
v_add_f32 v64,0x358637bd,v64
v_rcp_f32 v64,v64
s_nop 0
v_cndmask_b32 v61,v64,v60,s[32:33]
v_add_f32 v68,0x358637bd,v68
v_rcp_f32 v68,v68
v_add_f32 v72,0x358637bd,v72
v_rcp_f32 v72,v72
s_nop 0
v_cndmask_b32 v69,v72,v68,s[32:33]
v_mul_f32 v80,v80,v60
v_mul_f32 v81,v81,v60
v_mul_f32 v82,v82,v60
v_mul_f32 v83,v83,v60
v_cvt_pk_bf16_f32 v80,v80,v81
v_cvt_pk_bf16_f32 v81,v82,v83
buffer_store_dwordx2 v[80:81],v244,s[8:11],s54 offen sc1
v_mul_f32 v84,v84,v61
v_mul_f32 v85,v85,v61
v_mul_f32 v86,v86,v64
v_mul_f32 v87,v87,v64
v_cvt_pk_bf16_f32 v84,v84,v85
v_cvt_pk_bf16_f32 v85,v86,v87
buffer_store_dwordx2 v[84:85],v245,s[8:11],s54 offen sc1
v_mul_f32 v88,v88,v64
v_mul_f32 v89,v89,v64
v_mul_f32 v90,v90,v64
v_mul_f32 v91,v91,v64
v_cvt_pk_bf16_f32 v88,v88,v89
v_cvt_pk_bf16_f32 v89,v90,v91
buffer_store_dwordx2 v[88:89],v246,s[8:11],s54 offen sc1
v_mul_f32 v92,v92,v68
v_mul_f32 v93,v93,v68
v_mul_f32 v94,v94,v68
v_mul_f32 v95,v95,v68
v_cvt_pk_bf16_f32 v92,v92,v93
v_cvt_pk_bf16_f32 v93,v94,v95
buffer_store_dwordx2 v[92:93],v244,s[8:11],s55 offen sc1
v_mul_f32 v96,v96,v69
v_mul_f32 v97,v97,v69
v_mul_f32 v98,v98,v72
v_mul_f32 v99,v99,v72
v_cvt_pk_bf16_f32 v96,v96,v97
v_cvt_pk_bf16_f32 v97,v98,v99
buffer_store_dwordx2 v[96:97],v245,s[8:11],s55 offen sc1
v_mul_f32 v100,v100,v72
v_mul_f32 v101,v101,v72
v_mul_f32 v102,v102,v72
v_mul_f32 v103,v103,v72
v_cvt_pk_bf16_f32 v100,v100,v101
v_cvt_pk_bf16_f32 v101,v102,v103
buffer_store_dwordx2 v[100:101],v246,s[8:11],s55 offen sc1
s_lshl_b32 s78,s44,11
s_lshl_b32 s47,s45,4
s_add_u32 s78,s78,s47
s_lshl_b32 s47,s22,2
s_add_u32 s78,s78,s47
s_add_u32 s78,s78,0x1338000
PH_k2_1:
s_lshl_b32 s44,s3,2
s_and_b32 s45,s23,3
s_add_u32 s44,s44,s45
s_lshr_b32 s45,s23,2
v_and_b32 v2,7,v0
v_lshl_add_u32 v2,v15,3,v2
v_lshlrev_b32 v2,4,v2
v_add_u32 v2,4096,v2
s_mul_i32 s55,s22,5
s_mov_b32 s56,0
s_cmp_eq_u32 s22,3
s_cselect_b32 s46,1,0
s_sub_u32 s55,s55,s46
s_cmp_ge_u32 s22,2
s_cselect_b32 s56,0x40000000,0
s_add_u32 s46,s22,0
s_and_b32 s46,s46,3
s_lshl_b32 s47,s44,2
s_add_u32 s46,s46,s47
s_mul_i32 s46,s46,18
s_add_u32 s46,s46,s55
s_lshl_b32 s46,s46,10
s_add_u32 s24,s46,0x4000000
s_add_u32 s46,s22,1
s_and_b32 s46,s46,3
s_lshl_b32 s47,s44,2
s_add_u32 s46,s46,s47
s_mul_i32 s46,s46,18
s_add_u32 s46,s46,s55
s_lshl_b32 s46,s46,10
s_add_u32 s25,s46,0x4000000
s_add_u32 s46,s22,2
s_and_b32 s46,s46,3
s_lshl_b32 s47,s44,2
s_add_u32 s46,s46,s47
s_mul_i32 s46,s46,18
s_add_u32 s46,s46,s55
s_lshl_b32 s46,s46,10
s_add_u32 s26,s46,0x4000000
s_add_u32 s46,s22,3
s_and_b32 s46,s46,3
s_lshl_b32 s47,s44,2
s_add_u32 s46,s46,s47
s_mul_i32 s46,s46,18
s_add_u32 s46,s46,s55
s_lshl_b32 s46,s46,10
s_add_u32 s27,s46,0x4000000
s_mul_i32 s46,s45,18
s_add_u32 s46,s46,s55
s_mul_i32 s28,s46,4608
s_add_u32 s28,s28,0x2a0000
s_add_u32 s28,s28,18432
s_lshr_b32 s51,s44,1
s_lshl_b32 s79,s51,11
s_add_u32 s79,s79,0x1338000
v_mov_b32 v13,1
v_mov_b32 v12,0
s_waitcnt vmcnt(0)
s_mov_b32 exec_lo,0x1
s_mov_b32 exec_hi,0x0
buffer_atomic_or v13,v12,s[8:11],s78 offen sc1
s_mov_b64 exec,-1
v_lshlrev_b32 v198,2,v0
s_cmp_eq_u32 s22,0
s_cselect_b32 s79,s79,0x40000000
v_mov_b32 v199,0
buffer_atomic_or v199,v198,s[8:11],s79 offen sc0 sc1
s_mul_i32 s46,s45,72
v_lshlrev_b32 v4,2,v15
v_add_u32 v4,s46,v4
v_lshrrev_b32 v5,3,v4
v_lshlrev_b32 v5,8,v5
v_lshl_add_u32 v5,v14,4,v5
v_and_b32 v10,4,v4
v_lshl_add_u32 v5,v10,1,v5
v_add_u32 v4,16,v4
v_lshrrev_b32 v6,3,v4
v_lshlrev_b32 v6,8,v6
v_lshl_add_u32 v6,v14,4,v6
v_and_b32 v10,4,v4
v_lshl_add_u32 v6,v10,1,v6
v_add_u32 v4,16,v4
v_lshrrev_b32 v7,3,v4
v_lshlrev_b32 v7,8,v7
v_lshl_add_u32 v7,v14,4,v7
v_and_b32 v10,4,v4
v_lshl_add_u32 v7,v10,1,v7
v_add_u32 v4,16,v4
v_lshrrev_b32 v8,3,v4
v_lshlrev_b32 v8,8,v8
v_lshl_add_u32 v8,v14,4,v8
v_and_b32 v10,4,v4
v_lshl_add_u32 v8,v10,1,v8
v_add_u32 v4,16,v4
v_lshrrev_b32 v9,3,v4
v_lshlrev_b32 v9,8,v9
v_lshl_add_u32 v9,v14,4,v9
v_and_b32 v10,4,v4
v_lshl_add_u32 v9,v10,1,v9
v_cmp_gt_u32 vcc,2,v15
v_mov_b32 v10,0x7ff00000
s_nop 0
v_cndmask_b32 v9,v10,v9,vcc
s_lshl_b32 s50,s44,2
s_add_u32 s50,s50,s22
s_mul_i32 s52,s50,18432
s_add_u32 s54,s52,0x1900000
s_add_u32 s57,s52,0x1b80000
buffer_load_dwordx2 v[206:207],v5,s[8:11],s54 offen sc1
buffer_load_dwordx2 v[208:209],v6,s[8:11],s54 offen sc1
buffer_load_dwordx2 v[210:211],v7,s[8:11],s54 offen sc1
buffer_load_dwordx2 v[212:213],v8,s[8:11],s54 offen sc1
buffer_load_dwordx2 v[214:215],v9,s[8:11],s54 offen sc1
s_add_u32 s46,s22,1
s_and_b32 s46,s46,3
s_mul_i32 s46,s46,3
s_add_u32 s46,s46,0
s_mul_i32 s46,s46,5120
s_add_u32 s46,s46,98304
v_add_u32 v241,s46,v1
s_add_u32 s46,s22,2
s_and_b32 s46,s46,3
s_mul_i32 s46,s46,3
s_add_u32 s46,s46,1
s_mul_i32 s46,s46,5120
s_add_u32 s46,s46,98304
v_add_u32 v242,s46,v1
s_add_u32 s46,s22,3
s_and_b32 s46,s46,3
s_mul_i32 s46,s46,3
s_add_u32 s46,s46,2
s_mul_i32 s46,s46,5120
s_add_u32 s46,s46,98304
v_add_u32 v243,s46,v1
s_mul_i32 s46,s22,15360
s_add_u32 s46,s46,98304
v_add_u32 v240,s46,v1
v_mov_b32 v244,0
v_mov_b32 v245,0
v_mov_b32 v246,0
v_mov_b32 v247,0
s_lshl_b32 s46,s50,7
s_lshl_b32 s47,s45,14
s_add_u32 s46,s46,s47
s_add_u32 s29,s46,0x1e60000
v_lshlrev_b32 v248,3,v14
s_waitcnt vmcnt(0)
v_lshlrev_b32 v216,16,v206
v_and_b32 v217,0xffff0000,v206
v_lshlrev_b32 v218,16,v207
v_and_b32 v219,0xffff0000,v207
v_lshlrev_b32 v220,16,v208
v_and_b32 v221,0xffff0000,v208
v_lshlrev_b32 v222,16,v209
v_and_b32 v223,0xffff0000,v209
v_lshlrev_b32 v224,16,v210
v_and_b32 v225,0xffff0000,v210
v_lshlrev_b32 v226,16,v211
v_and_b32 v227,0xffff0000,v211
v_lshlrev_b32 v228,16,v212
v_and_b32 v229,0xffff0000,v212
v_lshlrev_b32 v230,16,v213
v_and_b32 v231,0xffff0000,v213
v_lshlrev_b32 v232,16,v214
v_and_b32 v233,0xffff0000,v214
v_lshlrev_b32 v234,16,v215
v_and_b32 v235,0xffff0000,v215
s_getpc_b64 s[58:59]
PC_mega_kernel_13:
s_mul_i32 s46,s23,4
s_add_u32 s46,s46,s22
s_lshl_b32 s46,s46,10
v_add_u32 v13,s46,v1
v_add_u32 v13,PH_k3_1-PC_mega_kernel_13,v13
v_min_u32 v13,PH_k4_1-PC_mega_kernel_13-16,v13
v_and_b32 v13,-4,v13
global_load_dwordx4 a[252:255],v13,s[58:59]
v_cmp_eq_u32 vcc,0,v199
s_cbranch_vccz DW_mega_kernel_14G
s_mov_b32 s53,0
s_cmp_lg_u32 s22,0
s_cbranch_scc1 DW_mega_kernel_14G
DW_mega_kernel_14:
s_nop 7
s_nop 3
v_mov_b32 v199,0
buffer_atomic_or v199,v198,s[8:11],s79 offen sc0 sc1
s_add_u32 s53,s53,1
s_waitcnt vmcnt(0)
v_cmp_eq_u32 vcc,0,v199
s_cbranch_vccz DW_mega_kernel_14G
s_cmp_lt_u32 s53,100000
s_cbranch_scc1 DW_mega_kernel_14
DW_mega_kernel_14G:
s_nop 7
s_nop 3
s_barrier
buffer_load_dwordx4 v[16:19],v1,s[8:11],s24 offen offset:0 sc1
buffer_load_dwordx4 v[20:23],v1,s[8:11],s25 offen offset:0 sc1
buffer_load_dwordx4 v[24:27],v1,s[8:11],s26 offen offset:0 sc1
buffer_load_dwordx4 v[28:31],v1,s[8:11],s27 offen offset:0 sc1
buffer_load_dwordx4 v[52:55],v1,s[8:11],s24 offen offset:1024 sc1
buffer_load_dwordx4 v[56:59],v1,s[8:11],s25 offen offset:1024 sc1
buffer_load_dwordx4 v[60:63],v1,s[8:11],s26 offen offset:1024 sc1
buffer_load_dwordx4 v[64:67],v1,s[8:11],s27 offen offset:1024 sc1
buffer_load_dwordx4 v[88:91],v1,s[8:11],s24 offen offset:2048 sc1
buffer_load_dwordx4 v[92:95],v1,s[8:11],s25 offen offset:2048 sc1
buffer_load_dwordx4 v[96:99],v1,s[8:11],s26 offen offset:2048 sc1
buffer_load_dwordx4 v[100:103],v1,s[8:11],s27 offen offset:2048 sc1
buffer_load_dwordx4 v[124:127],v1,s[8:11],s24 offen offset:3072 sc1
buffer_load_dwordx4 v[128:131],v1,s[8:11],s25 offen offset:3072 sc1
buffer_load_dwordx4 v[132:135],v1,s[8:11],s26 offen offset:3072 sc1
buffer_load_dwordx4 v[136:139],v1,s[8:11],s27 offen offset:3072 sc1
s_add_u32 s24,s24,4096
s_add_u32 s25,s25,4096
s_add_u32 s26,s26,4096
s_add_u32 s27,s27,4096
s_add_u32 s24,s24,s56
s_add_u32 s25,s25,s56
s_add_u32 s26,s26,s56
s_add_u32 s27,s27,s56
buffer_load_dwordx4 v[160:163],v1,s[8:11],s24 offen offset:0 sc1
buffer_load_dwordx4 v[164:167],v1,s[8:11],s25 offen offset:0 sc1
buffer_load_dwordx4 v[168:171],v1,s[8:11],s26 offen offset:0 sc1
buffer_load_dwordx4 v[172:175],v1,s[8:11],s27 offen offset:0 sc1
s_waitcnt vmcnt(19)
MF v[216:219],a[0:3],v[16:19],v[216:219]
MF v[220:223],a[4:7],v[16:19],v[220:223]
MF v[224:227],a[8:11],v[16:19],v[224:227]
MF v[228:231],a[12:15],v[16:19],v[228:231]
MF v[232:235],a[16:19],v[16:19],v[232:235]
s_waitcnt vmcnt(18)
MF a[100:103],a[0:3],v[20:23],0
MF a[104:107],a[4:7],v[20:23],0
MF a[108:111],a[8:11],v[20:23],0
MF a[112:115],a[12:15],v[20:23],0
MF a[116:119],a[16:19],v[20:23],0
s_waitcnt vmcnt(17)
MF a[120:123],a[0:3],v[24:27],0
MF a[124:127],a[4:7],v[24:27],0
MF a[128:131],a[8:11],v[24:27],0
MF a[132:135],a[12:15],v[24:27],0
MF a[136:139],a[16:19],v[24:27],0
s_waitcnt vmcnt(16)
MF a[140:143],a[0:3],v[28:31],0
MF a[144:147],a[4:7],v[28:31],0
MF a[148:151],a[8:11],v[28:31],0
MF a[152:155],a[12:15],v[28:31],0
MF a[156:159],a[16:19],v[28:31],0
s_waitcnt vmcnt(15)
MF v[216:219],a[20:23],v[52:55],v[216:219]
s_lshl_b32 s49,s22,10
s_lshr_b32 s48,s3,1
s_lshl_b32 s48,s48,2
s_lshr_b32 s20,s23,3
s_add_u32 s48,s48,s20
s_mul_i32 s48,s48,331776
s_add_u32 s48,s48,0x350000
s_add_u32 s48,s48,s49
v_add_u32 v253,4096,v1
v_add_u32 v254,8192,v1
v_add_u32 v255,12288,v1
s_add_u32 m0,s49,0
s_add_u32 s20,s48,0
buffer_load_dwordx4 v1,s[8:11],s20 offen sc1 lds
MF v[220:223],a[24:27],v[52:55],v[220:223]
MF v[224:227],a[28:31],v[52:55],v[224:227]
s_add_u32 m0,s49,4096
s_nop 0
buffer_load_dwordx4 v253,s[8:11],s20 offen sc1 lds
MF v[228:231],a[32:35],v[52:55],v[228:231]
MF v[232:235],a[36:39],v[52:55],v[232:235]
s_add_u32 m0,s49,8192
s_nop 0
buffer_load_dwordx4 v254,s[8:11],s20 offen sc1 lds
s_waitcnt vmcnt(17)
MF a[100:103],a[20:23],v[56:59],a[100:103]
MF a[104:107],a[24:27],v[56:59],a[104:107]
s_add_u32 m0,s49,12288
s_nop 0
buffer_load_dwordx4 v255,s[8:11],s20 offen sc1 lds
MF a[108:111],a[28:31],v[56:59],a[108:111]
MF a[112:115],a[32:35],v[56:59],a[112:115]
s_add_u32 m0,s49,16384
s_add_u32 s20,s48,16384
buffer_load_dwordx4 v1,s[8:11],s20 offen sc1 lds
MF a[116:119],a[36:39],v[56:59],a[116:119]
s_waitcnt vmcnt(18)
MF a[120:123],a[20:23],v[60:63],a[120:123]
s_add_u32 m0,s49,20480
s_nop 0
buffer_load_dwordx4 v253,s[8:11],s20 offen sc1 lds
MF a[124:127],a[24:27],v[60:63],a[124:127]
MF a[128:131],a[28:31],v[60:63],a[128:131]
s_add_u32 m0,s49,24576
s_nop 0
buffer_load_dwordx4 v254,s[8:11],s20 offen sc1 lds
MF a[132:135],a[32:35],v[60:63],a[132:135]
MF a[136:139],a[36:39],v[60:63],a[136:139]
s_add_u32 m0,s49,28672
s_nop 0
buffer_load_dwordx4 v255,s[8:11],s20 offen sc1 lds
s_waitcnt vmcnt(20)
MF a[140:143],a[20:23],v[64:67],a[140:143]
MF a[144:147],a[24:27],v[64:67],a[144:147]
MF a[148:151],a[28:31],v[64:67],a[148:151]
MF a[152:155],a[32:35],v[64:67],a[152:155]
MF a[156:159],a[36:39],v[64:67],a[156:159]
s_waitcnt vmcnt(19)
MF v[216:219],a[40:43],v[88:91],v[216:219]
s_add_u32 m0,s49,32768
s_add_u32 s20,s48,32768
buffer_load_dwordx4 v1,s[8:11],s20 offen sc1 lds
MF v[220:223],a[44:47],v[88:91],v[220:223]
MF v[224:227],a[48:51],v[88:91],v[224:227]
s_add_u32 m0,s49,36864
s_nop 0
buffer_load_dwordx4 v253,s[8:11],s20 offen sc1 lds
MF v[228:231],a[52:55],v[88:91],v[228:231]
MF v[232:235],a[56:59],v[88:91],v[232:235]
s_add_u32 m0,s49,40960
s_nop 0
buffer_load_dwordx4 v254,s[8:11],s20 offen sc1 lds
s_waitcnt vmcnt(21)
MF a[100:103],a[40:43],v[92:95],a[100:103]
MF a[104:107],a[44:47],v[92:95],a[104:107]
s_add_u32 m0,s49,45056
s_nop 0
buffer_load_dwordx4 v255,s[8:11],s20 offen sc1 lds
MF a[108:111],a[48:51],v[92:95],a[108:111]
MF a[112:115],a[52:55],v[92:95],a[112:115]
s_add_u32 m0,s49,49152
s_add_u32 s20,s48,49152
buffer_load_dwordx4 v1,s[8:11],s20 offen sc1 lds
MF a[116:119],a[56:59],v[92:95],a[116:119]
s_waitcnt vmcnt(22)
MF a[120:123],a[40:43],v[96:99],a[120:123]
s_add_u32 m0,s49,53248
s_nop 0
buffer_load_dwordx4 v253,s[8:11],s20 offen sc1 lds
MF a[124:127],a[44:47],v[96:99],a[124:127]
MF a[128:131],a[48:51],v[96:99],a[128:131]
s_add_u32 m0,s49,57344
s_nop 0
buffer_load_dwordx4 v254,s[8:11],s20 offen sc1 lds
MF a[132:135],a[52:55],v[96:99],a[132:135]
MF a[136:139],a[56:59],v[96:99],a[136:139]
s_add_u32 m0,s49,61440
s_nop 0
buffer_load_dwordx4 v255,s[8:11],s20 offen sc1 lds
s_waitcnt vmcnt(24)
MF a[140:143],a[40:43],v[100:103],a[140:143]
MF a[144:147],a[44:47],v[100:103],a[144:147]
MF a[148:151],a[48:51],v[100:103],a[148:151]
MF a[152:155],a[52:55],v[100:103],a[152:155]
MF a[156:159],a[56:59],v[100:103],a[156:159]
s_waitcnt vmcnt(23)
MF v[216:219],a[60:63],v[124:127],v[216:219]
s_add_u32 m0,s49,65536
s_add_u32 s20,s48,65536
buffer_load_dwordx4 v1,s[8:11],s20 offen sc1 lds
MF v[220:223],a[64:67],v[124:127],v[220:223]
MF v[224:227],a[68:71],v[124:127],v[224:227]
s_add_u32 m0,s49,69632
s_nop 0
buffer_load_dwordx4 v253,s[8:11],s20 offen sc1 lds
MF v[228:231],a[72:75],v[124:127],v[228:231]
MF v[232:235],a[76:79],v[124:127],v[232:235]
s_add_u32 m0,s49,73728
s_nop 0
buffer_load_dwordx4 v254,s[8:11],s20 offen sc1 lds
s_waitcnt vmcnt(25)
MF a[100:103],a[60:63],v[128:131],a[100:103]
MF a[104:107],a[64:67],v[128:131],a[104:107]
s_add_u32 m0,s49,77824
s_nop 0
buffer_load_dwordx4 v255,s[8:11],s20 offen sc1 lds
MF a[108:111],a[68:71],v[128:131],a[108:111]
MF a[112:115],a[72:75],v[128:131],a[112:115]
s_add_u32 m0,s49,81920
s_add_u32 s20,s48,81920
buffer_load_dwordx4 v1,s[8:11],s20 offen sc1 lds
MF a[116:119],a[76:79],v[128:131],a[116:119]
s_waitcnt vmcnt(26)
MF a[120:123],a[60:63],v[132:135],a[120:123]
s_add_u32 m0,s49,86016
s_nop 0
buffer_load_dwordx4 v253,s[8:11],s20 offen sc1 lds
MF a[124:127],a[64:67],v[132:135],a[124:127]
MF a[128:131],a[68:71],v[132:135],a[128:131]
s_add_u32 m0,s49,90112
s_nop 0
buffer_load_dwordx4 v254,s[8:11],s20 offen sc1 lds
MF a[132:135],a[72:75],v[132:135],a[132:135]
MF a[136:139],a[76:79],v[132:135],a[136:139]
s_add_u32 m0,s49,94208
s_nop 0
buffer_load_dwordx4 v255,s[8:11],s20 offen sc1 lds
s_waitcnt vmcnt(28)
MF a[140:143],a[60:63],v[136:139],a[140:143]
MF a[144:147],a[64:67],v[136:139],a[144:147]
MF a[148:151],a[68:71],v[136:139],a[148:151]
MF a[152:155],a[72:75],v[136:139],a[152:155]
MF a[156:159],a[76:79],v[136:139],a[156:159]
s_waitcnt vmcnt(26)
MF a[100:103],a[80:83],v[164:167],a[100:103]
MF a[104:107],a[84:87],v[164:167],a[104:107]
MF a[108:111],a[88:91],v[164:167],a[108:111]
MF a[112:115],a[92:95],v[164:167],a[112:115]
MF a[116:119],a[96:99],v[164:167],a[116:119]
s_waitcnt vmcnt(25)
MF a[120:123],a[80:83],v[168:171],a[120:123]
MF a[124:127],a[84:87],v[168:171],a[124:127]
MF a[128:131],a[88:91],v[168:171],a[128:131]
ds_write_b128 v241,a[100:103] offset:0
MF a[132:135],a[92:95],v[168:171],a[132:135]
ds_write_b128 v241,a[104:107] offset:1024
MF a[136:139],a[96:99],v[168:171],a[136:139]
ds_write_b128 v241,a[108:111] offset:2048
s_waitcnt vmcnt(24)
MF a[140:143],a[80:83],v[172:175],a[140:143]
ds_write_b128 v241,a[112:115] offset:3072
MF a[144:147],a[84:87],v[172:175],a[144:147]
ds_write_b128 v241,a[116:119] offset:4096
MF a[148:151],a[88:91],v[172:175],a[148:151]
ds_write_b128 v242,a[120:123] offset:0
MF a[152:155],a[92:95],v[172:175],a[152:155]
ds_write_b128 v242,a[124:127] offset:1024
MF a[156:159],a[96:99],v[172:175],a[156:159]
ds_write_b128 v242,a[128:131] offset:2048
MF v[216:219],a[80:83],v[160:163],v[216:219]
ds_write_b128 v242,a[132:135] offset:3072
MF v[220:223],a[84:87],v[160:163],v[220:223]
ds_write_b128 v242,a[136:139] offset:4096
MF v[224:227],a[88:91],v[160:163],v[224:227]
ds_write_b128 v243,a[140:143] offset:0
MF v[228:231],a[92:95],v[160:163],v[228:231]
ds_write_b128 v243,a[144:147] offset:1024
MF v[232:235],a[96:99],v[160:163],v[232:235]
ds_write_b128 v243,a[148:151] offset:2048
ds_write_b128 v243,a[152:155] offset:3072
ds_write_b128 v243,a[156:159] offset:4096
s_waitcnt lgkmcnt(0)
s_barrier
ds_read_b128 v[16:19],v240 offset:0
ds_read_b128 v[20:23],v240 offset:5120
ds_read_b128 v[24:27],v240 offset:10240
ds_read_b128 v[28:31],v240 offset:1024
ds_read_b128 v[32:35],v240 offset:6144
ds_read_b128 v[36:39],v240 offset:11264
ds_read_b128 v[40:43],v240 offset:2048
ds_read_b128 v[44:47],v240 offset:7168
ds_read_b128 v[48:51],v240 offset:12288
ds_read_b128 v[52:55],v240 offset:3072
ds_read_b128 v[56:59],v240 offset:8192
ds_read_b128 v[60:63],v240 offset:13312
ds_read_b128 v[64:67],v240 offset:4096
ds_read_b128 v[68:71],v240 offset:9216
ds_read_b128 v[72:75],v240 offset:14336
s_waitcnt lgkmcnt(12)
v_pk_add_f32 v[16:17],v[16:17],v[20:21]
v_pk_add_f32 v[216:217],v[216:217],v[24:25]
v_pk_add_f32 v[18:19],v[18:19],v[22:23]
v_pk_add_f32 v[218:219],v[218:219],v[26:27]
v_pk_add_f32 v[216:217],v[216:217],v[16:17]
v_pk_add_f32 v[218:219],v[218:219],v[18:19]
v_cvt_pk_bf16_f32 v16,v216,v217
v_cvt_pk_bf16_f32 v17,v218,v219
buffer_store_dwordx2 v[16:17],v5,s[8:11],s57 offen sc1
v_pk_add_f32 v[244:245],v[244:245],v[216:217]
v_pk_fma_f32 v[246:247],v[216:217],v[216:217],v[246:247]
v_pk_add_f32 v[244:245],v[244:245],v[218:219]
v_pk_fma_f32 v[246:247],v[218:219],v[218:219],v[246:247]
s_waitcnt lgkmcnt(9)
v_pk_add_f32 v[28:29],v[28:29],v[32:33]
v_pk_add_f32 v[220:221],v[220:221],v[36:37]
v_pk_add_f32 v[30:31],v[30:31],v[34:35]
v_pk_add_f32 v[222:223],v[222:223],v[38:39]
v_pk_add_f32 v[220:221],v[220:221],v[28:29]
v_pk_add_f32 v[222:223],v[222:223],v[30:31]
v_cvt_pk_bf16_f32 v28,v220,v221
v_cvt_pk_bf16_f32 v29,v222,v223
buffer_store_dwordx2 v[28:29],v6,s[8:11],s57 offen sc1
v_pk_add_f32 v[244:245],v[244:245],v[220:221]
v_pk_fma_f32 v[246:247],v[220:221],v[220:221],v[246:247]
v_pk_add_f32 v[244:245],v[244:245],v[222:223]
v_pk_fma_f32 v[246:247],v[222:223],v[222:223],v[246:247]
s_waitcnt lgkmcnt(6)
v_pk_add_f32 v[40:41],v[40:41],v[44:45]
v_pk_add_f32 v[224:225],v[224:225],v[48:49]
v_pk_add_f32 v[42:43],v[42:43],v[46:47]
v_pk_add_f32 v[226:227],v[226:227],v[50:51]
v_pk_add_f32 v[224:225],v[224:225],v[40:41]
v_pk_add_f32 v[226:227],v[226:227],v[42:43]
v_cvt_pk_bf16_f32 v40,v224,v225
v_cvt_pk_bf16_f32 v41,v226,v227
buffer_store_dwordx2 v[40:41],v7,s[8:11],s57 offen sc1
v_pk_add_f32 v[244:245],v[244:245],v[224:225]
v_pk_fma_f32 v[246:247],v[224:225],v[224:225],v[246:247]
v_pk_add_f32 v[244:245],v[244:245],v[226:227]
v_pk_fma_f32 v[246:247],v[226:227],v[226:227],v[246:247]
s_waitcnt lgkmcnt(3)
v_pk_add_f32 v[52:53],v[52:53],v[56:57]
v_pk_add_f32 v[228:229],v[228:229],v[60:61]
v_pk_add_f32 v[54:55],v[54:55],v[58:59]
v_pk_add_f32 v[230:231],v[230:231],v[62:63]
v_pk_add_f32 v[228:229],v[228:229],v[52:53]
v_pk_add_f32 v[230:231],v[230:231],v[54:55]
v_cvt_pk_bf16_f32 v52,v228,v229
v_cvt_pk_bf16_f32 v53,v230,v231
buffer_store_dwordx2 v[52:53],v8,s[8:11],s57 offen sc1
v_pk_add_f32 v[244:245],v[244:245],v[228:229]
v_pk_fma_f32 v[246:247],v[228:229],v[228:229],v[246:247]
v_pk_add_f32 v[244:245],v[244:245],v[230:231]
v_pk_fma_f32 v[246:247],v[230:231],v[230:231],v[246:247]
s_waitcnt lgkmcnt(0)
s_mov_b32 exec_lo,0xffffffff
s_mov_b32 exec_hi,0x0
v_pk_add_f32 v[64:65],v[64:65],v[68:69]
v_pk_add_f32 v[232:233],v[232:233],v[72:73]
v_pk_add_f32 v[66:67],v[66:67],v[70:71]
v_pk_add_f32 v[234:235],v[234:235],v[74:75]
v_pk_add_f32 v[232:233],v[232:233],v[64:65]
v_pk_add_f32 v[234:235],v[234:235],v[66:67]
v_cvt_pk_bf16_f32 v64,v232,v233
v_cvt_pk_bf16_f32 v65,v234,v235
buffer_store_dwordx2 v[64:65],v9,s[8:11],s57 offen sc1
v_pk_add_f32 v[244:245],v[244:245],v[232:233]
v_pk_fma_f32 v[246:247],v[232:233],v[232:233],v[246:247]
v_pk_add_f32 v[244:245],v[244:245],v[234:235]
v_pk_fma_f32 v[246:247],v[234:235],v[234:235],v[246:247]
s_mov_b64 exec,-1
v_add_f32 v12,v244,v245
v_add_f32 v13,v246,v247
v_mov_b32 v10,v12
v_mov_b32 v11,v13
s_nop 0
v_permlane32_swap_b32 v12,v10
v_permlane32_swap_b32 v13,v11
v_add_f32 v12,v12,v10
v_add_f32 v13,v13,v11
v_mov_b32 v10,v12
v_mov_b32 v11,v13
s_nop 0
v_permlane16_swap_b32 v12,v10
v_permlane16_swap_b32 v13,v11
v_add_f32 v12,v12,v10
v_add_f32 v13,v13,v11
s_mov_b64 exec,0xffff
buffer_store_dwordx2 v[12:13],v248,s[8:11],s29 offen sc1
s_mov_b64 exec,-1
s_barrier
s_mov_b64 exec,-1
s_and_b32 s46,s44,1
s_lshl_b32 s46,s46,3
s_add_u32 s46,s46,s45
s_lshl_b32 s78,s51,11
s_lshl_b32 s47,s46,4
s_add_u32 s78,s78,s47
s_lshl_b32 s47,s22,2
s_add_u32 s78,s78,s47
s_add_u32 s78,s78,0x1340000
s_mov_b64 exec,-1
PH_k3_1:
s_and_b32 s44,s3,1
s_lshl_b32 s44,s44,3
s_and_b32 s45,s23,7
s_add_u32 s44,s44,s45
s_lshr_b32 s45,s3,1
s_lshl_b32 s45,s45,2
s_lshr_b32 s46,s23,3
s_add_u32 s45,s45,s46
v_add_u32 v2,65536,v1
v_add_u32 v3,131072,v1
s_lshl_b32 s46,s44,3
s_lshl_b32 s47,s22,1
s_add_u32 s46,s46,s47
s_mul_i32 s24,s46,18432
s_add_u32 s24,s24,0x1b80000
s_add_u32 s27,s24,18432
s_add_u32 s29,s24,16384
s_add_u32 s21,s27,16384
s_lshl_b32 s79,s44,11
s_add_u32 s79,s79,0x1340000
v_mov_b32 v13,1
v_mov_b32 v12,0
s_waitcnt vmcnt(0)
s_mov_b32 exec_lo,0x1
s_mov_b32 exec_hi,0x0
buffer_atomic_or v13,v12,s[8:11],s78 offen sc1
s_mov_b64 exec,-1
v_lshlrev_b32 v198,2,v0
s_cmp_eq_u32 s22,0
s_cselect_b32 s79,s79,0x40000000
v_mov_b32 v199,0
buffer_atomic_or v199,v198,s[8:11],s79 offen sc0 sc1
s_add_u32 m0,s49,98304
s_add_u32 s20,s48,98304
buffer_load_dwordx4 v1,s[8:11],s20 offen sc1 lds
s_add_u32 m0,s49,102400
s_nop 0
buffer_load_dwordx4 v253,s[8:11],s20 offen sc1 lds
s_add_u32 m0,s49,106496
s_nop 0
buffer_load_dwordx4 v254,s[8:11],s20 offen sc1 lds
s_add_u32 m0,s49,110592
s_nop 0
buffer_load_dwordx4 v255,s[8:11],s20 offen sc1 lds
s_add_u32 m0,s49,114688
s_add_u32 s20,s48,114688
buffer_load_dwordx4 v1,s[8:11],s20 offen sc1 lds
s_add_u32 m0,s49,118784
s_nop 0
buffer_load_dwordx4 v253,s[8:11],s20 offen sc1 lds
s_mul_i32 s31,s45,1152
s_add_u32 s31,s31,0x860000
s_lshl_b32 s46,s22,9
v_lshlrev_b32 v12,3,v0
v_add_u32 v201,s46,v12
v_min_u32 v201,1144,v201
buffer_load_dwordx2 v[192:193],v201,s[8:11],s31 offen sc1
s_add_u32 s31,s31,18432
buffer_load_dwordx2 v[194:195],v201,s[8:11],s31 offen sc1
v_mov_b32 v248,0xbdd2d3e8
v_mov_b32 v249,0xc0135761
v_mov_b32 v250,1.0
v_mov_b32 v224,0
v_mov_b32 v225,0
v_mov_b32 v226,0
v_mov_b32 v227,0
v_mov_b32 v228,0
v_mov_b32 v229,0
v_mov_b32 v230,0
v_mov_b32 v231,0
v_mov_b32 v232,0
v_mov_b32 v233,0
v_mov_b32 v234,0
v_mov_b32 v235,0
v_mov_b32 v236,0
v_mov_b32 v237,0
v_mov_b32 v238,0
v_mov_b32 v239,0
s_lshl_b32 s50,s44,2
s_add_u32 s50,s50,s22
s_lshl_b32 s51,s50,12
s_add_u32 s51,s51,0x4300000
s_lshl_b32 s52,s45,8
s_add_u32 s52,s52,s51
s_lshl_b32 s30,s22,8
s_add_u32 s30,s30,159744
v_lshlrev_b32 v252,4,v15
v_add_u32 v252,s30,v252
v_lshrrev_b32 v4,1,v15
v_lshl_add_u32 v4,v4,4,v14
v_lshlrev_b32 v4,4,v4
v_and_b32 v5,1,v15
v_lshl_add_u32 v222,v5,3,v4
v_and_b32 v4,1,v0
v_lshlrev_b32 v4,7,v4
v_lshrrev_b32 v6,1,v0
v_lshl_add_u32 v4,v6,2,v4
v_add_u32 v223,s30,v4
s_lshl_b32 s46,s45,6
s_add_u32 s46,s46,s50
s_mul_i32 s46,s46,9216
s_add_u32 s34,s46,0x4400000
s_add_u32 s35,s34,4096
s_add_u32 s36,s34,8192
s_getpc_b64 s[58:59]
PC_mega_kernel_15:
s_mul_i32 s46,s23,4
s_add_u32 s46,s46,s22
s_lshl_b32 s46,s46,10
v_add_u32 v13,s46,v1
v_add_u32 v13,PH_k4_1-PC_mega_kernel_15,v13
v_min_u32 v13,PH_k5_1-PC_mega_kernel_15-16,v13
v_and_b32 v13,-4,v13
global_load_dwordx4 a[252:255],v13,s[58:59]
s_waitcnt vmcnt(9)
v_cmp_eq_u32 vcc,0,v199
s_cbranch_vccz DW_mega_kernel_16G
s_mov_b32 s53,0
s_cmp_lg_u32 s22,0
s_cbranch_scc1 DW_mega_kernel_16G
DW_mega_kernel_16:
s_nop 7
s_nop 3
v_mov_b32 v199,0
buffer_atomic_or v199,v198,s[8:11],s79 offen sc0 sc1
s_add_u32 s53,s53,1
s_waitcnt vmcnt(0)
v_cmp_eq_u32 vcc,0,v199
s_cbranch_vccz DW_mega_kernel_16G
s_cmp_lt_u32 s53,100000
s_cbranch_scc1 DW_mega_kernel_16
DW_mega_kernel_16G:
s_nop 7
s_nop 3
s_barrier
s_lshl_b32 s78,s45,11
s_lshl_b32 s47,s44,4
s_add_u32 s78,s78,s47
s_lshl_b32 s47,s22,2
s_add_u32 s78,s78,s47
s_add_u32 s78,s78,0x1348000
v_and_b32 v12,31,v0
v_lshlrev_b32 v12,3,v12
v_lshrrev_b32 v13,5,v0
v_lshl_add_u32 v12,v13,16,v12
s_lshl_b32 s46,s44,10
s_lshl_b32 s47,s22,8
s_add_u32 s46,s46,s47
s_add_u32 s46,s46,0x1e60000
buffer_load_dwordx2 v[4:5],v12,s[8:11],s46 offen sc1
s_add_u32 s46,s46,16384
buffer_load_dwordx2 v[6:7],v12,s[8:11],s46 offen sc1
s_add_u32 s46,s46,16384
buffer_load_dwordx2 v[8:9],v12,s[8:11],s46 offen sc1
s_add_u32 s46,s46,16384
buffer_load_dwordx2 v[10:11],v12,s[8:11],s46 offen sc1
buffer_load_dwordx4 a[0:3],v1,s[8:11],s24 offen offset:0 sc1
buffer_load_dwordx4 a[4:7],v1,s[8:11],s27 offen offset:0 sc1
buffer_load_dwordx4 a[8:11],v1,s[8:11],s24 offen offset:1024 sc1
buffer_load_dwordx4 a[12:15],v1,s[8:11],s27 offen offset:1024 sc1
buffer_load_dwordx4 a[16:19],v1,s[8:11],s24 offen offset:2048 sc1
buffer_load_dwordx4 a[20:23],v1,s[8:11],s27 offen offset:2048 sc1
buffer_load_dwordx4 a[24:27],v1,s[8:11],s24 offen offset:3072 sc1
buffer_load_dwordx4 a[28:31],v1,s[8:11],s27 offen offset:3072 sc1
s_waitcnt lgkmcnt(0)
s_barrier
ds_read_b128 v[16:19],v1 offset:0
ds_read_b128 v[20:23],v1 offset:1024
ds_read_b128 v[24:27],v1 offset:2048
ds_read_b128 v[28:31],v1 offset:3072
ds_read_b128 v[32:35],v1 offset:4096
ds_read_b128 v[36:39],v1 offset:5120
ds_read_b128 v[40:43],v1 offset:6144
s_waitcnt vmcnt(6)
s_waitcnt lgkmcnt(5)
MF v[48:51],a[0:3],v[16:19],0
buffer_load_dwordx4 a[32:35],v253,s[8:11],s24 offen offset:0 sc1
MF v[84:87],a[4:7],v[16:19],0
ds_read_b128 v[44:47],v1 offset:7168
MF v[52:55],a[0:3],v[20:23],0
MF v[88:91],a[4:7],v[20:23],0
ds_read_b128 v[16:19],v1 offset:8192
s_waitcnt lgkmcnt(5)
MF v[56:59],a[0:3],v[24:27],0
MF v[92:95],a[4:7],v[24:27],0
ds_read_b128 v[20:23],v1 offset:9216
MF v[60:63],a[0:3],v[28:31],0
buffer_load_dwordx4 a[36:39],v253,s[8:11],s27 offen offset:0 sc1
MF v[96:99],a[4:7],v[28:31],0
ds_read_b128 v[24:27],v1 offset:10240
s_waitcnt lgkmcnt(5)
MF v[64:67],a[0:3],v[32:35],0
MF v[100:103],a[4:7],v[32:35],0
ds_read_b128 v[28:31],v1 offset:11264
v_add_f32 v192,v192,v194
v_add_f32 v193,v193,v195
v_add_u32 v201,160768,v201
ds_write_b64 v201,v[192:193]
MF v[68:71],a[0:3],v[36:39],0
MF v[104:107],a[4:7],v[36:39],0
s_barrier
ds_read_b128 v[32:35],v1 offset:12288
s_waitcnt lgkmcnt(6)
MF v[72:75],a[0:3],v[40:43],0
buffer_load_dwordx4 a[40:43],v253,s[8:11],s24 offen offset:1024 sc1
MF v[108:111],a[4:7],v[40:43],0
ds_read_b128 v[36:39],v1 offset:13312
MF v[76:79],a[0:3],v[44:47],0
MF v[112:115],a[4:7],v[44:47],0
ds_read_b128 v[40:43],v1 offset:14336
s_waitcnt lgkmcnt(6)
MF v[80:83],a[0:3],v[16:19],0
MF v[116:119],a[4:7],v[16:19],0
ds_read_b128 v[44:47],v1 offset:15360
s_waitcnt vmcnt(7)
MF v[48:51],a[8:11],v[20:23],v[48:51]
buffer_load_dwordx4 a[44:47],v253,s[8:11],s27 offen offset:1024 sc1
MF v[84:87],a[12:15],v[20:23],v[84:87]
ds_read_b128 v[16:19],v1 offset:16384
s_waitcnt lgkmcnt(6)
MF v[52:55],a[8:11],v[24:27],v[52:55]
MF v[88:91],a[12:15],v[24:27],v[88:91]
ds_read_b128 v[20:23],v1 offset:17408
MF v[56:59],a[8:11],v[28:31],v[56:59]
MF v[92:95],a[12:15],v[28:31],v[92:95]
ds_read_b128 v[24:27],v1 offset:18432
s_waitcnt lgkmcnt(5)
MF v[60:63],a[8:11],v[32:35],v[60:63]
buffer_load_dwordx4 a[48:51],v253,s[8:11],s24 offen offset:2048 sc1
MF v[96:99],a[12:15],v[32:35],v[96:99]
ds_read_b128 v[28:31],v1 offset:19456
MF v[64:67],a[8:11],v[36:39],v[64:67]
MF v[100:103],a[12:15],v[36:39],v[100:103]
ds_read_b128 v[32:35],v1 offset:20480
s_waitcnt lgkmcnt(5)
MF v[68:71],a[8:11],v[40:43],v[68:71]
MF v[104:107],a[12:15],v[40:43],v[104:107]
ds_read_b128 v[36:39],v1 offset:21504
MF v[72:75],a[8:11],v[44:47],v[72:75]
buffer_load_dwordx4 a[52:55],v253,s[8:11],s27 offen offset:2048 sc1
MF v[108:111],a[12:15],v[44:47],v[108:111]
ds_read_b128 v[40:43],v1 offset:22528
s_waitcnt lgkmcnt(5)
MF v[76:79],a[8:11],v[16:19],v[76:79]
MF v[112:115],a[12:15],v[16:19],v[112:115]
ds_read_b128 v[44:47],v1 offset:23552
MF v[80:83],a[8:11],v[20:23],v[80:83]
MF v[116:119],a[12:15],v[20:23],v[116:119]
ds_read_b128 v[16:19],v1 offset:24576
s_waitcnt vmcnt(8)
s_waitcnt lgkmcnt(5)
MF v[48:51],a[16:19],v[24:27],v[48:51]
buffer_load_dwordx4 a[56:59],v253,s[8:11],s24 offen offset:3072 sc1
MF v[84:87],a[20:23],v[24:27],v[84:87]
ds_read_b128 v[20:23],v1 offset:25600
MF v[52:55],a[16:19],v[28:31],v[52:55]
MF v[88:91],a[20:23],v[28:31],v[88:91]
ds_read_b128 v[24:27],v1 offset:26624
s_waitcnt lgkmcnt(5)
MF v[56:59],a[16:19],v[32:35],v[56:59]
MF v[92:95],a[20:23],v[32:35],v[92:95]
ds_read_b128 v[28:31],v1 offset:27648
MF v[60:63],a[16:19],v[36:39],v[60:63]
buffer_load_dwordx4 a[60:63],v253,s[8:11],s27 offen offset:3072 sc1
MF v[96:99],a[20:23],v[36:39],v[96:99]
ds_read_b128 v[32:35],v1 offset:28672
s_waitcnt lgkmcnt(5)
MF v[64:67],a[16:19],v[40:43],v[64:67]
MF v[100:103],a[20:23],v[40:43],v[100:103]
ds_read_b128 v[36:39],v1 offset:29696
MF v[68:71],a[16:19],v[44:47],v[68:71]
MF v[104:107],a[20:23],v[44:47],v[104:107]
ds_read_b128 v[40:43],v1 offset:30720
s_waitcnt lgkmcnt(5)
MF v[72:75],a[16:19],v[16:19],v[72:75]
buffer_load_dwordx4 a[64:67],v254,s[8:11],s24 offen offset:0 sc1
MF v[108:111],a[20:23],v[16:19],v[108:111]
ds_read_b128 v[44:47],v1 offset:31744
MF v[76:79],a[16:19],v[20:23],v[76:79]
MF v[112:115],a[20:23],v[20:23],v[112:115]
ds_read_b128 v[16:19],v1 offset:32768
s_waitcnt lgkmcnt(5)
MF v[80:83],a[16:19],v[24:27],v[80:83]
MF v[116:119],a[20:23],v[24:27],v[116:119]
ds_read_b128 v[20:23],v1 offset:33792
s_waitcnt vmcnt(9)
MF v[48:51],a[24:27],v[28:31],v[48:51]
buffer_load_dwordx4 a[68:71],v254,s[8:11],s27 offen offset:0 sc1
MF v[84:87],a[28:31],v[28:31],v[84:87]
ds_read_b128 v[24:27],v1 offset:34816
s_waitcnt lgkmcnt(5)
MF v[52:55],a[24:27],v[32:35],v[52:55]
MF v[88:91],a[28:31],v[32:35],v[88:91]
ds_read_b128 v[28:31],v1 offset:35840
MF v[56:59],a[24:27],v[36:39],v[56:59]
MF v[92:95],a[28:31],v[36:39],v[92:95]
s_barrier
ds_read_b128 v[32:35],v1 offset:36864
s_waitcnt lgkmcnt(5)
MF v[60:63],a[24:27],v[40:43],v[60:63]
buffer_load_dwordx4 a[72:75],v254,s[8:11],s24 offen offset:1024 sc1
MF v[96:99],a[28:31],v[40:43],v[96:99]
ds_read_b128 v[36:39],v1 offset:37888
MF v[64:67],a[24:27],v[44:47],v[64:67]
MF v[100:103],a[28:31],v[44:47],v[100:103]
ds_read_b128 v[40:43],v1 offset:38912
s_waitcnt lgkmcnt(5)
MF v[68:71],a[24:27],v[16:19],v[68:71]
MF v[104:107],a[28:31],v[16:19],v[104:107]
ds_read_b128 v[44:47],v1 offset:39936
MF v[72:75],a[24:27],v[20:23],v[72:75]
buffer_load_dwordx4 a[76:79],v254,s[8:11],s27 offen offset:1024 sc1
MF v[108:111],a[28:31],v[20:23],v[108:111]
ds_read_b128 v[16:19],v1 offset:40960
s_waitcnt lgkmcnt(5)
MF v[76:79],a[24:27],v[24:27],v[76:79]
MF v[112:115],a[28:31],v[24:27],v[112:115]
ds_read_b128 v[20:23],v1 offset:41984
MF v[80:83],a[24:27],v[28:31],v[80:83]
MF v[116:119],a[28:31],v[28:31],v[116:119]
ds_read_b128 v[24:27],v1 offset:43008
s_waitcnt vmcnt(10)
s_waitcnt lgkmcnt(5)
MF v[48:51],a[32:35],v[32:35],v[48:51]
buffer_load_dwordx4 a[80:83],v254,s[8:11],s24 offen offset:2048 sc1
MF v[84:87],a[36:39],v[32:35],v[84:87]
ds_read_b128 v[28:31],v1 offset:44032
MF v[52:55],a[32:35],v[36:39],v[52:55]
MF v[88:91],a[36:39],v[36:39],v[88:91]
ds_read_b128 v[32:35],v1 offset:45056
s_waitcnt lgkmcnt(5)
MF v[56:59],a[32:35],v[40:43],v[56:59]
v_add_f32 v4,v4,v6
v_add_f32 v8,v8,v10
v_add_f32 v4,v4,v8
v_add_f32 v5,v5,v7
v_add_f32 v9,v9,v11
v_add_f32 v5,v5,v9
v_mov_b32 v6,v4
s_nop 1
v_permlane32_swap_b32 v4,v6
v_add_f32 v4,v4,v6
v_mov_b32 v6,v5
s_nop 1
v_permlane32_swap_b32 v5,v6
v_add_f32 v5,v5,v6
v_mul_f32 v4,0xbae38e39,v4
v_mul_f32 v5,0x3ae38e39,v5
v_mul_f32 v6,v4,v4
v_sub_f32 v5,v5,v6
v_max_f32 v5,0,v5
v_add_f32 v5,0x3727c5ac,v5
v_rsq_f32 v5,v5
v_cmp_gt_u32 vcc,32,v0
s_nop 1
v_cndmask_b32 v4,v5,v4,vcc
s_lshl_b32 s30,s22,8
s_add_u32 s30,s30,159744
v_lshlrev_b32 v6,2,v0
v_add_u32 v6,s30,v6
ds_write_b32 v6,v4
MF v[92:95],a[36:39],v[40:43],v[92:95]
ds_read_b128 v[36:39],v1 offset:46080
v_lshlrev_b32 v13,2,v14
v_add_u32 v13,s30,v13
MF v[60:63],a[32:35],v[44:47],v[60:63]
buffer_load_dwordx4 a[84:87],v254,s[8:11],s27 offen offset:2048 sc1
ds_read_b128 v[202:205],v252 offset:0
MF v[96:99],a[36:39],v[44:47],v[96:99]
ds_read_b128 v[40:43],v1 offset:47104
s_waitcnt lgkmcnt(7)
MF v[64:67],a[32:35],v[16:19],v[64:67]
ds_read_b128 v[210:213],v252 offset:128
ds_read_b32 v218,v13 offset:0
MF v[100:103],a[36:39],v[16:19],v[100:103]
ds_read_b128 v[44:47],v1 offset:48128
ds_read_b32 v220,v13 offset:128
MF v[68:71],a[32:35],v[20:23],v[68:71]
ds_read_b128 v[206:209],v252 offset:64
ds_read_b128 v[214:217],v252 offset:192
MF v[104:107],a[36:39],v[20:23],v[104:107]
ds_read_b128 v[16:19],v1 offset:49152
s_waitcnt lgkmcnt(12)
MF v[72:75],a[32:35],v[24:27],v[72:75]
buffer_load_dwordx4 a[88:91],v254,s[8:11],s24 offen offset:3072 sc1
ds_read_b32 v219,v13 offset:64
MF v[108:111],a[36:39],v[24:27],v[108:111]
ds_read_b128 v[20:23],v1 offset:50176
ds_read_b32 v221,v13 offset:192
MF v[76:79],a[32:35],v[28:31],v[76:79]
v_lshlrev_b32 v13,2,v14
v_add_u32 v13,160768,v13
MF v[112:115],a[36:39],v[28:31],v[112:115]
s_waitcnt lgkmcnt(12)
ds_read_b128 v[24:27],v1 offset:51200
MF v[80:83],a[32:35],v[32:35],v[80:83]
ds_read_b32 v192,v13 offset:0
ds_read_b32 v193,v13 offset:64
MF v[116:119],a[36:39],v[32:35],v[116:119]
s_waitcnt lgkmcnt(12)
ds_read_b128 v[28:31],v1 offset:52224
s_waitcnt vmcnt(11)
MF v[48:51],a[40:43],v[36:39],v[48:51]
buffer_load_dwordx4 a[92:95],v254,s[8:11],s27 offen offset:3072 sc1
ds_read_b32 v194,v13 offset:128
MF v[84:87],a[44:47],v[36:39],v[84:87]
ds_read_b128 v[32:35],v1 offset:53248
s_waitcnt lgkmcnt(13)
MF v[52:55],a[40:43],v[40:43],v[52:55]
ds_read_b32 v195,v13 offset:192
ds_read_b32 v196,v13 offset:256
MF v[88:91],a[44:47],v[40:43],v[88:91]
s_waitcnt lgkmcnt(12)
ds_read_b128 v[36:39],v1 offset:54272
MF v[56:59],a[40:43],v[44:47],v[56:59]
ds_read_b32 v197,v13 offset:320
ds_read_b32 v198,v13 offset:384
MF v[92:95],a[44:47],v[44:47],v[92:95]
s_waitcnt lgkmcnt(12)
ds_read_b128 v[40:43],v1 offset:55296
s_add_u32 m0,s49,122880
MF v[60:63],a[40:43],v[16:19],v[60:63]
buffer_load_dwordx4 v254,s[8:11],s20 offen sc1 lds
ds_read_b32 v199,v13 offset:448
MF v[96:99],a[44:47],v[16:19],v[96:99]
ds_read_b128 v[44:47],v1 offset:56320
s_waitcnt lgkmcnt(12)
ds_read_b32 v200,v13 offset:512
MF v[64:67],a[40:43],v[20:23],v[64:67]
MF v[100:103],a[44:47],v[20:23],v[100:103]
ds_read_b128 v[16:19],v1 offset:57344
s_waitcnt lgkmcnt(12)
MF v[68:71],a[40:43],v[24:27],v[68:71]
MF v[104:107],a[44:47],v[24:27],v[104:107]
ds_read_b128 v[20:23],v1 offset:58368
s_add_u32 m0,s49,126976
MF v[72:75],a[40:43],v[28:31],v[72:75]
buffer_load_dwordx4 v255,s[8:11],s20 offen sc1 lds
MF v[108:111],a[44:47],v[28:31],v[108:111]
ds_read_b128 v[24:27],v1 offset:59392
s_waitcnt lgkmcnt(9)
MF v[76:79],a[40:43],v[32:35],v[76:79]
MF v[112:115],a[44:47],v[32:35],v[112:115]
ds_read_b128 v[28:31],v1 offset:60416
MF v[80:83],a[40:43],v[36:39],v[80:83]
MF v[116:119],a[44:47],v[36:39],v[116:119]
ds_read_b128 v[32:35],v1 offset:61440
s_waitcnt vmcnt(12)
s_waitcnt lgkmcnt(6)
s_add_u32 m0,s49,131072
s_add_u32 s20,s48,131072
MF v[48:51],a[48:51],v[40:43],v[48:51]
buffer_load_dwordx4 v1,s[8:11],s20 offen sc1 lds
MF v[84:87],a[52:55],v[40:43],v[84:87]
ds_read_b128 v[36:39],v1 offset:62464
MF v[52:55],a[48:51],v[44:47],v[52:55]
MF v[88:91],a[52:55],v[44:47],v[88:91]
ds_read_b128 v[40:43],v1 offset:63488
s_waitcnt lgkmcnt(5)
MF v[56:59],a[48:51],v[16:19],v[56:59]
MF v[92:95],a[52:55],v[16:19],v[92:95]
ds_read_b128 v[44:47],v1 offset:64512
s_add_u32 m0,s49,135168
MF v[60:63],a[48:51],v[20:23],v[60:63]
buffer_load_dwordx4 v253,s[8:11],s20 offen sc1 lds
MF v[96:99],a[52:55],v[20:23],v[96:99]
ds_read_b128 v[16:19],v2 offset:0
s_waitcnt lgkmcnt(5)
MF v[64:67],a[48:51],v[24:27],v[64:67]
MF v[100:103],a[52:55],v[24:27],v[100:103]
ds_read_b128 v[20:23],v2 offset:1024
MF v[68:71],a[48:51],v[28:31],v[68:71]
MF v[104:107],a[52:55],v[28:31],v[104:107]
ds_read_b128 v[24:27],v2 offset:2048
s_waitcnt lgkmcnt(5)
s_add_u32 m0,s49,139264
MF v[72:75],a[48:51],v[32:35],v[72:75]
buffer_load_dwordx4 v254,s[8:11],s20 offen sc1 lds
MF v[108:111],a[52:55],v[32:35],v[108:111]
ds_read_b128 v[28:31],v2 offset:3072
MF v[76:79],a[48:51],v[36:39],v[76:79]
MF v[112:115],a[52:55],v[36:39],v[112:115]
ds_read_b128 v[32:35],v2 offset:4096
s_waitcnt lgkmcnt(5)
MF v[80:83],a[48:51],v[40:43],v[80:83]
MF v[116:119],a[52:55],v[40:43],v[116:119]
ds_read_b128 v[36:39],v2 offset:5120
s_waitcnt vmcnt(13)
s_add_u32 m0,s49,143360
MF v[48:51],a[56:59],v[44:47],v[48:51]
buffer_load_dwordx4 v255,s[8:11],s20 offen sc1 lds
MF v[84:87],a[60:63],v[44:47],v[84:87]
ds_read_b128 v[40:43],v2 offset:6144
s_waitcnt lgkmcnt(5)
MF v[52:55],a[56:59],v[16:19],v[52:55]
MF v[88:91],a[60:63],v[16:19],v[88:91]
ds_read_b128 v[44:47],v2 offset:7168
MF v[56:59],a[56:59],v[20:23],v[56:59]
MF v[92:95],a[60:63],v[20:23],v[92:95]
s_barrier
ds_read_b128 v[16:19],v2 offset:8192
s_waitcnt lgkmcnt(5)
MF v[60:63],a[56:59],v[24:27],v[60:63]
buffer_load_dwordx4 a[96:99],v255,s[8:11],s24 offen offset:0 sc1
MF v[96:99],a[60:63],v[24:27],v[96:99]
ds_read_b128 v[20:23],v2 offset:9216
MF v[64:67],a[56:59],v[28:31],v[64:67]
MF v[100:103],a[60:63],v[28:31],v[100:103]
ds_read_b128 v[24:27],v2 offset:10240
s_waitcnt lgkmcnt(5)
MF v[68:71],a[56:59],v[32:35],v[68:71]
MF v[104:107],a[60:63],v[32:35],v[104:107]
ds_read_b128 v[28:31],v2 offset:11264
MF v[72:75],a[56:59],v[36:39],v[72:75]
buffer_load_dwordx4 a[100:103],v255,s[8:11],s27 offen offset:0 sc1
MF v[108:111],a[60:63],v[36:39],v[108:111]
ds_read_b128 v[32:35],v2 offset:12288
s_waitcnt lgkmcnt(5)
MF v[76:79],a[56:59],v[40:43],v[76:79]
MF v[112:115],a[60:63],v[40:43],v[112:115]
ds_read_b128 v[36:39],v2 offset:13312
MF v[80:83],a[56:59],v[44:47],v[80:83]
MF v[116:119],a[60:63],v[44:47],v[116:119]
ds_read_b128 v[40:43],v2 offset:14336
s_waitcnt vmcnt(14)
s_waitcnt lgkmcnt(5)
MF v[48:51],a[64:67],v[16:19],v[48:51]
buffer_load_dwordx4 a[104:107],v255,s[8:11],s24 offen offset:1024 sc1
MF v[84:87],a[68:71],v[16:19],v[84:87]
ds_read_b128 v[44:47],v2 offset:15360
MF v[52:55],a[64:67],v[20:23],v[52:55]
MF v[88:91],a[68:71],v[20:23],v[88:91]
ds_read_b128 v[16:19],v2 offset:16384
s_waitcnt lgkmcnt(5)
MF v[56:59],a[64:67],v[24:27],v[56:59]
MF v[92:95],a[68:71],v[24:27],v[92:95]
ds_read_b128 v[20:23],v2 offset:17408
MF v[60:63],a[64:67],v[28:31],v[60:63]
buffer_load_dwordx4 a[108:111],v255,s[8:11],s27 offen offset:1024 sc1
MF v[96:99],a[68:71],v[28:31],v[96:99]
ds_read_b128 v[24:27],v2 offset:18432
s_waitcnt lgkmcnt(5)
MF v[64:67],a[64:67],v[32:35],v[64:67]
MF v[100:103],a[68:71],v[32:35],v[100:103]
ds_read_b128 v[28:31],v2 offset:19456
MF v[68:71],a[64:67],v[36:39],v[68:71]
MF v[104:107],a[68:71],v[36:39],v[104:107]
ds_read_b128 v[32:35],v2 offset:20480
s_waitcnt lgkmcnt(5)
MF v[72:75],a[64:67],v[40:43],v[72:75]
buffer_load_dwordx4 a[112:115],v255,s[8:11],s24 offen offset:2048 sc1
MF v[108:111],a[68:71],v[40:43],v[108:111]
ds_read_b128 v[36:39],v2 offset:21504
MF v[76:79],a[64:67],v[44:47],v[76:79]
MF v[112:115],a[68:71],v[44:47],v[112:115]
ds_read_b128 v[40:43],v2 offset:22528
s_waitcnt lgkmcnt(5)
MF v[80:83],a[64:67],v[16:19],v[80:83]
MF v[116:119],a[68:71],v[16:19],v[116:119]
ds_read_b128 v[44:47],v2 offset:23552
s_waitcnt vmcnt(15)
MF v[48:51],a[72:75],v[20:23],v[48:51]
buffer_load_dwordx4 a[116:119],v255,s[8:11],s27 offen offset:2048 sc1
MF v[84:87],a[76:79],v[20:23],v[84:87]
ds_read_b128 v[16:19],v2 offset:24576
s_waitcnt lgkmcnt(5)
MF v[52:55],a[72:75],v[24:27],v[52:55]
MF v[88:91],a[76:79],v[24:27],v[88:91]
ds_read_b128 v[20:23],v2 offset:25600
MF v[56:59],a[72:75],v[28:31],v[56:59]
MF v[92:95],a[76:79],v[28:31],v[92:95]
ds_read_b128 v[24:27],v2 offset:26624
s_waitcnt lgkmcnt(5)
MF v[60:63],a[72:75],v[32:35],v[60:63]
buffer_load_dwordx4 a[120:123],v255,s[8:11],s24 offen offset:3072 sc1
MF v[96:99],a[76:79],v[32:35],v[96:99]
ds_read_b128 v[28:31],v2 offset:27648
MF v[64:67],a[72:75],v[36:39],v[64:67]
MF v[100:103],a[76:79],v[36:39],v[100:103]
ds_read_b128 v[32:35],v2 offset:28672
s_waitcnt lgkmcnt(5)
MF v[68:71],a[72:75],v[40:43],v[68:71]
MF v[104:107],a[76:79],v[40:43],v[104:107]
ds_read_b128 v[36:39],v2 offset:29696
MF v[72:75],a[72:75],v[44:47],v[72:75]
buffer_load_dwordx4 a[124:127],v255,s[8:11],s27 offen offset:3072 sc1
MF v[108:111],a[76:79],v[44:47],v[108:111]
ds_read_b128 v[40:43],v2 offset:30720
s_waitcnt lgkmcnt(5)
MF v[76:79],a[72:75],v[16:19],v[76:79]
MF v[112:115],a[76:79],v[16:19],v[112:115]
ds_read_b128 v[44:47],v2 offset:31744
MF v[80:83],a[72:75],v[20:23],v[80:83]
MF v[116:119],a[76:79],v[20:23],v[116:119]
ds_read_b128 v[16:19],v2 offset:32768
s_waitcnt vmcnt(16)
s_waitcnt lgkmcnt(5)
s_add_u32 m0,s49,147456
s_add_u32 s20,s48,147456
MF v[48:51],a[80:83],v[24:27],v[48:51]
buffer_load_dwordx4 v1,s[8:11],s20 offen sc1 lds
MF v[84:87],a[84:87],v[24:27],v[84:87]
ds_read_b128 v[20:23],v2 offset:33792
MF v[52:55],a[80:83],v[28:31],v[52:55]
MF v[88:91],a[84:87],v[28:31],v[88:91]
ds_read_b128 v[24:27],v2 offset:34816
s_waitcnt lgkmcnt(5)
MF v[56:59],a[80:83],v[32:35],v[56:59]
MF v[92:95],a[84:87],v[32:35],v[92:95]
ds_read_b128 v[28:31],v2 offset:35840
s_add_u32 m0,s49,151552
MF v[60:63],a[80:83],v[36:39],v[60:63]
buffer_load_dwordx4 v253,s[8:11],s20 offen sc1 lds
MF v[96:99],a[84:87],v[36:39],v[96:99]
ds_read_b128 v[32:35],v2 offset:36864
s_waitcnt lgkmcnt(5)
MF v[64:67],a[80:83],v[40:43],v[64:67]
MF v[100:103],a[84:87],v[40:43],v[100:103]
ds_read_b128 v[36:39],v2 offset:37888
MF v[68:71],a[80:83],v[44:47],v[68:71]
MF v[104:107],a[84:87],v[44:47],v[104:107]
ds_read_b128 v[40:43],v2 offset:38912
s_waitcnt lgkmcnt(5)
s_add_u32 m0,s49,155648
MF v[72:75],a[80:83],v[16:19],v[72:75]
buffer_load_dwordx4 v254,s[8:11],s20 offen sc1 lds
MF v[108:111],a[84:87],v[16:19],v[108:111]
ds_read_b128 v[44:47],v2 offset:39936
MF v[76:79],a[80:83],v[20:23],v[76:79]
MF v[112:115],a[84:87],v[20:23],v[112:115]
ds_read_b128 v[16:19],v2 offset:40960
s_waitcnt lgkmcnt(5)
MF v[80:83],a[80:83],v[24:27],v[80:83]
MF v[116:119],a[84:87],v[24:27],v[116:119]
ds_read_b128 v[20:23],v2 offset:41984
s_waitcnt vmcnt(17)
s_add_u32 m0,s49,0
MF v[48:51],a[88:91],v[28:31],v[48:51]
buffer_load_dwordx4 v255,s[8:11],s20 offen sc1 lds
MF v[84:87],a[92:95],v[28:31],v[84:87]
ds_read_b128 v[24:27],v2 offset:43008
s_waitcnt lgkmcnt(5)
MF v[52:55],a[88:91],v[32:35],v[52:55]
MF v[88:91],a[92:95],v[32:35],v[88:91]
ds_read_b128 v[28:31],v2 offset:44032
MF v[56:59],a[88:91],v[36:39],v[56:59]
MF v[92:95],a[92:95],v[36:39],v[92:95]
s_waitcnt vmcnt(12)
s_barrier
ds_read_b128 v[32:35],v2 offset:45056
s_waitcnt lgkmcnt(5)
s_add_u32 m0,s49,4096
s_add_u32 s20,s48,163840
MF v[60:63],a[88:91],v[40:43],v[60:63]
buffer_load_dwordx4 v1,s[8:11],s20 offen sc1 lds
MF v[96:99],a[92:95],v[40:43],v[96:99]
ds_read_b128 v[36:39],v2 offset:46080
MF v[64:67],a[88:91],v[44:47],v[64:67]
MF v[100:103],a[92:95],v[44:47],v[100:103]
ds_read_b128 v[40:43],v2 offset:47104
s_waitcnt lgkmcnt(5)
MF v[68:71],a[88:91],v[16:19],v[68:71]
MF v[104:107],a[92:95],v[16:19],v[104:107]
ds_read_b128 v[44:47],v2 offset:48128
s_add_u32 m0,s49,8192
MF v[72:75],a[88:91],v[20:23],v[72:75]
buffer_load_dwordx4 v253,s[8:11],s20 offen sc1 lds
MF v[108:111],a[92:95],v[20:23],v[108:111]
ds_read_b128 v[16:19],v2 offset:49152
s_waitcnt lgkmcnt(5)
MF v[76:79],a[88:91],v[24:27],v[76:79]
MF v[112:115],a[92:95],v[24:27],v[112:115]
ds_read_b128 v[20:23],v2 offset:50176
MF v[80:83],a[88:91],v[28:31],v[80:83]
MF v[116:119],a[92:95],v[28:31],v[116:119]
ds_read_b128 v[24:27],v2 offset:51200
s_waitcnt vmcnt(12)
s_waitcnt lgkmcnt(5)
s_add_u32 m0,s49,12288
MF v[48:51],a[96:99],v[32:35],v[48:51]
buffer_load_dwordx4 v254,s[8:11],s20 offen sc1 lds
MF v[84:87],a[100:103],v[32:35],v[84:87]
ds_read_b128 v[28:31],v2 offset:52224
MF v[52:55],a[96:99],v[36:39],v[52:55]
MF v[88:91],a[100:103],v[36:39],v[88:91]
ds_read_b128 v[32:35],v2 offset:53248
s_waitcnt lgkmcnt(5)
MF v[56:59],a[96:99],v[40:43],v[56:59]
MF v[92:95],a[100:103],v[40:43],v[92:95]
ds_read_b128 v[36:39],v2 offset:54272
s_add_u32 m0,s49,16384
MF v[60:63],a[96:99],v[44:47],v[60:63]
buffer_load_dwordx4 v255,s[8:11],s20 offen sc1 lds
MF v[96:99],a[100:103],v[44:47],v[96:99]
ds_read_b128 v[40:43],v2 offset:55296
s_waitcnt lgkmcnt(5)
MF v[64:67],a[96:99],v[16:19],v[64:67]
MF v[100:103],a[100:103],v[16:19],v[100:103]
ds_read_b128 v[44:47],v2 offset:56320
MF v[68:71],a[96:99],v[20:23],v[68:71]
MF v[104:107],a[100:103],v[20:23],v[104:107]
ds_read_b128 v[16:19],v2 offset:57344
s_waitcnt lgkmcnt(5)
s_add_u32 m0,s49,20480
s_add_u32 s20,s48,180224
MF v[72:75],a[96:99],v[24:27],v[72:75]
buffer_load_dwordx4 v1,s[8:11],s20 offen sc1 lds
MF v[108:111],a[100:103],v[24:27],v[108:111]
ds_read_b128 v[20:23],v2 offset:58368
MF v[76:79],a[96:99],v[28:31],v[76:79]
MF v[112:115],a[100:103],v[28:31],v[112:115]
ds_read_b128 v[24:27],v2 offset:59392
s_waitcnt lgkmcnt(5)
MF v[80:83],a[96:99],v[32:35],v[80:83]
MF v[116:119],a[100:103],v[32:35],v[116:119]
ds_read_b128 v[28:31],v2 offset:60416
s_waitcnt vmcnt(13)
MF v[48:51],a[104:107],v[36:39],v[48:51]
buffer_load_dwordx4 a[128:131],v1,s[8:11],s29 offen offset:0 sc1
MF v[84:87],a[108:111],v[36:39],v[84:87]
ds_read_b128 v[32:35],v2 offset:61440
s_waitcnt lgkmcnt(5)
MF v[52:55],a[104:107],v[40:43],v[52:55]
MF v[88:91],a[108:111],v[40:43],v[88:91]
ds_read_b128 v[36:39],v2 offset:62464
MF v[56:59],a[104:107],v[44:47],v[56:59]
MF v[92:95],a[108:111],v[44:47],v[92:95]
ds_read_b128 v[40:43],v2 offset:63488
s_waitcnt lgkmcnt(5)
MF v[60:63],a[104:107],v[16:19],v[60:63]
buffer_load_dwordx4 a[132:135],v1,s[8:11],s21 offen offset:0 sc1
MF v[96:99],a[108:111],v[16:19],v[96:99]
ds_read_b128 v[44:47],v2 offset:64512
MF v[64:67],a[104:107],v[20:23],v[64:67]
MF v[100:103],a[108:111],v[20:23],v[100:103]
ds_read_b128 v[16:19],v3 offset:0
s_waitcnt lgkmcnt(5)
MF v[68:71],a[104:107],v[24:27],v[68:71]
MF v[104:107],a[108:111],v[24:27],v[104:107]
ds_read_b128 v[20:23],v3 offset:1024
MF v[72:75],a[104:107],v[28:31],v[72:75]
buffer_load_dwordx4 a[136:139],v1,s[8:11],s29 offen offset:1024 sc1
MF v[108:111],a[108:111],v[28:31],v[108:111]
ds_read_b128 v[24:27],v3 offset:2048
s_waitcnt lgkmcnt(5)
MF v[76:79],a[104:107],v[32:35],v[76:79]
MF v[112:115],a[108:111],v[32:35],v[112:115]
ds_read_b128 v[28:31],v3 offset:3072
MF v[80:83],a[104:107],v[36:39],v[80:83]
MF v[116:119],a[108:111],v[36:39],v[116:119]
ds_read_b128 v[32:35],v3 offset:4096
s_waitcnt vmcnt(14)
s_waitcnt lgkmcnt(5)
MF v[48:51],a[112:115],v[40:43],v[48:51]
buffer_load_dwordx4 a[140:143],v1,s[8:11],s21 offen offset:1024 sc1
MF v[84:87],a[116:119],v[40:43],v[84:87]
ds_read_b128 v[36:39],v3 offset:5120
MF v[52:55],a[112:115],v[44:47],v[52:55]
MF v[88:91],a[116:119],v[44:47],v[88:91]
ds_read_b128 v[40:43],v3 offset:6144
s_waitcnt lgkmcnt(5)
MF v[56:59],a[112:115],v[16:19],v[56:59]
MF v[92:95],a[116:119],v[16:19],v[92:95]
ds_read_b128 v[44:47],v3 offset:7168
s_add_u32 m0,s49,24576
MF v[60:63],a[112:115],v[20:23],v[60:63]
buffer_load_dwordx4 v253,s[8:11],s20 offen sc1 lds
MF v[96:99],a[116:119],v[20:23],v[96:99]
ds_read_b128 v[16:19],v3 offset:8192
s_waitcnt lgkmcnt(5)
MF v[64:67],a[112:115],v[24:27],v[64:67]
MF v[100:103],a[116:119],v[24:27],v[100:103]
ds_read_b128 v[20:23],v3 offset:9216
MF v[68:71],a[112:115],v[28:31],v[68:71]
MF v[104:107],a[116:119],v[28:31],v[104:107]
ds_read_b128 v[24:27],v3 offset:10240
s_waitcnt lgkmcnt(5)
s_add_u32 m0,s49,28672
MF v[72:75],a[112:115],v[32:35],v[72:75]
buffer_load_dwordx4 v254,s[8:11],s20 offen sc1 lds
MF v[108:111],a[116:119],v[32:35],v[108:111]
ds_read_b128 v[28:31],v3 offset:11264
MF v[76:79],a[112:115],v[36:39],v[76:79]
MF v[112:115],a[116:119],v[36:39],v[112:115]
ds_read_b128 v[32:35],v3 offset:12288
s_waitcnt lgkmcnt(5)
MF v[80:83],a[112:115],v[40:43],v[80:83]
MF v[116:119],a[116:119],v[40:43],v[116:119]
ds_read_b128 v[36:39],v3 offset:13312
s_waitcnt vmcnt(15)
s_add_u32 m0,s49,32768
MF v[48:51],a[120:123],v[44:47],v[48:51]
buffer_load_dwordx4 v255,s[8:11],s20 offen sc1 lds
MF v[84:87],a[124:127],v[44:47],v[84:87]
ds_read_b128 v[40:43],v3 offset:14336
s_waitcnt lgkmcnt(5)
MF v[52:55],a[120:123],v[16:19],v[52:55]
MF v[88:91],a[124:127],v[16:19],v[88:91]
ds_read_b128 v[44:47],v3 offset:15360
MF v[56:59],a[120:123],v[20:23],v[56:59]
MF v[92:95],a[124:127],v[20:23],v[92:95]
s_waitcnt vmcnt(7)
s_barrier
ds_read_b128 v[16:19],v3 offset:16384
s_waitcnt lgkmcnt(5)
s_add_u32 m0,s49,36864
s_add_u32 s20,s48,196608
MF v[60:63],a[120:123],v[24:27],v[60:63]
buffer_load_dwordx4 v1,s[8:11],s20 offen sc1 lds
MF v[96:99],a[124:127],v[24:27],v[96:99]
ds_read_b128 v[20:23],v3 offset:17408
MF v[64:67],a[120:123],v[28:31],v[64:67]
MF v[100:103],a[124:127],v[28:31],v[100:103]
ds_read_b128 v[24:27],v3 offset:18432
s_waitcnt lgkmcnt(5)
MF v[68:71],a[120:123],v[32:35],v[68:71]
MF v[104:107],a[124:127],v[32:35],v[104:107]
ds_read_b128 v[28:31],v3 offset:19456
s_add_u32 m0,s49,40960
MF v[72:75],a[120:123],v[36:39],v[72:75]
buffer_load_dwordx4 v253,s[8:11],s20 offen sc1 lds
MF v[108:111],a[124:127],v[36:39],v[108:111]
ds_read_b128 v[32:35],v3 offset:20480
s_waitcnt lgkmcnt(5)
MF v[76:79],a[120:123],v[40:43],v[76:79]
MF v[112:115],a[124:127],v[40:43],v[112:115]
ds_read_b128 v[36:39],v3 offset:21504
MF v[80:83],a[120:123],v[44:47],v[80:83]
MF v[116:119],a[124:127],v[44:47],v[116:119]
ds_read_b128 v[40:43],v3 offset:22528
s_waitcnt vmcnt(7)
s_waitcnt lgkmcnt(5)
s_add_u32 m0,s49,45056
MF v[48:51],a[128:131],v[16:19],v[48:51]
buffer_load_dwordx4 v254,s[8:11],s20 offen sc1 lds
MF v[84:87],a[132:135],v[16:19],v[84:87]
ds_read_b128 v[44:47],v3 offset:23552
MF v[52:55],a[128:131],v[20:23],v[52:55]
MF v[88:91],a[132:135],v[20:23],v[88:91]
ds_read_b128 v[16:19],v3 offset:24576
s_waitcnt lgkmcnt(5)
MF v[56:59],a[128:131],v[24:27],v[56:59]
MF v[92:95],a[132:135],v[24:27],v[92:95]
ds_read_b128 v[20:23],v3 offset:25600
s_add_u32 m0,s49,49152
MF v[60:63],a[128:131],v[28:31],v[60:63]
buffer_load_dwordx4 v255,s[8:11],s20 offen sc1 lds
MF v[96:99],a[132:135],v[28:31],v[96:99]
ds_read_b128 v[24:27],v3 offset:26624
s_waitcnt lgkmcnt(5)
MF v[64:67],a[128:131],v[32:35],v[64:67]
MF v[100:103],a[132:135],v[32:35],v[100:103]
ds_read_b128 v[28:31],v3 offset:27648
MF v[68:71],a[128:131],v[36:39],v[68:71]
MF v[104:107],a[132:135],v[36:39],v[104:107]
ds_read_b128 v[32:35],v1 offset:0
s_waitcnt lgkmcnt(5)
s_add_u32 m0,s49,53248
s_add_u32 s20,s48,212992
MF v[72:75],a[128:131],v[40:43],v[72:75]
buffer_load_dwordx4 v1,s[8:11],s20 offen sc1 lds
MF v[108:111],a[132:135],v[40:43],v[108:111]
ds_read_b128 v[36:39],v1 offset:1024
MF v[76:79],a[128:131],v[44:47],v[76:79]
MF v[112:115],a[132:135],v[44:47],v[112:115]
ds_read_b128 v[40:43],v1 offset:2048
s_waitcnt lgkmcnt(5)
MF v[80:83],a[128:131],v[16:19],v[80:83]
MF v[116:119],a[132:135],v[16:19],v[116:119]
ds_read_b128 v[44:47],v1 offset:3072
s_waitcnt vmcnt(8)
s_add_u32 m0,s49,57344
MF v[48:51],a[136:139],v[20:23],v[48:51]
buffer_load_dwordx4 v253,s[8:11],s20 offen sc1 lds
MF v[84:87],a[140:143],v[20:23],v[84:87]
ds_read_b128 v[16:19],v1 offset:4096
s_waitcnt lgkmcnt(5)
MF v[52:55],a[136:139],v[24:27],v[52:55]
MF v[88:91],a[140:143],v[24:27],v[88:91]
ds_read_b128 v[20:23],v1 offset:5120
MF v[56:59],a[136:139],v[28:31],v[56:59]
MF v[92:95],a[140:143],v[28:31],v[92:95]
ds_read_b128 v[24:27],v1 offset:6144
s_waitcnt lgkmcnt(5)
s_add_u32 m0,s49,61440
MF v[60:63],a[136:139],v[32:35],v[60:63]
buffer_load_dwordx4 v254,s[8:11],s20 offen sc1 lds
MF v[96:99],a[140:143],v[32:35],v[96:99]
ds_read_b128 v[28:31],v1 offset:7168
MF v[64:67],a[136:139],v[36:39],v[64:67]
MF v[100:103],a[140:143],v[36:39],v[100:103]
ds_read_b128 v[32:35],v1 offset:8192
s_waitcnt lgkmcnt(5)
MF v[68:71],a[136:139],v[40:43],v[68:71]
MF v[104:107],a[140:143],v[40:43],v[104:107]
ds_read_b128 v[36:39],v1 offset:9216
s_add_u32 m0,s49,65536
MF v[72:75],a[136:139],v[44:47],v[72:75]
buffer_load_dwordx4 v255,s[8:11],s20 offen sc1 lds
MF v[108:111],a[140:143],v[44:47],v[108:111]
ds_read_b128 v[40:43],v1 offset:10240
s_waitcnt lgkmcnt(5)
MF v[76:79],a[136:139],v[16:19],v[76:79]
MF v[112:115],a[140:143],v[16:19],v[112:115]
ds_read_b128 v[44:47],v1 offset:11264
MF v[80:83],a[136:139],v[20:23],v[80:83]
MF v[116:119],a[140:143],v[20:23],v[116:119]
s_waitcnt lgkmcnt(0)
s_nop 7
v_pk_fma_f32 v[48:49],v[202:203],v[192:193],v[48:49] op_sel_hi:[1,0,1]
v_pk_fma_f32 v[50:51],v[204:205],v[192:193],v[50:51] op_sel_hi:[1,0,1]
v_pk_fma_f32 v[84:85],v[206:207],v[192:193],v[84:85] op_sel_hi:[1,0,1]
v_pk_mul_f32 v[48:49],v[48:49],v[210:211]
v_pk_mul_f32 v[50:51],v[50:51],v[212:213]
v_pk_mul_f32 v[84:85],v[84:85],v[214:215]
v_pk_mul_f32 v[240:241],v[48:49],v[48:49]
v_pk_mul_f32 v[242:243],v[50:51],v[50:51]
v_pk_mul_f32 v[244:245],v[84:85],v[84:85]
v_pk_fma_f32 v[240:241],v[240:241],v[248:249],v[248:249] op_sel:[0,0,1] op_sel_hi:[1,0,1]
v_pk_fma_f32 v[242:243],v[242:243],v[248:249],v[248:249] op_sel:[0,0,1] op_sel_hi:[1,0,1]
v_pk_fma_f32 v[244:245],v[244:245],v[248:249],v[248:249] op_sel:[0,0,1] op_sel_hi:[1,0,1]
v_pk_mul_f32 v[240:241],v[240:241],v[48:49]
v_pk_mul_f32 v[242:243],v[242:243],v[50:51]
v_pk_mul_f32 v[244:245],v[244:245],v[84:85]
v_exp_f32 v240,v240
v_pk_fma_f32 v[86:87],v[208:209],v[192:193],v[86:87] op_sel_hi:[1,0,1]
v_exp_f32 v242,v242
v_pk_fma_f32 v[52:53],v[202:203],v[192:193],v[52:53] op_sel:[0,1,0]
v_exp_f32 v241,v241
v_pk_mul_f32 v[86:87],v[86:87],v[216:217]
v_exp_f32 v243,v243
v_pk_add_f32 v[240:241],v[240:241],v[250:251] op_sel_hi:[1,0]
v_exp_f32 v244,v244
v_pk_add_f32 v[242:243],v[242:243],v[250:251] op_sel_hi:[1,0]
v_rcp_f32 v240,v240
s_add_u32 m0,s49,69632
s_add_u32 s20,s48,229376
buffer_load_dwordx4 v1,s[8:11],s20 offen sc1 lds
v_pk_mul_f32 v[246:247],v[86:87],v[86:87]
v_rcp_f32 v242,v242
v_pk_mul_f32 v[52:53],v[52:53],v[210:211]
v_rcp_f32 v241,v241
v_pk_fma_f32 v[246:247],v[246:247],v[248:249],v[248:249] op_sel:[0,0,1] op_sel_hi:[1,0,1]
v_rcp_f32 v243,v243
v_pk_mul_f32 v[48:49],v[48:49],v[240:241]
v_exp_f32 v245,v245
v_pk_mul_f32 v[50:51],v[50:51],v[242:243]
v_pk_add_f32 v[224:225],v[224:225],v[48:49]
v_pk_add_f32 v[244:245],v[244:245],v[250:251] op_sel_hi:[1,0]
v_pk_add_f32 v[226:227],v[226:227],v[50:51]
v_pk_fma_f32 v[232:233],v[48:49],v[48:49],v[232:233]
v_rcp_f32 v244,v244
v_pk_fma_f32 v[234:235],v[50:51],v[50:51],v[234:235]
v_pk_mul_f32 v[246:247],v[246:247],v[86:87]
v_rcp_f32 v245,v245
v_pk_mul_f32 v[4:5],v[52:53],v[52:53]
v_exp_f32 v246,v246
v_pk_mul_f32 v[84:85],v[84:85],v[244:245]
v_pk_fma_f32 v[4:5],v[4:5],v[248:249],v[248:249] op_sel:[0,0,1] op_sel_hi:[1,0,1]
v_exp_f32 v247,v247
v_pk_add_f32 v[228:229],v[228:229],v[84:85]
v_pk_mul_f32 v[4:5],v[4:5],v[52:53]
v_pk_add_f32 v[246:247],v[246:247],v[250:251] op_sel_hi:[1,0]
v_pk_fma_f32 v[236:237],v[84:85],v[84:85],v[236:237]
s_add_u32 m0,s49,73728
s_nop 0
buffer_load_dwordx4 v253,s[8:11],s20 offen sc1 lds
v_exp_f32 v4,v4
v_pk_fma_f32 v[54:55],v[204:205],v[192:193],v[54:55] op_sel:[0,1,0]
v_rcp_f32 v246,v246
v_pk_fma_f32 v[88:89],v[206:207],v[192:193],v[88:89] op_sel:[0,1,0]
v_exp_f32 v5,v5
v_pk_mul_f32 v[54:55],v[54:55],v[212:213]
v_rcp_f32 v247,v247
v_pk_add_f32 v[4:5],v[4:5],v[250:251] op_sel_hi:[1,0]
v_pk_mul_f32 v[6:7],v[54:55],v[54:55]
v_pk_mul_f32 v[86:87],v[86:87],v[246:247]
v_rcp_f32 v4,v4
v_pk_fma_f32 v[6:7],v[6:7],v[248:249],v[248:249] op_sel:[0,0,1] op_sel_hi:[1,0,1]
v_pk_add_f32 v[230:231],v[230:231],v[86:87]
v_rcp_f32 v5,v5
v_pk_mul_f32 v[6:7],v[6:7],v[54:55]
v_pk_fma_f32 v[238:239],v[86:87],v[86:87],v[238:239]
v_pk_mul_f32 v[52:53],v[52:53],v[4:5]
v_exp_f32 v6,v6
v_pk_mul_f32 v[88:89],v[88:89],v[214:215]
v_pk_add_f32 v[224:225],v[224:225],v[52:53]
v_exp_f32 v7,v7
v_pk_mul_f32 v[8:9],v[88:89],v[88:89]
v_pk_fma_f32 v[232:233],v[52:53],v[52:53],v[232:233]
v_pk_add_f32 v[6:7],v[6:7],v[250:251] op_sel_hi:[1,0]
v_pk_fma_f32 v[8:9],v[8:9],v[248:249],v[248:249] op_sel:[0,0,1] op_sel_hi:[1,0,1]
v_pk_fma_f32 v[90:91],v[208:209],v[192:193],v[90:91] op_sel:[0,1,0]
s_add_u32 m0,s49,77824
s_nop 0
buffer_load_dwordx4 v254,s[8:11],s20 offen sc1 lds
v_rcp_f32 v6,v6
v_pk_mul_f32 v[8:9],v[8:9],v[88:89]
v_pk_mul_f32 v[90:91],v[90:91],v[216:217]
v_rcp_f32 v7,v7
v_pk_fma_f32 v[56:57],v[202:203],v[194:195],v[56:57] op_sel_hi:[1,0,1]
v_exp_f32 v8,v8
v_pk_mul_f32 v[54:55],v[54:55],v[6:7]
v_pk_mul_f32 v[10:11],v[90:91],v[90:91]
v_exp_f32 v9,v9
v_pk_add_f32 v[226:227],v[226:227],v[54:55]
v_pk_fma_f32 v[10:11],v[10:11],v[248:249],v[248:249] op_sel:[0,0,1] op_sel_hi:[1,0,1]
v_pk_add_f32 v[8:9],v[8:9],v[250:251] op_sel_hi:[1,0]
v_pk_fma_f32 v[234:235],v[54:55],v[54:55],v[234:235]
v_pk_mul_f32 v[10:11],v[10:11],v[90:91]
v_rcp_f32 v8,v8
v_pk_mul_f32 v[56:57],v[56:57],v[210:211]
v_exp_f32 v10,v10
v_pk_fma_f32 v[58:59],v[204:205],v[194:195],v[58:59] op_sel_hi:[1,0,1]
v_rcp_f32 v9,v9
v_pk_mul_f32 v[240:241],v[56:57],v[56:57]
v_exp_f32 v11,v11
v_pk_mul_f32 v[88:89],v[88:89],v[8:9]
v_pk_fma_f32 v[240:241],v[240:241],v[248:249],v[248:249] op_sel:[0,0,1] op_sel_hi:[1,0,1]
v_pk_add_f32 v[10:11],v[10:11],v[250:251] op_sel_hi:[1,0]
v_pk_add_f32 v[228:229],v[228:229],v[88:89]
v_pk_mul_f32 v[240:241],v[240:241],v[56:57]
s_add_u32 m0,s49,81920
s_nop 0
buffer_load_dwordx4 v255,s[8:11],s20 offen sc1 lds
v_rcp_f32 v10,v10
v_pk_fma_f32 v[236:237],v[88:89],v[88:89],v[236:237]
v_exp_f32 v240,v240
v_pk_mul_f32 v[58:59],v[58:59],v[212:213]
v_rcp_f32 v11,v11
v_pk_fma_f32 v[92:93],v[206:207],v[194:195],v[92:93] op_sel_hi:[1,0,1]
v_exp_f32 v241,v241
v_pk_mul_f32 v[90:91],v[90:91],v[10:11]
v_pk_mul_f32 v[242:243],v[58:59],v[58:59]
v_pk_add_f32 v[240:241],v[240:241],v[250:251] op_sel_hi:[1,0]
v_pk_add_f32 v[230:231],v[230:231],v[90:91]
v_pk_fma_f32 v[242:243],v[242:243],v[248:249],v[248:249] op_sel:[0,0,1] op_sel_hi:[1,0,1]
v_rcp_f32 v240,v240
v_pk_fma_f32 v[238:239],v[90:91],v[90:91],v[238:239]
v_pk_mul_f32 v[242:243],v[242:243],v[58:59]
v_rcp_f32 v241,v241
v_pk_mul_f32 v[92:93],v[92:93],v[214:215]
v_exp_f32 v242,v242
v_pk_mul_f32 v[56:57],v[56:57],v[240:241]
v_pk_mul_f32 v[244:245],v[92:93],v[92:93]
v_exp_f32 v243,v243
v_pk_add_f32 v[224:225],v[224:225],v[56:57]
v_pk_fma_f32 v[244:245],v[244:245],v[248:249],v[248:249] op_sel:[0,0,1] op_sel_hi:[1,0,1]
v_pk_add_f32 v[242:243],v[242:243],v[250:251] op_sel_hi:[1,0]
v_pk_fma_f32 v[232:233],v[56:57],v[56:57],v[232:233]
v_pk_mul_f32 v[244:245],v[244:245],v[92:93]
s_add_u32 m0,s49,86016
s_add_u32 s20,s48,245760
buffer_load_dwordx4 v1,s[8:11],s20 offen sc1 lds
v_rcp_f32 v242,v242
v_pk_fma_f32 v[94:95],v[208:209],v[194:195],v[94:95] op_sel_hi:[1,0,1]
v_exp_f32 v244,v244
v_pk_fma_f32 v[60:61],v[202:203],v[194:195],v[60:61] op_sel:[0,1,0]
v_rcp_f32 v243,v243
v_pk_mul_f32 v[94:95],v[94:95],v[216:217]
v_exp_f32 v245,v245
v_pk_mul_f32 v[58:59],v[58:59],v[242:243]
v_pk_mul_f32 v[246:247],v[94:95],v[94:95]
v_pk_add_f32 v[244:245],v[244:245],v[250:251] op_sel_hi:[1,0]
v_pk_add_f32 v[226:227],v[226:227],v[58:59]
v_pk_fma_f32 v[246:247],v[246:247],v[248:249],v[248:249] op_sel:[0,0,1] op_sel_hi:[1,0,1]
v_rcp_f32 v244,v244
v_pk_fma_f32 v[234:235],v[58:59],v[58:59],v[234:235]
v_pk_mul_f32 v[246:247],v[246:247],v[94:95]
v_rcp_f32 v245,v245
v_pk_mul_f32 v[60:61],v[60:61],v[210:211]
v_exp_f32 v246,v246
v_pk_mul_f32 v[92:93],v[92:93],v[244:245]
v_pk_mul_f32 v[4:5],v[60:61],v[60:61]
v_exp_f32 v247,v247
v_pk_add_f32 v[228:229],v[228:229],v[92:93]
v_pk_fma_f32 v[4:5],v[4:5],v[248:249],v[248:249] op_sel:[0,0,1] op_sel_hi:[1,0,1]
v_pk_add_f32 v[246:247],v[246:247],v[250:251] op_sel_hi:[1,0]
v_pk_fma_f32 v[236:237],v[92:93],v[92:93],v[236:237]
v_pk_mul_f32 v[4:5],v[4:5],v[60:61]
s_add_u32 m0,s49,90112
s_nop 0
buffer_load_dwordx4 v253,s[8:11],s20 offen sc1 lds
v_rcp_f32 v246,v246
v_pk_fma_f32 v[62:63],v[204:205],v[194:195],v[62:63] op_sel:[0,1,0]
v_exp_f32 v4,v4
v_pk_fma_f32 v[96:97],v[206:207],v[194:195],v[96:97] op_sel:[0,1,0]
v_rcp_f32 v247,v247
v_pk_mul_f32 v[62:63],v[62:63],v[212:213]
v_exp_f32 v5,v5
v_pk_mul_f32 v[94:95],v[94:95],v[246:247]
v_pk_mul_f32 v[6:7],v[62:63],v[62:63]
v_pk_add_f32 v[4:5],v[4:5],v[250:251] op_sel_hi:[1,0]
v_pk_add_f32 v[230:231],v[230:231],v[94:95]
v_pk_fma_f32 v[6:7],v[6:7],v[248:249],v[248:249] op_sel:[0,0,1] op_sel_hi:[1,0,1]
v_rcp_f32 v4,v4
v_pk_fma_f32 v[238:239],v[94:95],v[94:95],v[238:239]
v_pk_mul_f32 v[6:7],v[6:7],v[62:63]
v_rcp_f32 v5,v5
v_pk_mul_f32 v[96:97],v[96:97],v[214:215]
v_exp_f32 v6,v6
v_pk_mul_f32 v[60:61],v[60:61],v[4:5]
v_pk_mul_f32 v[8:9],v[96:97],v[96:97]
v_exp_f32 v7,v7
v_pk_add_f32 v[224:225],v[224:225],v[60:61]
v_pk_fma_f32 v[8:9],v[8:9],v[248:249],v[248:249] op_sel:[0,0,1] op_sel_hi:[1,0,1]
v_pk_add_f32 v[6:7],v[6:7],v[250:251] op_sel_hi:[1,0]
v_pk_fma_f32 v[232:233],v[60:61],v[60:61],v[232:233]
v_pk_mul_f32 v[8:9],v[8:9],v[96:97]
s_add_u32 m0,s49,94208
s_nop 0
buffer_load_dwordx4 v254,s[8:11],s20 offen sc1 lds
v_rcp_f32 v6,v6
v_pk_fma_f32 v[98:99],v[208:209],v[194:195],v[98:99] op_sel:[0,1,0]
v_exp_f32 v8,v8
v_pk_fma_f32 v[64:65],v[202:203],v[196:197],v[64:65] op_sel_hi:[1,0,1]
v_rcp_f32 v7,v7
v_pk_mul_f32 v[98:99],v[98:99],v[216:217]
v_exp_f32 v9,v9
v_pk_mul_f32 v[62:63],v[62:63],v[6:7]
v_pk_mul_f32 v[10:11],v[98:99],v[98:99]
v_pk_add_f32 v[8:9],v[8:9],v[250:251] op_sel_hi:[1,0]
v_pk_add_f32 v[226:227],v[226:227],v[62:63]
v_pk_fma_f32 v[10:11],v[10:11],v[248:249],v[248:249] op_sel:[0,0,1] op_sel_hi:[1,0,1]
v_rcp_f32 v8,v8
v_pk_fma_f32 v[234:235],v[62:63],v[62:63],v[234:235]
v_pk_mul_f32 v[10:11],v[10:11],v[98:99]
v_rcp_f32 v9,v9
v_pk_mul_f32 v[64:65],v[64:65],v[210:211]
v_exp_f32 v10,v10
v_pk_mul_f32 v[96:97],v[96:97],v[8:9]
v_pk_mul_f32 v[240:241],v[64:65],v[64:65]
v_exp_f32 v11,v11
v_pk_add_f32 v[228:229],v[228:229],v[96:97]
v_pk_fma_f32 v[240:241],v[240:241],v[248:249],v[248:249] op_sel:[0,0,1] op_sel_hi:[1,0,1]
v_pk_add_f32 v[10:11],v[10:11],v[250:251] op_sel_hi:[1,0]
v_pk_fma_f32 v[236:237],v[96:97],v[96:97],v[236:237]
v_pk_mul_f32 v[240:241],v[240:241],v[64:65]
s_add_u32 m0,s49,98304
s_nop 0
buffer_load_dwordx4 v255,s[8:11],s20 offen sc1 lds
v_rcp_f32 v10,v10
v_pk_fma_f32 v[66:67],v[204:205],v[196:197],v[66:67] op_sel_hi:[1,0,1]
v_exp_f32 v240,v240
v_pk_fma_f32 v[100:101],v[206:207],v[196:197],v[100:101] op_sel_hi:[1,0,1]
v_rcp_f32 v11,v11
v_pk_mul_f32 v[66:67],v[66:67],v[212:213]
v_exp_f32 v241,v241
v_pk_mul_f32 v[98:99],v[98:99],v[10:11]
v_pk_mul_f32 v[242:243],v[66:67],v[66:67]
v_pk_add_f32 v[240:241],v[240:241],v[250:251] op_sel_hi:[1,0]
v_pk_add_f32 v[230:231],v[230:231],v[98:99]
v_pk_fma_f32 v[242:243],v[242:243],v[248:249],v[248:249] op_sel:[0,0,1] op_sel_hi:[1,0,1]
v_rcp_f32 v240,v240
v_pk_fma_f32 v[238:239],v[98:99],v[98:99],v[238:239]
v_pk_mul_f32 v[242:243],v[242:243],v[66:67]
v_rcp_f32 v241,v241
v_pk_mul_f32 v[100:101],v[100:101],v[214:215]
v_exp_f32 v242,v242
v_pk_mul_f32 v[64:65],v[64:65],v[240:241]
v_pk_mul_f32 v[244:245],v[100:101],v[100:101]
v_exp_f32 v243,v243
v_pk_add_f32 v[224:225],v[224:225],v[64:65]
v_pk_fma_f32 v[244:245],v[244:245],v[248:249],v[248:249] op_sel:[0,0,1] op_sel_hi:[1,0,1]
v_pk_add_f32 v[242:243],v[242:243],v[250:251] op_sel_hi:[1,0]
v_pk_fma_f32 v[232:233],v[64:65],v[64:65],v[232:233]
v_pk_mul_f32 v[244:245],v[244:245],v[100:101]
s_add_u32 m0,s49,102400
s_add_u32 s20,s48,262144
buffer_load_dwordx4 v1,s[8:11],s20 offen sc1 lds
v_rcp_f32 v242,v242
v_pk_fma_f32 v[102:103],v[208:209],v[196:197],v[102:103] op_sel_hi:[1,0,1]
v_exp_f32 v244,v244
v_pk_fma_f32 v[68:69],v[202:203],v[196:197],v[68:69] op_sel:[0,1,0]
v_rcp_f32 v243,v243
v_pk_mul_f32 v[102:103],v[102:103],v[216:217]
v_exp_f32 v245,v245
v_pk_mul_f32 v[66:67],v[66:67],v[242:243]
v_pk_mul_f32 v[246:247],v[102:103],v[102:103]
v_pk_add_f32 v[244:245],v[244:245],v[250:251] op_sel_hi:[1,0]
v_pk_add_f32 v[226:227],v[226:227],v[66:67]
v_pk_fma_f32 v[246:247],v[246:247],v[248:249],v[248:249] op_sel:[0,0,1] op_sel_hi:[1,0,1]
v_rcp_f32 v244,v244
v_pk_fma_f32 v[234:235],v[66:67],v[66:67],v[234:235]
v_pk_mul_f32 v[246:247],v[246:247],v[102:103]
v_rcp_f32 v245,v245
v_pk_mul_f32 v[68:69],v[68:69],v[210:211]
v_exp_f32 v246,v246
v_pk_mul_f32 v[100:101],v[100:101],v[244:245]
v_pk_mul_f32 v[4:5],v[68:69],v[68:69]
v_exp_f32 v247,v247
v_pk_add_f32 v[228:229],v[228:229],v[100:101]
v_pk_fma_f32 v[4:5],v[4:5],v[248:249],v[248:249] op_sel:[0,0,1] op_sel_hi:[1,0,1]
v_pk_add_f32 v[246:247],v[246:247],v[250:251] op_sel_hi:[1,0]
v_pk_fma_f32 v[236:237],v[100:101],v[100:101],v[236:237]
v_pk_mul_f32 v[4:5],v[4:5],v[68:69]
s_add_u32 m0,s49,106496
s_nop 0
buffer_load_dwordx4 v253,s[8:11],s20 offen sc1 lds
v_rcp_f32 v246,v246
v_pk_fma_f32 v[70:71],v[204:205],v[196:197],v[70:71] op_sel:[0,1,0]
v_exp_f32 v4,v4
v_pk_fma_f32 v[104:105],v[206:207],v[196:197],v[104:105] op_sel:[0,1,0]
v_rcp_f32 v247,v247
v_pk_mul_f32 v[70:71],v[70:71],v[212:213]
v_exp_f32 v5,v5
v_pk_mul_f32 v[102:103],v[102:103],v[246:247]
v_pk_mul_f32 v[6:7],v[70:71],v[70:71]
v_pk_add_f32 v[4:5],v[4:5],v[250:251] op_sel_hi:[1,0]
v_pk_add_f32 v[230:231],v[230:231],v[102:103]
v_pk_fma_f32 v[6:7],v[6:7],v[248:249],v[248:249] op_sel:[0,0,1] op_sel_hi:[1,0,1]
v_rcp_f32 v4,v4
v_pk_fma_f32 v[238:239],v[102:103],v[102:103],v[238:239]
v_pk_mul_f32 v[6:7],v[6:7],v[70:71]
v_rcp_f32 v5,v5
v_pk_mul_f32 v[104:105],v[104:105],v[214:215]
v_exp_f32 v6,v6
v_pk_mul_f32 v[68:69],v[68:69],v[4:5]
v_pk_mul_f32 v[8:9],v[104:105],v[104:105]
v_exp_f32 v7,v7
v_pk_add_f32 v[224:225],v[224:225],v[68:69]
v_pk_fma_f32 v[8:9],v[8:9],v[248:249],v[248:249] op_sel:[0,0,1] op_sel_hi:[1,0,1]
v_pk_add_f32 v[6:7],v[6:7],v[250:251] op_sel_hi:[1,0]
v_pk_fma_f32 v[232:233],v[68:69],v[68:69],v[232:233]
v_pk_mul_f32 v[8:9],v[8:9],v[104:105]
s_add_u32 m0,s49,110592
s_nop 0
buffer_load_dwordx4 v254,s[8:11],s20 offen sc1 lds
v_rcp_f32 v6,v6
v_pk_fma_f32 v[106:107],v[208:209],v[196:197],v[106:107] op_sel:[0,1,0]
v_exp_f32 v8,v8
v_pk_fma_f32 v[72:73],v[202:203],v[198:199],v[72:73] op_sel_hi:[1,0,1]
v_rcp_f32 v7,v7
v_pk_mul_f32 v[106:107],v[106:107],v[216:217]
v_exp_f32 v9,v9
v_pk_mul_f32 v[70:71],v[70:71],v[6:7]
v_pk_mul_f32 v[10:11],v[106:107],v[106:107]
v_pk_add_f32 v[8:9],v[8:9],v[250:251] op_sel_hi:[1,0]
v_pk_add_f32 v[226:227],v[226:227],v[70:71]
v_pk_fma_f32 v[10:11],v[10:11],v[248:249],v[248:249] op_sel:[0,0,1] op_sel_hi:[1,0,1]
v_rcp_f32 v8,v8
v_pk_fma_f32 v[234:235],v[70:71],v[70:71],v[234:235]
v_pk_mul_f32 v[10:11],v[10:11],v[106:107]
v_rcp_f32 v9,v9
v_pk_mul_f32 v[72:73],v[72:73],v[210:211]
v_exp_f32 v10,v10
v_pk_mul_f32 v[104:105],v[104:105],v[8:9]
v_pk_mul_f32 v[240:241],v[72:73],v[72:73]
v_exp_f32 v11,v11
v_pk_add_f32 v[228:229],v[228:229],v[104:105]
v_pk_fma_f32 v[240:241],v[240:241],v[248:249],v[248:249] op_sel:[0,0,1] op_sel_hi:[1,0,1]
v_pk_add_f32 v[10:11],v[10:11],v[250:251] op_sel_hi:[1,0]
v_pk_fma_f32 v[236:237],v[104:105],v[104:105],v[236:237]
v_pk_mul_f32 v[240:241],v[240:241],v[72:73]
s_add_u32 m0,s49,114688
s_nop 0
buffer_load_dwordx4 v255,s[8:11],s20 offen sc1 lds
v_rcp_f32 v10,v10
v_pk_fma_f32 v[74:75],v[204:205],v[198:199],v[74:75] op_sel_hi:[1,0,1]
v_exp_f32 v240,v240
v_pk_fma_f32 v[108:109],v[206:207],v[198:199],v[108:109] op_sel_hi:[1,0,1]
v_rcp_f32 v11,v11
v_pk_mul_f32 v[74:75],v[74:75],v[212:213]
v_exp_f32 v241,v241
v_pk_mul_f32 v[106:107],v[106:107],v[10:11]
v_pk_mul_f32 v[242:243],v[74:75],v[74:75]
v_pk_add_f32 v[240:241],v[240:241],v[250:251] op_sel_hi:[1,0]
v_pk_add_f32 v[230:231],v[230:231],v[106:107]
v_pk_fma_f32 v[242:243],v[242:243],v[248:249],v[248:249] op_sel:[0,0,1] op_sel_hi:[1,0,1]
v_rcp_f32 v240,v240
v_pk_fma_f32 v[238:239],v[106:107],v[106:107],v[238:239]
v_pk_mul_f32 v[242:243],v[242:243],v[74:75]
v_rcp_f32 v241,v241
v_pk_mul_f32 v[108:109],v[108:109],v[214:215]
v_exp_f32 v242,v242
v_pk_mul_f32 v[72:73],v[72:73],v[240:241]
v_pk_mul_f32 v[244:245],v[108:109],v[108:109]
v_exp_f32 v243,v243
v_pk_add_f32 v[224:225],v[224:225],v[72:73]
v_pk_fma_f32 v[244:245],v[244:245],v[248:249],v[248:249] op_sel:[0,0,1] op_sel_hi:[1,0,1]
v_pk_add_f32 v[242:243],v[242:243],v[250:251] op_sel_hi:[1,0]
v_pk_fma_f32 v[232:233],v[72:73],v[72:73],v[232:233]
v_pk_mul_f32 v[244:245],v[244:245],v[108:109]
s_add_u32 m0,s49,118784
s_add_u32 s20,s48,278528
buffer_load_dwordx4 v1,s[8:11],s20 offen sc1 lds
v_rcp_f32 v242,v242
v_pk_fma_f32 v[110:111],v[208:209],v[198:199],v[110:111] op_sel_hi:[1,0,1]
v_exp_f32 v244,v244
v_pk_fma_f32 v[76:77],v[202:203],v[198:199],v[76:77] op_sel:[0,1,0]
v_rcp_f32 v243,v243
v_pk_mul_f32 v[110:111],v[110:111],v[216:217]
v_exp_f32 v245,v245
v_pk_mul_f32 v[74:75],v[74:75],v[242:243]
v_pk_mul_f32 v[246:247],v[110:111],v[110:111]
v_pk_add_f32 v[244:245],v[244:245],v[250:251] op_sel_hi:[1,0]
v_pk_add_f32 v[226:227],v[226:227],v[74:75]
v_pk_fma_f32 v[246:247],v[246:247],v[248:249],v[248:249] op_sel:[0,0,1] op_sel_hi:[1,0,1]
v_rcp_f32 v244,v244
v_pk_fma_f32 v[234:235],v[74:75],v[74:75],v[234:235]
v_pk_mul_f32 v[246:247],v[246:247],v[110:111]
v_rcp_f32 v245,v245
v_pk_mul_f32 v[76:77],v[76:77],v[210:211]
v_exp_f32 v246,v246
v_pk_mul_f32 v[108:109],v[108:109],v[244:245]
v_pk_mul_f32 v[4:5],v[76:77],v[76:77]
v_exp_f32 v247,v247
v_pk_add_f32 v[228:229],v[228:229],v[108:109]
v_pk_fma_f32 v[4:5],v[4:5],v[248:249],v[248:249] op_sel:[0,0,1] op_sel_hi:[1,0,1]
v_pk_add_f32 v[246:247],v[246:247],v[250:251] op_sel_hi:[1,0]
v_pk_fma_f32 v[236:237],v[108:109],v[108:109],v[236:237]
v_pk_mul_f32 v[4:5],v[4:5],v[76:77]
s_add_u32 m0,s49,122880
s_nop 0
buffer_load_dwordx4 v253,s[8:11],s20 offen sc1 lds
v_rcp_f32 v246,v246
v_pk_fma_f32 v[78:79],v[204:205],v[198:199],v[78:79] op_sel:[0,1,0]
v_exp_f32 v4,v4
v_pk_fma_f32 v[112:113],v[206:207],v[198:199],v[112:113] op_sel:[0,1,0]
v_rcp_f32 v247,v247
v_pk_mul_f32 v[78:79],v[78:79],v[212:213]
v_exp_f32 v5,v5
v_pk_mul_f32 v[110:111],v[110:111],v[246:247]
v_pk_mul_f32 v[6:7],v[78:79],v[78:79]
v_pk_add_f32 v[4:5],v[4:5],v[250:251] op_sel_hi:[1,0]
v_pk_add_f32 v[230:231],v[230:231],v[110:111]
v_pk_fma_f32 v[6:7],v[6:7],v[248:249],v[248:249] op_sel:[0,0,1] op_sel_hi:[1,0,1]
v_rcp_f32 v4,v4
v_pk_fma_f32 v[238:239],v[110:111],v[110:111],v[238:239]
v_pk_mul_f32 v[6:7],v[6:7],v[78:79]
v_rcp_f32 v5,v5
v_pk_mul_f32 v[112:113],v[112:113],v[214:215]
v_exp_f32 v6,v6
v_pk_mul_f32 v[76:77],v[76:77],v[4:5]
v_pk_mul_f32 v[8:9],v[112:113],v[112:113]
v_exp_f32 v7,v7
v_pk_add_f32 v[224:225],v[224:225],v[76:77]
v_pk_fma_f32 v[8:9],v[8:9],v[248:249],v[248:249] op_sel:[0,0,1] op_sel_hi:[1,0,1]
v_pk_add_f32 v[6:7],v[6:7],v[250:251] op_sel_hi:[1,0]
v_pk_fma_f32 v[232:233],v[76:77],v[76:77],v[232:233]
v_pk_mul_f32 v[8:9],v[8:9],v[112:113]
s_add_u32 m0,s49,126976
s_nop 0
buffer_load_dwordx4 v254,s[8:11],s20 offen sc1 lds
v_rcp_f32 v6,v6
v_pk_fma_f32 v[114:115],v[208:209],v[198:199],v[114:115] op_sel:[0,1,0]
v_exp_f32 v8,v8
v_pk_fma_f32 v[80:81],v[202:203],v[200:201],v[80:81] op_sel_hi:[1,0,1]
v_rcp_f32 v7,v7
v_pk_mul_f32 v[114:115],v[114:115],v[216:217]
v_exp_f32 v9,v9
v_pk_mul_f32 v[78:79],v[78:79],v[6:7]
v_pk_mul_f32 v[10:11],v[114:115],v[114:115]
v_pk_add_f32 v[8:9],v[8:9],v[250:251] op_sel_hi:[1,0]
v_pk_add_f32 v[226:227],v[226:227],v[78:79]
v_pk_fma_f32 v[10:11],v[10:11],v[248:249],v[248:249] op_sel:[0,0,1] op_sel_hi:[1,0,1]
v_rcp_f32 v8,v8
v_pk_fma_f32 v[234:235],v[78:79],v[78:79],v[234:235]
v_pk_mul_f32 v[10:11],v[10:11],v[114:115]
v_rcp_f32 v9,v9
v_pk_mul_f32 v[80:81],v[80:81],v[210:211]
v_exp_f32 v10,v10
v_pk_mul_f32 v[112:113],v[112:113],v[8:9]
v_pk_mul_f32 v[240:241],v[80:81],v[80:81]
v_exp_f32 v11,v11
v_pk_add_f32 v[228:229],v[228:229],v[112:113]
v_pk_fma_f32 v[240:241],v[240:241],v[248:249],v[248:249] op_sel:[0,0,1] op_sel_hi:[1,0,1]
v_pk_add_f32 v[10:11],v[10:11],v[250:251] op_sel_hi:[1,0]
v_pk_fma_f32 v[236:237],v[112:113],v[112:113],v[236:237]
v_pk_mul_f32 v[240:241],v[240:241],v[80:81]
s_add_u32 m0,s49,131072
s_nop 0
buffer_load_dwordx4 v255,s[8:11],s20 offen sc1 lds
v_rcp_f32 v10,v10
v_pk_fma_f32 v[82:83],v[204:205],v[200:201],v[82:83] op_sel_hi:[1,0,1]
v_exp_f32 v240,v240
v_pk_fma_f32 v[116:117],v[206:207],v[200:201],v[116:117] op_sel_hi:[1,0,1]
v_rcp_f32 v11,v11
v_pk_mul_f32 v[82:83],v[82:83],v[212:213]
v_exp_f32 v241,v241
v_pk_mul_f32 v[114:115],v[114:115],v[10:11]
v_pk_mul_f32 v[242:243],v[82:83],v[82:83]
v_pk_add_f32 v[240:241],v[240:241],v[250:251] op_sel_hi:[1,0]
v_pk_add_f32 v[230:231],v[230:231],v[114:115]
v_pk_fma_f32 v[242:243],v[242:243],v[248:249],v[248:249] op_sel:[0,0,1] op_sel_hi:[1,0,1]
v_rcp_f32 v240,v240
v_pk_fma_f32 v[238:239],v[114:115],v[114:115],v[238:239]
v_pk_mul_f32 v[242:243],v[242:243],v[82:83]
v_rcp_f32 v241,v241
v_pk_mul_f32 v[116:117],v[116:117],v[214:215]
v_exp_f32 v242,v242
v_pk_mul_f32 v[80:81],v[80:81],v[240:241]
v_pk_mul_f32 v[244:245],v[116:117],v[116:117]
v_exp_f32 v243,v243
v_pk_add_f32 v[224:225],v[224:225],v[80:81]
v_pk_fma_f32 v[244:245],v[244:245],v[248:249],v[248:249] op_sel:[0,0,1] op_sel_hi:[1,0,1]
v_pk_add_f32 v[242:243],v[242:243],v[250:251] op_sel_hi:[1,0]
v_pk_fma_f32 v[232:233],v[80:81],v[80:81],v[232:233]
v_pk_mul_f32 v[244:245],v[244:245],v[116:117]
v_rcp_f32 v242,v242
v_pk_fma_f32 v[118:119],v[208:209],v[200:201],v[118:119] op_sel_hi:[1,0,1]
v_exp_f32 v244,v244
v_rcp_f32 v243,v243
v_pk_mul_f32 v[118:119],v[118:119],v[216:217]
v_exp_f32 v245,v245
v_pk_mul_f32 v[82:83],v[82:83],v[242:243]
v_pk_mul_f32 v[246:247],v[118:119],v[118:119]
v_pk_add_f32 v[244:245],v[244:245],v[250:251] op_sel_hi:[1,0]
v_pk_add_f32 v[226:227],v[226:227],v[82:83]
v_pk_fma_f32 v[246:247],v[246:247],v[248:249],v[248:249] op_sel:[0,0,1] op_sel_hi:[1,0,1]
v_rcp_f32 v244,v244
v_pk_fma_f32 v[234:235],v[82:83],v[82:83],v[234:235]
v_pk_mul_f32 v[246:247],v[246:247],v[118:119]
v_rcp_f32 v245,v245
s_nop 0
v_pk_mul_f32 v[116:117],v[116:117],v[244:245]
v_exp_f32 v246,v246
v_pk_add_f32 v[228:229],v[228:229],v[116:117]
v_exp_f32 v247,v247
v_pk_fma_f32 v[236:237],v[116:117],v[116:117],v[236:237]
v_pk_add_f32 v[246:247],v[246:247],v[250:251] op_sel_hi:[1,0]
v_rcp_f32 v246,v246
v_rcp_f32 v247,v247
s_nop 0
v_pk_mul_f32 v[118:119],v[118:119],v[246:247]
v_pk_add_f32 v[230:231],v[230:231],v[118:119]
v_pk_fma_f32 v[238:239],v[118:119],v[118:119],v[238:239]
v_add_f32_dpp v224,v224,v224 row_ror:8 row_mask:0xf bank_mask:0xf
v_add_f32_dpp v225,v225,v225 row_ror:8 row_mask:0xf bank_mask:0xf
v_add_f32_dpp v226,v226,v226 row_ror:8 row_mask:0xf bank_mask:0xf
v_add_f32_dpp v227,v227,v227 row_ror:8 row_mask:0xf bank_mask:0xf
v_add_f32_dpp v228,v228,v228 row_ror:8 row_mask:0xf bank_mask:0xf
v_add_f32_dpp v229,v229,v229 row_ror:8 row_mask:0xf bank_mask:0xf
v_add_f32_dpp v230,v230,v230 row_ror:8 row_mask:0xf bank_mask:0xf
v_add_f32_dpp v231,v231,v231 row_ror:8 row_mask:0xf bank_mask:0xf
v_add_f32_dpp v232,v232,v232 row_ror:8 row_mask:0xf bank_mask:0xf
v_add_f32_dpp v233,v233,v233 row_ror:8 row_mask:0xf bank_mask:0xf
v_add_f32_dpp v234,v234,v234 row_ror:8 row_mask:0xf bank_mask:0xf
v_add_f32_dpp v235,v235,v235 row_ror:8 row_mask:0xf bank_mask:0xf
v_add_f32_dpp v236,v236,v236 row_ror:8 row_mask:0xf bank_mask:0xf
v_add_f32_dpp v237,v237,v237 row_ror:8 row_mask:0xf bank_mask:0xf
v_add_f32_dpp v238,v238,v238 row_ror:8 row_mask:0xf bank_mask:0xf
v_add_f32_dpp v239,v239,v239 row_ror:8 row_mask:0xf bank_mask:0xf
v_add_f32_dpp v224,v224,v224 row_ror:4 row_mask:0xf bank_mask:0xf
v_add_f32_dpp v225,v225,v225 row_ror:4 row_mask:0xf bank_mask:0xf
v_add_f32_dpp v226,v226,v226 row_ror:4 row_mask:0xf bank_mask:0xf
v_add_f32_dpp v227,v227,v227 row_ror:4 row_mask:0xf bank_mask:0xf
v_add_f32_dpp v228,v228,v228 row_ror:4 row_mask:0xf bank_mask:0xf
v_add_f32_dpp v229,v229,v229 row_ror:4 row_mask:0xf bank_mask:0xf
v_add_f32_dpp v230,v230,v230 row_ror:4 row_mask:0xf bank_mask:0xf
v_add_f32_dpp v231,v231,v231 row_ror:4 row_mask:0xf bank_mask:0xf
v_add_f32_dpp v232,v232,v232 row_ror:4 row_mask:0xf bank_mask:0xf
v_add_f32_dpp v233,v233,v233 row_ror:4 row_mask:0xf bank_mask:0xf
v_add_f32_dpp v234,v234,v234 row_ror:4 row_mask:0xf bank_mask:0xf
v_add_f32_dpp v235,v235,v235 row_ror:4 row_mask:0xf bank_mask:0xf
v_add_f32_dpp v236,v236,v236 row_ror:4 row_mask:0xf bank_mask:0xf
v_add_f32_dpp v237,v237,v237 row_ror:4 row_mask:0xf bank_mask:0xf
v_add_f32_dpp v238,v238,v238 row_ror:4 row_mask:0xf bank_mask:0xf
v_add_f32_dpp v239,v239,v239 row_ror:4 row_mask:0xf bank_mask:0xf
v_add_f32_dpp v224,v224,v224 row_ror:2 row_mask:0xf bank_mask:0xf
v_add_f32_dpp v225,v225,v225 row_ror:2 row_mask:0xf bank_mask:0xf
v_add_f32_dpp v226,v226,v226 row_ror:2 row_mask:0xf bank_mask:0xf
v_add_f32_dpp v227,v227,v227 row_ror:2 row_mask:0xf bank_mask:0xf
v_add_f32_dpp v228,v228,v228 row_ror:2 row_mask:0xf bank_mask:0xf
v_add_f32_dpp v229,v229,v229 row_ror:2 row_mask:0xf bank_mask:0xf
v_add_f32_dpp v230,v230,v230 row_ror:2 row_mask:0xf bank_mask:0xf
v_add_f32_dpp v231,v231,v231 row_ror:2 row_mask:0xf bank_mask:0xf
v_add_f32_dpp v232,v232,v232 row_ror:2 row_mask:0xf bank_mask:0xf
v_add_f32_dpp v233,v233,v233 row_ror:2 row_mask:0xf bank_mask:0xf
v_add_f32_dpp v234,v234,v234 row_ror:2 row_mask:0xf bank_mask:0xf
v_add_f32_dpp v235,v235,v235 row_ror:2 row_mask:0xf bank_mask:0xf
v_add_f32_dpp v236,v236,v236 row_ror:2 row_mask:0xf bank_mask:0xf
v_add_f32_dpp v237,v237,v237 row_ror:2 row_mask:0xf bank_mask:0xf
v_add_f32_dpp v238,v238,v238 row_ror:2 row_mask:0xf bank_mask:0xf
v_add_f32_dpp v239,v239,v239 row_ror:2 row_mask:0xf bank_mask:0xf
v_add_f32_dpp v224,v224,v224 row_ror:1 row_mask:0xf bank_mask:0xf
v_add_f32_dpp v225,v225,v225 row_ror:1 row_mask:0xf bank_mask:0xf
v_add_f32_dpp v226,v226,v226 row_ror:1 row_mask:0xf bank_mask:0xf
v_add_f32_dpp v227,v227,v227 row_ror:1 row_mask:0xf bank_mask:0xf
v_add_f32_dpp v228,v228,v228 row_ror:1 row_mask:0xf bank_mask:0xf
v_add_f32_dpp v229,v229,v229 row_ror:1 row_mask:0xf bank_mask:0xf
v_add_f32_dpp v230,v230,v230 row_ror:1 row_mask:0xf bank_mask:0xf
v_add_f32_dpp v231,v231,v231 row_ror:1 row_mask:0xf bank_mask:0xf
v_add_f32_dpp v232,v232,v232 row_ror:1 row_mask:0xf bank_mask:0xf
v_add_f32_dpp v233,v233,v233 row_ror:1 row_mask:0xf bank_mask:0xf
v_add_f32_dpp v234,v234,v234 row_ror:1 row_mask:0xf bank_mask:0xf
v_add_f32_dpp v235,v235,v235 row_ror:1 row_mask:0xf bank_mask:0xf
v_add_f32_dpp v236,v236,v236 row_ror:1 row_mask:0xf bank_mask:0xf
v_add_f32_dpp v237,v237,v237 row_ror:1 row_mask:0xf bank_mask:0xf
v_add_f32_dpp v238,v238,v238 row_ror:1 row_mask:0xf bank_mask:0xf
v_add_f32_dpp v239,v239,v239 row_ror:1 row_mask:0xf bank_mask:0xf
s_mov_b32 exec_lo,0x00010001
s_mov_b32 exec_hi,0x00010001
ds_write_b128 v252,v[224:227] offset:0
ds_write_b128 v252,v[232:235] offset:128
ds_write_b128 v252,v[228:231] offset:64
ds_write_b128 v252,v[236:239] offset:192
s_mov_b64 exec,-1
ds_read_b32 v6,v223
v_lshlrev_b32 v5,2,v0
s_waitcnt lgkmcnt(0)
buffer_store_dword v6,v5,s[8:11],s52 offen sc0 sc1
ds_read_b128 v[16:19],v1 offset:12288
MF v[120:123],v[24:27],a[0:3],0
s_lshl_b32 s24,s44,19
s_lshl_b32 s27,s22,14
MF v[156:159],v[24:27],a[4:7],0
ds_read_b128 v[20:23],v1 offset:13312
s_add_u32 s24,s24,s27
s_add_u32 s24,s24,0x880000
MF v[124:127],v[28:31],a[0:3],0
s_lshl_b32 s27,s22,1
s_mul_i32 s29,s22,10240
MF v[160:163],v[28:31],a[4:7],0
ds_read_b128 v[24:27],v1 offset:14336
s_lshl_b32 s21,s22,13
MF v[128:131],v[32:35],a[0:3],0
s_add_u32 s84,s27,0
s_and_b32 s84,s84,7
MF v[164:167],v[32:35],a[4:7],0
ds_read_b128 v[28:31],v1 offset:15360
s_lshl_b32 s84,s84,16
s_add_u32 s84,s84,s24
MF v[132:135],v[36:39],a[0:3],0
s_add_u32 s85,s27,1
s_and_b32 s85,s85,7
MF v[168:171],v[36:39],a[4:7],0
ds_read_b128 v[32:35],v1 offset:16384
s_lshl_b32 s85,s85,16
s_add_u32 s85,s85,s24
MF v[136:139],v[40:43],a[0:3],0
s_add_u32 s86,s27,2
s_and_b32 s86,s86,7
MF v[172:175],v[40:43],a[4:7],0
ds_read_b128 v[36:39],v1 offset:17408
s_lshl_b32 s86,s86,16
s_add_u32 s86,s86,s24
MF v[140:143],v[44:47],a[0:3],0
s_add_u32 s87,s27,3
s_and_b32 s87,s87,7
MF v[176:179],v[44:47],a[4:7],0
ds_read_b128 v[40:43],v1 offset:18432
s_waitcnt lgkmcnt(5)
MF v[144:147],v[16:19],a[0:3],0
s_lshl_b32 s87,s87,16
s_add_u32 s87,s87,s24
MF v[180:183],v[16:19],a[4:7],0
ds_read_b128 v[44:47],v1 offset:19456
s_add_u32 s88,s27,4
s_and_b32 s88,s88,7
MF v[148:151],v[20:23],a[0:3],0
s_lshl_b32 s88,s88,16
s_add_u32 s88,s88,s24
MF v[184:187],v[20:23],a[4:7],0
ds_read_b128 v[16:19],v1 offset:20480
s_waitcnt lgkmcnt(5)
MF v[152:155],v[24:27],a[0:3],0
s_add_u32 s89,s27,5
s_and_b32 s89,s89,7
MF v[188:191],v[24:27],a[4:7],0
ds_read_b128 v[20:23],v1 offset:21504
s_lshl_b32 s89,s89,16
s_add_u32 s89,s89,s24
MF v[120:123],v[28:31],a[8:11],v[120:123]
s_add_u32 s90,s27,6
s_and_b32 s90,s90,7
MF v[156:159],v[28:31],a[12:15],v[156:159]
ds_read_b128 v[24:27],v1 offset:22528
s_waitcnt lgkmcnt(5)
MF v[124:127],v[32:35],a[8:11],v[124:127]
s_lshl_b32 s90,s90,16
s_add_u32 s90,s90,s24
MF v[160:163],v[32:35],a[12:15],v[160:163]
ds_read_b128 v[28:31],v1 offset:23552
s_add_u32 s91,s27,7
s_and_b32 s91,s91,7
MF v[128:131],v[36:39],a[8:11],v[128:131]
s_lshl_b32 s91,s91,16
s_add_u32 s91,s91,s24
MF v[164:167],v[36:39],a[12:15],v[164:167]
s_waitcnt vmcnt(19)
s_barrier
ds_read_b128 v[32:35],v1 offset:24576
s_waitcnt lgkmcnt(5)
s_add_u32 m0,s49,135168
s_add_u32 s20,s48,294912
MF v[132:135],v[40:43],a[8:11],v[132:135]
buffer_load_dwordx4 v1,s[8:11],s20 offen sc1 lds
MF v[168:171],v[40:43],a[12:15],v[168:171]
ds_read_b128 v[36:39],v1 offset:25600
MF v[136:139],v[44:47],a[8:11],v[136:139]
MF v[172:175],v[44:47],a[12:15],v[172:175]
ds_read_b128 v[40:43],v1 offset:26624
s_waitcnt lgkmcnt(5)
MF v[140:143],v[16:19],a[8:11],v[140:143]
MF v[176:179],v[16:19],a[12:15],v[176:179]
ds_read_b128 v[44:47],v1 offset:27648
s_add_u32 m0,s49,139264
MF v[144:147],v[20:23],a[8:11],v[144:147]
buffer_load_dwordx4 v253,s[8:11],s20 offen sc1 lds
MF v[180:183],v[20:23],a[12:15],v[180:183]
ds_read_b128 v[16:19],v1 offset:28672
s_waitcnt lgkmcnt(5)
MF v[148:151],v[24:27],a[8:11],v[148:151]
MF v[184:187],v[24:27],a[12:15],v[184:187]
ds_read_b128 v[20:23],v1 offset:29696
MF v[152:155],v[28:31],a[8:11],v[152:155]
MF v[188:191],v[28:31],a[12:15],v[188:191]
ds_read_b128 v[24:27],v1 offset:30720
s_waitcnt lgkmcnt(5)
s_add_u32 m0,s49,143360
MF v[120:123],v[32:35],a[16:19],v[120:123]
buffer_load_dwordx4 v254,s[8:11],s20 offen sc1 lds
MF v[156:159],v[32:35],a[20:23],v[156:159]
ds_read_b128 v[28:31],v1 offset:31744
MF v[124:127],v[36:39],a[16:19],v[124:127]
MF v[160:163],v[36:39],a[20:23],v[160:163]
ds_read_b128 v[32:35],v1 offset:32768
s_waitcnt lgkmcnt(5)
MF v[128:131],v[40:43],a[16:19],v[128:131]
MF v[164:167],v[40:43],a[20:23],v[164:167]
ds_read_b128 v[36:39],v1 offset:33792
s_add_u32 m0,s49,147456
MF v[132:135],v[44:47],a[16:19],v[132:135]
buffer_load_dwordx4 v255,s[8:11],s20 offen sc1 lds
MF v[168:171],v[44:47],a[20:23],v[168:171]
ds_read_b128 v[40:43],v1 offset:34816
s_waitcnt lgkmcnt(5)
MF v[136:139],v[16:19],a[16:19],v[136:139]
MF v[172:175],v[16:19],a[20:23],v[172:175]
ds_read_b128 v[44:47],v1 offset:35840
MF v[140:143],v[20:23],a[16:19],v[140:143]
MF v[176:179],v[20:23],a[20:23],v[176:179]
ds_read_b128 v[16:19],v1 offset:36864
s_waitcnt lgkmcnt(5)
s_add_u32 m0,s49,151552
s_add_u32 s20,s48,311296
MF v[144:147],v[24:27],a[16:19],v[144:147]
buffer_load_dwordx4 v1,s[8:11],s20 offen sc1 lds
MF v[180:183],v[24:27],a[20:23],v[180:183]
ds_read_b128 v[20:23],v1 offset:37888
MF v[148:151],v[28:31],a[16:19],v[148:151]
MF v[184:187],v[28:31],a[20:23],v[184:187]
ds_read_b128 v[24:27],v1 offset:38912
s_waitcnt lgkmcnt(5)
MF v[152:155],v[32:35],a[16:19],v[152:155]
MF v[188:191],v[32:35],a[20:23],v[188:191]
ds_read_b128 v[28:31],v1 offset:39936
s_add_u32 m0,s49,155648
MF v[120:123],v[36:39],a[24:27],v[120:123]
buffer_load_dwordx4 v253,s[8:11],s20 offen sc1 lds
MF v[156:159],v[36:39],a[28:31],v[156:159]
ds_read_b128 v[32:35],v1 offset:40960
s_waitcnt lgkmcnt(5)
MF v[124:127],v[40:43],a[24:27],v[124:127]
MF v[160:163],v[40:43],a[28:31],v[160:163]
ds_read_b128 v[36:39],v1 offset:41984
MF v[128:131],v[44:47],a[24:27],v[128:131]
MF v[164:167],v[44:47],a[28:31],v[164:167]
ds_read_b128 v[40:43],v1 offset:43008
s_waitcnt lgkmcnt(5)
s_add_u32 m0,s49,0
MF v[132:135],v[16:19],a[24:27],v[132:135]
buffer_load_dwordx4 v254,s[8:11],s20 offen sc1 lds
MF v[168:171],v[16:19],a[28:31],v[168:171]
ds_read_b128 v[44:47],v1 offset:44032
MF v[136:139],v[20:23],a[24:27],v[136:139]
MF v[172:175],v[20:23],a[28:31],v[172:175]
ds_read_b128 v[16:19],v1 offset:45056
s_waitcnt lgkmcnt(5)
MF v[140:143],v[24:27],a[24:27],v[140:143]
MF v[176:179],v[24:27],a[28:31],v[176:179]
ds_read_b128 v[20:23],v1 offset:46080
s_add_u32 m0,s49,4096
MF v[144:147],v[28:31],a[24:27],v[144:147]
buffer_load_dwordx4 v255,s[8:11],s20 offen sc1 lds
MF v[180:183],v[28:31],a[28:31],v[180:183]
ds_read_b128 v[24:27],v1 offset:47104
s_waitcnt lgkmcnt(5)
MF v[148:151],v[32:35],a[24:27],v[148:151]
MF v[184:187],v[32:35],a[28:31],v[184:187]
ds_read_b128 v[28:31],v1 offset:48128
MF v[152:155],v[36:39],a[24:27],v[152:155]
MF v[188:191],v[36:39],a[28:31],v[188:191]
ds_read_b128 v[32:35],v1 offset:49152
s_waitcnt lgkmcnt(5)
s_add_u32 m0,s49,8192
s_add_u32 s20,s48,327680
MF v[120:123],v[40:43],a[32:35],v[120:123]
buffer_load_dwordx4 v1,s[8:11],s20 offen sc1 lds
MF v[156:159],v[40:43],a[36:39],v[156:159]
ds_read_b128 v[36:39],v1 offset:50176
MF v[124:127],v[44:47],a[32:35],v[124:127]
MF v[160:163],v[44:47],a[36:39],v[160:163]
ds_read_b128 v[40:43],v1 offset:51200
s_waitcnt lgkmcnt(5)
MF v[128:131],v[16:19],a[32:35],v[128:131]
MF v[164:167],v[16:19],a[36:39],v[164:167]
ds_read_b128 v[44:47],v1 offset:52224
MF v[132:135],v[20:23],a[32:35],v[132:135]
MF v[168:171],v[20:23],a[36:39],v[168:171]
ds_read_b128 v[16:19],v1 offset:53248
s_waitcnt lgkmcnt(5)
MF v[136:139],v[24:27],a[32:35],v[136:139]
MF v[172:175],v[24:27],a[36:39],v[172:175]
ds_read_b128 v[20:23],v1 offset:54272
MF v[140:143],v[28:31],a[32:35],v[140:143]
MF v[176:179],v[28:31],a[36:39],v[176:179]
ds_read_b128 v[24:27],v1 offset:55296
s_waitcnt lgkmcnt(5)
MF v[144:147],v[32:35],a[32:35],v[144:147]
MF v[180:183],v[32:35],a[36:39],v[180:183]
ds_read_b128 v[28:31],v1 offset:56320
MF v[148:151],v[36:39],a[32:35],v[148:151]
MF v[184:187],v[36:39],a[36:39],v[184:187]
ds_read_b128 v[32:35],v1 offset:57344
s_waitcnt lgkmcnt(5)
MF v[152:155],v[40:43],a[32:35],v[152:155]
MF v[188:191],v[40:43],a[36:39],v[188:191]
ds_read_b128 v[36:39],v1 offset:58368
MF v[120:123],v[44:47],a[40:43],v[120:123]
MF v[156:159],v[44:47],a[44:47],v[156:159]
ds_read_b128 v[40:43],v1 offset:59392
s_waitcnt lgkmcnt(5)
MF v[124:127],v[16:19],a[40:43],v[124:127]
MF v[160:163],v[16:19],a[44:47],v[160:163]
ds_read_b128 v[44:47],v1 offset:60416
MF v[128:131],v[20:23],a[40:43],v[128:131]
MF v[164:167],v[20:23],a[44:47],v[164:167]
s_waitcnt vmcnt(19)
s_barrier
ds_read_b128 v[16:19],v1 offset:61440
s_waitcnt lgkmcnt(5)
MF v[132:135],v[24:27],a[40:43],v[132:135]
MF v[168:171],v[24:27],a[44:47],v[168:171]
ds_read_b128 v[20:23],v1 offset:62464
MF v[136:139],v[28:31],a[40:43],v[136:139]
buffer_load_dwordx4 v[224:227],v1,s[8:11],s51 offen offset:0 sc0 sc1
buffer_load_dwordx4 v[228:231],v1,s[8:11],s51 offen offset:1024 sc0 sc1
buffer_load_dwordx4 v[232:235],v1,s[8:11],s51 offen offset:2048 sc0 sc1
buffer_load_dwordx4 v[236:239],v1,s[8:11],s51 offen offset:3072 sc0 sc1
MF v[172:175],v[28:31],a[44:47],v[172:175]
ds_read_b128 v[24:27],v1 offset:63488
s_waitcnt lgkmcnt(5)
MF v[140:143],v[32:35],a[40:43],v[140:143]
s_add_u32 m0,s29,11264
s_nop 0
buffer_load_dwordx4 v1,s[8:11],s88 offen offset:1024 sc1 lds
MF v[176:179],v[32:35],a[44:47],v[176:179]
ds_read_b128 v[28:31],v1 offset:64512
MF v[144:147],v[36:39],a[40:43],v[144:147]
s_add_u32 m0,s29,12288
s_nop 0
buffer_load_dwordx4 v1,s[8:11],s89 offen offset:1024 sc1 lds
MF v[180:183],v[36:39],a[44:47],v[180:183]
ds_read_b128 v[32:35],v2 offset:0
s_waitcnt lgkmcnt(5)
MF v[148:151],v[40:43],a[40:43],v[148:151]
MF v[184:187],v[40:43],a[44:47],v[184:187]
ds_read_b128 v[36:39],v2 offset:1024
s_add_u32 m0,s29,13312
s_nop 0
buffer_load_dwordx4 v1,s[8:11],s90 offen offset:1024 sc1 lds
MF v[152:155],v[44:47],a[40:43],v[152:155]
MF v[188:191],v[44:47],a[44:47],v[188:191]
ds_read_b128 v[40:43],v2 offset:2048
s_waitcnt lgkmcnt(5)
MF v[120:123],v[16:19],a[48:51],v[120:123]
s_add_u32 m0,s29,14336
s_nop 0
buffer_load_dwordx4 v1,s[8:11],s91 offen offset:1024 sc1 lds
MF v[156:159],v[16:19],a[52:55],v[156:159]
ds_read_b128 v[44:47],v2 offset:3072
MF v[124:127],v[20:23],a[48:51],v[124:127]
s_add_u32 m0,s29,14336
s_nop 0
buffer_load_dwordx4 v1,s[8:11],s84 offen offset:2048 sc1 lds
MF v[160:163],v[20:23],a[52:55],v[160:163]
ds_read_b128 v[16:19],v2 offset:4096
s_waitcnt lgkmcnt(5)
MF v[128:131],v[24:27],a[48:51],v[128:131]
MF v[164:167],v[24:27],a[52:55],v[164:167]
ds_read_b128 v[20:23],v2 offset:5120
s_add_u32 m0,s29,15360
s_nop 0
buffer_load_dwordx4 v1,s[8:11],s85 offen offset:2048 sc1 lds
MF v[132:135],v[28:31],a[48:51],v[132:135]
MF v[168:171],v[28:31],a[52:55],v[168:171]
ds_read_b128 v[24:27],v2 offset:6144
s_waitcnt lgkmcnt(5)
MF v[136:139],v[32:35],a[48:51],v[136:139]
s_add_u32 m0,s29,16384
s_nop 0
buffer_load_dwordx4 v1,s[8:11],s86 offen offset:2048 sc1 lds
MF v[172:175],v[32:35],a[52:55],v[172:175]
ds_read_b128 v[28:31],v2 offset:7168
MF v[140:143],v[36:39],a[48:51],v[140:143]
s_add_u32 m0,s29,17408
s_nop 0
buffer_load_dwordx4 v1,s[8:11],s87 offen offset:2048 sc1 lds
MF v[176:179],v[36:39],a[52:55],v[176:179]
ds_read_b128 v[32:35],v2 offset:8192
s_waitcnt lgkmcnt(5)
MF v[144:147],v[40:43],a[48:51],v[144:147]
MF v[180:183],v[40:43],a[52:55],v[180:183]
ds_read_b128 v[36:39],v2 offset:9216
s_add_u32 m0,s29,18432
s_nop 0
buffer_load_dwordx4 v1,s[8:11],s88 offen offset:2048 sc1 lds
MF v[148:151],v[44:47],a[48:51],v[148:151]
MF v[184:187],v[44:47],a[52:55],v[184:187]
ds_read_b128 v[40:43],v2 offset:10240
s_waitcnt lgkmcnt(5)
MF v[152:155],v[16:19],a[48:51],v[152:155]
s_add_u32 m0,s29,19456
s_nop 0
buffer_load_dwordx4 v1,s[8:11],s89 offen offset:2048 sc1 lds
MF v[188:191],v[16:19],a[52:55],v[188:191]
ds_read_b128 v[44:47],v2 offset:11264
MF v[120:123],v[20:23],a[56:59],v[120:123]
MF v[156:159],v[20:23],a[60:63],v[156:159]
ds_read_b128 v[16:19],v2 offset:12288
s_waitcnt lgkmcnt(5)
MF v[124:127],v[24:27],a[56:59],v[124:127]
MF v[160:163],v[24:27],a[60:63],v[160:163]
ds_read_b128 v[20:23],v2 offset:13312
MF v[128:131],v[28:31],a[56:59],v[128:131]
MF v[164:167],v[28:31],a[60:63],v[164:167]
ds_read_b128 v[24:27],v2 offset:14336
s_waitcnt lgkmcnt(5)
MF v[132:135],v[32:35],a[56:59],v[132:135]
MF v[168:171],v[32:35],a[60:63],v[168:171]
ds_read_b128 v[28:31],v2 offset:15360
MF v[136:139],v[36:39],a[56:59],v[136:139]
MF v[172:175],v[36:39],a[60:63],v[172:175]
ds_read_b128 v[32:35],v2 offset:16384
s_waitcnt lgkmcnt(5)
MF v[140:143],v[40:43],a[56:59],v[140:143]
MF v[176:179],v[40:43],a[60:63],v[176:179]
ds_read_b128 v[36:39],v2 offset:17408
MF v[144:147],v[44:47],a[56:59],v[144:147]
MF v[180:183],v[44:47],a[60:63],v[180:183]
ds_read_b128 v[40:43],v2 offset:18432
s_waitcnt lgkmcnt(5)
MF v[148:151],v[16:19],a[56:59],v[148:151]
MF v[184:187],v[16:19],a[60:63],v[184:187]
ds_read_b128 v[44:47],v2 offset:19456
MF v[152:155],v[20:23],a[56:59],v[152:155]
s_waitcnt vmcnt(10)
v_max_u32 v240,v224,v225
v_max3_u32 v240,v240,v226,v227
v_max3_u32 v240,v240,v228,v229
v_max3_u32 v240,v240,v230,v231
v_max3_u32 v240,v240,v232,v233
v_max3_u32 v240,v240,v234,v235
v_max3_u32 v240,v240,v236,v237
v_max3_u32 v240,v240,v238,v239
v_cmp_eq_u32 vcc,-1,v240
s_cbranch_vccz k3_1_P3G
s_mov_b32 s53,0
k3_1_P3:
s_nop 7
s_nop 3
buffer_load_dwordx4 v[224:227],v1,s[8:11],s51 offen offset:0 sc0 sc1
buffer_load_dwordx4 v[228:231],v1,s[8:11],s51 offen offset:1024 sc0 sc1
buffer_load_dwordx4 v[232:235],v1,s[8:11],s51 offen offset:2048 sc0 sc1
buffer_load_dwordx4 v[236:239],v1,s[8:11],s51 offen offset:3072 sc0 sc1
s_add_u32 s53,s53,1
s_waitcnt vmcnt(0)
v_max_u32 v240,v224,v225
v_max3_u32 v240,v240,v226,v227
v_max3_u32 v240,v240,v228,v229
v_max3_u32 v240,v240,v230,v231
v_max3_u32 v240,v240,v232,v233
v_max3_u32 v240,v240,v234,v235
v_max3_u32 v240,v240,v236,v237
v_max3_u32 v240,v240,v238,v239
v_cmp_eq_u32 vcc,-1,v240
s_cbranch_vccz k3_1_P3G
s_cmp_lt_u32 s53,100000
s_cbranch_scc1 k3_1_P3
k3_1_P3G:
s_nop 7
s_nop 3
v_add_f32 v224,v224,v228
MF v[188:191],v[20:23],a[60:63],v[188:191]
ds_read_b128 v[16:19],v2 offset:20480
s_waitcnt lgkmcnt(5)
MF v[120:123],v[24:27],a[64:67],v[120:123]
v_add_f32 v225,v225,v229
v_add_f32 v226,v226,v230
MF v[156:159],v[24:27],a[68:71],v[156:159]
ds_read_b128 v[20:23],v2 offset:21504
v_add_f32 v227,v227,v231
MF v[124:127],v[28:31],a[64:67],v[124:127]
v_add_f32 v224,v224,v232
v_add_f32 v225,v225,v233
MF v[160:163],v[28:31],a[68:71],v[160:163]
ds_read_b128 v[24:27],v2 offset:22528
s_waitcnt lgkmcnt(5)
MF v[128:131],v[32:35],a[64:67],v[128:131]
v_add_f32 v226,v226,v234
v_add_f32 v227,v227,v235
MF v[164:167],v[32:35],a[68:71],v[164:167]
ds_read_b128 v[28:31],v2 offset:23552
v_add_f32 v224,v224,v236
MF v[132:135],v[36:39],a[64:67],v[132:135]
v_add_f32 v225,v225,v237
v_add_f32 v226,v226,v238
MF v[168:171],v[36:39],a[68:71],v[168:171]
ds_read_b128 v[32:35],v2 offset:24576
s_waitcnt lgkmcnt(5)
MF v[136:139],v[40:43],a[64:67],v[136:139]
v_add_f32 v227,v227,v239
v_mov_b32 v228,v224
MF v[172:175],v[40:43],a[68:71],v[172:175]
ds_read_b128 v[36:39],v2 offset:25600
v_mov_b32 v229,v225
MF v[140:143],v[44:47],a[64:67],v[140:143]
v_mov_b32 v230,v226
v_mov_b32 v231,v227
MF v[176:179],v[44:47],a[68:71],v[176:179]
ds_read_b128 v[40:43],v2 offset:26624
s_waitcnt lgkmcnt(5)
MF v[144:147],v[16:19],a[64:67],v[144:147]
v_permlane32_swap_b32 v224,v228
v_permlane32_swap_b32 v225,v229
MF v[180:183],v[16:19],a[68:71],v[180:183]
ds_read_b128 v[44:47],v2 offset:27648
v_permlane32_swap_b32 v226,v230
MF v[148:151],v[20:23],a[64:67],v[148:151]
v_permlane32_swap_b32 v227,v231
v_add_f32 v224,v224,v228
MF v[184:187],v[20:23],a[68:71],v[184:187]
ds_read_b128 v[16:19],v2 offset:28672
s_waitcnt lgkmcnt(5)
MF v[152:155],v[24:27],a[64:67],v[152:155]
v_add_f32 v225,v225,v229
v_add_f32 v226,v226,v230
MF v[188:191],v[24:27],a[68:71],v[188:191]
ds_read_b128 v[20:23],v2 offset:29696
v_add_f32 v227,v227,v231
MF v[120:123],v[28:31],a[72:75],v[120:123]
v_mov_b32 v228,v224
v_mov_b32 v229,v225
MF v[156:159],v[28:31],a[76:79],v[156:159]
ds_read_b128 v[24:27],v2 offset:30720
s_waitcnt lgkmcnt(5)
MF v[124:127],v[32:35],a[72:75],v[124:127]
v_mov_b32 v230,v226
v_mov_b32 v231,v227
MF v[160:163],v[32:35],a[76:79],v[160:163]
ds_read_b128 v[28:31],v2 offset:31744
v_permlane16_swap_b32 v224,v228
MF v[128:131],v[36:39],a[72:75],v[128:131]
v_permlane16_swap_b32 v225,v229
v_permlane16_swap_b32 v226,v230
MF v[164:167],v[36:39],a[76:79],v[164:167]
s_barrier
ds_read_b128 v[32:35],v2 offset:32768
s_waitcnt lgkmcnt(5)
MF v[132:135],v[40:43],a[72:75],v[132:135]
v_permlane16_swap_b32 v227,v231
v_add_f32 v224,v224,v228
MF v[168:171],v[40:43],a[76:79],v[168:171]
ds_read_b128 v[36:39],v2 offset:33792
v_add_f32 v225,v225,v229
MF v[136:139],v[44:47],a[72:75],v[136:139]
v_add_f32 v226,v226,v230
v_add_f32 v227,v227,v231
MF v[172:175],v[44:47],a[76:79],v[172:175]
ds_read_b128 v[40:43],v2 offset:34816
s_waitcnt lgkmcnt(5)
MF v[140:143],v[16:19],a[72:75],v[140:143]
v_mul_f32 v232,0xb9e38e39,v224
v_mul_f32 v233,0xb9e38e39,v226
MF v[176:179],v[16:19],a[76:79],v[176:179]
ds_read_b128 v[44:47],v2 offset:35840
v_mul_f32 v225,0x39e38e39,v225
MF v[144:147],v[20:23],a[72:75],v[144:147]
v_mul_f32 v227,0x39e38e39,v227
v_mul_f32 v224,v232,v232
MF v[180:183],v[20:23],a[76:79],v[180:183]
ds_read_b128 v[16:19],v2 offset:36864
s_waitcnt lgkmcnt(5)
MF v[148:151],v[24:27],a[72:75],v[148:151]
v_mul_f32 v226,v233,v233
v_sub_f32 v225,v225,v224
MF v[184:187],v[24:27],a[76:79],v[184:187]
ds_read_b128 v[20:23],v2 offset:37888
v_sub_f32 v227,v227,v226
MF v[152:155],v[28:31],a[72:75],v[152:155]
v_max_f32 v225,0,v225
v_max_f32 v227,0,v227
MF v[188:191],v[28:31],a[76:79],v[188:191]
ds_read_b128 v[24:27],v2 offset:38912
s_waitcnt lgkmcnt(5)
MF v[120:123],v[32:35],a[80:83],v[120:123]
v_add_f32 v225,0x3727c5ac,v225
v_add_f32 v227,0x3727c5ac,v227
MF v[156:159],v[32:35],a[84:87],v[156:159]
ds_read_b128 v[28:31],v2 offset:39936
v_rsq_f32 v234,v225
MF v[124:127],v[36:39],a[80:83],v[124:127]
v_rsq_f32 v235,v227
MF v[160:163],v[36:39],a[84:87],v[160:163]
ds_read_b128 v[32:35],v2 offset:40960
s_waitcnt lgkmcnt(5)
MF v[128:131],v[40:43],a[80:83],v[128:131]
v_mul_f32 v232,v232,v234
v_mul_f32 v233,v233,v235
MF v[164:167],v[40:43],a[84:87],v[164:167]
ds_read_b128 v[36:39],v2 offset:41984
v_lshlrev_b32 v4,3,v14
MF v[132:135],v[44:47],a[80:83],v[132:135]
v_add_u32 v4,s30,v4
s_mov_b64 exec,0xffff
ds_write_b64 v4,v[232:233]
ds_write_b64 v4,v[234:235] offset:128
s_mov_b64 exec,-1
MF v[168:171],v[44:47],a[84:87],v[168:171]
ds_read_b128 v[40:43],v2 offset:43008
s_waitcnt lgkmcnt(7)
MF v[136:139],v[16:19],a[80:83],v[136:139]
ds_read_b128 v[202:205],v252 offset:0
ds_read_b128 v[210:213],v252 offset:128
MF v[172:175],v[16:19],a[84:87],v[172:175]
ds_read_b128 v[44:47],v2 offset:44032
ds_read_b128 v[206:209],v252 offset:64
MF v[140:143],v[20:23],a[80:83],v[140:143]
ds_read_b128 v[214:217],v252 offset:192
s_add_u32 m0,s21,51200
s_nop 0
buffer_load_dwordx4 v1,s[8:11],s90 offen offset:2048 sc1 lds
MF v[176:179],v[20:23],a[84:87],v[176:179]
ds_read_b128 v[16:19],v2 offset:45056
s_waitcnt lgkmcnt(11)
MF v[144:147],v[24:27],a[80:83],v[144:147]
MF v[180:183],v[24:27],a[84:87],v[180:183]
ds_read_b128 v[20:23],v2 offset:46080
s_add_u32 m0,s21,52224
s_nop 0
buffer_load_dwordx4 v1,s[8:11],s91 offen offset:2048 sc1 lds
MF v[148:151],v[28:31],a[80:83],v[148:151]
MF v[184:187],v[28:31],a[84:87],v[184:187]
ds_read_b128 v[24:27],v2 offset:47104
s_waitcnt lgkmcnt(11)
MF v[152:155],v[32:35],a[80:83],v[152:155]
s_waitcnt lgkmcnt(3)
v_fma_f32 v48,v48,v210,v202
MF v[188:191],v[32:35],a[84:87],v[188:191]
ds_read_b128 v[28:31],v2 offset:48128
v_fma_f32 v49,v49,v211,v203
MF v[120:123],v[36:39],a[88:91],v[120:123]
v_fma_f32 v50,v50,v212,v204
v_fma_f32 v51,v51,v213,v205
MF v[156:159],v[36:39],a[92:95],v[156:159]
ds_read_b128 v[32:35],v2 offset:49152
v_cvt_pk_bf16_f32 v48,v48,v49
MF v[124:127],v[40:43],a[88:91],v[124:127]
v_cvt_pk_bf16_f32 v49,v50,v51
buffer_store_dwordx2 v[48:49],v222,s[8:11],s34 offen offset:0 sc1
MF v[160:163],v[40:43],a[92:95],v[160:163]
ds_read_b128 v[36:39],v2 offset:50176
v_fma_f32 v84,v84,v214,v206
MF v[128:131],v[44:47],a[88:91],v[128:131]
v_fma_f32 v85,v85,v215,v207
v_fma_f32 v86,v86,v216,v208
MF v[164:167],v[44:47],a[92:95],v[164:167]
ds_read_b128 v[40:43],v2 offset:51200
s_waitcnt lgkmcnt(5)
MF v[132:135],v[16:19],a[88:91],v[132:135]
v_fma_f32 v87,v87,v217,v209
v_cvt_pk_bf16_f32 v84,v84,v85
MF v[168:171],v[16:19],a[92:95],v[168:171]
ds_read_b128 v[44:47],v2 offset:52224
v_cvt_pk_bf16_f32 v85,v86,v87
MF v[136:139],v[20:23],a[88:91],v[136:139]
buffer_store_dwordx2 v[84:85],v222,s[8:11],s34 offen offset:512 sc1
v_fma_f32 v52,v52,v210,v202
MF v[172:175],v[20:23],a[92:95],v[172:175]
ds_read_b128 v[16:19],v2 offset:53248
s_waitcnt lgkmcnt(5)
MF v[140:143],v[24:27],a[88:91],v[140:143]
v_fma_f32 v53,v53,v211,v203
v_fma_f32 v54,v54,v212,v204
MF v[176:179],v[24:27],a[92:95],v[176:179]
ds_read_b128 v[20:23],v2 offset:54272
v_fma_f32 v55,v55,v213,v205
MF v[144:147],v[28:31],a[88:91],v[144:147]
v_cvt_pk_bf16_f32 v52,v52,v53
v_cvt_pk_bf16_f32 v53,v54,v55
MF v[180:183],v[28:31],a[92:95],v[180:183]
ds_read_b128 v[24:27],v2 offset:55296
s_waitcnt lgkmcnt(5)
MF v[148:151],v[32:35],a[88:91],v[148:151]
buffer_store_dwordx2 v[52:53],v222,s[8:11],s34 offen offset:1024 sc1
v_fma_f32 v88,v88,v214,v206
MF v[184:187],v[32:35],a[92:95],v[184:187]
ds_read_b128 v[28:31],v2 offset:56320
v_fma_f32 v89,v89,v215,v207
MF v[152:155],v[36:39],a[88:91],v[152:155]
v_fma_f32 v90,v90,v216,v208
v_fma_f32 v91,v91,v217,v209
MF v[188:191],v[36:39],a[92:95],v[188:191]
ds_read_b128 v[32:35],v2 offset:57344
s_waitcnt lgkmcnt(5)
MF v[120:123],v[40:43],a[96:99],v[120:123]
v_cvt_pk_bf16_f32 v88,v88,v89
v_cvt_pk_bf16_f32 v89,v90,v91
MF v[156:159],v[40:43],a[100:103],v[156:159]
ds_read_b128 v[36:39],v2 offset:58368
buffer_store_dwordx2 v[88:89],v222,s[8:11],s34 offen offset:1536 sc1
MF v[124:127],v[44:47],a[96:99],v[124:127]
v_fma_f32 v56,v56,v210,v202
v_fma_f32 v57,v57,v211,v203
MF v[160:163],v[44:47],a[100:103],v[160:163]
ds_read_b128 v[40:43],v2 offset:59392
s_waitcnt lgkmcnt(5)
MF v[128:131],v[16:19],a[96:99],v[128:131]
v_fma_f32 v58,v58,v212,v204
v_fma_f32 v59,v59,v213,v205
MF v[164:167],v[16:19],a[100:103],v[164:167]
ds_read_b128 v[44:47],v2 offset:60416
v_cvt_pk_bf16_f32 v56,v56,v57
MF v[132:135],v[20:23],a[96:99],v[132:135]
v_cvt_pk_bf16_f32 v57,v58,v59
buffer_store_dwordx2 v[56:57],v222,s[8:11],s34 offen offset:2048 sc1
MF v[168:171],v[20:23],a[100:103],v[168:171]
ds_read_b128 v[16:19],v2 offset:61440
s_waitcnt lgkmcnt(5)
MF v[136:139],v[24:27],a[96:99],v[136:139]
v_fma_f32 v92,v92,v214,v206
v_fma_f32 v93,v93,v215,v207
MF v[172:175],v[24:27],a[100:103],v[172:175]
ds_read_b128 v[20:23],v2 offset:62464
v_fma_f32 v94,v94,v216,v208
MF v[140:143],v[28:31],a[96:99],v[140:143]
v_fma_f32 v95,v95,v217,v209
v_cvt_pk_bf16_f32 v92,v92,v93
MF v[176:179],v[28:31],a[100:103],v[176:179]
ds_read_b128 v[24:27],v2 offset:63488
s_waitcnt lgkmcnt(5)
MF v[144:147],v[32:35],a[96:99],v[144:147]
v_cvt_pk_bf16_f32 v93,v94,v95
buffer_store_dwordx2 v[92:93],v222,s[8:11],s34 offen offset:2560 sc1
MF v[180:183],v[32:35],a[100:103],v[180:183]
ds_read_b128 v[28:31],v2 offset:64512
v_fma_f32 v60,v60,v210,v202
MF v[148:151],v[36:39],a[96:99],v[148:151]
v_fma_f32 v61,v61,v211,v203
v_fma_f32 v62,v62,v212,v204
MF v[184:187],v[36:39],a[100:103],v[184:187]
ds_read_b128 v[32:35],v3 offset:0
s_waitcnt lgkmcnt(5)
MF v[152:155],v[40:43],a[96:99],v[152:155]
v_fma_f32 v63,v63,v213,v205
v_cvt_pk_bf16_f32 v60,v60,v61
MF v[188:191],v[40:43],a[100:103],v[188:191]
ds_read_b128 v[36:39],v3 offset:1024
v_cvt_pk_bf16_f32 v61,v62,v63
MF v[120:123],v[44:47],a[104:107],v[120:123]
buffer_store_dwordx2 v[60:61],v222,s[8:11],s34 offen offset:3072 sc1
v_fma_f32 v96,v96,v214,v206
MF v[156:159],v[44:47],a[108:111],v[156:159]
ds_read_b128 v[40:43],v3 offset:2048
s_waitcnt lgkmcnt(5)
MF v[124:127],v[16:19],a[104:107],v[124:127]
v_fma_f32 v97,v97,v215,v207
v_fma_f32 v98,v98,v216,v208
MF v[160:163],v[16:19],a[108:111],v[160:163]
ds_read_b128 v[44:47],v3 offset:3072
v_fma_f32 v99,v99,v217,v209
MF v[128:131],v[20:23],a[104:107],v[128:131]
v_cvt_pk_bf16_f32 v96,v96,v97
v_cvt_pk_bf16_f32 v97,v98,v99
MF v[164:167],v[20:23],a[108:111],v[164:167]
s_barrier
ds_read_b128 v[16:19],v3 offset:4096
s_waitcnt lgkmcnt(5)
MF v[132:135],v[24:27],a[104:107],v[132:135]
buffer_store_dwordx2 v[96:97],v222,s[8:11],s34 offen offset:3584 sc1
v_fma_f32 v64,v64,v210,v202
MF v[168:171],v[24:27],a[108:111],v[168:171]
ds_read_b128 v[20:23],v3 offset:5120
v_fma_f32 v65,v65,v211,v203
MF v[136:139],v[28:31],a[104:107],v[136:139]
v_fma_f32 v66,v66,v212,v204
v_fma_f32 v67,v67,v213,v205
MF v[172:175],v[28:31],a[108:111],v[172:175]
ds_read_b128 v[24:27],v3 offset:6144
s_waitcnt lgkmcnt(5)
MF v[140:143],v[32:35],a[104:107],v[140:143]
v_cvt_pk_bf16_f32 v64,v64,v65
v_cvt_pk_bf16_f32 v65,v66,v67
MF v[176:179],v[32:35],a[108:111],v[176:179]
ds_read_b128 v[28:31],v3 offset:7168
buffer_store_dwordx2 v[64:65],v222,s[8:11],s35 offen offset:0 sc1
MF v[144:147],v[36:39],a[104:107],v[144:147]
v_fma_f32 v100,v100,v214,v206
v_fma_f32 v101,v101,v215,v207
MF v[180:183],v[36:39],a[108:111],v[180:183]
ds_read_b128 v[32:35],v3 offset:8192
s_waitcnt lgkmcnt(5)
MF v[148:151],v[40:43],a[104:107],v[148:151]
v_fma_f32 v102,v102,v216,v208
v_fma_f32 v103,v103,v217,v209
MF v[184:187],v[40:43],a[108:111],v[184:187]
ds_read_b128 v[36:39],v3 offset:9216
v_cvt_pk_bf16_f32 v100,v100,v101
MF v[152:155],v[44:47],a[104:107],v[152:155]
v_cvt_pk_bf16_f32 v101,v102,v103
buffer_store_dwordx2 v[100:101],v222,s[8:11],s35 offen offset:512 sc1
MF v[188:191],v[44:47],a[108:111],v[188:191]
ds_read_b128 v[40:43],v3 offset:10240
s_waitcnt lgkmcnt(5)
MF v[120:123],v[16:19],a[112:115],v[120:123]
v_fma_f32 v68,v68,v210,v202
v_fma_f32 v69,v69,v211,v203
MF v[156:159],v[16:19],a[116:119],v[156:159]
ds_read_b128 v[44:47],v3 offset:11264
v_fma_f32 v70,v70,v212,v204
MF v[124:127],v[20:23],a[112:115],v[124:127]
v_fma_f32 v71,v71,v213,v205
v_cvt_pk_bf16_f32 v68,v68,v69
MF v[160:163],v[20:23],a[116:119],v[160:163]
ds_read_b128 v[16:19],v3 offset:12288
s_waitcnt lgkmcnt(5)
MF v[128:131],v[24:27],a[112:115],v[128:131]
v_cvt_pk_bf16_f32 v69,v70,v71
buffer_store_dwordx2 v[68:69],v222,s[8:11],s35 offen offset:1024 sc1
MF v[164:167],v[24:27],a[116:119],v[164:167]
ds_read_b128 v[20:23],v3 offset:13312
v_fma_f32 v104,v104,v214,v206
MF v[132:135],v[28:31],a[112:115],v[132:135]
v_fma_f32 v105,v105,v215,v207
v_fma_f32 v106,v106,v216,v208
MF v[168:171],v[28:31],a[116:119],v[168:171]
ds_read_b128 v[24:27],v3 offset:14336
s_waitcnt lgkmcnt(5)
MF v[136:139],v[32:35],a[112:115],v[136:139]
v_fma_f32 v107,v107,v217,v209
v_cvt_pk_bf16_f32 v104,v104,v105
MF v[172:175],v[32:35],a[116:119],v[172:175]
ds_read_b128 v[28:31],v3 offset:15360
v_cvt_pk_bf16_f32 v105,v106,v107
MF v[140:143],v[36:39],a[112:115],v[140:143]
buffer_store_dwordx2 v[104:105],v222,s[8:11],s35 offen offset:1536 sc1
v_fma_f32 v72,v72,v210,v202
MF v[176:179],v[36:39],a[116:119],v[176:179]
ds_read_b128 v[32:35],v3 offset:16384
s_waitcnt lgkmcnt(5)
MF v[144:147],v[40:43],a[112:115],v[144:147]
v_fma_f32 v73,v73,v211,v203
v_fma_f32 v74,v74,v212,v204
MF v[180:183],v[40:43],a[116:119],v[180:183]
ds_read_b128 v[36:39],v3 offset:17408
v_fma_f32 v75,v75,v213,v205
MF v[148:151],v[44:47],a[112:115],v[148:151]
v_cvt_pk_bf16_f32 v72,v72,v73
v_cvt_pk_bf16_f32 v73,v74,v75
MF v[184:187],v[44:47],a[116:119],v[184:187]
ds_read_b128 v[40:43],v3 offset:18432
s_waitcnt lgkmcnt(5)
MF v[152:155],v[16:19],a[112:115],v[152:155]
buffer_store_dwordx2 v[72:73],v222,s[8:11],s35 offen offset:2048 sc1
v_fma_f32 v108,v108,v214,v206
MF v[188:191],v[16:19],a[116:119],v[188:191]
ds_read_b128 v[44:47],v3 offset:19456
v_fma_f32 v109,v109,v215,v207
MF v[120:123],v[20:23],a[120:123],v[120:123]
v_fma_f32 v110,v110,v216,v208
v_fma_f32 v111,v111,v217,v209
MF v[156:159],v[20:23],a[124:127],v[156:159]
ds_read_b128 v[16:19],v3 offset:20480
s_waitcnt lgkmcnt(5)
MF v[124:127],v[24:27],a[120:123],v[124:127]
v_cvt_pk_bf16_f32 v108,v108,v109
v_cvt_pk_bf16_f32 v109,v110,v111
MF v[160:163],v[24:27],a[124:127],v[160:163]
ds_read_b128 v[20:23],v3 offset:21504
buffer_store_dwordx2 v[108:109],v222,s[8:11],s35 offen offset:2560 sc1
MF v[128:131],v[28:31],a[120:123],v[128:131]
v_fma_f32 v76,v76,v210,v202
v_fma_f32 v77,v77,v211,v203
MF v[164:167],v[28:31],a[124:127],v[164:167]
ds_read_b128 v[24:27],v3 offset:22528
s_waitcnt lgkmcnt(5)
MF v[132:135],v[32:35],a[120:123],v[132:135]
v_fma_f32 v78,v78,v212,v204
v_fma_f32 v79,v79,v213,v205
MF v[168:171],v[32:35],a[124:127],v[168:171]
ds_read_b128 v[28:31],v3 offset:23552
v_cvt_pk_bf16_f32 v76,v76,v77
MF v[136:139],v[36:39],a[120:123],v[136:139]
v_cvt_pk_bf16_f32 v77,v78,v79
buffer_store_dwordx2 v[76:77],v222,s[8:11],s35 offen offset:3072 sc1
MF v[172:175],v[36:39],a[124:127],v[172:175]
ds_read_b128 v[32:35],v3 offset:24576
s_waitcnt lgkmcnt(5)
MF v[140:143],v[40:43],a[120:123],v[140:143]
v_fma_f32 v112,v112,v214,v206
v_fma_f32 v113,v113,v215,v207
MF v[176:179],v[40:43],a[124:127],v[176:179]
ds_read_b128 v[36:39],v3 offset:25600
v_fma_f32 v114,v114,v216,v208
MF v[144:147],v[44:47],a[120:123],v[144:147]
v_fma_f32 v115,v115,v217,v209
v_cvt_pk_bf16_f32 v112,v112,v113
MF v[180:183],v[44:47],a[124:127],v[180:183]
ds_read_b128 v[40:43],v3 offset:26624
s_waitcnt lgkmcnt(5)
MF v[148:151],v[16:19],a[120:123],v[148:151]
v_cvt_pk_bf16_f32 v113,v114,v115
buffer_store_dwordx2 v[112:113],v222,s[8:11],s35 offen offset:3584 sc1
MF v[184:187],v[16:19],a[124:127],v[184:187]
ds_read_b128 v[44:47],v3 offset:27648
v_fma_f32 v80,v80,v210,v202
MF v[152:155],v[20:23],a[120:123],v[152:155]
v_fma_f32 v81,v81,v211,v203
v_fma_f32 v82,v82,v212,v204
MF v[188:191],v[20:23],a[124:127],v[188:191]
ds_read_b128 v[16:19],v1 offset:0
s_waitcnt lgkmcnt(5)
MF v[120:123],v[24:27],a[128:131],v[120:123]
v_fma_f32 v83,v83,v213,v205
v_cvt_pk_bf16_f32 v80,v80,v81
MF v[156:159],v[24:27],a[132:135],v[156:159]
ds_read_b128 v[20:23],v1 offset:1024
v_cvt_pk_bf16_f32 v81,v82,v83
MF v[124:127],v[28:31],a[128:131],v[124:127]
buffer_store_dwordx2 v[80:81],v222,s[8:11],s36 offen offset:0 sc1
v_fma_f32 v116,v116,v214,v206
MF v[160:163],v[28:31],a[132:135],v[160:163]
ds_read_b128 v[24:27],v1 offset:2048
s_waitcnt lgkmcnt(5)
MF v[128:131],v[32:35],a[128:131],v[128:131]
v_fma_f32 v117,v117,v215,v207
v_fma_f32 v118,v118,v216,v208
MF v[164:167],v[32:35],a[132:135],v[164:167]
ds_read_b128 v[28:31],v1 offset:3072
v_fma_f32 v119,v119,v217,v209
MF v[132:135],v[36:39],a[128:131],v[132:135]
v_cvt_pk_bf16_f32 v116,v116,v117
v_cvt_pk_bf16_f32 v117,v118,v119
MF v[168:171],v[36:39],a[132:135],v[168:171]
ds_read_b128 v[32:35],v1 offset:4096
s_waitcnt lgkmcnt(5)
MF v[136:139],v[40:43],a[128:131],v[136:139]
buffer_store_dwordx2 v[116:117],v222,s[8:11],s36 offen offset:512 sc1
v_lshlrev_b32 v13,4,v15
v_add_u32 v13,161344,v13
MF v[172:175],v[40:43],a[132:135],v[172:175]
ds_read_b128 v[36:39],v1 offset:5120
ds_read_b128 v[48:51],v13 offset:0
MF v[140:143],v[44:47],a[128:131],v[140:143]
ds_read_b128 v[52:55],v13 offset:64
ds_read_b128 v[56:59],v13 offset:128
MF v[176:179],v[44:47],a[132:135],v[176:179]
ds_read_b128 v[40:43],v1 offset:6144
s_waitcnt lgkmcnt(8)
MF v[144:147],v[16:19],a[128:131],v[144:147]
ds_read_b128 v[60:63],v13 offset:192
ds_read_b128 v[64:67],v13 offset:256
MF v[180:183],v[16:19],a[132:135],v[180:183]
ds_read_b128 v[44:47],v1 offset:7168
ds_read_b128 v[68:71],v13 offset:320
MF v[148:151],v[20:23],a[128:131],v[148:151]
ds_read_b128 v[72:75],v13 offset:384
ds_read_b128 v[76:79],v13 offset:448
MF v[184:187],v[20:23],a[132:135],v[184:187]
ds_read_b128 v[16:19],v1 offset:8192
s_waitcnt lgkmcnt(13)
MF v[152:155],v[24:27],a[128:131],v[152:155]
ds_read_b128 v[80:83],v13 offset:512
s_add_u32 m0,s21,52224
s_nop 0
buffer_load_dwordx4 v1,s[8:11],s84 offen offset:3072 sc1 lds
MF v[188:191],v[24:27],a[132:135],v[188:191]
ds_read_b128 v[20:23],v1 offset:9216
MF v[120:123],v[28:31],a[136:139],v[120:123]
s_add_u32 m0,s21,53248
s_nop 0
buffer_load_dwordx4 v1,s[8:11],s85 offen offset:3072 sc1 lds
MF v[156:159],v[28:31],a[140:143],v[156:159]
s_waitcnt lgkmcnt(12)
ds_read_b128 v[24:27],v1 offset:10240
MF v[124:127],v[32:35],a[136:139],v[124:127]
MF v[160:163],v[32:35],a[140:143],v[160:163]
ds_read_b128 v[28:31],v1 offset:11264
s_add_u32 m0,s21,54272
s_nop 0
buffer_load_dwordx4 v1,s[8:11],s86 offen offset:3072 sc1 lds
MF v[128:131],v[36:39],a[136:139],v[128:131]
MF v[164:167],v[36:39],a[140:143],v[164:167]
s_waitcnt lgkmcnt(8)
s_add_u32 m0,s21,55296
s_nop 0
buffer_load_dwordx4 v1,s[8:11],s87 offen offset:3072 sc1 lds
MF v[132:135],v[40:43],a[136:139],v[132:135]
MF v[168:171],v[40:43],a[140:143],v[168:171]
s_add_u32 m0,s21,56320
s_nop 0
buffer_load_dwordx4 v1,s[8:11],s88 offen offset:3072 sc1 lds
MF v[136:139],v[44:47],a[136:139],v[136:139]
MF v[172:175],v[44:47],a[140:143],v[172:175]
s_waitcnt lgkmcnt(2)
s_add_u32 m0,s21,57344
s_nop 0
buffer_load_dwordx4 v1,s[8:11],s89 offen offset:3072 sc1 lds
MF v[140:143],v[16:19],a[136:139],v[140:143]
MF v[176:179],v[16:19],a[140:143],v[176:179]
MF v[144:147],v[20:23],a[136:139],v[144:147]
MF v[180:183],v[20:23],a[140:143],v[180:183]
s_waitcnt lgkmcnt(0)
MF v[148:151],v[24:27],a[136:139],v[148:151]
MF v[184:187],v[24:27],a[140:143],v[184:187]
MF v[152:155],v[28:31],a[136:139],v[152:155]
MF v[188:191],v[28:31],a[140:143],v[188:191]
v_mov_b32 v13,1
v_mov_b32 v12,0
s_waitcnt vmcnt(6)
s_mov_b32 exec_lo,0x1
s_mov_b32 exec_hi,0x0
buffer_atomic_or v13,v12,s[8:11],s78 offen sc1
s_mov_b64 exec,-1
s_lshl_b32 s46,s44,4
s_add_u32 s46,s46,s45
s_lshl_b32 s46,s46,3
s_lshl_b32 s47,s22,1
s_add_u32 s46,s46,s47
s_mul_i32 s46,s46,4608
s_add_u32 s34,s46,0x4d00000
s_add_u32 s35,s34,4096
s_add_u32 s36,s34,8192
v_lshlrev_b32 v9,3,v0
s_waitcnt lgkmcnt(0)
s_nop 7
v_pk_fma_f32 v[120:121],v[218:219],v[48:49],v[120:121] op_sel_hi:[0,1,1]
v_pk_fma_f32 v[122:123],v[218:219],v[50:51],v[122:123] op_sel_hi:[0,1,1]
v_pk_fma_f32 v[156:157],v[218:219],v[48:49],v[156:157] op_sel:[1,0,0]
v_pk_fma_f32 v[158:159],v[218:219],v[50:51],v[158:159] op_sel:[1,0,0]
v_pk_mul_f32 v[120:121],v[120:121],v[220:221] op_sel_hi:[1,0]
v_pk_mul_f32 v[122:123],v[122:123],v[220:221] op_sel_hi:[1,0]
v_pk_mul_f32 v[156:157],v[156:157],v[220:221] op_sel:[0,1]
v_pk_mul_f32 v[158:159],v[158:159],v[220:221] op_sel:[0,1]
v_cvt_pk_bf16_f32 v120,v120,v121
v_cvt_pk_bf16_f32 v121,v122,v123
v_accvgpr_write_b32 a216,v120
v_accvgpr_write_b32 a217,v121
v_cvt_pk_bf16_f32 v156,v156,v157
v_cvt_pk_bf16_f32 v157,v158,v159
v_accvgpr_write_b32 a234,v156
v_accvgpr_write_b32 a235,v157
v_pk_fma_f32 v[124:125],v[218:219],v[52:53],v[124:125] op_sel_hi:[0,1,1]
v_pk_fma_f32 v[126:127],v[218:219],v[54:55],v[126:127] op_sel_hi:[0,1,1]
v_pk_fma_f32 v[160:161],v[218:219],v[52:53],v[160:161] op_sel:[1,0,0]
v_pk_fma_f32 v[162:163],v[218:219],v[54:55],v[162:163] op_sel:[1,0,0]
v_pk_mul_f32 v[124:125],v[124:125],v[220:221] op_sel_hi:[1,0]
v_pk_mul_f32 v[126:127],v[126:127],v[220:221] op_sel_hi:[1,0]
v_pk_mul_f32 v[160:161],v[160:161],v[220:221] op_sel:[0,1]
v_pk_mul_f32 v[162:163],v[162:163],v[220:221] op_sel:[0,1]
v_cvt_pk_bf16_f32 v124,v124,v125
v_cvt_pk_bf16_f32 v125,v126,v127
v_accvgpr_write_b32 a218,v124
v_accvgpr_write_b32 a219,v125
v_cvt_pk_bf16_f32 v160,v160,v161
v_cvt_pk_bf16_f32 v161,v162,v163
v_accvgpr_write_b32 a236,v160
v_accvgpr_write_b32 a237,v161
v_pk_fma_f32 v[128:129],v[218:219],v[56:57],v[128:129] op_sel_hi:[0,1,1]
v_pk_fma_f32 v[130:131],v[218:219],v[58:59],v[130:131] op_sel_hi:[0,1,1]
v_pk_fma_f32 v[164:165],v[218:219],v[56:57],v[164:165] op_sel:[1,0,0]
v_pk_fma_f32 v[166:167],v[218:219],v[58:59],v[166:167] op_sel:[1,0,0]
v_pk_mul_f32 v[128:129],v[128:129],v[220:221] op_sel_hi:[1,0]
v_pk_mul_f32 v[130:131],v[130:131],v[220:221] op_sel_hi:[1,0]
v_pk_mul_f32 v[164:165],v[164:165],v[220:221] op_sel:[0,1]
v_pk_mul_f32 v[166:167],v[166:167],v[220:221] op_sel:[0,1]
v_cvt_pk_bf16_f32 v128,v128,v129
v_cvt_pk_bf16_f32 v129,v130,v131
v_accvgpr_write_b32 a220,v128
v_accvgpr_write_b32 a221,v129
v_cvt_pk_bf16_f32 v164,v164,v165
v_cvt_pk_bf16_f32 v165,v166,v167
v_accvgpr_write_b32 a238,v164
v_accvgpr_write_b32 a239,v165
v_pk_fma_f32 v[132:133],v[218:219],v[60:61],v[132:133] op_sel_hi:[0,1,1]
v_pk_fma_f32 v[134:135],v[218:219],v[62:63],v[134:135] op_sel_hi:[0,1,1]
v_pk_fma_f32 v[168:169],v[218:219],v[60:61],v[168:169] op_sel:[1,0,0]
v_pk_fma_f32 v[170:171],v[218:219],v[62:63],v[170:171] op_sel:[1,0,0]
v_pk_mul_f32 v[132:133],v[132:133],v[220:221] op_sel_hi:[1,0]
v_pk_mul_f32 v[134:135],v[134:135],v[220:221] op_sel_hi:[1,0]
v_pk_mul_f32 v[168:169],v[168:169],v[220:221] op_sel:[0,1]
v_pk_mul_f32 v[170:171],v[170:171],v[220:221] op_sel:[0,1]
v_cvt_pk_bf16_f32 v132,v132,v133
v_cvt_pk_bf16_f32 v133,v134,v135
v_accvgpr_write_b32 a222,v132
v_accvgpr_write_b32 a223,v133
v_cvt_pk_bf16_f32 v168,v168,v169
v_cvt_pk_bf16_f32 v169,v170,v171
v_accvgpr_write_b32 a240,v168
v_accvgpr_write_b32 a241,v169
v_pk_fma_f32 v[136:137],v[218:219],v[64:65],v[136:137] op_sel_hi:[0,1,1]
v_pk_fma_f32 v[138:139],v[218:219],v[66:67],v[138:139] op_sel_hi:[0,1,1]
v_pk_fma_f32 v[172:173],v[218:219],v[64:65],v[172:173] op_sel:[1,0,0]
v_pk_fma_f32 v[174:175],v[218:219],v[66:67],v[174:175] op_sel:[1,0,0]
v_pk_mul_f32 v[136:137],v[136:137],v[220:221] op_sel_hi:[1,0]
v_pk_mul_f32 v[138:139],v[138:139],v[220:221] op_sel_hi:[1,0]
v_pk_mul_f32 v[172:173],v[172:173],v[220:221] op_sel:[0,1]
v_pk_mul_f32 v[174:175],v[174:175],v[220:221] op_sel:[0,1]
v_cvt_pk_bf16_f32 v136,v136,v137
v_cvt_pk_bf16_f32 v137,v138,v139
v_accvgpr_write_b32 a224,v136
v_accvgpr_write_b32 a225,v137
v_cvt_pk_bf16_f32 v172,v172,v173
v_cvt_pk_bf16_f32 v173,v174,v175
v_accvgpr_write_b32 a242,v172
v_accvgpr_write_b32 a243,v173
v_pk_fma_f32 v[140:141],v[218:219],v[68:69],v[140:141] op_sel_hi:[0,1,1]
v_pk_fma_f32 v[142:143],v[218:219],v[70:71],v[142:143] op_sel_hi:[0,1,1]
v_pk_fma_f32 v[176:177],v[218:219],v[68:69],v[176:177] op_sel:[1,0,0]
v_pk_fma_f32 v[178:179],v[218:219],v[70:71],v[178:179] op_sel:[1,0,0]
v_pk_mul_f32 v[140:141],v[140:141],v[220:221] op_sel_hi:[1,0]
v_pk_mul_f32 v[142:143],v[142:143],v[220:221] op_sel_hi:[1,0]
v_pk_mul_f32 v[176:177],v[176:177],v[220:221] op_sel:[0,1]
v_pk_mul_f32 v[178:179],v[178:179],v[220:221] op_sel:[0,1]
v_cvt_pk_bf16_f32 v140,v140,v141
v_cvt_pk_bf16_f32 v141,v142,v143
v_accvgpr_write_b32 a226,v140
v_accvgpr_write_b32 a227,v141
v_cvt_pk_bf16_f32 v176,v176,v177
v_cvt_pk_bf16_f32 v177,v178,v179
v_accvgpr_write_b32 a244,v176
v_accvgpr_write_b32 a245,v177
v_pk_fma_f32 v[144:145],v[218:219],v[72:73],v[144:145] op_sel_hi:[0,1,1]
v_pk_fma_f32 v[146:147],v[218:219],v[74:75],v[146:147] op_sel_hi:[0,1,1]
v_pk_fma_f32 v[180:181],v[218:219],v[72:73],v[180:181] op_sel:[1,0,0]
v_pk_fma_f32 v[182:183],v[218:219],v[74:75],v[182:183] op_sel:[1,0,0]
v_pk_mul_f32 v[144:145],v[144:145],v[220:221] op_sel_hi:[1,0]
v_pk_mul_f32 v[146:147],v[146:147],v[220:221] op_sel_hi:[1,0]
v_pk_mul_f32 v[180:181],v[180:181],v[220:221] op_sel:[0,1]
v_pk_mul_f32 v[182:183],v[182:183],v[220:221] op_sel:[0,1]
v_cvt_pk_bf16_f32 v144,v144,v145
v_cvt_pk_bf16_f32 v145,v146,v147
v_accvgpr_write_b32 a228,v144
v_accvgpr_write_b32 a229,v145
v_cvt_pk_bf16_f32 v180,v180,v181
v_cvt_pk_bf16_f32 v181,v182,v183
v_accvgpr_write_b32 a246,v180
v_accvgpr_write_b32 a247,v181
v_pk_fma_f32 v[148:149],v[218:219],v[76:77],v[148:149] op_sel_hi:[0,1,1]
v_pk_fma_f32 v[150:151],v[218:219],v[78:79],v[150:151] op_sel_hi:[0,1,1]
v_pk_fma_f32 v[184:185],v[218:219],v[76:77],v[184:185] op_sel:[1,0,0]
v_pk_fma_f32 v[186:187],v[218:219],v[78:79],v[186:187] op_sel:[1,0,0]
v_pk_mul_f32 v[148:149],v[148:149],v[220:221] op_sel_hi:[1,0]
v_pk_mul_f32 v[150:151],v[150:151],v[220:221] op_sel_hi:[1,0]
v_pk_mul_f32 v[184:185],v[184:185],v[220:221] op_sel:[0,1]
v_pk_mul_f32 v[186:187],v[186:187],v[220:221] op_sel:[0,1]
v_cvt_pk_bf16_f32 v148,v148,v149
v_cvt_pk_bf16_f32 v149,v150,v151
v_accvgpr_write_b32 a230,v148
v_accvgpr_write_b32 a231,v149
v_cvt_pk_bf16_f32 v184,v184,v185
v_cvt_pk_bf16_f32 v185,v186,v187
v_accvgpr_write_b32 a248,v184
v_accvgpr_write_b32 a249,v185
v_pk_fma_f32 v[152:153],v[218:219],v[80:81],v[152:153] op_sel_hi:[0,1,1]
v_pk_fma_f32 v[154:155],v[218:219],v[82:83],v[154:155] op_sel_hi:[0,1,1]
v_pk_fma_f32 v[188:189],v[218:219],v[80:81],v[188:189] op_sel:[1,0,0]
v_pk_fma_f32 v[190:191],v[218:219],v[82:83],v[190:191] op_sel:[1,0,0]
v_pk_mul_f32 v[152:153],v[152:153],v[220:221] op_sel_hi:[1,0]
v_pk_mul_f32 v[154:155],v[154:155],v[220:221] op_sel_hi:[1,0]
v_pk_mul_f32 v[188:189],v[188:189],v[220:221] op_sel:[0,1]
v_pk_mul_f32 v[190:191],v[190:191],v[220:221] op_sel:[0,1]
v_cvt_pk_bf16_f32 v152,v152,v153
v_cvt_pk_bf16_f32 v153,v154,v155
v_accvgpr_write_b32 a232,v152
v_accvgpr_write_b32 a233,v153
v_cvt_pk_bf16_f32 v188,v188,v189
v_cvt_pk_bf16_f32 v189,v190,v191
v_accvgpr_write_b32 a250,v188
v_accvgpr_write_b32 a251,v189
PH_k4_1:
s_and_b32 s44,s3,1
s_lshl_b32 s44,s44,3
s_and_b32 s45,s23,7
s_add_u32 s44,s44,s45
s_lshr_b32 s45,s3,1
s_lshl_b32 s45,s45,2
s_lshr_b32 s46,s23,3
s_add_u32 s45,s45,s46
v_add_u32 v2,4096,v1
v_add_u32 v3,8192,v1
v_add_u32 v4,12288,v1
s_lshl_b32 s46,s22,1
s_add_u32 s46,s46,0
s_and_b32 s46,s46,7
s_lshl_b32 s47,s44,3
s_add_u32 s46,s46,s47
s_lshl_b32 s46,s46,16
s_lshl_b32 s47,s22,14
s_add_u32 s46,s46,s47
s_add_u32 s24,s46,0x880000
s_lshl_b32 s46,s22,1
s_add_u32 s46,s46,1
s_and_b32 s46,s46,7
s_lshl_b32 s47,s44,3
s_add_u32 s46,s46,s47
s_lshl_b32 s46,s46,16
s_lshl_b32 s47,s22,14
s_add_u32 s46,s46,s47
s_add_u32 s25,s46,0x880000
s_lshl_b32 s46,s22,1
s_add_u32 s46,s46,2
s_and_b32 s46,s46,7
s_lshl_b32 s47,s44,3
s_add_u32 s46,s46,s47
s_lshl_b32 s46,s46,16
s_lshl_b32 s47,s22,14
s_add_u32 s46,s46,s47
s_add_u32 s26,s46,0x880000
s_lshl_b32 s46,s22,1
s_add_u32 s46,s46,3
s_and_b32 s46,s46,7
s_lshl_b32 s47,s44,3
s_add_u32 s46,s46,s47
s_lshl_b32 s46,s46,16
s_lshl_b32 s47,s22,14
s_add_u32 s46,s46,s47
s_add_u32 s27,s46,0x880000
s_lshl_b32 s46,s22,1
s_add_u32 s46,s46,4
s_and_b32 s46,s46,7
s_lshl_b32 s47,s44,3
s_add_u32 s46,s46,s47
s_lshl_b32 s46,s46,16
s_lshl_b32 s47,s22,14
s_add_u32 s46,s46,s47
s_add_u32 s28,s46,0x880000
s_lshl_b32 s46,s22,1
s_add_u32 s46,s46,5
s_and_b32 s46,s46,7
s_lshl_b32 s47,s44,3
s_add_u32 s46,s46,s47
s_lshl_b32 s46,s46,16
s_lshl_b32 s47,s22,14
s_add_u32 s46,s46,s47
s_add_u32 s29,s46,0x880000
s_lshl_b32 s46,s22,1
s_add_u32 s46,s46,6
s_and_b32 s46,s46,7
s_lshl_b32 s47,s44,3
s_add_u32 s46,s46,s47
s_lshl_b32 s46,s46,16
s_lshl_b32 s47,s22,14
s_add_u32 s46,s46,s47
s_add_u32 s30,s46,0x880000
s_lshl_b32 s46,s22,1
s_add_u32 s46,s46,7
s_and_b32 s46,s46,7
s_lshl_b32 s47,s44,3
s_add_u32 s46,s46,s47
s_lshl_b32 s46,s46,16
s_lshl_b32 s47,s22,14
s_add_u32 s46,s46,s47
s_add_u32 s31,s46,0x880000
s_lshl_b32 s46,s45,6
s_lshl_b32 s47,s22,4
s_add_u32 s46,s46,s47
s_mul_i32 s32,s46,9216
s_add_u32 s32,s32,0x4400000
s_lshl_b32 s79,s45,11
s_add_u32 s79,s79,0x1348000
v_lshlrev_b32 v198,2,v0
s_cmp_eq_u32 s22,0
s_cselect_b32 s79,s79,0x40000000
v_mov_b32 v199,0
buffer_atomic_or v199,v198,s[8:11],s79 offen sc0 sc1
buffer_load_dwordx4 v[16:19],v1,s[8:11],s24 offen offset:0 sc1
buffer_load_dwordx4 v[20:23],v1,s[8:11],s25 offen offset:0 sc1
buffer_load_dwordx4 v[24:27],v1,s[8:11],s26 offen offset:0 sc1
buffer_load_dwordx4 v[28:31],v1,s[8:11],s27 offen offset:0 sc1
buffer_load_dwordx4 v[32:35],v1,s[8:11],s28 offen offset:0 sc1
buffer_load_dwordx4 v[36:39],v1,s[8:11],s29 offen offset:0 sc1
buffer_load_dwordx4 v[40:43],v1,s[8:11],s30 offen offset:0 sc1
buffer_load_dwordx4 v[44:47],v1,s[8:11],s31 offen offset:0 sc1
buffer_load_dwordx4 v[48:51],v1,s[8:11],s24 offen offset:1024 sc1
buffer_load_dwordx4 v[52:55],v1,s[8:11],s25 offen offset:1024 sc1
buffer_load_dwordx4 v[56:59],v1,s[8:11],s26 offen offset:1024 sc1
buffer_load_dwordx4 v[60:63],v1,s[8:11],s27 offen offset:1024 sc1
v_lshlrev_b32 v12,1,v14
s_lshl_b32 s46,s44,8
s_lshl_b32 s47,s22,6
s_add_u32 s46,s46,s47
buffer_load_ushort v10,v12,s[12:15],s46 offen offset:0
buffer_load_ushort v11,v12,s[12:15],s46 offen offset:32
s_add_u32 s46,s22,1
s_and_b32 s46,s46,3
s_mul_i32 s46,s46,18432
s_add_u32 s46,s46,0
v_add_u32 v5,s46,v1
s_add_u32 s46,s22,2
s_and_b32 s46,s46,3
s_mul_i32 s46,s46,18432
s_add_u32 s46,s46,73728
v_add_u32 v6,s46,v1
s_add_u32 s46,s22,3
s_and_b32 s46,s46,3
s_mul_i32 s46,s46,18432
s_add_u32 s46,s46,0
v_add_u32 v7,s46,v1
s_mul_i32 s46,s22,18432
v_add_u32 v8,s46,v1
v_add_u32 v9,73728,v8
s_getpc_b64 s[58:59]
PC_mega_kernel_17:
s_mul_i32 s46,s23,4
s_add_u32 s46,s46,s22
s_lshl_b32 s46,s46,10
v_add_u32 v13,s46,v1
v_add_u32 v13,PH_k5_1-PC_mega_kernel_17,v13
v_min_u32 v13,END_mega_kernel-PC_mega_kernel_17-16,v13
v_and_b32 v13,-4,v13
global_load_dwordx4 a[252:255],v13,s[58:59]
s_waitcnt vmcnt(15)
v_cmp_eq_u32 vcc,0,v199
s_cbranch_vccz DW_mega_kernel_18G
s_mov_b32 s53,0
s_cmp_lg_u32 s22,0
s_cbranch_scc1 DW_mega_kernel_18G
DW_mega_kernel_18:
s_nop 7
s_nop 3
v_mov_b32 v199,0
buffer_atomic_or v199,v198,s[8:11],s79 offen sc0 sc1
s_add_u32 s53,s53,1
s_waitcnt vmcnt(0)
v_cmp_eq_u32 vcc,0,v199
s_cbranch_vccz DW_mega_kernel_18G
s_cmp_lt_u32 s53,100000
s_cbranch_scc1 DW_mega_kernel_18
DW_mega_kernel_18G:
s_nop 7
s_nop 3
s_barrier
s_add_u32 s33,s32,0
buffer_load_dwordx4 v[64:67],v1,s[8:11],s33 offen offset:0 sc1
buffer_load_dwordx4 v[68:71],v1,s[8:11],s33 offen offset:1024 sc1
buffer_load_dwordx4 v[72:75],v1,s[8:11],s33 offen offset:2048 sc1
buffer_load_dwordx4 v[76:79],v1,s[8:11],s33 offen offset:3072 sc1
s_add_u32 s33,s32,4096
buffer_load_dwordx4 v[80:83],v1,s[8:11],s33 offen offset:0 sc1
buffer_load_dwordx4 v[84:87],v1,s[8:11],s33 offen offset:1024 sc1
buffer_load_dwordx4 v[88:91],v1,s[8:11],s33 offen offset:2048 sc1
buffer_load_dwordx4 v[92:95],v1,s[8:11],s33 offen offset:3072 sc1
s_add_u32 s33,s32,8192
buffer_load_dwordx4 v[96:99],v1,s[8:11],s33 offen offset:0 sc1
s_mul_i32 s46,s22,10240
v_add_u32 v12,s46,v1
s_lshl_b32 s46,s22,13
v_add_u32 v177,s46,v1
s_add_u32 s33,s32,9216
buffer_load_dwordx4 v[100:103],v1,s[8:11],s33 offen offset:0 sc1
buffer_load_dwordx4 v[104:107],v1,s[8:11],s33 offen offset:1024 sc1
buffer_load_dwordx4 v[108:111],v1,s[8:11],s33 offen offset:2048 sc1
buffer_load_dwordx4 v[112:115],v1,s[8:11],s33 offen offset:3072 sc1
s_add_u32 s33,s32,13312
buffer_load_dwordx4 v[116:119],v1,s[8:11],s33 offen offset:0 sc1
buffer_load_dwordx4 v[120:123],v1,s[8:11],s33 offen offset:1024 sc1
buffer_load_dwordx4 v[124:127],v1,s[8:11],s33 offen offset:2048 sc1
buffer_load_dwordx4 v[128:131],v1,s[8:11],s33 offen offset:3072 sc1
s_add_u32 s33,s32,17408
buffer_load_dwordx4 v[132:135],v1,s[8:11],s33 offen offset:0 sc1
s_waitcnt vmcnt(32)
s_waitcnt vmcnt(17)
MF v[184:187],v[64:67],v[16:19],0
s_waitcnt vmcnt(16)
MF v[188:191],v[68:71],v[16:19],0
s_waitcnt vmcnt(15)
MF v[192:195],v[72:75],v[16:19],0
s_add_u32 s33,s32,18432
buffer_load_dwordx4 v[136:139],v1,s[8:11],s33 offen offset:0 sc1
s_waitcnt vmcnt(15)
MF v[196:199],v[76:79],v[16:19],0
s_waitcnt vmcnt(14)
MF v[200:203],v[80:83],v[16:19],0
s_waitcnt vmcnt(13)
MF v[204:207],v[84:87],v[16:19],0
s_waitcnt vmcnt(12)
MF v[208:211],v[88:91],v[16:19],0
buffer_load_dwordx4 v[140:143],v1,s[8:11],s33 offen offset:1024 sc1
s_waitcnt vmcnt(12)
MF v[212:215],v[92:95],v[16:19],0
s_waitcnt vmcnt(11)
MF v[216:219],v[96:99],v[16:19],0
ds_read_b128 v[16:19],v12 offset:12288
MF v[220:223],v[64:67],v[20:23],0
v_mov_b32 v13,0xbdd2d3e8
MF v[224:227],v[68:71],v[20:23],0
v_accvgpr_read_b32 v176,a216
v_accvgpr_read_b32 v182,a217
MF v[228:231],v[72:75],v[20:23],0
buffer_load_dwordx4 v[144:147],v1,s[8:11],s33 offen offset:2048 sc1
MF v[232:235],v[76:79],v[20:23],0
v_lshlrev_b32 v172,16,v176
MF v[236:239],v[80:83],v[20:23],0
v_lshlrev_b32 v178,16,v182
v_and_b32 v173,0xffff0000,v176
MF v[240:243],v[84:87],v[20:23],0
v_and_b32 v179,0xffff0000,v182
MF v[244:247],v[88:91],v[20:23],0
buffer_load_dwordx4 v[148:151],v1,s[8:11],s33 offen offset:3072 sc1
MF v[248:251],v[92:95],v[20:23],0
v_mul_f32 v174,v172,v172
MF v[252:255],v[96:99],v[20:23],0
ds_read_b128 v[20:23],v12 offset:13312
MF a[0:3],v[64:67],v[24:27],0
v_mul_f32 v180,v178,v178
MF a[4:7],v[68:71],v[24:27],0
v_mul_f32 v175,v173,v173
v_mul_f32 v181,v179,v179
MF a[8:11],v[72:75],v[24:27],0
s_add_u32 s33,s32,22528
buffer_load_dwordx4 v[152:155],v1,s[8:11],s33 offen offset:0 sc1
MF a[12:15],v[76:79],v[24:27],0
v_fmaak_f32 v174,v174,v13,0xc0135761
MF a[16:19],v[80:83],v[24:27],0
v_fmaak_f32 v180,v180,v13,0xc0135761
v_fmaak_f32 v175,v175,v13,0xc0135761
MF a[20:23],v[84:87],v[24:27],0
v_fmaak_f32 v181,v181,v13,0xc0135761
MF a[24:27],v[88:91],v[24:27],0
buffer_load_dwordx4 v[156:159],v1,s[8:11],s33 offen offset:1024 sc1
MF a[28:31],v[92:95],v[24:27],0
v_mul_f32 v174,v174,v172
MF a[32:35],v[96:99],v[24:27],0
ds_read_b128 v[24:27],v12 offset:14336
MF a[36:39],v[64:67],v[28:31],0
v_mul_f32 v180,v180,v178
MF a[40:43],v[68:71],v[28:31],0
v_mul_f32 v175,v175,v173
v_mul_f32 v181,v181,v179
MF a[44:47],v[72:75],v[28:31],0
buffer_load_dwordx4 v[160:163],v1,s[8:11],s33 offen offset:2048 sc1
MF a[48:51],v[76:79],v[28:31],0
v_exp_f32 v174,v174
MF a[52:55],v[80:83],v[28:31],0
v_exp_f32 v180,v180
MF a[56:59],v[84:87],v[28:31],0
v_exp_f32 v175,v175
MF a[60:63],v[88:91],v[28:31],0
buffer_load_dwordx4 v[164:167],v1,s[8:11],s33 offen offset:3072 sc1
MF a[64:67],v[92:95],v[28:31],0
v_exp_f32 v181,v181
MF a[68:71],v[96:99],v[28:31],0
ds_read_b128 v[28:31],v12 offset:15360
MF a[72:75],v[64:67],v[32:35],0
v_add_f32 v174,1.0,v174
MF a[76:79],v[68:71],v[32:35],0
v_add_f32 v180,1.0,v180
v_add_f32 v175,1.0,v175
MF a[80:83],v[72:75],v[32:35],0
s_add_u32 s33,s32,26624
buffer_load_dwordx4 v[168:171],v1,s[8:11],s33 offen offset:0 sc1
MF a[84:87],v[76:79],v[32:35],0
v_add_f32 v181,1.0,v181
MF a[88:91],v[80:83],v[32:35],0
v_rcp_f32 v174,v174
MF a[92:95],v[84:87],v[32:35],0
v_rcp_f32 v180,v180
MF a[96:99],v[88:91],v[32:35],0
MF a[100:103],v[92:95],v[32:35],0
v_rcp_f32 v175,v175
MF a[104:107],v[96:99],v[32:35],0
ds_read_b128 v[32:35],v12 offset:16384
MF a[108:111],v[64:67],v[36:39],0
v_rcp_f32 v181,v181
MF a[112:115],v[68:71],v[36:39],0
v_mul_f32 v172,v172,v174
v_mul_f32 v178,v178,v180
MF a[116:119],v[72:75],v[36:39],0
v_mul_f32 v173,v173,v175
MF a[120:123],v[76:79],v[36:39],0
v_mul_f32 v179,v179,v181
MF a[124:127],v[80:83],v[36:39],0
v_cvt_pk_bf16_f32 v176,v172,v173
v_cvt_pk_bf16_f32 v182,v178,v179
MF a[128:131],v[84:87],v[36:39],0
v_accvgpr_write_b32 a216,v176
MF a[132:135],v[88:91],v[36:39],0
v_accvgpr_write_b32 a217,v182
MF a[136:139],v[92:95],v[36:39],0
v_accvgpr_read_b32 v176,a218
MF a[140:143],v[96:99],v[36:39],0
ds_read_b128 v[36:39],v12 offset:17408
MF a[144:147],v[64:67],v[40:43],0
v_accvgpr_read_b32 v182,a219
MF a[148:151],v[68:71],v[40:43],0
v_lshlrev_b32 v172,16,v176
v_lshlrev_b32 v178,16,v182
MF a[152:155],v[72:75],v[40:43],0
v_and_b32 v173,0xffff0000,v176
MF a[156:159],v[76:79],v[40:43],0
v_and_b32 v179,0xffff0000,v182
MF a[160:163],v[80:83],v[40:43],0
v_mul_f32 v174,v172,v172
v_mul_f32 v180,v178,v178
MF a[164:167],v[84:87],v[40:43],0
v_mul_f32 v175,v173,v173
MF a[168:171],v[88:91],v[40:43],0
v_mul_f32 v181,v179,v179
MF a[172:175],v[92:95],v[40:43],0
v_fmaak_f32 v174,v174,v13,0xc0135761
MF a[176:179],v[96:99],v[40:43],0
ds_read_b128 v[40:43],v12 offset:18432
MF a[180:183],v[64:67],v[44:47],0
v_fmaak_f32 v180,v180,v13,0xc0135761
MF a[184:187],v[68:71],v[44:47],0
v_fmaak_f32 v175,v175,v13,0xc0135761
v_fmaak_f32 v181,v181,v13,0xc0135761
MF a[188:191],v[72:75],v[44:47],0
v_mul_f32 v174,v174,v172
MF a[192:195],v[76:79],v[44:47],0
v_mul_f32 v180,v180,v178
MF a[196:199],v[80:83],v[44:47],0
v_mul_f32 v175,v175,v173
v_mul_f32 v181,v181,v179
MF a[200:203],v[84:87],v[44:47],0
v_exp_f32 v174,v174
MF a[204:207],v[88:91],v[44:47],0
v_exp_f32 v180,v180
MF a[208:211],v[92:95],v[44:47],0
v_exp_f32 v175,v175
MF a[212:215],v[96:99],v[44:47],0
ds_read_b128 v[44:47],v12 offset:19456
s_waitcnt vmcnt(17)
MF v[184:187],v[100:103],v[48:51],v[184:187]
s_waitcnt vmcnt(16)
MF v[188:191],v[104:107],v[48:51],v[188:191]
s_waitcnt vmcnt(15)
MF v[192:195],v[108:111],v[48:51],v[192:195]
s_add_u32 s33,s32,27648
buffer_load_dwordx4 v[64:67],v1,s[8:11],s33 offen offset:0 sc1
s_waitcnt vmcnt(15)
MF v[196:199],v[112:115],v[48:51],v[196:199]
s_waitcnt vmcnt(14)
MF v[200:203],v[116:119],v[48:51],v[200:203]
s_waitcnt vmcnt(13)
MF v[204:207],v[120:123],v[48:51],v[204:207]
s_waitcnt vmcnt(12)
MF v[208:211],v[124:127],v[48:51],v[208:211]
buffer_load_dwordx4 v[68:71],v1,s[8:11],s33 offen offset:1024 sc1
s_waitcnt vmcnt(12)
MF v[212:215],v[128:131],v[48:51],v[212:215]
s_waitcnt vmcnt(11)
MF v[216:219],v[132:135],v[48:51],v[216:219]
ds_read_b128 v[48:51],v12 offset:20480
MF v[220:223],v[100:103],v[52:55],v[220:223]
v_exp_f32 v181,v181
MF v[224:227],v[104:107],v[52:55],v[224:227]
v_add_f32 v174,1.0,v174
v_add_f32 v180,1.0,v180
MF v[228:231],v[108:111],v[52:55],v[228:231]
buffer_load_dwordx4 v[72:75],v1,s[8:11],s33 offen offset:2048 sc1
MF v[232:235],v[112:115],v[52:55],v[232:235]
v_add_f32 v175,1.0,v175
MF v[236:239],v[116:119],v[52:55],v[236:239]
v_add_f32 v181,1.0,v181
v_rcp_f32 v174,v174
MF v[240:243],v[120:123],v[52:55],v[240:243]
v_rcp_f32 v180,v180
MF v[244:247],v[124:127],v[52:55],v[244:247]
buffer_load_dwordx4 v[76:79],v1,s[8:11],s33 offen offset:3072 sc1
MF v[248:251],v[128:131],v[52:55],v[248:251]
v_rcp_f32 v175,v175
MF v[252:255],v[132:135],v[52:55],v[252:255]
ds_read_b128 v[52:55],v12 offset:21504
MF a[0:3],v[100:103],v[56:59],a[0:3]
v_rcp_f32 v181,v181
MF a[4:7],v[104:107],v[56:59],a[4:7]
v_mul_f32 v172,v172,v174
v_mul_f32 v178,v178,v180
MF a[8:11],v[108:111],v[56:59],a[8:11]
s_add_u32 s33,s32,31744
buffer_load_dwordx4 v[80:83],v1,s[8:11],s33 offen offset:0 sc1
MF a[12:15],v[112:115],v[56:59],a[12:15]
v_mul_f32 v173,v173,v175
MF a[16:19],v[116:119],v[56:59],a[16:19]
v_mul_f32 v179,v179,v181
v_cvt_pk_bf16_f32 v176,v172,v173
MF a[20:23],v[120:123],v[56:59],a[20:23]
v_cvt_pk_bf16_f32 v182,v178,v179
MF a[24:27],v[124:127],v[56:59],a[24:27]
buffer_load_dwordx4 v[84:87],v1,s[8:11],s33 offen offset:1024 sc1
MF a[28:31],v[128:131],v[56:59],a[28:31]
v_accvgpr_write_b32 a218,v176
MF a[32:35],v[132:135],v[56:59],a[32:35]
ds_read_b128 v[56:59],v177 offset:53248
MF a[36:39],v[100:103],v[60:63],a[36:39]
v_accvgpr_write_b32 a219,v182
MF a[40:43],v[104:107],v[60:63],a[40:43]
v_accvgpr_read_b32 v176,a220
v_accvgpr_read_b32 v182,a221
MF a[44:47],v[108:111],v[60:63],a[44:47]
buffer_load_dwordx4 v[88:91],v1,s[8:11],s33 offen offset:2048 sc1
MF a[48:51],v[112:115],v[60:63],a[48:51]
v_lshlrev_b32 v172,16,v176
MF a[52:55],v[116:119],v[60:63],a[52:55]
v_lshlrev_b32 v178,16,v182
v_and_b32 v173,0xffff0000,v176
MF a[56:59],v[120:123],v[60:63],a[56:59]
v_and_b32 v179,0xffff0000,v182
MF a[60:63],v[124:127],v[60:63],a[60:63]
buffer_load_dwordx4 v[92:95],v1,s[8:11],s33 offen offset:3072 sc1
MF a[64:67],v[128:131],v[60:63],a[64:67]
v_mul_f32 v174,v172,v172
MF a[68:71],v[132:135],v[60:63],a[68:71]
ds_read_b128 v[60:63],v177 offset:54272
s_waitcnt lgkmcnt(11)
MF a[72:75],v[100:103],v[16:19],a[72:75]
v_mul_f32 v180,v178,v178
MF a[76:79],v[104:107],v[16:19],a[76:79]
v_mul_f32 v175,v173,v173
v_mul_f32 v181,v179,v179
MF a[80:83],v[108:111],v[16:19],a[80:83]
s_add_u32 s33,s32,35840
buffer_load_dwordx4 v[96:99],v1,s[8:11],s33 offen offset:0 sc1
MF a[84:87],v[112:115],v[16:19],a[84:87]
v_fmaak_f32 v174,v174,v13,0xc0135761
MF a[88:91],v[116:119],v[16:19],a[88:91]
v_fmaak_f32 v180,v180,v13,0xc0135761
v_fmaak_f32 v175,v175,v13,0xc0135761
MF a[92:95],v[120:123],v[16:19],a[92:95]
v_fmaak_f32 v181,v181,v13,0xc0135761
MF a[96:99],v[124:127],v[16:19],a[96:99]
MF a[100:103],v[128:131],v[16:19],a[100:103]
v_mul_f32 v174,v174,v172
MF a[104:107],v[132:135],v[16:19],a[104:107]
ds_read_b128 v[16:19],v177 offset:55296
s_waitcnt lgkmcnt(11)
MF a[108:111],v[100:103],v[20:23],a[108:111]
v_mul_f32 v180,v180,v178
MF a[112:115],v[104:107],v[20:23],a[112:115]
v_mul_f32 v175,v175,v173
v_mul_f32 v181,v181,v179
MF a[116:119],v[108:111],v[20:23],a[116:119]
v_exp_f32 v174,v174
MF a[120:123],v[112:115],v[20:23],a[120:123]
v_exp_f32 v180,v180
MF a[124:127],v[116:119],v[20:23],a[124:127]
v_exp_f32 v175,v175
MF a[128:131],v[120:123],v[20:23],a[128:131]
v_exp_f32 v181,v181
MF a[132:135],v[124:127],v[20:23],a[132:135]
v_add_f32 v174,1.0,v174
MF a[136:139],v[128:131],v[20:23],a[136:139]
v_add_f32 v180,1.0,v180
MF a[140:143],v[132:135],v[20:23],a[140:143]
ds_read_b128 v[20:23],v177 offset:56320
s_waitcnt lgkmcnt(11)
MF a[144:147],v[100:103],v[24:27],a[144:147]
v_add_f32 v175,1.0,v175
MF a[148:151],v[104:107],v[24:27],a[148:151]
v_add_f32 v181,1.0,v181
v_rcp_f32 v174,v174
MF a[152:155],v[108:111],v[24:27],a[152:155]
v_rcp_f32 v180,v180
MF a[156:159],v[112:115],v[24:27],a[156:159]
v_rcp_f32 v175,v175
MF a[160:163],v[116:119],v[24:27],a[160:163]
v_rcp_f32 v181,v181
MF a[164:167],v[120:123],v[24:27],a[164:167]
v_mul_f32 v172,v172,v174
MF a[168:171],v[124:127],v[24:27],a[168:171]
v_mul_f32 v178,v178,v180
MF a[172:175],v[128:131],v[24:27],a[172:175]
v_mul_f32 v173,v173,v175
MF a[176:179],v[132:135],v[24:27],a[176:179]
ds_read_b128 v[24:27],v177 offset:57344
s_waitcnt lgkmcnt(11)
MF a[180:183],v[100:103],v[28:31],a[180:183]
v_mul_f32 v179,v179,v181
MF a[184:187],v[104:107],v[28:31],a[184:187]
v_cvt_pk_bf16_f32 v176,v172,v173
v_cvt_pk_bf16_f32 v182,v178,v179
MF a[188:191],v[108:111],v[28:31],a[188:191]
v_accvgpr_write_b32 a220,v176
MF a[192:195],v[112:115],v[28:31],a[192:195]
v_accvgpr_write_b32 a221,v182
MF a[196:199],v[116:119],v[28:31],a[196:199]
v_accvgpr_read_b32 v176,a222
v_accvgpr_read_b32 v182,a223
MF a[200:203],v[120:123],v[28:31],a[200:203]
v_lshlrev_b32 v172,16,v176
MF a[204:207],v[124:127],v[28:31],a[204:207]
v_lshlrev_b32 v178,16,v182
MF a[208:211],v[128:131],v[28:31],a[208:211]
v_and_b32 v173,0xffff0000,v176
MF a[212:215],v[132:135],v[28:31],a[212:215]
ds_read_b128 v[28:31],v177 offset:58368
s_waitcnt vmcnt(17)
s_waitcnt lgkmcnt(11)
MF v[184:187],v[136:139],v[32:35],v[184:187]
s_waitcnt vmcnt(16)
MF v[188:191],v[140:143],v[32:35],v[188:191]
s_waitcnt vmcnt(15)
MF v[192:195],v[144:147],v[32:35],v[192:195]
s_add_u32 s33,s32,36864
buffer_load_dwordx4 v[100:103],v1,s[8:11],s33 offen offset:0 sc1
s_waitcnt vmcnt(15)
MF v[196:199],v[148:151],v[32:35],v[196:199]
s_waitcnt vmcnt(14)
MF v[200:203],v[152:155],v[32:35],v[200:203]
s_waitcnt vmcnt(13)
MF v[204:207],v[156:159],v[32:35],v[204:207]
s_waitcnt vmcnt(12)
MF v[208:211],v[160:163],v[32:35],v[208:211]
buffer_load_dwordx4 v[104:107],v1,s[8:11],s33 offen offset:1024 sc1
s_waitcnt vmcnt(12)
MF v[212:215],v[164:167],v[32:35],v[212:215]
s_waitcnt vmcnt(11)
MF v[216:219],v[168:171],v[32:35],v[216:219]
ds_read_b128 v[32:35],v177 offset:59392
s_waitcnt lgkmcnt(11)
MF v[220:223],v[136:139],v[36:39],v[220:223]
v_and_b32 v179,0xffff0000,v182
MF v[224:227],v[140:143],v[36:39],v[224:227]
v_mul_f32 v174,v172,v172
v_mul_f32 v180,v178,v178
MF v[228:231],v[144:147],v[36:39],v[228:231]
buffer_load_dwordx4 v[108:111],v1,s[8:11],s33 offen offset:2048 sc1
MF v[232:235],v[148:151],v[36:39],v[232:235]
v_mul_f32 v175,v173,v173
MF v[236:239],v[152:155],v[36:39],v[236:239]
v_mul_f32 v181,v179,v179
v_fmaak_f32 v174,v174,v13,0xc0135761
MF v[240:243],v[156:159],v[36:39],v[240:243]
v_fmaak_f32 v180,v180,v13,0xc0135761
MF v[244:247],v[160:163],v[36:39],v[244:247]
buffer_load_dwordx4 v[112:115],v1,s[8:11],s33 offen offset:3072 sc1
MF v[248:251],v[164:167],v[36:39],v[248:251]
v_fmaak_f32 v175,v175,v13,0xc0135761
MF v[252:255],v[168:171],v[36:39],v[252:255]
ds_read_b128 v[36:39],v177 offset:60416
s_waitcnt lgkmcnt(11)
MF a[0:3],v[136:139],v[40:43],a[0:3]
v_fmaak_f32 v181,v181,v13,0xc0135761
MF a[4:7],v[140:143],v[40:43],a[4:7]
v_mul_f32 v174,v174,v172
v_mul_f32 v180,v180,v178
MF a[8:11],v[144:147],v[40:43],a[8:11]
s_add_u32 s33,s32,40960
buffer_load_dwordx4 v[116:119],v1,s[8:11],s33 offen offset:0 sc1
MF a[12:15],v[148:151],v[40:43],a[12:15]
v_mul_f32 v175,v175,v173
MF a[16:19],v[152:155],v[40:43],a[16:19]
v_mul_f32 v181,v181,v179
v_exp_f32 v174,v174
MF a[20:23],v[156:159],v[40:43],a[20:23]
v_exp_f32 v180,v180
MF a[24:27],v[160:163],v[40:43],a[24:27]
buffer_load_dwordx4 v[120:123],v1,s[8:11],s33 offen offset:1024 sc1
MF a[28:31],v[164:167],v[40:43],a[28:31]
v_exp_f32 v175,v175
MF a[32:35],v[168:171],v[40:43],a[32:35]
buffer_load_dwordx4 v[40:43],v1,s[8:11],s30 offen offset:3072 sc1
s_waitcnt lgkmcnt(10)
MF a[36:39],v[136:139],v[44:47],a[36:39]
v_exp_f32 v181,v181
MF a[40:43],v[140:143],v[44:47],a[40:43]
v_add_f32 v174,1.0,v174
v_add_f32 v180,1.0,v180
MF a[44:47],v[144:147],v[44:47],a[44:47]
buffer_load_dwordx4 v[124:127],v1,s[8:11],s33 offen offset:2048 sc1
MF a[48:51],v[148:151],v[44:47],a[48:51]
v_add_f32 v175,1.0,v175
MF a[52:55],v[152:155],v[44:47],a[52:55]
v_add_f32 v181,1.0,v181
v_rcp_f32 v174,v174
MF a[56:59],v[156:159],v[44:47],a[56:59]
v_rcp_f32 v180,v180
MF a[60:63],v[160:163],v[44:47],a[60:63]
buffer_load_dwordx4 v[128:131],v1,s[8:11],s33 offen offset:3072 sc1
MF a[64:67],v[164:167],v[44:47],a[64:67]
v_rcp_f32 v175,v175
MF a[68:71],v[168:171],v[44:47],a[68:71]
buffer_load_dwordx4 v[44:47],v1,s[8:11],s31 offen offset:3072 sc1
s_waitcnt lgkmcnt(9)
MF a[72:75],v[136:139],v[48:51],a[72:75]
v_rcp_f32 v181,v181
MF a[76:79],v[140:143],v[48:51],a[76:79]
v_mul_f32 v172,v172,v174
v_mul_f32 v178,v178,v180
MF a[80:83],v[144:147],v[48:51],a[80:83]
s_add_u32 s33,s32,45056
buffer_load_dwordx4 v[132:135],v1,s[8:11],s33 offen offset:0 sc1
MF a[84:87],v[148:151],v[48:51],a[84:87]
v_mul_f32 v173,v173,v175
MF a[88:91],v[152:155],v[48:51],a[88:91]
v_mul_f32 v179,v179,v181
v_cvt_pk_bf16_f32 v176,v172,v173
MF a[92:95],v[156:159],v[48:51],a[92:95]
v_cvt_pk_bf16_f32 v182,v178,v179
MF a[96:99],v[160:163],v[48:51],a[96:99]
MF a[100:103],v[164:167],v[48:51],a[100:103]
v_accvgpr_write_b32 a222,v176
MF a[104:107],v[168:171],v[48:51],a[104:107]
buffer_load_dwordx4 v[48:51],v2,s[8:11],s24 offen offset:0 sc1
s_waitcnt lgkmcnt(8)
MF a[108:111],v[136:139],v[52:55],a[108:111]
v_accvgpr_write_b32 a223,v182
MF a[112:115],v[140:143],v[52:55],a[112:115]
v_accvgpr_read_b32 v176,a224
v_accvgpr_read_b32 v182,a225
MF a[116:119],v[144:147],v[52:55],a[116:119]
v_lshlrev_b32 v172,16,v176
MF a[120:123],v[148:151],v[52:55],a[120:123]
v_lshlrev_b32 v178,16,v182
MF a[124:127],v[152:155],v[52:55],a[124:127]
v_and_b32 v173,0xffff0000,v176
v_and_b32 v179,0xffff0000,v182
MF a[128:131],v[156:159],v[52:55],a[128:131]
v_mul_f32 v174,v172,v172
MF a[132:135],v[160:163],v[52:55],a[132:135]
v_mul_f32 v180,v178,v178
MF a[136:139],v[164:167],v[52:55],a[136:139]
v_mul_f32 v175,v173,v173
MF a[140:143],v[168:171],v[52:55],a[140:143]
buffer_load_dwordx4 v[52:55],v2,s[8:11],s25 offen offset:0 sc1
s_waitcnt lgkmcnt(7)
MF a[144:147],v[136:139],v[56:59],a[144:147]
v_mul_f32 v181,v179,v179
MF a[148:151],v[140:143],v[56:59],a[148:151]
v_fmaak_f32 v174,v174,v13,0xc0135761
v_fmaak_f32 v180,v180,v13,0xc0135761
MF a[152:155],v[144:147],v[56:59],a[152:155]
v_fmaak_f32 v175,v175,v13,0xc0135761
MF a[156:159],v[148:151],v[56:59],a[156:159]
v_fmaak_f32 v181,v181,v13,0xc0135761
MF a[160:163],v[152:155],v[56:59],a[160:163]
v_mul_f32 v174,v174,v172
v_mul_f32 v180,v180,v178
MF a[164:167],v[156:159],v[56:59],a[164:167]
v_mul_f32 v175,v175,v173
MF a[168:171],v[160:163],v[56:59],a[168:171]
v_mul_f32 v181,v181,v179
MF a[172:175],v[164:167],v[56:59],a[172:175]
v_exp_f32 v174,v174
MF a[176:179],v[168:171],v[56:59],a[176:179]
buffer_load_dwordx4 v[56:59],v2,s[8:11],s26 offen offset:0 sc1
s_waitcnt lgkmcnt(6)
MF a[180:183],v[136:139],v[60:63],a[180:183]
v_exp_f32 v180,v180
MF a[184:187],v[140:143],v[60:63],a[184:187]
v_exp_f32 v175,v175
MF a[188:191],v[144:147],v[60:63],a[188:191]
v_exp_f32 v181,v181
MF a[192:195],v[148:151],v[60:63],a[192:195]
v_add_f32 v174,1.0,v174
MF a[196:199],v[152:155],v[60:63],a[196:199]
v_add_f32 v180,1.0,v180
v_add_f32 v175,1.0,v175
MF a[200:203],v[156:159],v[60:63],a[200:203]
v_add_f32 v181,1.0,v181
MF a[204:207],v[160:163],v[60:63],a[204:207]
v_rcp_f32 v174,v174
MF a[208:211],v[164:167],v[60:63],a[208:211]
v_rcp_f32 v180,v180
MF a[212:215],v[168:171],v[60:63],a[212:215]
buffer_load_dwordx4 v[60:63],v2,s[8:11],s27 offen offset:0 sc1
s_waitcnt vmcnt(23)
s_waitcnt lgkmcnt(5)
MF v[184:187],v[64:67],v[16:19],v[184:187]
s_waitcnt vmcnt(22)
MF v[188:191],v[68:71],v[16:19],v[188:191]
s_waitcnt vmcnt(21)
MF v[192:195],v[72:75],v[16:19],v[192:195]
s_add_u32 s33,s32,46080
buffer_load_dwordx4 v[136:139],v1,s[8:11],s33 offen offset:0 sc1
s_waitcnt vmcnt(21)
MF v[196:199],v[76:79],v[16:19],v[196:199]
s_waitcnt vmcnt(20)
MF v[200:203],v[80:83],v[16:19],v[200:203]
s_waitcnt vmcnt(19)
MF v[204:207],v[84:87],v[16:19],v[204:207]
s_waitcnt vmcnt(18)
MF v[208:211],v[88:91],v[16:19],v[208:211]
buffer_load_dwordx4 v[140:143],v1,s[8:11],s33 offen offset:1024 sc1
s_waitcnt vmcnt(18)
MF v[212:215],v[92:95],v[16:19],v[212:215]
s_waitcnt vmcnt(17)
MF v[216:219],v[96:99],v[16:19],v[216:219]
buffer_load_dwordx4 v[16:19],v2,s[8:11],s28 offen offset:0 sc1
s_waitcnt lgkmcnt(4)
MF v[220:223],v[64:67],v[20:23],v[220:223]
v_rcp_f32 v175,v175
MF v[224:227],v[68:71],v[20:23],v[224:227]
v_rcp_f32 v181,v181
MF v[228:231],v[72:75],v[20:23],v[228:231]
buffer_load_dwordx4 v[144:147],v1,s[8:11],s33 offen offset:2048 sc1
MF v[232:235],v[76:79],v[20:23],v[232:235]
v_mul_f32 v172,v172,v174
MF v[236:239],v[80:83],v[20:23],v[236:239]
v_mul_f32 v178,v178,v180
v_mul_f32 v173,v173,v175
MF v[240:243],v[84:87],v[20:23],v[240:243]
v_mul_f32 v179,v179,v181
MF v[244:247],v[88:91],v[20:23],v[244:247]
buffer_load_dwordx4 v[148:151],v1,s[8:11],s33 offen offset:3072 sc1
MF v[248:251],v[92:95],v[20:23],v[248:251]
v_cvt_pk_bf16_f32 v176,v172,v173
MF v[252:255],v[96:99],v[20:23],v[252:255]
buffer_load_dwordx4 v[20:23],v2,s[8:11],s29 offen offset:0 sc1
s_waitcnt lgkmcnt(3)
MF a[0:3],v[64:67],v[24:27],a[0:3]
v_cvt_pk_bf16_f32 v182,v178,v179
MF a[4:7],v[68:71],v[24:27],a[4:7]
v_accvgpr_write_b32 a224,v176
v_accvgpr_write_b32 a225,v182
MF a[8:11],v[72:75],v[24:27],a[8:11]
s_add_u32 s33,s32,50176
buffer_load_dwordx4 v[152:155],v1,s[8:11],s33 offen offset:0 sc1
MF a[12:15],v[76:79],v[24:27],a[12:15]
v_accvgpr_read_b32 v176,a226
MF a[16:19],v[80:83],v[24:27],a[16:19]
v_accvgpr_read_b32 v182,a227
v_lshlrev_b32 v172,16,v176
MF a[20:23],v[84:87],v[24:27],a[20:23]
v_lshlrev_b32 v178,16,v182
MF a[24:27],v[88:91],v[24:27],a[24:27]
buffer_load_dwordx4 v[156:159],v1,s[8:11],s33 offen offset:1024 sc1
MF a[28:31],v[92:95],v[24:27],a[28:31]
v_and_b32 v173,0xffff0000,v176
MF a[32:35],v[96:99],v[24:27],a[32:35]
buffer_load_dwordx4 v[24:27],v2,s[8:11],s30 offen offset:0 sc1
s_waitcnt lgkmcnt(2)
MF a[36:39],v[64:67],v[28:31],a[36:39]
v_and_b32 v179,0xffff0000,v182
MF a[40:43],v[68:71],v[28:31],a[40:43]
v_mul_f32 v174,v172,v172
v_mul_f32 v180,v178,v178
MF a[44:47],v[72:75],v[28:31],a[44:47]
buffer_load_dwordx4 v[160:163],v1,s[8:11],s33 offen offset:2048 sc1
MF a[48:51],v[76:79],v[28:31],a[48:51]
v_mul_f32 v175,v173,v173
MF a[52:55],v[80:83],v[28:31],a[52:55]
v_mul_f32 v181,v179,v179
v_fmaak_f32 v174,v174,v13,0xc0135761
MF a[56:59],v[84:87],v[28:31],a[56:59]
v_fmaak_f32 v180,v180,v13,0xc0135761
MF a[60:63],v[88:91],v[28:31],a[60:63]
buffer_load_dwordx4 v[164:167],v1,s[8:11],s33 offen offset:3072 sc1
MF a[64:67],v[92:95],v[28:31],a[64:67]
v_fmaak_f32 v175,v175,v13,0xc0135761
MF a[68:71],v[96:99],v[28:31],a[68:71]
buffer_load_dwordx4 v[28:31],v2,s[8:11],s31 offen offset:0 sc1
s_waitcnt lgkmcnt(1)
MF a[72:75],v[64:67],v[32:35],a[72:75]
v_fmaak_f32 v181,v181,v13,0xc0135761
MF a[76:79],v[68:71],v[32:35],a[76:79]
v_mul_f32 v174,v174,v172
v_mul_f32 v180,v180,v178
MF a[80:83],v[72:75],v[32:35],a[80:83]
s_add_u32 s33,s32,54272
buffer_load_dwordx4 v[168:171],v1,s[8:11],s33 offen offset:0 sc1
MF a[84:87],v[76:79],v[32:35],a[84:87]
v_mul_f32 v175,v175,v173
MF a[88:91],v[80:83],v[32:35],a[88:91]
v_mul_f32 v181,v181,v179
v_exp_f32 v174,v174
MF a[92:95],v[84:87],v[32:35],a[92:95]
v_exp_f32 v180,v180
MF a[96:99],v[88:91],v[32:35],a[96:99]
MF a[100:103],v[92:95],v[32:35],a[100:103]
v_exp_f32 v175,v175
MF a[104:107],v[96:99],v[32:35],a[104:107]
buffer_load_dwordx4 v[32:35],v2,s[8:11],s24 offen offset:1024 sc1
s_waitcnt lgkmcnt(0)
MF a[108:111],v[64:67],v[36:39],a[108:111]
v_exp_f32 v181,v181
MF a[112:115],v[68:71],v[36:39],a[112:115]
v_add_f32 v174,1.0,v174
v_add_f32 v180,1.0,v180
MF a[116:119],v[72:75],v[36:39],a[116:119]
v_add_f32 v175,1.0,v175
MF a[120:123],v[76:79],v[36:39],a[120:123]
v_add_f32 v181,1.0,v181
MF a[124:127],v[80:83],v[36:39],a[124:127]
v_rcp_f32 v174,v174
MF a[128:131],v[84:87],v[36:39],a[128:131]
v_rcp_f32 v180,v180
MF a[132:135],v[88:91],v[36:39],a[132:135]
v_rcp_f32 v175,v175
MF a[136:139],v[92:95],v[36:39],a[136:139]
v_rcp_f32 v181,v181
MF a[140:143],v[96:99],v[36:39],a[140:143]
buffer_load_dwordx4 v[36:39],v2,s[8:11],s25 offen offset:1024 sc1
s_waitcnt vmcnt(23)
MF a[144:147],v[64:67],v[40:43],a[144:147]
v_mul_f32 v172,v172,v174
MF a[148:151],v[68:71],v[40:43],a[148:151]
v_mul_f32 v178,v178,v180
v_mul_f32 v173,v173,v175
MF a[152:155],v[72:75],v[40:43],a[152:155]
v_mul_f32 v179,v179,v181
MF a[156:159],v[76:79],v[40:43],a[156:159]
v_cvt_pk_bf16_f32 v176,v172,v173
MF a[160:163],v[80:83],v[40:43],a[160:163]
v_cvt_pk_bf16_f32 v182,v178,v179
v_accvgpr_write_b32 a226,v176
MF a[164:167],v[84:87],v[40:43],a[164:167]
v_accvgpr_write_b32 a227,v182
MF a[168:171],v[88:91],v[40:43],a[168:171]
v_accvgpr_read_b32 v176,a228
MF a[172:175],v[92:95],v[40:43],a[172:175]
v_accvgpr_read_b32 v182,a229
MF a[176:179],v[96:99],v[40:43],a[176:179]
buffer_load_dwordx4 v[40:43],v2,s[8:11],s26 offen offset:1024 sc1
s_waitcnt vmcnt(21)
MF a[180:183],v[64:67],v[44:47],a[180:183]
v_lshlrev_b32 v172,16,v176
MF a[184:187],v[68:71],v[44:47],a[184:187]
v_lshlrev_b32 v178,16,v182
v_and_b32 v173,0xffff0000,v176
MF a[188:191],v[72:75],v[44:47],a[188:191]
v_and_b32 v179,0xffff0000,v182
MF a[192:195],v[76:79],v[44:47],a[192:195]
v_mul_f32 v174,v172,v172
MF a[196:199],v[80:83],v[44:47],a[196:199]
v_mul_f32 v180,v178,v178
v_mul_f32 v175,v173,v173
MF a[200:203],v[84:87],v[44:47],a[200:203]
v_mul_f32 v181,v179,v179
MF a[204:207],v[88:91],v[44:47],a[204:207]
v_fmaak_f32 v174,v174,v13,0xc0135761
MF a[208:211],v[92:95],v[44:47],a[208:211]
v_fmaak_f32 v180,v180,v13,0xc0135761
MF a[212:215],v[96:99],v[44:47],a[212:215]
buffer_load_dwordx4 v[44:47],v2,s[8:11],s27 offen offset:1024 sc1
s_waitcnt vmcnt(20)
MF v[184:187],v[100:103],v[48:51],v[184:187]
MF v[188:191],v[104:107],v[48:51],v[188:191]
MF v[192:195],v[108:111],v[48:51],v[192:195]
s_add_u32 s33,s32,55296
buffer_load_dwordx4 v[64:67],v1,s[8:11],s33 offen offset:0 sc1
MF v[196:199],v[112:115],v[48:51],v[196:199]
MF v[200:203],v[116:119],v[48:51],v[200:203]
MF v[204:207],v[120:123],v[48:51],v[204:207]
MF v[208:211],v[124:127],v[48:51],v[208:211]
buffer_load_dwordx4 v[68:71],v1,s[8:11],s33 offen offset:1024 sc1
MF v[212:215],v[128:131],v[48:51],v[212:215]
MF v[216:219],v[132:135],v[48:51],v[216:219]
buffer_load_dwordx4 v[48:51],v2,s[8:11],s28 offen offset:1024 sc1
s_waitcnt vmcnt(22)
MF v[220:223],v[100:103],v[52:55],v[220:223]
v_fmaak_f32 v175,v175,v13,0xc0135761
MF v[224:227],v[104:107],v[52:55],v[224:227]
v_fmaak_f32 v181,v181,v13,0xc0135761
v_mul_f32 v174,v174,v172
MF v[228:231],v[108:111],v[52:55],v[228:231]
buffer_load_dwordx4 v[72:75],v1,s[8:11],s33 offen offset:2048 sc1
MF v[232:235],v[112:115],v[52:55],v[232:235]
v_mul_f32 v180,v180,v178
MF v[236:239],v[116:119],v[52:55],v[236:239]
v_mul_f32 v175,v175,v173
v_mul_f32 v181,v181,v179
MF v[240:243],v[120:123],v[52:55],v[240:243]
v_exp_f32 v174,v174
MF v[244:247],v[124:127],v[52:55],v[244:247]
buffer_load_dwordx4 v[76:79],v1,s[8:11],s33 offen offset:3072 sc1
MF v[248:251],v[128:131],v[52:55],v[248:251]
v_exp_f32 v180,v180
MF v[252:255],v[132:135],v[52:55],v[252:255]
buffer_load_dwordx4 v[52:55],v2,s[8:11],s29 offen offset:1024 sc1
s_waitcnt vmcnt(24)
MF a[0:3],v[100:103],v[56:59],a[0:3]
v_exp_f32 v175,v175
MF a[4:7],v[104:107],v[56:59],a[4:7]
v_exp_f32 v181,v181
MF a[8:11],v[108:111],v[56:59],a[8:11]
s_add_u32 s33,s32,59392
buffer_load_dwordx4 v[80:83],v1,s[8:11],s33 offen offset:0 sc1
MF a[12:15],v[112:115],v[56:59],a[12:15]
v_add_f32 v174,1.0,v174
MF a[16:19],v[116:119],v[56:59],a[16:19]
v_add_f32 v180,1.0,v180
v_add_f32 v175,1.0,v175
MF a[20:23],v[120:123],v[56:59],a[20:23]
v_add_f32 v181,1.0,v181
MF a[24:27],v[124:127],v[56:59],a[24:27]
buffer_load_dwordx4 v[84:87],v1,s[8:11],s33 offen offset:1024 sc1
MF a[28:31],v[128:131],v[56:59],a[28:31]
v_rcp_f32 v174,v174
MF a[32:35],v[132:135],v[56:59],a[32:35]
buffer_load_dwordx4 v[56:59],v2,s[8:11],s30 offen offset:1024 sc1
s_waitcnt vmcnt(26)
MF a[36:39],v[100:103],v[60:63],a[36:39]
v_rcp_f32 v180,v180
MF a[40:43],v[104:107],v[60:63],a[40:43]
v_rcp_f32 v175,v175
MF a[44:47],v[108:111],v[60:63],a[44:47]
buffer_load_dwordx4 v[88:91],v1,s[8:11],s33 offen offset:2048 sc1
MF a[48:51],v[112:115],v[60:63],a[48:51]
v_rcp_f32 v181,v181
MF a[52:55],v[116:119],v[60:63],a[52:55]
v_mul_f32 v172,v172,v174
v_mul_f32 v178,v178,v180
MF a[56:59],v[120:123],v[60:63],a[56:59]
v_mul_f32 v173,v173,v175
MF a[60:63],v[124:127],v[60:63],a[60:63]
buffer_load_dwordx4 v[92:95],v1,s[8:11],s33 offen offset:3072 sc1
MF a[64:67],v[128:131],v[60:63],a[64:67]
v_mul_f32 v179,v179,v181
MF a[68:71],v[132:135],v[60:63],a[68:71]
buffer_load_dwordx4 v[60:63],v2,s[8:11],s31 offen offset:1024 sc1
s_waitcnt vmcnt(26)
MF a[72:75],v[100:103],v[16:19],a[72:75]
v_cvt_pk_bf16_f32 v176,v172,v173
MF a[76:79],v[104:107],v[16:19],a[76:79]
v_cvt_pk_bf16_f32 v182,v178,v179
v_accvgpr_write_b32 a228,v176
MF a[80:83],v[108:111],v[16:19],a[80:83]
s_add_u32 s33,s32,63488
buffer_load_dwordx4 v[96:99],v1,s[8:11],s33 offen offset:0 sc1
MF a[84:87],v[112:115],v[16:19],a[84:87]
v_accvgpr_write_b32 a229,v182
MF a[88:91],v[116:119],v[16:19],a[88:91]
v_accvgpr_read_b32 v176,a230
v_accvgpr_read_b32 v182,a231
MF a[92:95],v[120:123],v[16:19],a[92:95]
v_lshlrev_b32 v172,16,v176
MF a[96:99],v[124:127],v[16:19],a[96:99]
MF a[100:103],v[128:131],v[16:19],a[100:103]
v_lshlrev_b32 v178,16,v182
MF a[104:107],v[132:135],v[16:19],a[104:107]
buffer_load_dwordx4 v[16:19],v2,s[8:11],s24 offen offset:2048 sc1
s_waitcnt vmcnt(25)
MF a[108:111],v[100:103],v[20:23],a[108:111]
v_and_b32 v173,0xffff0000,v176
MF a[112:115],v[104:107],v[20:23],a[112:115]
v_and_b32 v179,0xffff0000,v182
v_mul_f32 v174,v172,v172
MF a[116:119],v[108:111],v[20:23],a[116:119]
v_mul_f32 v180,v178,v178
MF a[120:123],v[112:115],v[20:23],a[120:123]
v_mul_f32 v175,v173,v173
MF a[124:127],v[116:119],v[20:23],a[124:127]
v_mul_f32 v181,v179,v179
v_fmaak_f32 v174,v174,v13,0xc0135761
MF a[128:131],v[120:123],v[20:23],a[128:131]
v_fmaak_f32 v180,v180,v13,0xc0135761
MF a[132:135],v[124:127],v[20:23],a[132:135]
v_fmaak_f32 v175,v175,v13,0xc0135761
MF a[136:139],v[128:131],v[20:23],a[136:139]
v_fmaak_f32 v181,v181,v13,0xc0135761
MF a[140:143],v[132:135],v[20:23],a[140:143]
buffer_load_dwordx4 v[20:23],v2,s[8:11],s25 offen offset:2048 sc1
s_waitcnt vmcnt(23)
MF a[144:147],v[100:103],v[24:27],a[144:147]
v_mul_f32 v174,v174,v172
MF a[148:151],v[104:107],v[24:27],a[148:151]
v_mul_f32 v180,v180,v178
v_mul_f32 v175,v175,v173
MF a[152:155],v[108:111],v[24:27],a[152:155]
v_mul_f32 v181,v181,v179
MF a[156:159],v[112:115],v[24:27],a[156:159]
v_exp_f32 v174,v174
MF a[160:163],v[116:119],v[24:27],a[160:163]
v_exp_f32 v180,v180
MF a[164:167],v[120:123],v[24:27],a[164:167]
v_exp_f32 v175,v175
MF a[168:171],v[124:127],v[24:27],a[168:171]
v_exp_f32 v181,v181
MF a[172:175],v[128:131],v[24:27],a[172:175]
v_add_f32 v174,1.0,v174
MF a[176:179],v[132:135],v[24:27],a[176:179]
buffer_load_dwordx4 v[24:27],v2,s[8:11],s26 offen offset:2048 sc1
s_waitcnt vmcnt(21)
MF a[180:183],v[100:103],v[28:31],a[180:183]
v_add_f32 v180,1.0,v180
MF a[184:187],v[104:107],v[28:31],a[184:187]
v_add_f32 v175,1.0,v175
v_add_f32 v181,1.0,v181
MF a[188:191],v[108:111],v[28:31],a[188:191]
v_rcp_f32 v174,v174
MF a[192:195],v[112:115],v[28:31],a[192:195]
v_rcp_f32 v180,v180
MF a[196:199],v[116:119],v[28:31],a[196:199]
v_rcp_f32 v175,v175
MF a[200:203],v[120:123],v[28:31],a[200:203]
v_rcp_f32 v181,v181
MF a[204:207],v[124:127],v[28:31],a[204:207]
v_mul_f32 v172,v172,v174
MF a[208:211],v[128:131],v[28:31],a[208:211]
v_mul_f32 v178,v178,v180
MF a[212:215],v[132:135],v[28:31],a[212:215]
buffer_load_dwordx4 v[28:31],v2,s[8:11],s27 offen offset:2048 sc1
s_waitcnt vmcnt(20)
MF v[184:187],v[136:139],v[32:35],v[184:187]
MF v[188:191],v[140:143],v[32:35],v[188:191]
MF v[192:195],v[144:147],v[32:35],v[192:195]
s_add_u32 s33,s32,64512
buffer_load_dwordx4 v[100:103],v1,s[8:11],s33 offen offset:0 sc1
MF v[196:199],v[148:151],v[32:35],v[196:199]
MF v[200:203],v[152:155],v[32:35],v[200:203]
MF v[204:207],v[156:159],v[32:35],v[204:207]
MF v[208:211],v[160:163],v[32:35],v[208:211]
buffer_load_dwordx4 v[104:107],v1,s[8:11],s33 offen offset:1024 sc1
MF v[212:215],v[164:167],v[32:35],v[212:215]
MF v[216:219],v[168:171],v[32:35],v[216:219]
buffer_load_dwordx4 v[32:35],v2,s[8:11],s28 offen offset:2048 sc1
s_waitcnt vmcnt(22)
MF v[220:223],v[136:139],v[36:39],v[220:223]
v_mul_f32 v173,v173,v175
MF v[224:227],v[140:143],v[36:39],v[224:227]
v_mul_f32 v179,v179,v181
v_cvt_pk_bf16_f32 v176,v172,v173
MF v[228:231],v[144:147],v[36:39],v[228:231]
buffer_load_dwordx4 v[108:111],v1,s[8:11],s33 offen offset:2048 sc1
MF v[232:235],v[148:151],v[36:39],v[232:235]
v_cvt_pk_bf16_f32 v182,v178,v179
MF v[236:239],v[152:155],v[36:39],v[236:239]
v_accvgpr_write_b32 a230,v176
v_accvgpr_write_b32 a231,v182
MF v[240:243],v[156:159],v[36:39],v[240:243]
v_accvgpr_read_b32 v176,a232
MF v[244:247],v[160:163],v[36:39],v[244:247]
buffer_load_dwordx4 v[112:115],v1,s[8:11],s33 offen offset:3072 sc1
MF v[248:251],v[164:167],v[36:39],v[248:251]
v_accvgpr_read_b32 v182,a233
MF v[252:255],v[168:171],v[36:39],v[252:255]
buffer_load_dwordx4 v[36:39],v2,s[8:11],s29 offen offset:2048 sc1
s_waitcnt vmcnt(24)
MF a[0:3],v[136:139],v[40:43],a[0:3]
v_lshlrev_b32 v172,16,v176
MF a[4:7],v[140:143],v[40:43],a[4:7]
v_lshlrev_b32 v178,16,v182
v_and_b32 v173,0xffff0000,v176
MF a[8:11],v[144:147],v[40:43],a[8:11]
s_add_u32 s33,s32,68608
buffer_load_dwordx4 v[116:119],v1,s[8:11],s33 offen offset:0 sc1
MF a[12:15],v[148:151],v[40:43],a[12:15]
v_and_b32 v179,0xffff0000,v182
MF a[16:19],v[152:155],v[40:43],a[16:19]
v_mul_f32 v174,v172,v172
v_mul_f32 v180,v178,v178
MF a[20:23],v[156:159],v[40:43],a[20:23]
v_mul_f32 v175,v173,v173
MF a[24:27],v[160:163],v[40:43],a[24:27]
buffer_load_dwordx4 v[120:123],v1,s[8:11],s33 offen offset:1024 sc1
MF a[28:31],v[164:167],v[40:43],a[28:31]
v_mul_f32 v181,v179,v179
MF a[32:35],v[168:171],v[40:43],a[32:35]
buffer_load_dwordx4 v[40:43],v2,s[8:11],s30 offen offset:2048 sc1
s_waitcnt vmcnt(26)
MF a[36:39],v[136:139],v[44:47],a[36:39]
v_fmaak_f32 v174,v174,v13,0xc0135761
MF a[40:43],v[140:143],v[44:47],a[40:43]
v_fmaak_f32 v180,v180,v13,0xc0135761
v_fmaak_f32 v175,v175,v13,0xc0135761
MF a[44:47],v[144:147],v[44:47],a[44:47]
buffer_load_dwordx4 v[124:127],v1,s[8:11],s33 offen offset:2048 sc1
MF a[48:51],v[148:151],v[44:47],a[48:51]
v_fmaak_f32 v181,v181,v13,0xc0135761
MF a[52:55],v[152:155],v[44:47],a[52:55]
v_mul_f32 v174,v174,v172
v_mul_f32 v180,v180,v178
MF a[56:59],v[156:159],v[44:47],a[56:59]
v_mul_f32 v175,v175,v173
MF a[60:63],v[160:163],v[44:47],a[60:63]
buffer_load_dwordx4 v[128:131],v1,s[8:11],s33 offen offset:3072 sc1
MF a[64:67],v[164:167],v[44:47],a[64:67]
v_mul_f32 v181,v181,v179
MF a[68:71],v[168:171],v[44:47],a[68:71]
buffer_load_dwordx4 v[44:47],v2,s[8:11],s31 offen offset:2048 sc1
s_waitcnt vmcnt(26)
MF a[72:75],v[136:139],v[48:51],a[72:75]
v_exp_f32 v174,v174
MF a[76:79],v[140:143],v[48:51],a[76:79]
v_exp_f32 v180,v180
MF a[80:83],v[144:147],v[48:51],a[80:83]
s_add_u32 s33,s32,72704
buffer_load_dwordx4 v[132:135],v1,s[8:11],s33 offen offset:0 sc1
MF a[84:87],v[148:151],v[48:51],a[84:87]
v_exp_f32 v175,v175
MF a[88:91],v[152:155],v[48:51],a[88:91]
v_exp_f32 v181,v181
MF a[92:95],v[156:159],v[48:51],a[92:95]
v_add_f32 v174,1.0,v174
MF a[96:99],v[160:163],v[48:51],a[96:99]
MF a[100:103],v[164:167],v[48:51],a[100:103]
v_add_f32 v180,1.0,v180
MF a[104:107],v[168:171],v[48:51],a[104:107]
buffer_load_dwordx4 v[48:51],v2,s[8:11],s24 offen offset:3072 sc1
s_waitcnt vmcnt(25)
MF a[108:111],v[136:139],v[52:55],a[108:111]
v_add_f32 v175,1.0,v175
MF a[112:115],v[140:143],v[52:55],a[112:115]
v_add_f32 v181,1.0,v181
v_rcp_f32 v174,v174
MF a[116:119],v[144:147],v[52:55],a[116:119]
v_rcp_f32 v180,v180
MF a[120:123],v[148:151],v[52:55],a[120:123]
v_rcp_f32 v175,v175
MF a[124:127],v[152:155],v[52:55],a[124:127]
v_rcp_f32 v181,v181
MF a[128:131],v[156:159],v[52:55],a[128:131]
v_mul_f32 v172,v172,v174
MF a[132:135],v[160:163],v[52:55],a[132:135]
v_mul_f32 v178,v178,v180
MF a[136:139],v[164:167],v[52:55],a[136:139]
v_mul_f32 v173,v173,v175
MF a[140:143],v[168:171],v[52:55],a[140:143]
buffer_load_dwordx4 v[52:55],v2,s[8:11],s25 offen offset:3072 sc1
s_waitcnt vmcnt(23)
MF a[144:147],v[136:139],v[56:59],a[144:147]
v_mul_f32 v179,v179,v181
MF a[148:151],v[140:143],v[56:59],a[148:151]
v_cvt_pk_bf16_f32 v176,v172,v173
v_cvt_pk_bf16_f32 v182,v178,v179
MF a[152:155],v[144:147],v[56:59],a[152:155]
v_accvgpr_write_b32 a232,v176
MF a[156:159],v[148:151],v[56:59],a[156:159]
v_accvgpr_write_b32 a233,v182
MF a[160:163],v[152:155],v[56:59],a[160:163]
v_accvgpr_read_b32 v176,a234
v_accvgpr_read_b32 v182,a235
MF a[164:167],v[156:159],v[56:59],a[164:167]
v_lshlrev_b32 v172,16,v176
MF a[168:171],v[160:163],v[56:59],a[168:171]
v_lshlrev_b32 v178,16,v182
MF a[172:175],v[164:167],v[56:59],a[172:175]
v_and_b32 v173,0xffff0000,v176
MF a[176:179],v[168:171],v[56:59],a[176:179]
buffer_load_dwordx4 v[56:59],v2,s[8:11],s26 offen offset:3072 sc1
s_waitcnt vmcnt(21)
MF a[180:183],v[136:139],v[60:63],a[180:183]
v_and_b32 v179,0xffff0000,v182
MF a[184:187],v[140:143],v[60:63],a[184:187]
v_mul_f32 v174,v172,v172
v_mul_f32 v180,v178,v178
MF a[188:191],v[144:147],v[60:63],a[188:191]
v_mul_f32 v175,v173,v173
MF a[192:195],v[148:151],v[60:63],a[192:195]
v_mul_f32 v181,v179,v179
MF a[196:199],v[152:155],v[60:63],a[196:199]
v_fmaak_f32 v174,v174,v13,0xc0135761
v_fmaak_f32 v180,v180,v13,0xc0135761
MF a[200:203],v[156:159],v[60:63],a[200:203]
v_fmaak_f32 v175,v175,v13,0xc0135761
MF a[204:207],v[160:163],v[60:63],a[204:207]
v_fmaak_f32 v181,v181,v13,0xc0135761
MF a[208:211],v[164:167],v[60:63],a[208:211]
v_mul_f32 v174,v174,v172
MF a[212:215],v[168:171],v[60:63],a[212:215]
buffer_load_dwordx4 v[60:63],v2,s[8:11],s27 offen offset:3072 sc1
s_waitcnt vmcnt(20)
MF v[184:187],v[64:67],v[16:19],v[184:187]
MF v[188:191],v[68:71],v[16:19],v[188:191]
MF v[192:195],v[72:75],v[16:19],v[192:195]
s_add_u32 s33,s32,73728
buffer_load_dwordx4 v[136:139],v1,s[8:11],s33 offen offset:0 sc1
MF v[196:199],v[76:79],v[16:19],v[196:199]
MF v[200:203],v[80:83],v[16:19],v[200:203]
MF v[204:207],v[84:87],v[16:19],v[204:207]
MF v[208:211],v[88:91],v[16:19],v[208:211]
buffer_load_dwordx4 v[140:143],v1,s[8:11],s33 offen offset:1024 sc1
MF v[212:215],v[92:95],v[16:19],v[212:215]
MF v[216:219],v[96:99],v[16:19],v[216:219]
buffer_load_dwordx4 v[16:19],v2,s[8:11],s28 offen offset:3072 sc1
s_waitcnt vmcnt(22)
MF v[220:223],v[64:67],v[20:23],v[220:223]
v_mul_f32 v180,v180,v178
MF v[224:227],v[68:71],v[20:23],v[224:227]
v_mul_f32 v175,v175,v173
v_mul_f32 v181,v181,v179
MF v[228:231],v[72:75],v[20:23],v[228:231]
buffer_load_dwordx4 v[144:147],v1,s[8:11],s33 offen offset:2048 sc1
MF v[232:235],v[76:79],v[20:23],v[232:235]
v_exp_f32 v174,v174
MF v[236:239],v[80:83],v[20:23],v[236:239]
v_exp_f32 v180,v180
MF v[240:243],v[84:87],v[20:23],v[240:243]
v_exp_f32 v175,v175
MF v[244:247],v[88:91],v[20:23],v[244:247]
buffer_load_dwordx4 v[148:151],v1,s[8:11],s33 offen offset:3072 sc1
MF v[248:251],v[92:95],v[20:23],v[248:251]
v_exp_f32 v181,v181
MF v[252:255],v[96:99],v[20:23],v[252:255]
buffer_load_dwordx4 v[20:23],v2,s[8:11],s29 offen offset:3072 sc1
s_waitcnt vmcnt(24)
MF a[0:3],v[64:67],v[24:27],a[0:3]
v_add_f32 v174,1.0,v174
MF a[4:7],v[68:71],v[24:27],a[4:7]
v_add_f32 v180,1.0,v180
v_add_f32 v175,1.0,v175
MF a[8:11],v[72:75],v[24:27],a[8:11]
s_add_u32 s33,s32,77824
buffer_load_dwordx4 v[152:155],v1,s[8:11],s33 offen offset:0 sc1
MF a[12:15],v[76:79],v[24:27],a[12:15]
v_add_f32 v181,1.0,v181
MF a[16:19],v[80:83],v[24:27],a[16:19]
v_rcp_f32 v174,v174
MF a[20:23],v[84:87],v[24:27],a[20:23]
v_rcp_f32 v180,v180
MF a[24:27],v[88:91],v[24:27],a[24:27]
buffer_load_dwordx4 v[156:159],v1,s[8:11],s33 offen offset:1024 sc1
MF a[28:31],v[92:95],v[24:27],a[28:31]
v_rcp_f32 v175,v175
MF a[32:35],v[96:99],v[24:27],a[32:35]
buffer_load_dwordx4 v[24:27],v2,s[8:11],s30 offen offset:3072 sc1
s_waitcnt vmcnt(26)
MF a[36:39],v[64:67],v[28:31],a[36:39]
v_rcp_f32 v181,v181
MF a[40:43],v[68:71],v[28:31],a[40:43]
v_mul_f32 v172,v172,v174
v_mul_f32 v178,v178,v180
MF a[44:47],v[72:75],v[28:31],a[44:47]
buffer_load_dwordx4 v[160:163],v1,s[8:11],s33 offen offset:2048 sc1
MF a[48:51],v[76:79],v[28:31],a[48:51]
v_mul_f32 v173,v173,v175
MF a[52:55],v[80:83],v[28:31],a[52:55]
v_mul_f32 v179,v179,v181
v_cvt_pk_bf16_f32 v176,v172,v173
MF a[56:59],v[84:87],v[28:31],a[56:59]
v_cvt_pk_bf16_f32 v182,v178,v179
MF a[60:63],v[88:91],v[28:31],a[60:63]
buffer_load_dwordx4 v[164:167],v1,s[8:11],s33 offen offset:3072 sc1
MF a[64:67],v[92:95],v[28:31],a[64:67]
v_accvgpr_write_b32 a234,v176
MF a[68:71],v[96:99],v[28:31],a[68:71]
buffer_load_dwordx4 v[28:31],v2,s[8:11],s31 offen offset:3072 sc1
s_waitcnt vmcnt(26)
MF a[72:75],v[64:67],v[32:35],a[72:75]
v_accvgpr_write_b32 a235,v182
MF a[76:79],v[68:71],v[32:35],a[76:79]
v_accvgpr_read_b32 v176,a236
v_accvgpr_read_b32 v182,a237
MF a[80:83],v[72:75],v[32:35],a[80:83]
s_add_u32 s33,s32,81920
buffer_load_dwordx4 v[168:171],v1,s[8:11],s33 offen offset:0 sc1
MF a[84:87],v[76:79],v[32:35],a[84:87]
v_lshlrev_b32 v172,16,v176
MF a[88:91],v[80:83],v[32:35],a[88:91]
v_lshlrev_b32 v178,16,v182
v_and_b32 v173,0xffff0000,v176
MF a[92:95],v[84:87],v[32:35],a[92:95]
v_and_b32 v179,0xffff0000,v182
MF a[96:99],v[88:91],v[32:35],a[96:99]
MF a[100:103],v[92:95],v[32:35],a[100:103]
v_mul_f32 v174,v172,v172
MF a[104:107],v[96:99],v[32:35],a[104:107]
buffer_load_dwordx4 v[32:35],v3,s[8:11],s24 offen offset:0 sc1
s_waitcnt vmcnt(25)
MF a[108:111],v[64:67],v[36:39],a[108:111]
v_mul_f32 v180,v178,v178
MF a[112:115],v[68:71],v[36:39],a[112:115]
v_mul_f32 v175,v173,v173
v_mul_f32 v181,v179,v179
MF a[116:119],v[72:75],v[36:39],a[116:119]
v_fmaak_f32 v174,v174,v13,0xc0135761
MF a[120:123],v[76:79],v[36:39],a[120:123]
v_fmaak_f32 v180,v180,v13,0xc0135761
MF a[124:127],v[80:83],v[36:39],a[124:127]
v_fmaak_f32 v175,v175,v13,0xc0135761
v_fmaak_f32 v181,v181,v13,0xc0135761
MF a[128:131],v[84:87],v[36:39],a[128:131]
v_mul_f32 v174,v174,v172
MF a[132:135],v[88:91],v[36:39],a[132:135]
v_mul_f32 v180,v180,v178
MF a[136:139],v[92:95],v[36:39],a[136:139]
v_mul_f32 v175,v175,v173
MF a[140:143],v[96:99],v[36:39],a[140:143]
buffer_load_dwordx4 v[36:39],v3,s[8:11],s25 offen offset:0 sc1
s_waitcnt vmcnt(23)
MF a[144:147],v[64:67],v[40:43],a[144:147]
v_mul_f32 v181,v181,v179
MF a[148:151],v[68:71],v[40:43],a[148:151]
v_exp_f32 v174,v174
MF a[152:155],v[72:75],v[40:43],a[152:155]
v_exp_f32 v180,v180
MF a[156:159],v[76:79],v[40:43],a[156:159]
v_exp_f32 v175,v175
MF a[160:163],v[80:83],v[40:43],a[160:163]
v_exp_f32 v181,v181
MF a[164:167],v[84:87],v[40:43],a[164:167]
v_add_f32 v174,1.0,v174
MF a[168:171],v[88:91],v[40:43],a[168:171]
v_add_f32 v180,1.0,v180
MF a[172:175],v[92:95],v[40:43],a[172:175]
v_add_f32 v175,1.0,v175
MF a[176:179],v[96:99],v[40:43],a[176:179]
buffer_load_dwordx4 v[40:43],v3,s[8:11],s26 offen offset:0 sc1
s_waitcnt vmcnt(21)
MF a[180:183],v[64:67],v[44:47],a[180:183]
v_add_f32 v181,1.0,v181
MF a[184:187],v[68:71],v[44:47],a[184:187]
v_rcp_f32 v174,v174
MF a[188:191],v[72:75],v[44:47],a[188:191]
v_rcp_f32 v180,v180
MF a[192:195],v[76:79],v[44:47],a[192:195]
v_rcp_f32 v175,v175
MF a[196:199],v[80:83],v[44:47],a[196:199]
v_rcp_f32 v181,v181
MF a[200:203],v[84:87],v[44:47],a[200:203]
v_mul_f32 v172,v172,v174
MF a[204:207],v[88:91],v[44:47],a[204:207]
v_mul_f32 v178,v178,v180
MF a[208:211],v[92:95],v[44:47],a[208:211]
v_mul_f32 v173,v173,v175
MF a[212:215],v[96:99],v[44:47],a[212:215]
buffer_load_dwordx4 v[44:47],v3,s[8:11],s27 offen offset:0 sc1
s_waitcnt vmcnt(20)
MF v[184:187],v[100:103],v[48:51],v[184:187]
MF v[188:191],v[104:107],v[48:51],v[188:191]
MF v[192:195],v[108:111],v[48:51],v[192:195]
s_add_u32 s33,s32,82944
buffer_load_dwordx4 v[64:67],v1,s[8:11],s33 offen offset:0 sc1
MF v[196:199],v[112:115],v[48:51],v[196:199]
MF v[200:203],v[116:119],v[48:51],v[200:203]
MF v[204:207],v[120:123],v[48:51],v[204:207]
MF v[208:211],v[124:127],v[48:51],v[208:211]
buffer_load_dwordx4 v[68:71],v1,s[8:11],s33 offen offset:1024 sc1
MF v[212:215],v[128:131],v[48:51],v[212:215]
MF v[216:219],v[132:135],v[48:51],v[216:219]
buffer_load_dwordx4 v[48:51],v3,s[8:11],s28 offen offset:0 sc1
s_waitcnt vmcnt(22)
MF v[220:223],v[100:103],v[52:55],v[220:223]
v_mul_f32 v179,v179,v181
MF v[224:227],v[104:107],v[52:55],v[224:227]
v_cvt_pk_bf16_f32 v176,v172,v173
v_cvt_pk_bf16_f32 v182,v178,v179
MF v[228:231],v[108:111],v[52:55],v[228:231]
buffer_load_dwordx4 v[72:75],v1,s[8:11],s33 offen offset:2048 sc1
MF v[232:235],v[112:115],v[52:55],v[232:235]
v_accvgpr_write_b32 a236,v176
MF v[236:239],v[116:119],v[52:55],v[236:239]
v_accvgpr_write_b32 a237,v182
v_accvgpr_read_b32 v176,a238
MF v[240:243],v[120:123],v[52:55],v[240:243]
v_accvgpr_read_b32 v182,a239
MF v[244:247],v[124:127],v[52:55],v[244:247]
buffer_load_dwordx4 v[76:79],v1,s[8:11],s33 offen offset:3072 sc1
MF v[248:251],v[128:131],v[52:55],v[248:251]
v_lshlrev_b32 v172,16,v176
MF v[252:255],v[132:135],v[52:55],v[252:255]
buffer_load_dwordx4 v[52:55],v3,s[8:11],s29 offen offset:0 sc1
s_waitcnt vmcnt(24)
MF a[0:3],v[100:103],v[56:59],a[0:3]
v_lshlrev_b32 v178,16,v182
MF a[4:7],v[104:107],v[56:59],a[4:7]
v_and_b32 v173,0xffff0000,v176
v_and_b32 v179,0xffff0000,v182
MF a[8:11],v[108:111],v[56:59],a[8:11]
s_add_u32 s33,s32,87040
buffer_load_dwordx4 v[80:83],v1,s[8:11],s33 offen offset:0 sc1
MF a[12:15],v[112:115],v[56:59],a[12:15]
v_mul_f32 v174,v172,v172
MF a[16:19],v[116:119],v[56:59],a[16:19]
v_mul_f32 v180,v178,v178
v_mul_f32 v175,v173,v173
MF a[20:23],v[120:123],v[56:59],a[20:23]
v_mul_f32 v181,v179,v179
MF a[24:27],v[124:127],v[56:59],a[24:27]
buffer_load_dwordx4 v[84:87],v1,s[8:11],s33 offen offset:1024 sc1
MF a[28:31],v[128:131],v[56:59],a[28:31]
v_fmaak_f32 v174,v174,v13,0xc0135761
MF a[32:35],v[132:135],v[56:59],a[32:35]
buffer_load_dwordx4 v[56:59],v3,s[8:11],s30 offen offset:0 sc1
s_waitcnt vmcnt(26)
MF a[36:39],v[100:103],v[60:63],a[36:39]
v_fmaak_f32 v180,v180,v13,0xc0135761
MF a[40:43],v[104:107],v[60:63],a[40:43]
v_fmaak_f32 v175,v175,v13,0xc0135761
v_fmaak_f32 v181,v181,v13,0xc0135761
MF a[44:47],v[108:111],v[60:63],a[44:47]
buffer_load_dwordx4 v[88:91],v1,s[8:11],s33 offen offset:2048 sc1
MF a[48:51],v[112:115],v[60:63],a[48:51]
v_mul_f32 v174,v174,v172
MF a[52:55],v[116:119],v[60:63],a[52:55]
v_mul_f32 v180,v180,v178
v_mul_f32 v175,v175,v173
MF a[56:59],v[120:123],v[60:63],a[56:59]
v_mul_f32 v181,v181,v179
MF a[60:63],v[124:127],v[60:63],a[60:63]
buffer_load_dwordx4 v[92:95],v1,s[8:11],s33 offen offset:3072 sc1
MF a[64:67],v[128:131],v[60:63],a[64:67]
v_exp_f32 v174,v174
MF a[68:71],v[132:135],v[60:63],a[68:71]
buffer_load_dwordx4 v[60:63],v3,s[8:11],s31 offen offset:0 sc1
s_waitcnt vmcnt(26)
MF a[72:75],v[100:103],v[16:19],a[72:75]
v_exp_f32 v180,v180
MF a[76:79],v[104:107],v[16:19],a[76:79]
v_exp_f32 v175,v175
MF a[80:83],v[108:111],v[16:19],a[80:83]
s_add_u32 s33,s32,91136
buffer_load_dwordx4 v[96:99],v1,s[8:11],s33 offen offset:0 sc1
MF a[84:87],v[112:115],v[16:19],a[84:87]
v_exp_f32 v181,v181
MF a[88:91],v[116:119],v[16:19],a[88:91]
v_add_f32 v174,1.0,v174
v_add_f32 v180,1.0,v180
MF a[92:95],v[120:123],v[16:19],a[92:95]
v_add_f32 v175,1.0,v175
MF a[96:99],v[124:127],v[16:19],a[96:99]
MF a[100:103],v[128:131],v[16:19],a[100:103]
v_add_f32 v181,1.0,v181
MF a[104:107],v[132:135],v[16:19],a[104:107]
buffer_load_dwordx4 v[16:19],v3,s[8:11],s24 offen offset:1024 sc1
s_waitcnt vmcnt(25)
MF a[108:111],v[100:103],v[20:23],a[108:111]
v_rcp_f32 v174,v174
MF a[112:115],v[104:107],v[20:23],a[112:115]
v_rcp_f32 v180,v180
MF a[116:119],v[108:111],v[20:23],a[116:119]
v_rcp_f32 v175,v175
MF a[120:123],v[112:115],v[20:23],a[120:123]
v_rcp_f32 v181,v181
MF a[124:127],v[116:119],v[20:23],a[124:127]
v_mul_f32 v172,v172,v174
v_mul_f32 v178,v178,v180
MF a[128:131],v[120:123],v[20:23],a[128:131]
v_mul_f32 v173,v173,v175
MF a[132:135],v[124:127],v[20:23],a[132:135]
v_mul_f32 v179,v179,v181
MF a[136:139],v[128:131],v[20:23],a[136:139]
v_cvt_pk_bf16_f32 v176,v172,v173
MF a[140:143],v[132:135],v[20:23],a[140:143]
buffer_load_dwordx4 v[20:23],v3,s[8:11],s25 offen offset:1024 sc1
s_waitcnt vmcnt(23)
MF a[144:147],v[100:103],v[24:27],a[144:147]
v_cvt_pk_bf16_f32 v182,v178,v179
MF a[148:151],v[104:107],v[24:27],a[148:151]
v_accvgpr_write_b32 a238,v176
v_accvgpr_write_b32 a239,v182
MF a[152:155],v[108:111],v[24:27],a[152:155]
v_accvgpr_read_b32 v176,a240
MF a[156:159],v[112:115],v[24:27],a[156:159]
v_accvgpr_read_b32 v182,a241
MF a[160:163],v[116:119],v[24:27],a[160:163]
v_lshlrev_b32 v172,16,v176
v_lshlrev_b32 v178,16,v182
MF a[164:167],v[120:123],v[24:27],a[164:167]
v_and_b32 v173,0xffff0000,v176
MF a[168:171],v[124:127],v[24:27],a[168:171]
v_and_b32 v179,0xffff0000,v182
MF a[172:175],v[128:131],v[24:27],a[172:175]
v_mul_f32 v174,v172,v172
MF a[176:179],v[132:135],v[24:27],a[176:179]
buffer_load_dwordx4 v[24:27],v3,s[8:11],s26 offen offset:1024 sc1
s_waitcnt vmcnt(21)
MF a[180:183],v[100:103],v[28:31],a[180:183]
v_mul_f32 v180,v178,v178
MF a[184:187],v[104:107],v[28:31],a[184:187]
v_mul_f32 v175,v173,v173
v_mul_f32 v181,v179,v179
MF a[188:191],v[108:111],v[28:31],a[188:191]
v_fmaak_f32 v174,v174,v13,0xc0135761
MF a[192:195],v[112:115],v[28:31],a[192:195]
v_fmaak_f32 v180,v180,v13,0xc0135761
MF a[196:199],v[116:119],v[28:31],a[196:199]
v_fmaak_f32 v175,v175,v13,0xc0135761
v_fmaak_f32 v181,v181,v13,0xc0135761
MF a[200:203],v[120:123],v[28:31],a[200:203]
v_mul_f32 v174,v174,v172
MF a[204:207],v[124:127],v[28:31],a[204:207]
v_mul_f32 v180,v180,v178
MF a[208:211],v[128:131],v[28:31],a[208:211]
v_mul_f32 v175,v175,v173
MF a[212:215],v[132:135],v[28:31],a[212:215]
buffer_load_dwordx4 v[28:31],v3,s[8:11],s27 offen offset:1024 sc1
s_waitcnt vmcnt(20)
MF v[184:187],v[136:139],v[32:35],v[184:187]
MF v[188:191],v[140:143],v[32:35],v[188:191]
MF v[192:195],v[144:147],v[32:35],v[192:195]
s_add_u32 s33,s32,92160
buffer_load_dwordx4 v[100:103],v1,s[8:11],s33 offen offset:0 sc1
MF v[196:199],v[148:151],v[32:35],v[196:199]
MF v[200:203],v[152:155],v[32:35],v[200:203]
MF v[204:207],v[156:159],v[32:35],v[204:207]
MF v[208:211],v[160:163],v[32:35],v[208:211]
buffer_load_dwordx4 v[104:107],v1,s[8:11],s33 offen offset:1024 sc1
MF v[212:215],v[164:167],v[32:35],v[212:215]
MF v[216:219],v[168:171],v[32:35],v[216:219]
buffer_load_dwordx4 v[32:35],v3,s[8:11],s28 offen offset:1024 sc1
s_waitcnt vmcnt(22)
MF v[220:223],v[136:139],v[36:39],v[220:223]
v_mul_f32 v181,v181,v179
MF v[224:227],v[140:143],v[36:39],v[224:227]
v_exp_f32 v174,v174
MF v[228:231],v[144:147],v[36:39],v[228:231]
buffer_load_dwordx4 v[108:111],v1,s[8:11],s33 offen offset:2048 sc1
MF v[232:235],v[148:151],v[36:39],v[232:235]
v_exp_f32 v180,v180
MF v[236:239],v[152:155],v[36:39],v[236:239]
v_exp_f32 v175,v175
MF v[240:243],v[156:159],v[36:39],v[240:243]
v_exp_f32 v181,v181
MF v[244:247],v[160:163],v[36:39],v[244:247]
buffer_load_dwordx4 v[112:115],v1,s[8:11],s33 offen offset:3072 sc1
MF v[248:251],v[164:167],v[36:39],v[248:251]
v_add_f32 v174,1.0,v174
MF v[252:255],v[168:171],v[36:39],v[252:255]
buffer_load_dwordx4 v[36:39],v3,s[8:11],s29 offen offset:1024 sc1
s_waitcnt vmcnt(24)
MF a[0:3],v[136:139],v[40:43],a[0:3]
v_add_f32 v180,1.0,v180
MF a[4:7],v[140:143],v[40:43],a[4:7]
v_add_f32 v175,1.0,v175
v_add_f32 v181,1.0,v181
MF a[8:11],v[144:147],v[40:43],a[8:11]
s_add_u32 s33,s32,96256
buffer_load_dwordx4 v[116:119],v1,s[8:11],s33 offen offset:0 sc1
MF a[12:15],v[148:151],v[40:43],a[12:15]
v_rcp_f32 v174,v174
MF a[16:19],v[152:155],v[40:43],a[16:19]
v_rcp_f32 v180,v180
MF a[20:23],v[156:159],v[40:43],a[20:23]
v_rcp_f32 v175,v175
MF a[24:27],v[160:163],v[40:43],a[24:27]
buffer_load_dwordx4 v[120:123],v1,s[8:11],s33 offen offset:1024 sc1
MF a[28:31],v[164:167],v[40:43],a[28:31]
v_rcp_f32 v181,v181
MF a[32:35],v[168:171],v[40:43],a[32:35]
buffer_load_dwordx4 v[40:43],v3,s[8:11],s30 offen offset:1024 sc1
s_waitcnt vmcnt(26)
MF a[36:39],v[136:139],v[44:47],a[36:39]
v_mul_f32 v172,v172,v174
MF a[40:43],v[140:143],v[44:47],a[40:43]
v_mul_f32 v178,v178,v180
v_mul_f32 v173,v173,v175
MF a[44:47],v[144:147],v[44:47],a[44:47]
buffer_load_dwordx4 v[124:127],v1,s[8:11],s33 offen offset:2048 sc1
MF a[48:51],v[148:151],v[44:47],a[48:51]
v_mul_f32 v179,v179,v181
MF a[52:55],v[152:155],v[44:47],a[52:55]
v_cvt_pk_bf16_f32 v176,v172,v173
v_cvt_pk_bf16_f32 v182,v178,v179
MF a[56:59],v[156:159],v[44:47],a[56:59]
v_accvgpr_write_b32 a240,v176
MF a[60:63],v[160:163],v[44:47],a[60:63]
buffer_load_dwordx4 v[128:131],v1,s[8:11],s33 offen offset:3072 sc1
MF a[64:67],v[164:167],v[44:47],a[64:67]
v_accvgpr_write_b32 a241,v182
MF a[68:71],v[168:171],v[44:47],a[68:71]
buffer_load_dwordx4 v[44:47],v3,s[8:11],s31 offen offset:1024 sc1
s_waitcnt vmcnt(26)
MF a[72:75],v[136:139],v[48:51],a[72:75]
v_accvgpr_read_b32 v176,a242
MF a[76:79],v[140:143],v[48:51],a[76:79]
v_accvgpr_read_b32 v182,a243
v_lshlrev_b32 v172,16,v176
MF a[80:83],v[144:147],v[48:51],a[80:83]
s_add_u32 s33,s32,100352
buffer_load_dwordx4 v[132:135],v1,s[8:11],s33 offen offset:0 sc1
MF a[84:87],v[148:151],v[48:51],a[84:87]
v_lshlrev_b32 v178,16,v182
MF a[88:91],v[152:155],v[48:51],a[88:91]
v_and_b32 v173,0xffff0000,v176
v_and_b32 v179,0xffff0000,v182
MF a[92:95],v[156:159],v[48:51],a[92:95]
v_mul_f32 v174,v172,v172
MF a[96:99],v[160:163],v[48:51],a[96:99]
MF a[100:103],v[164:167],v[48:51],a[100:103]
v_mul_f32 v180,v178,v178
MF a[104:107],v[168:171],v[48:51],a[104:107]
buffer_load_dwordx4 v[48:51],v3,s[8:11],s24 offen offset:2048 sc1
s_waitcnt vmcnt(25)
MF a[108:111],v[136:139],v[52:55],a[108:111]
v_mul_f32 v175,v173,v173
MF a[112:115],v[140:143],v[52:55],a[112:115]
v_mul_f32 v181,v179,v179
v_fmaak_f32 v174,v174,v13,0xc0135761
MF a[116:119],v[144:147],v[52:55],a[116:119]
v_fmaak_f32 v180,v180,v13,0xc0135761
MF a[120:123],v[148:151],v[52:55],a[120:123]
v_fmaak_f32 v175,v175,v13,0xc0135761
MF a[124:127],v[152:155],v[52:55],a[124:127]
v_fmaak_f32 v181,v181,v13,0xc0135761
v_mul_f32 v174,v174,v172
MF a[128:131],v[156:159],v[52:55],a[128:131]
v_mul_f32 v180,v180,v178
MF a[132:135],v[160:163],v[52:55],a[132:135]
v_mul_f32 v175,v175,v173
MF a[136:139],v[164:167],v[52:55],a[136:139]
v_mul_f32 v181,v181,v179
MF a[140:143],v[168:171],v[52:55],a[140:143]
buffer_load_dwordx4 v[52:55],v3,s[8:11],s25 offen offset:2048 sc1
s_waitcnt vmcnt(23)
MF a[144:147],v[136:139],v[56:59],a[144:147]
v_exp_f32 v174,v174
MF a[148:151],v[140:143],v[56:59],a[148:151]
v_exp_f32 v180,v180
MF a[152:155],v[144:147],v[56:59],a[152:155]
v_exp_f32 v175,v175
MF a[156:159],v[148:151],v[56:59],a[156:159]
v_exp_f32 v181,v181
MF a[160:163],v[152:155],v[56:59],a[160:163]
v_add_f32 v174,1.0,v174
v_add_f32 v180,1.0,v180
MF a[164:167],v[156:159],v[56:59],a[164:167]
v_add_f32 v175,1.0,v175
MF a[168:171],v[160:163],v[56:59],a[168:171]
v_add_f32 v181,1.0,v181
MF a[172:175],v[164:167],v[56:59],a[172:175]
v_rcp_f32 v174,v174
MF a[176:179],v[168:171],v[56:59],a[176:179]
buffer_load_dwordx4 v[56:59],v3,s[8:11],s26 offen offset:2048 sc1
s_waitcnt vmcnt(21)
MF a[180:183],v[136:139],v[60:63],a[180:183]
v_rcp_f32 v180,v180
MF a[184:187],v[140:143],v[60:63],a[184:187]
v_rcp_f32 v175,v175
MF a[188:191],v[144:147],v[60:63],a[188:191]
v_rcp_f32 v181,v181
MF a[192:195],v[148:151],v[60:63],a[192:195]
v_mul_f32 v172,v172,v174
MF a[196:199],v[152:155],v[60:63],a[196:199]
v_mul_f32 v178,v178,v180
v_mul_f32 v173,v173,v175
MF a[200:203],v[156:159],v[60:63],a[200:203]
v_mul_f32 v179,v179,v181
MF a[204:207],v[160:163],v[60:63],a[204:207]
v_cvt_pk_bf16_f32 v176,v172,v173
MF a[208:211],v[164:167],v[60:63],a[208:211]
v_cvt_pk_bf16_f32 v182,v178,v179
MF a[212:215],v[168:171],v[60:63],a[212:215]
buffer_load_dwordx4 v[60:63],v3,s[8:11],s27 offen offset:2048 sc1
s_waitcnt vmcnt(20)
MF v[184:187],v[64:67],v[16:19],v[184:187]
MF v[188:191],v[68:71],v[16:19],v[188:191]
MF v[192:195],v[72:75],v[16:19],v[192:195]
s_add_u32 s33,s32,101376
buffer_load_dwordx4 v[136:139],v1,s[8:11],s33 offen offset:0 sc1
MF v[196:199],v[76:79],v[16:19],v[196:199]
MF v[200:203],v[80:83],v[16:19],v[200:203]
MF v[204:207],v[84:87],v[16:19],v[204:207]
MF v[208:211],v[88:91],v[16:19],v[208:211]
buffer_load_dwordx4 v[140:143],v1,s[8:11],s33 offen offset:1024 sc1
MF v[212:215],v[92:95],v[16:19],v[212:215]
MF v[216:219],v[96:99],v[16:19],v[216:219]
buffer_load_dwordx4 v[16:19],v3,s[8:11],s28 offen offset:2048 sc1
s_waitcnt vmcnt(22)
MF v[220:223],v[64:67],v[20:23],v[220:223]
v_accvgpr_write_b32 a242,v176
MF v[224:227],v[68:71],v[20:23],v[224:227]
v_accvgpr_write_b32 a243,v182
v_accvgpr_read_b32 v176,a244
MF v[228:231],v[72:75],v[20:23],v[228:231]
buffer_load_dwordx4 v[144:147],v1,s[8:11],s33 offen offset:2048 sc1
MF v[232:235],v[76:79],v[20:23],v[232:235]
v_accvgpr_read_b32 v182,a245
MF v[236:239],v[80:83],v[20:23],v[236:239]
v_lshlrev_b32 v172,16,v176
v_lshlrev_b32 v178,16,v182
MF v[240:243],v[84:87],v[20:23],v[240:243]
v_and_b32 v173,0xffff0000,v176
MF v[244:247],v[88:91],v[20:23],v[244:247]
buffer_load_dwordx4 v[148:151],v1,s[8:11],s33 offen offset:3072 sc1
MF v[248:251],v[92:95],v[20:23],v[248:251]
v_and_b32 v179,0xffff0000,v182
MF v[252:255],v[96:99],v[20:23],v[252:255]
buffer_load_dwordx4 v[20:23],v3,s[8:11],s29 offen offset:2048 sc1
s_waitcnt vmcnt(24)
MF a[0:3],v[64:67],v[24:27],a[0:3]
v_mul_f32 v174,v172,v172
MF a[4:7],v[68:71],v[24:27],a[4:7]
v_mul_f32 v180,v178,v178
v_mul_f32 v175,v173,v173
MF a[8:11],v[72:75],v[24:27],a[8:11]
s_add_u32 s33,s32,105472
buffer_load_dwordx4 v[152:155],v1,s[8:11],s33 offen offset:0 sc1
MF a[12:15],v[76:79],v[24:27],a[12:15]
v_mul_f32 v181,v179,v179
MF a[16:19],v[80:83],v[24:27],a[16:19]
v_fmaak_f32 v174,v174,v13,0xc0135761
v_fmaak_f32 v180,v180,v13,0xc0135761
MF a[20:23],v[84:87],v[24:27],a[20:23]
v_fmaak_f32 v175,v175,v13,0xc0135761
MF a[24:27],v[88:91],v[24:27],a[24:27]
buffer_load_dwordx4 v[156:159],v1,s[8:11],s33 offen offset:1024 sc1
MF a[28:31],v[92:95],v[24:27],a[28:31]
v_fmaak_f32 v181,v181,v13,0xc0135761
MF a[32:35],v[96:99],v[24:27],a[32:35]
buffer_load_dwordx4 v[24:27],v3,s[8:11],s30 offen offset:2048 sc1
s_waitcnt vmcnt(26)
MF a[36:39],v[64:67],v[28:31],a[36:39]
v_mul_f32 v174,v174,v172
MF a[40:43],v[68:71],v[28:31],a[40:43]
v_mul_f32 v180,v180,v178
v_mul_f32 v175,v175,v173
MF a[44:47],v[72:75],v[28:31],a[44:47]
buffer_load_dwordx4 v[160:163],v1,s[8:11],s33 offen offset:2048 sc1
MF a[48:51],v[76:79],v[28:31],a[48:51]
v_mul_f32 v181,v181,v179
MF a[52:55],v[80:83],v[28:31],a[52:55]
v_exp_f32 v174,v174
MF a[56:59],v[84:87],v[28:31],a[56:59]
v_exp_f32 v180,v180
MF a[60:63],v[88:91],v[28:31],a[60:63]
buffer_load_dwordx4 v[164:167],v1,s[8:11],s33 offen offset:3072 sc1
MF a[64:67],v[92:95],v[28:31],a[64:67]
v_exp_f32 v175,v175
MF a[68:71],v[96:99],v[28:31],a[68:71]
buffer_load_dwordx4 v[28:31],v3,s[8:11],s31 offen offset:2048 sc1
s_waitcnt vmcnt(26)
MF a[72:75],v[64:67],v[32:35],a[72:75]
v_exp_f32 v181,v181
MF a[76:79],v[68:71],v[32:35],a[76:79]
v_add_f32 v174,1.0,v174
v_add_f32 v180,1.0,v180
MF a[80:83],v[72:75],v[32:35],a[80:83]
s_add_u32 s33,s32,109568
buffer_load_dwordx4 v[168:171],v1,s[8:11],s33 offen offset:0 sc1
MF a[84:87],v[76:79],v[32:35],a[84:87]
v_add_f32 v175,1.0,v175
MF a[88:91],v[80:83],v[32:35],a[88:91]
v_add_f32 v181,1.0,v181
v_rcp_f32 v174,v174
MF a[92:95],v[84:87],v[32:35],a[92:95]
v_rcp_f32 v180,v180
MF a[96:99],v[88:91],v[32:35],a[96:99]
MF a[100:103],v[92:95],v[32:35],a[100:103]
v_rcp_f32 v175,v175
MF a[104:107],v[96:99],v[32:35],a[104:107]
buffer_load_dwordx4 v[32:35],v3,s[8:11],s24 offen offset:3072 sc1
s_waitcnt vmcnt(25)
MF a[108:111],v[64:67],v[36:39],a[108:111]
v_rcp_f32 v181,v181
MF a[112:115],v[68:71],v[36:39],a[112:115]
v_mul_f32 v172,v172,v174
v_mul_f32 v178,v178,v180
MF a[116:119],v[72:75],v[36:39],a[116:119]
v_mul_f32 v173,v173,v175
MF a[120:123],v[76:79],v[36:39],a[120:123]
v_mul_f32 v179,v179,v181
MF a[124:127],v[80:83],v[36:39],a[124:127]
v_cvt_pk_bf16_f32 v176,v172,v173
v_cvt_pk_bf16_f32 v182,v178,v179
MF a[128:131],v[84:87],v[36:39],a[128:131]
v_accvgpr_write_b32 a244,v176
MF a[132:135],v[88:91],v[36:39],a[132:135]
v_accvgpr_write_b32 a245,v182
MF a[136:139],v[92:95],v[36:39],a[136:139]
v_accvgpr_read_b32 v176,a246
MF a[140:143],v[96:99],v[36:39],a[140:143]
buffer_load_dwordx4 v[36:39],v3,s[8:11],s25 offen offset:3072 sc1
s_waitcnt vmcnt(23)
MF a[144:147],v[64:67],v[40:43],a[144:147]
v_accvgpr_read_b32 v182,a247
MF a[148:151],v[68:71],v[40:43],a[148:151]
v_lshlrev_b32 v172,16,v176
v_lshlrev_b32 v178,16,v182
MF a[152:155],v[72:75],v[40:43],a[152:155]
v_and_b32 v173,0xffff0000,v176
MF a[156:159],v[76:79],v[40:43],a[156:159]
v_and_b32 v179,0xffff0000,v182
MF a[160:163],v[80:83],v[40:43],a[160:163]
v_mul_f32 v174,v172,v172
v_mul_f32 v180,v178,v178
MF a[164:167],v[84:87],v[40:43],a[164:167]
v_mul_f32 v175,v173,v173
MF a[168:171],v[88:91],v[40:43],a[168:171]
v_mul_f32 v181,v179,v179
MF a[172:175],v[92:95],v[40:43],a[172:175]
v_fmaak_f32 v174,v174,v13,0xc0135761
MF a[176:179],v[96:99],v[40:43],a[176:179]
buffer_load_dwordx4 v[40:43],v3,s[8:11],s26 offen offset:3072 sc1
s_waitcnt vmcnt(21)
MF a[180:183],v[64:67],v[44:47],a[180:183]
v_fmaak_f32 v180,v180,v13,0xc0135761
MF a[184:187],v[68:71],v[44:47],a[184:187]
v_fmaak_f32 v175,v175,v13,0xc0135761
v_fmaak_f32 v181,v181,v13,0xc0135761
MF a[188:191],v[72:75],v[44:47],a[188:191]
v_mul_f32 v174,v174,v172
MF a[192:195],v[76:79],v[44:47],a[192:195]
v_mul_f32 v180,v180,v178
MF a[196:199],v[80:83],v[44:47],a[196:199]
v_mul_f32 v175,v175,v173
v_mul_f32 v181,v181,v179
MF a[200:203],v[84:87],v[44:47],a[200:203]
v_exp_f32 v174,v174
MF a[204:207],v[88:91],v[44:47],a[204:207]
v_exp_f32 v180,v180
MF a[208:211],v[92:95],v[44:47],a[208:211]
v_exp_f32 v175,v175
MF a[212:215],v[96:99],v[44:47],a[212:215]
buffer_load_dwordx4 v[44:47],v3,s[8:11],s27 offen offset:3072 sc1
s_waitcnt vmcnt(20)
MF v[184:187],v[100:103],v[48:51],v[184:187]
MF v[188:191],v[104:107],v[48:51],v[188:191]
MF v[192:195],v[108:111],v[48:51],v[192:195]
s_add_u32 s33,s32,110592
buffer_load_dwordx4 v[64:67],v1,s[8:11],s33 offen offset:0 sc1
MF v[196:199],v[112:115],v[48:51],v[196:199]
MF v[200:203],v[116:119],v[48:51],v[200:203]
MF v[204:207],v[120:123],v[48:51],v[204:207]
MF v[208:211],v[124:127],v[48:51],v[208:211]
buffer_load_dwordx4 v[68:71],v1,s[8:11],s33 offen offset:1024 sc1
MF v[212:215],v[128:131],v[48:51],v[212:215]
MF v[216:219],v[132:135],v[48:51],v[216:219]
buffer_load_dwordx4 v[48:51],v3,s[8:11],s28 offen offset:3072 sc1
s_waitcnt vmcnt(22)
MF v[220:223],v[100:103],v[52:55],v[220:223]
v_exp_f32 v181,v181
MF v[224:227],v[104:107],v[52:55],v[224:227]
v_add_f32 v174,1.0,v174
v_add_f32 v180,1.0,v180
MF v[228:231],v[108:111],v[52:55],v[228:231]
buffer_load_dwordx4 v[72:75],v1,s[8:11],s33 offen offset:2048 sc1
MF v[232:235],v[112:115],v[52:55],v[232:235]
v_add_f32 v175,1.0,v175
MF v[236:239],v[116:119],v[52:55],v[236:239]
v_add_f32 v181,1.0,v181
v_rcp_f32 v174,v174
MF v[240:243],v[120:123],v[52:55],v[240:243]
v_rcp_f32 v180,v180
MF v[244:247],v[124:127],v[52:55],v[244:247]
buffer_load_dwordx4 v[76:79],v1,s[8:11],s33 offen offset:3072 sc1
MF v[248:251],v[128:131],v[52:55],v[248:251]
v_rcp_f32 v175,v175
MF v[252:255],v[132:135],v[52:55],v[252:255]
buffer_load_dwordx4 v[52:55],v3,s[8:11],s29 offen offset:3072 sc1
s_waitcnt vmcnt(24)
MF a[0:3],v[100:103],v[56:59],a[0:3]
v_rcp_f32 v181,v181
MF a[4:7],v[104:107],v[56:59],a[4:7]
v_mul_f32 v172,v172,v174
v_mul_f32 v178,v178,v180
MF a[8:11],v[108:111],v[56:59],a[8:11]
s_add_u32 s33,s32,114688
buffer_load_dwordx4 v[80:83],v1,s[8:11],s33 offen offset:0 sc1
MF a[12:15],v[112:115],v[56:59],a[12:15]
v_mul_f32 v173,v173,v175
MF a[16:19],v[116:119],v[56:59],a[16:19]
v_mul_f32 v179,v179,v181
v_cvt_pk_bf16_f32 v176,v172,v173
MF a[20:23],v[120:123],v[56:59],a[20:23]
v_cvt_pk_bf16_f32 v182,v178,v179
MF a[24:27],v[124:127],v[56:59],a[24:27]
buffer_load_dwordx4 v[84:87],v1,s[8:11],s33 offen offset:1024 sc1
MF a[28:31],v[128:131],v[56:59],a[28:31]
v_accvgpr_write_b32 a246,v176
MF a[32:35],v[132:135],v[56:59],a[32:35]
buffer_load_dwordx4 v[56:59],v3,s[8:11],s30 offen offset:3072 sc1
s_waitcnt vmcnt(26)
MF a[36:39],v[100:103],v[60:63],a[36:39]
v_accvgpr_write_b32 a247,v182
MF a[40:43],v[104:107],v[60:63],a[40:43]
v_accvgpr_read_b32 v176,a248
v_accvgpr_read_b32 v182,a249
MF a[44:47],v[108:111],v[60:63],a[44:47]
buffer_load_dwordx4 v[88:91],v1,s[8:11],s33 offen offset:2048 sc1
MF a[48:51],v[112:115],v[60:63],a[48:51]
v_lshlrev_b32 v172,16,v176
MF a[52:55],v[116:119],v[60:63],a[52:55]
v_lshlrev_b32 v178,16,v182
v_and_b32 v173,0xffff0000,v176
MF a[56:59],v[120:123],v[60:63],a[56:59]
v_and_b32 v179,0xffff0000,v182
MF a[60:63],v[124:127],v[60:63],a[60:63]
buffer_load_dwordx4 v[92:95],v1,s[8:11],s33 offen offset:3072 sc1
MF a[64:67],v[128:131],v[60:63],a[64:67]
v_mul_f32 v174,v172,v172
MF a[68:71],v[132:135],v[60:63],a[68:71]
buffer_load_dwordx4 v[60:63],v3,s[8:11],s31 offen offset:3072 sc1
s_waitcnt vmcnt(26)
MF a[72:75],v[100:103],v[16:19],a[72:75]
v_mul_f32 v180,v178,v178
MF a[76:79],v[104:107],v[16:19],a[76:79]
v_mul_f32 v175,v173,v173
v_mul_f32 v181,v179,v179
MF a[80:83],v[108:111],v[16:19],a[80:83]
s_add_u32 s33,s32,118784
buffer_load_dwordx4 v[96:99],v1,s[8:11],s33 offen offset:0 sc1
MF a[84:87],v[112:115],v[16:19],a[84:87]
v_fmaak_f32 v174,v174,v13,0xc0135761
MF a[88:91],v[116:119],v[16:19],a[88:91]
v_fmaak_f32 v180,v180,v13,0xc0135761
v_fmaak_f32 v175,v175,v13,0xc0135761
MF a[92:95],v[120:123],v[16:19],a[92:95]
v_fmaak_f32 v181,v181,v13,0xc0135761
MF a[96:99],v[124:127],v[16:19],a[96:99]
MF a[100:103],v[128:131],v[16:19],a[100:103]
v_mul_f32 v174,v174,v172
MF a[104:107],v[132:135],v[16:19],a[104:107]
buffer_load_dwordx4 v[16:19],v4,s[8:11],s26 offen offset:0 sc1
s_waitcnt vmcnt(25)
MF a[108:111],v[100:103],v[20:23],a[108:111]
v_mul_f32 v180,v180,v178
MF a[112:115],v[104:107],v[20:23],a[112:115]
v_mul_f32 v175,v175,v173
v_mul_f32 v181,v181,v179
MF a[116:119],v[108:111],v[20:23],a[116:119]
v_exp_f32 v174,v174
MF a[120:123],v[112:115],v[20:23],a[120:123]
v_exp_f32 v180,v180
MF a[124:127],v[116:119],v[20:23],a[124:127]
v_exp_f32 v175,v175
MF a[128:131],v[120:123],v[20:23],a[128:131]
v_exp_f32 v181,v181
MF a[132:135],v[124:127],v[20:23],a[132:135]
v_add_f32 v174,1.0,v174
MF a[136:139],v[128:131],v[20:23],a[136:139]
v_add_f32 v180,1.0,v180
MF a[140:143],v[132:135],v[20:23],a[140:143]
buffer_load_dwordx4 v[20:23],v4,s[8:11],s27 offen offset:0 sc1
s_waitcnt vmcnt(23)
MF a[144:147],v[100:103],v[24:27],a[144:147]
v_add_f32 v175,1.0,v175
MF a[148:151],v[104:107],v[24:27],a[148:151]
v_add_f32 v181,1.0,v181
v_rcp_f32 v174,v174
MF a[152:155],v[108:111],v[24:27],a[152:155]
v_rcp_f32 v180,v180
MF a[156:159],v[112:115],v[24:27],a[156:159]
v_rcp_f32 v175,v175
MF a[160:163],v[116:119],v[24:27],a[160:163]
v_rcp_f32 v181,v181
MF a[164:167],v[120:123],v[24:27],a[164:167]
v_mul_f32 v172,v172,v174
MF a[168:171],v[124:127],v[24:27],a[168:171]
v_mul_f32 v178,v178,v180
MF a[172:175],v[128:131],v[24:27],a[172:175]
v_mul_f32 v173,v173,v175
MF a[176:179],v[132:135],v[24:27],a[176:179]
buffer_load_dwordx4 v[24:27],v4,s[8:11],s28 offen offset:0 sc1
s_waitcnt vmcnt(21)
MF a[180:183],v[100:103],v[28:31],a[180:183]
v_mul_f32 v179,v179,v181
MF a[184:187],v[104:107],v[28:31],a[184:187]
v_cvt_pk_bf16_f32 v176,v172,v173
v_cvt_pk_bf16_f32 v182,v178,v179
MF a[188:191],v[108:111],v[28:31],a[188:191]
v_accvgpr_write_b32 a248,v176
MF a[192:195],v[112:115],v[28:31],a[192:195]
v_accvgpr_write_b32 a249,v182
MF a[196:199],v[116:119],v[28:31],a[196:199]
v_accvgpr_read_b32 v176,a250
v_accvgpr_read_b32 v182,a251
MF a[200:203],v[120:123],v[28:31],a[200:203]
v_lshlrev_b32 v172,16,v176
MF a[204:207],v[124:127],v[28:31],a[204:207]
v_lshlrev_b32 v178,16,v182
MF a[208:211],v[128:131],v[28:31],a[208:211]
v_and_b32 v173,0xffff0000,v176
MF a[212:215],v[132:135],v[28:31],a[212:215]
buffer_load_dwordx4 v[28:31],v4,s[8:11],s29 offen offset:0 sc1
s_waitcnt vmcnt(20)
MF v[184:187],v[136:139],v[32:35],v[184:187]
MF v[188:191],v[140:143],v[32:35],v[188:191]
MF v[192:195],v[144:147],v[32:35],v[192:195]
s_add_u32 s33,s32,119808
buffer_load_dwordx4 v[100:103],v1,s[8:11],s33 offen offset:0 sc1
MF v[196:199],v[148:151],v[32:35],v[196:199]
MF v[200:203],v[152:155],v[32:35],v[200:203]
MF v[204:207],v[156:159],v[32:35],v[204:207]
MF v[208:211],v[160:163],v[32:35],v[208:211]
buffer_load_dwordx4 v[104:107],v1,s[8:11],s33 offen offset:1024 sc1
MF v[212:215],v[164:167],v[32:35],v[212:215]
MF v[216:219],v[168:171],v[32:35],v[216:219]
buffer_load_dwordx4 v[32:35],v4,s[8:11],s30 offen offset:0 sc1
s_waitcnt vmcnt(22)
MF v[220:223],v[136:139],v[36:39],v[220:223]
v_and_b32 v179,0xffff0000,v182
MF v[224:227],v[140:143],v[36:39],v[224:227]
v_mul_f32 v174,v172,v172
v_mul_f32 v180,v178,v178
MF v[228:231],v[144:147],v[36:39],v[228:231]
buffer_load_dwordx4 v[108:111],v1,s[8:11],s33 offen offset:2048 sc1
MF v[232:235],v[148:151],v[36:39],v[232:235]
v_mul_f32 v175,v173,v173
MF v[236:239],v[152:155],v[36:39],v[236:239]
v_mul_f32 v181,v179,v179
v_fmaak_f32 v174,v174,v13,0xc0135761
MF v[240:243],v[156:159],v[36:39],v[240:243]
v_fmaak_f32 v180,v180,v13,0xc0135761
MF v[244:247],v[160:163],v[36:39],v[244:247]
buffer_load_dwordx4 v[112:115],v1,s[8:11],s33 offen offset:3072 sc1
MF v[248:251],v[164:167],v[36:39],v[248:251]
v_fmaak_f32 v175,v175,v13,0xc0135761
MF v[252:255],v[168:171],v[36:39],v[252:255]
buffer_load_dwordx4 v[36:39],v4,s[8:11],s31 offen offset:0 sc1
s_waitcnt vmcnt(24)
MF a[0:3],v[136:139],v[40:43],a[0:3]
v_fmaak_f32 v181,v181,v13,0xc0135761
MF a[4:7],v[140:143],v[40:43],a[4:7]
v_mul_f32 v174,v174,v172
v_mul_f32 v180,v180,v178
MF a[8:11],v[144:147],v[40:43],a[8:11]
s_add_u32 s33,s32,123904
buffer_load_dwordx4 v[116:119],v1,s[8:11],s33 offen offset:0 sc1
MF a[12:15],v[148:151],v[40:43],a[12:15]
v_mul_f32 v175,v175,v173
MF a[16:19],v[152:155],v[40:43],a[16:19]
v_mul_f32 v181,v181,v179
v_exp_f32 v174,v174
MF a[20:23],v[156:159],v[40:43],a[20:23]
v_exp_f32 v180,v180
MF a[24:27],v[160:163],v[40:43],a[24:27]
buffer_load_dwordx4 v[120:123],v1,s[8:11],s33 offen offset:1024 sc1
MF a[28:31],v[164:167],v[40:43],a[28:31]
v_exp_f32 v175,v175
MF a[32:35],v[168:171],v[40:43],a[32:35]
buffer_load_dwordx4 v[40:43],v4,s[8:11],s24 offen offset:0 sc1
s_waitcnt vmcnt(26)
MF a[36:39],v[136:139],v[44:47],a[36:39]
v_exp_f32 v181,v181
MF a[40:43],v[140:143],v[44:47],a[40:43]
v_add_f32 v174,1.0,v174
v_add_f32 v180,1.0,v180
MF a[44:47],v[144:147],v[44:47],a[44:47]
buffer_load_dwordx4 v[124:127],v1,s[8:11],s33 offen offset:2048 sc1
MF a[48:51],v[148:151],v[44:47],a[48:51]
v_add_f32 v175,1.0,v175
MF a[52:55],v[152:155],v[44:47],a[52:55]
v_add_f32 v181,1.0,v181
v_rcp_f32 v174,v174
MF a[56:59],v[156:159],v[44:47],a[56:59]
v_rcp_f32 v180,v180
MF a[60:63],v[160:163],v[44:47],a[60:63]
buffer_load_dwordx4 v[128:131],v1,s[8:11],s33 offen offset:3072 sc1
MF a[64:67],v[164:167],v[44:47],a[64:67]
v_rcp_f32 v175,v175
MF a[68:71],v[168:171],v[44:47],a[68:71]
buffer_load_dwordx4 v[44:47],v4,s[8:11],s25 offen offset:0 sc1
s_waitcnt vmcnt(26)
MF a[72:75],v[136:139],v[48:51],a[72:75]
v_rcp_f32 v181,v181
MF a[76:79],v[140:143],v[48:51],a[76:79]
v_mul_f32 v172,v172,v174
v_mul_f32 v178,v178,v180
MF a[80:83],v[144:147],v[48:51],a[80:83]
s_add_u32 s33,s32,128000
buffer_load_dwordx4 v[132:135],v1,s[8:11],s33 offen offset:0 sc1
MF a[84:87],v[148:151],v[48:51],a[84:87]
v_mul_f32 v173,v173,v175
MF a[88:91],v[152:155],v[48:51],a[88:91]
v_mul_f32 v179,v179,v181
v_cvt_pk_bf16_f32 v176,v172,v173
MF a[92:95],v[156:159],v[48:51],a[92:95]
v_cvt_pk_bf16_f32 v182,v178,v179
MF a[96:99],v[160:163],v[48:51],a[96:99]
MF a[100:103],v[164:167],v[48:51],a[100:103]
v_accvgpr_write_b32 a250,v176
MF a[104:107],v[168:171],v[48:51],a[104:107]
buffer_load_dwordx4 v[48:51],v4,s[8:11],s26 offen offset:1024 sc1
s_waitcnt vmcnt(25)
MF a[108:111],v[136:139],v[52:55],a[108:111]
v_accvgpr_write_b32 a251,v182
MF a[112:115],v[140:143],v[52:55],a[112:115]
MF a[116:119],v[144:147],v[52:55],a[116:119]
MF a[120:123],v[148:151],v[52:55],a[120:123]
MF a[124:127],v[152:155],v[52:55],a[124:127]
MF a[128:131],v[156:159],v[52:55],a[128:131]
MF a[132:135],v[160:163],v[52:55],a[132:135]
MF a[136:139],v[164:167],v[52:55],a[136:139]
MF a[140:143],v[168:171],v[52:55],a[140:143]
buffer_load_dwordx4 v[52:55],v4,s[8:11],s26 offen offset:2048 sc1
s_waitcnt vmcnt(23)
MF a[144:147],v[136:139],v[56:59],a[144:147]
MF a[148:151],v[140:143],v[56:59],a[148:151]
MF a[152:155],v[144:147],v[56:59],a[152:155]
MF a[156:159],v[148:151],v[56:59],a[156:159]
MF a[160:163],v[152:155],v[56:59],a[160:163]
MF a[164:167],v[156:159],v[56:59],a[164:167]
MF a[168:171],v[160:163],v[56:59],a[168:171]
MF a[172:175],v[164:167],v[56:59],a[172:175]
MF a[176:179],v[168:171],v[56:59],a[176:179]
buffer_load_dwordx4 v[56:59],v4,s[8:11],s26 offen offset:3072 sc1
s_waitcnt vmcnt(21)
MF a[180:183],v[136:139],v[60:63],a[180:183]
MF a[184:187],v[140:143],v[60:63],a[184:187]
MF a[188:191],v[144:147],v[60:63],a[188:191]
MF a[192:195],v[148:151],v[60:63],a[192:195]
MF a[196:199],v[152:155],v[60:63],a[196:199]
MF a[200:203],v[156:159],v[60:63],a[200:203]
MF a[204:207],v[160:163],v[60:63],a[204:207]
MF a[208:211],v[164:167],v[60:63],a[208:211]
MF a[212:215],v[168:171],v[60:63],a[212:215]
buffer_load_dwordx4 v[60:63],v4,s[8:11],s27 offen offset:1024 sc1
s_waitcnt vmcnt(20)
MF a[0:3],v[64:67],v[16:19],a[0:3]
s_add_u32 s33,s32,129024
buffer_load_dwordx4 v[136:139],v1,s[8:11],s33 offen offset:0 sc1
MF a[4:7],v[68:71],v[16:19],a[4:7]
MF a[8:11],v[72:75],v[16:19],a[8:11]
buffer_load_dwordx4 v[140:143],v1,s[8:11],s33 offen offset:1024 sc1
MF a[12:15],v[76:79],v[16:19],a[12:15]
MF a[16:19],v[80:83],v[16:19],a[16:19]
buffer_load_dwordx4 v[144:147],v1,s[8:11],s33 offen offset:2048 sc1
MF a[20:23],v[84:87],v[16:19],a[20:23]
MF a[24:27],v[88:91],v[16:19],a[24:27]
buffer_load_dwordx4 v[148:151],v1,s[8:11],s33 offen offset:3072 sc1
MF a[28:31],v[92:95],v[16:19],a[28:31]
MF a[32:35],v[96:99],v[16:19],a[32:35]
s_add_u32 s33,s32,133120
buffer_load_dwordx4 v[152:155],v1,s[8:11],s33 offen offset:0 sc1
buffer_load_dwordx4 v[16:19],v4,s[8:11],s27 offen offset:2048 sc1
s_waitcnt vmcnt(25)
MF a[36:39],v[64:67],v[20:23],a[36:39]
MF a[40:43],v[68:71],v[20:23],a[40:43]
buffer_load_dwordx4 v[156:159],v1,s[8:11],s33 offen offset:1024 sc1
MF a[44:47],v[72:75],v[20:23],a[44:47]
MF a[48:51],v[76:79],v[20:23],a[48:51]
buffer_load_dwordx4 v[160:163],v1,s[8:11],s33 offen offset:2048 sc1
MF a[52:55],v[80:83],v[20:23],a[52:55]
MF a[56:59],v[84:87],v[20:23],a[56:59]
buffer_load_dwordx4 v[164:167],v1,s[8:11],s33 offen offset:3072 sc1
MF a[60:63],v[88:91],v[20:23],a[60:63]
MF a[64:67],v[92:95],v[20:23],a[64:67]
s_add_u32 s33,s32,137216
buffer_load_dwordx4 v[168:171],v1,s[8:11],s33 offen offset:0 sc1
MF a[68:71],v[96:99],v[20:23],a[68:71]
buffer_load_dwordx4 v[20:23],v4,s[8:11],s27 offen offset:3072 sc1
s_waitcnt vmcnt(29)
MF a[72:75],v[64:67],v[24:27],a[72:75]
s_waitcnt vmcnt(28)
MF a[108:111],v[64:67],v[28:31],a[108:111]
s_waitcnt vmcnt(25)
MF a[144:147],v[64:67],v[32:35],a[144:147]
s_waitcnt vmcnt(22)
MF a[180:183],v[64:67],v[36:39],a[180:183]
s_waitcnt vmcnt(19)
MF v[184:187],v[64:67],v[40:43],v[184:187]
s_waitcnt vmcnt(16)
MF v[220:223],v[64:67],v[44:47],v[220:223]
s_add_u32 s33,s32,138240
buffer_load_dwordx4 v[64:67],v1,s[8:11],s33 offen offset:0 sc1
MF a[76:79],v[68:71],v[24:27],a[76:79]
MF a[112:115],v[68:71],v[28:31],a[112:115]
MF a[148:151],v[68:71],v[32:35],a[148:151]
MF a[184:187],v[68:71],v[36:39],a[184:187]
MF v[188:191],v[68:71],v[40:43],v[188:191]
MF v[224:227],v[68:71],v[44:47],v[224:227]
buffer_load_dwordx4 v[68:71],v1,s[8:11],s33 offen offset:1024 sc1
MF a[80:83],v[72:75],v[24:27],a[80:83]
MF a[116:119],v[72:75],v[28:31],a[116:119]
MF a[152:155],v[72:75],v[32:35],a[152:155]
MF a[188:191],v[72:75],v[36:39],a[188:191]
MF v[192:195],v[72:75],v[40:43],v[192:195]
MF v[228:231],v[72:75],v[44:47],v[228:231]
buffer_load_dwordx4 v[72:75],v1,s[8:11],s33 offen offset:2048 sc1
MF a[84:87],v[76:79],v[24:27],a[84:87]
MF a[120:123],v[76:79],v[28:31],a[120:123]
MF a[156:159],v[76:79],v[32:35],a[156:159]
MF a[192:195],v[76:79],v[36:39],a[192:195]
MF v[196:199],v[76:79],v[40:43],v[196:199]
MF v[232:235],v[76:79],v[44:47],v[232:235]
buffer_load_dwordx4 v[76:79],v1,s[8:11],s33 offen offset:3072 sc1
MF a[88:91],v[80:83],v[24:27],a[88:91]
MF a[124:127],v[80:83],v[28:31],a[124:127]
MF a[160:163],v[80:83],v[32:35],a[160:163]
MF a[196:199],v[80:83],v[36:39],a[196:199]
MF v[200:203],v[80:83],v[40:43],v[200:203]
MF v[236:239],v[80:83],v[44:47],v[236:239]
s_add_u32 s33,s32,142336
buffer_load_dwordx4 v[80:83],v1,s[8:11],s33 offen offset:0 sc1
MF a[92:95],v[84:87],v[24:27],a[92:95]
MF a[128:131],v[84:87],v[28:31],a[128:131]
MF a[164:167],v[84:87],v[32:35],a[164:167]
MF a[200:203],v[84:87],v[36:39],a[200:203]
MF v[204:207],v[84:87],v[40:43],v[204:207]
MF v[240:243],v[84:87],v[44:47],v[240:243]
buffer_load_dwordx4 v[84:87],v1,s[8:11],s33 offen offset:1024 sc1
MF a[96:99],v[88:91],v[24:27],a[96:99]
MF a[132:135],v[88:91],v[28:31],a[132:135]
MF a[168:171],v[88:91],v[32:35],a[168:171]
MF a[204:207],v[88:91],v[36:39],a[204:207]
MF v[208:211],v[88:91],v[40:43],v[208:211]
MF v[244:247],v[88:91],v[44:47],v[244:247]
buffer_load_dwordx4 v[88:91],v1,s[8:11],s33 offen offset:2048 sc1
MF a[100:103],v[92:95],v[24:27],a[100:103]
MF a[136:139],v[92:95],v[28:31],a[136:139]
MF a[172:175],v[92:95],v[32:35],a[172:175]
MF a[208:211],v[92:95],v[36:39],a[208:211]
MF v[212:215],v[92:95],v[40:43],v[212:215]
MF v[248:251],v[92:95],v[44:47],v[248:251]
buffer_load_dwordx4 v[92:95],v1,s[8:11],s33 offen offset:3072 sc1
MF a[104:107],v[96:99],v[24:27],a[104:107]
MF a[140:143],v[96:99],v[28:31],a[140:143]
MF a[176:179],v[96:99],v[32:35],a[176:179]
MF a[212:215],v[96:99],v[36:39],a[212:215]
MF v[216:219],v[96:99],v[40:43],v[216:219]
MF v[252:255],v[96:99],v[44:47],v[252:255]
s_add_u32 s33,s32,146432
buffer_load_dwordx4 v[96:99],v1,s[8:11],s33 offen offset:0 sc1
buffer_load_dwordx4 v[24:27],v4,s[8:11],s28 offen offset:1024 sc1
buffer_load_dwordx4 v[28:31],v4,s[8:11],s28 offen offset:2048 sc1
buffer_load_dwordx4 v[32:35],v4,s[8:11],s28 offen offset:3072 sc1
buffer_load_dwordx4 v[36:39],v4,s[8:11],s29 offen offset:1024 sc1
buffer_load_dwordx4 v[40:43],v4,s[8:11],s29 offen offset:2048 sc1
buffer_load_dwordx4 v[44:47],v4,s[8:11],s29 offen offset:3072 sc1
s_lshl_b32 s46,s44,4
s_add_u32 s46,s46,s45
s_lshl_b32 s46,s46,3
s_lshl_b32 s47,s22,1
s_add_u32 s46,s46,s47
s_mul_i32 s34,s46,4608
s_add_u32 s34,s34,0x4d00000
v_lshlrev_b32 v10,16,v10
v_lshlrev_b32 v11,16,v11
s_waitcnt vmcnt(29)
MF a[0:3],v[100:103],v[48:51],a[0:3]
v_add_f32 v184,v184,v10
v_add_f32 v185,v185,v10
s_waitcnt vmcnt(28)
s_waitcnt vmcnt(25)
MF a[0:3],v[136:139],v[52:55],a[0:3]
v_add_f32 v186,v186,v10
v_add_f32 v187,v187,v10
s_waitcnt vmcnt(14)
MF a[0:3],v[64:67],v[56:59],a[0:3]
v_add_f32 v188,v188,v10
v_add_f32 v189,v189,v10
MF a[4:7],v[104:107],v[48:51],a[4:7]
v_add_f32 v190,v190,v10
v_add_f32 v191,v191,v10
MF a[4:7],v[140:143],v[52:55],a[4:7]
s_nop 1
ds_write_b128 v5,a[0:3] offset:0
v_add_f32 v192,v192,v10
s_waitcnt vmcnt(13)
MF a[4:7],v[68:71],v[56:59],a[4:7]
v_add_f32 v193,v193,v10
v_add_f32 v194,v194,v10
MF a[8:11],v[108:111],v[48:51],a[8:11]
v_add_f32 v195,v195,v10
v_add_f32 v196,v196,v10
MF a[8:11],v[144:147],v[52:55],a[8:11]
s_nop 1
ds_write_b128 v5,a[4:7] offset:1024
v_add_f32 v197,v197,v10
s_waitcnt vmcnt(12)
MF a[8:11],v[72:75],v[56:59],a[8:11]
v_add_f32 v198,v198,v10
v_add_f32 v199,v199,v10
MF a[12:15],v[112:115],v[48:51],a[12:15]
v_add_f32 v200,v200,v10
v_add_f32 v201,v201,v10
MF a[12:15],v[148:151],v[52:55],a[12:15]
s_nop 1
ds_write_b128 v5,a[8:11] offset:2048
v_add_f32 v202,v202,v10
s_waitcnt vmcnt(11)
MF a[12:15],v[76:79],v[56:59],a[12:15]
v_add_f32 v203,v203,v10
v_add_f32 v204,v204,v10
MF a[16:19],v[116:119],v[48:51],a[16:19]
v_add_f32 v205,v205,v10
v_add_f32 v206,v206,v10
MF a[16:19],v[152:155],v[52:55],a[16:19]
s_nop 1
ds_write_b128 v5,a[12:15] offset:3072
v_add_f32 v207,v207,v10
s_waitcnt vmcnt(10)
MF a[16:19],v[80:83],v[56:59],a[16:19]
v_add_f32 v208,v208,v10
v_add_f32 v209,v209,v10
MF a[20:23],v[120:123],v[48:51],a[20:23]
v_add_f32 v210,v210,v10
v_add_f32 v211,v211,v10
MF a[20:23],v[156:159],v[52:55],a[20:23]
s_nop 1
ds_write_b128 v5,a[16:19] offset:4096
v_add_f32 v212,v212,v10
s_waitcnt vmcnt(9)
MF a[20:23],v[84:87],v[56:59],a[20:23]
v_add_f32 v213,v213,v10
v_add_f32 v214,v214,v10
MF a[24:27],v[124:127],v[48:51],a[24:27]
v_add_f32 v215,v215,v10
v_add_f32 v216,v216,v10
MF a[24:27],v[160:163],v[52:55],a[24:27]
s_nop 1
ds_write_b128 v5,a[20:23] offset:5120
v_add_f32 v217,v217,v10
s_waitcnt vmcnt(8)
MF a[24:27],v[88:91],v[56:59],a[24:27]
v_add_f32 v218,v218,v10
v_add_f32 v219,v219,v10
MF a[28:31],v[128:131],v[48:51],a[28:31]
v_add_f32 v220,v220,v11
v_add_f32 v221,v221,v11
MF a[28:31],v[164:167],v[52:55],a[28:31]
s_nop 1
ds_write_b128 v5,a[24:27] offset:6144
v_add_f32 v222,v222,v11
s_waitcnt vmcnt(7)
MF a[28:31],v[92:95],v[56:59],a[28:31]
v_add_f32 v223,v223,v11
v_add_f32 v224,v224,v11
MF a[32:35],v[132:135],v[48:51],a[32:35]
v_add_f32 v225,v225,v11
v_add_f32 v226,v226,v11
MF a[32:35],v[168:171],v[52:55],a[32:35]
s_nop 1
ds_write_b128 v5,a[28:31] offset:7168
v_add_f32 v227,v227,v11
s_waitcnt vmcnt(6)
MF a[32:35],v[96:99],v[56:59],a[32:35]
v_add_f32 v228,v228,v11
v_add_f32 v229,v229,v11
buffer_load_dwordx4 v[48:51],v4,s[8:11],s30 offen offset:1024 sc1
buffer_load_dwordx4 v[52:55],v4,s[8:11],s30 offen offset:2048 sc1
buffer_load_dwordx4 v[56:59],v4,s[8:11],s30 offen offset:3072 sc1
MF a[36:39],v[100:103],v[60:63],a[36:39]
v_add_f32 v230,v230,v11
v_add_f32 v231,v231,v11
MF a[36:39],v[136:139],v[16:19],a[36:39]
ds_write_b128 v5,a[32:35] offset:8192
v_add_f32 v232,v232,v11
MF a[36:39],v[64:67],v[20:23],a[36:39]
v_add_f32 v233,v233,v11
v_add_f32 v234,v234,v11
MF a[40:43],v[104:107],v[60:63],a[40:43]
v_add_f32 v235,v235,v11
v_add_f32 v236,v236,v11
MF a[40:43],v[140:143],v[16:19],a[40:43]
s_nop 1
ds_write_b128 v5,a[36:39] offset:9216
v_add_f32 v237,v237,v11
MF a[40:43],v[68:71],v[20:23],a[40:43]
v_add_f32 v238,v238,v11
v_add_f32 v239,v239,v11
MF a[44:47],v[108:111],v[60:63],a[44:47]
v_add_f32 v240,v240,v11
v_add_f32 v241,v241,v11
MF a[44:47],v[144:147],v[16:19],a[44:47]
s_nop 1
ds_write_b128 v5,a[40:43] offset:10240
v_add_f32 v242,v242,v11
MF a[44:47],v[72:75],v[20:23],a[44:47]
v_add_f32 v243,v243,v11
v_add_f32 v244,v244,v11
MF a[48:51],v[112:115],v[60:63],a[48:51]
v_add_f32 v245,v245,v11
v_add_f32 v246,v246,v11
MF a[48:51],v[148:151],v[16:19],a[48:51]
s_nop 1
ds_write_b128 v5,a[44:47] offset:11264
v_add_f32 v247,v247,v11
MF a[48:51],v[76:79],v[20:23],a[48:51]
v_add_f32 v248,v248,v11
v_add_f32 v249,v249,v11
MF a[52:55],v[116:119],v[60:63],a[52:55]
v_add_f32 v250,v250,v11
v_add_f32 v251,v251,v11
MF a[52:55],v[152:155],v[16:19],a[52:55]
s_nop 1
ds_write_b128 v5,a[48:51] offset:12288
v_add_f32 v252,v252,v11
MF a[52:55],v[80:83],v[20:23],a[52:55]
v_add_f32 v253,v253,v11
v_add_f32 v254,v254,v11
MF a[56:59],v[120:123],v[60:63],a[56:59]
v_add_f32 v255,v255,v11
MF a[56:59],v[156:159],v[16:19],a[56:59]
s_nop 2
ds_write_b128 v5,a[52:55] offset:13312
MF a[56:59],v[84:87],v[20:23],a[56:59]
MF a[60:63],v[124:127],v[60:63],a[60:63]
MF a[60:63],v[160:163],v[16:19],a[60:63]
s_nop 5
ds_write_b128 v5,a[56:59] offset:14336
MF a[60:63],v[88:91],v[20:23],a[60:63]
MF a[64:67],v[128:131],v[60:63],a[64:67]
MF a[64:67],v[164:167],v[16:19],a[64:67]
s_waitcnt lgkmcnt(12)
s_nop 4
ds_write_b128 v5,a[60:63] offset:15360
MF a[64:67],v[92:95],v[20:23],a[64:67]
MF a[68:71],v[132:135],v[60:63],a[68:71]
MF a[68:71],v[168:171],v[16:19],a[68:71]
s_nop 5
ds_write_b128 v5,a[64:67] offset:16384
MF a[68:71],v[96:99],v[20:23],a[68:71]
buffer_load_dwordx4 v[60:63],v4,s[8:11],s31 offen offset:1024 sc1
buffer_load_dwordx4 v[16:19],v4,s[8:11],s31 offen offset:2048 sc1
buffer_load_dwordx4 v[20:23],v4,s[8:11],s31 offen offset:3072 sc1
s_nop 4
ds_write_b128 v5,a[68:71] offset:17408
s_waitcnt lgkmcnt(0)
s_barrier
s_waitcnt vmcnt(11)
MF a[72:75],v[100:103],v[24:27],a[72:75]
ds_read_b128 v[172:175],v8 offset:0
ds_read_b128 v[176:179],v8 offset:1024
s_waitcnt vmcnt(10)
MF a[72:75],v[136:139],v[28:31],a[72:75]
ds_read_b128 v[180:183],v8 offset:2048
v_and_b32 v2,7,v0
v_lshl_add_u32 v2,v15,3,v2
v_lshlrev_b32 v2,4,v2
v_add_u32 v2,4096,v2
s_mul_i32 s48,s22,18
s_mov_b32 s49,0
s_lshr_b32 s20,s23,2
s_mul_i32 s20,s20,72
s_add_u32 s48,s48,s20
s_mul_i32 s48,s48,4608
s_add_u32 s48,s48,0x1080000
buffer_load_dwordx4 a[0:3],v1,s[8:11],s48 offen offset:0 sc1
s_waitcnt vmcnt(10)
MF a[72:75],v[64:67],v[32:35],a[72:75]
s_waitcnt lgkmcnt(2)
v_add_f32 v184,v184,v172
v_add_f32 v185,v185,v173
MF a[76:79],v[104:107],v[24:27],a[76:79]
v_add_f32 v186,v186,v174
v_add_f32 v187,v187,v175
MF a[76:79],v[140:143],v[28:31],a[76:79]
s_nop 0
ds_write_b128 v6,a[72:75] offset:0
ds_read_b128 v[172:175],v8 offset:3072
MF a[76:79],v[68:71],v[32:35],a[76:79]
buffer_load_dwordx4 a[4:7],v1,s[8:11],s48 offen offset:1024 sc1
s_waitcnt lgkmcnt(3)
v_add_f32 v188,v188,v176
v_add_f32 v189,v189,v177
MF a[80:83],v[108:111],v[24:27],a[80:83]
v_add_f32 v190,v190,v178
v_add_f32 v191,v191,v179
MF a[80:83],v[144:147],v[28:31],a[80:83]
ds_write_b128 v6,a[76:79] offset:1024
ds_read_b128 v[176:179],v8 offset:4096
MF a[80:83],v[72:75],v[32:35],a[80:83]
buffer_load_dwordx4 a[8:11],v1,s[8:11],s48 offen offset:2048 sc1
s_waitcnt lgkmcnt(4)
v_add_f32 v192,v192,v180
v_add_f32 v193,v193,v181
MF a[84:87],v[112:115],v[24:27],a[84:87]
v_add_f32 v194,v194,v182
v_add_f32 v195,v195,v183
MF a[84:87],v[148:151],v[28:31],a[84:87]
ds_write_b128 v6,a[80:83] offset:2048
ds_read_b128 v[180:183],v8 offset:5120
MF a[84:87],v[76:79],v[32:35],a[84:87]
buffer_load_dwordx4 a[12:15],v1,s[8:11],s48 offen offset:3072 sc1
s_waitcnt lgkmcnt(4)
v_add_f32 v196,v196,v172
v_add_f32 v197,v197,v173
MF a[88:91],v[116:119],v[24:27],a[88:91]
v_add_f32 v198,v198,v174
v_add_f32 v199,v199,v175
MF a[88:91],v[152:155],v[28:31],a[88:91]
ds_write_b128 v6,a[84:87] offset:3072
ds_read_b128 v[172:175],v8 offset:6144
MF a[88:91],v[80:83],v[32:35],a[88:91]
buffer_load_dwordx4 a[16:19],v2,s[8:11],s48 offen sc1
s_waitcnt lgkmcnt(4)
v_add_f32 v200,v200,v176
v_add_f32 v201,v201,v177
MF a[92:95],v[120:123],v[24:27],a[92:95]
v_add_f32 v202,v202,v178
v_add_f32 v203,v203,v179
MF a[92:95],v[156:159],v[28:31],a[92:95]
ds_write_b128 v6,a[88:91] offset:4096
ds_read_b128 v[176:179],v8 offset:7168
MF a[92:95],v[84:87],v[32:35],a[92:95]
s_add_u32 s48,s48,4608
buffer_load_dwordx4 a[20:23],v1,s[8:11],s48 offen offset:0 sc1
s_waitcnt lgkmcnt(4)
v_add_f32 v204,v204,v180
v_add_f32 v205,v205,v181
MF a[96:99],v[124:127],v[24:27],a[96:99]
v_add_f32 v206,v206,v182
v_add_f32 v207,v207,v183
MF a[96:99],v[160:163],v[28:31],a[96:99]
ds_write_b128 v6,a[92:95] offset:5120
ds_read_b128 v[180:183],v8 offset:8192
MF a[96:99],v[88:91],v[32:35],a[96:99]
buffer_load_dwordx4 a[24:27],v1,s[8:11],s48 offen offset:1024 sc1
s_waitcnt lgkmcnt(4)
v_add_f32 v208,v208,v172
v_add_f32 v209,v209,v173
MF a[100:103],v[128:131],v[24:27],a[100:103]
v_add_f32 v210,v210,v174
v_add_f32 v211,v211,v175
MF a[100:103],v[164:167],v[28:31],a[100:103]
ds_write_b128 v6,a[96:99] offset:6144
ds_read_b128 v[172:175],v8 offset:9216
MF a[100:103],v[92:95],v[32:35],a[100:103]
buffer_load_dwordx4 a[28:31],v1,s[8:11],s48 offen offset:2048 sc1
s_waitcnt lgkmcnt(4)
v_add_f32 v212,v212,v176
v_add_f32 v213,v213,v177
MF a[104:107],v[132:135],v[24:27],a[104:107]
v_add_f32 v214,v214,v178
v_add_f32 v215,v215,v179
MF a[104:107],v[168:171],v[28:31],a[104:107]
ds_write_b128 v6,a[100:103] offset:7168
ds_read_b128 v[176:179],v8 offset:10240
MF a[104:107],v[96:99],v[32:35],a[104:107]
buffer_load_dwordx4 a[32:35],v1,s[8:11],s48 offen offset:3072 sc1
s_waitcnt lgkmcnt(4)
v_add_f32 v216,v216,v180
v_add_f32 v217,v217,v181
buffer_load_dwordx4 v[24:27],v4,s[8:11],s24 offen offset:1024 sc1
buffer_load_dwordx4 v[28:31],v4,s[8:11],s24 offen offset:2048 sc1
buffer_load_dwordx4 v[32:35],v4,s[8:11],s24 offen offset:3072 sc1
s_waitcnt vmcnt(20)
MF a[108:111],v[100:103],v[36:39],a[108:111]
v_add_f32 v218,v218,v182
v_add_f32 v219,v219,v183
s_waitcnt vmcnt(19)
MF a[108:111],v[136:139],v[40:43],a[108:111]
ds_write_b128 v6,a[104:107] offset:8192
ds_read_b128 v[180:183],v8 offset:11264
s_waitcnt vmcnt(18)
MF a[108:111],v[64:67],v[44:47],a[108:111]
buffer_load_dwordx4 a[36:39],v2,s[8:11],s48 offen sc1
s_waitcnt lgkmcnt(4)
v_add_f32 v220,v220,v172
v_add_f32 v221,v221,v173
MF a[112:115],v[104:107],v[36:39],a[112:115]
v_add_f32 v222,v222,v174
v_add_f32 v223,v223,v175
MF a[112:115],v[140:143],v[40:43],a[112:115]
ds_write_b128 v6,a[108:111] offset:9216
ds_read_b128 v[172:175],v8 offset:12288
MF a[112:115],v[68:71],v[44:47],a[112:115]
s_add_u32 s48,s48,4608
buffer_load_dwordx4 a[40:43],v1,s[8:11],s48 offen offset:0 sc1
s_waitcnt lgkmcnt(4)
v_add_f32 v224,v224,v176
v_add_f32 v225,v225,v177
MF a[116:119],v[108:111],v[36:39],a[116:119]
v_add_f32 v226,v226,v178
v_add_f32 v227,v227,v179
MF a[116:119],v[144:147],v[40:43],a[116:119]
ds_write_b128 v6,a[112:115] offset:10240
ds_read_b128 v[176:179],v8 offset:13312
MF a[116:119],v[72:75],v[44:47],a[116:119]
buffer_load_dwordx4 a[44:47],v1,s[8:11],s48 offen offset:1024 sc1
s_waitcnt lgkmcnt(4)
v_add_f32 v228,v228,v180
v_add_f32 v229,v229,v181
MF a[120:123],v[112:115],v[36:39],a[120:123]
v_add_f32 v230,v230,v182
v_add_f32 v231,v231,v183
MF a[120:123],v[148:151],v[40:43],a[120:123]
ds_write_b128 v6,a[116:119] offset:11264
ds_read_b128 v[180:183],v8 offset:14336
MF a[120:123],v[76:79],v[44:47],a[120:123]
buffer_load_dwordx4 a[48:51],v1,s[8:11],s48 offen offset:2048 sc1
s_waitcnt lgkmcnt(4)
v_add_f32 v232,v232,v172
v_add_f32 v233,v233,v173
MF a[124:127],v[116:119],v[36:39],a[124:127]
v_add_f32 v234,v234,v174
v_add_f32 v235,v235,v175
MF a[124:127],v[152:155],v[40:43],a[124:127]
ds_write_b128 v6,a[120:123] offset:12288
ds_read_b128 v[172:175],v8 offset:15360
MF a[124:127],v[80:83],v[44:47],a[124:127]
buffer_load_dwordx4 a[52:55],v1,s[8:11],s48 offen offset:3072 sc1
s_waitcnt lgkmcnt(4)
v_add_f32 v236,v236,v176
v_add_f32 v237,v237,v177
MF a[128:131],v[120:123],v[36:39],a[128:131]
v_add_f32 v238,v238,v178
v_add_f32 v239,v239,v179
MF a[128:131],v[156:159],v[40:43],a[128:131]
ds_write_b128 v6,a[124:127] offset:13312
ds_read_b128 v[176:179],v8 offset:16384
MF a[128:131],v[84:87],v[44:47],a[128:131]
buffer_load_dwordx4 a[56:59],v2,s[8:11],s48 offen sc1
s_waitcnt lgkmcnt(4)
v_add_f32 v240,v240,v180
v_add_f32 v241,v241,v181
MF a[132:135],v[124:127],v[36:39],a[132:135]
v_add_f32 v242,v242,v182
v_add_f32 v243,v243,v183
MF a[132:135],v[160:163],v[40:43],a[132:135]
ds_write_b128 v6,a[128:131] offset:14336
ds_read_b128 v[180:183],v8 offset:17408
MF a[132:135],v[88:91],v[44:47],a[132:135]
s_add_u32 s48,s48,4608
buffer_load_dwordx4 a[60:63],v1,s[8:11],s48 offen offset:0 sc1
s_waitcnt lgkmcnt(4)
v_add_f32 v244,v244,v172
v_add_f32 v245,v245,v173
MF a[136:139],v[128:131],v[36:39],a[136:139]
v_add_f32 v246,v246,v174
v_add_f32 v247,v247,v175
MF a[136:139],v[164:167],v[40:43],a[136:139]
ds_write_b128 v6,a[132:135] offset:15360
buffer_load_dwordx4 a[64:67],v1,s[8:11],s48 offen offset:1024 sc1
MF a[136:139],v[92:95],v[44:47],a[136:139]
s_waitcnt lgkmcnt(3)
v_add_f32 v248,v248,v176
v_add_f32 v249,v249,v177
v_add_f32 v250,v250,v178
MF a[140:143],v[132:135],v[36:39],a[140:143]
v_add_f32 v251,v251,v179
buffer_load_dwordx4 a[68:71],v1,s[8:11],s48 offen offset:2048 sc1
MF a[140:143],v[168:171],v[40:43],a[140:143]
ds_write_b128 v6,a[136:139] offset:16384
s_waitcnt lgkmcnt(2)
v_add_f32 v252,v252,v180
MF a[140:143],v[96:99],v[44:47],a[140:143]
v_add_f32 v253,v253,v181
v_add_f32 v254,v254,v182
v_add_f32 v255,v255,v183
buffer_load_dwordx4 v[36:39],v4,s[8:11],s25 offen offset:1024 sc1
buffer_load_dwordx4 v[40:43],v4,s[8:11],s25 offen offset:2048 sc1
buffer_load_dwordx4 v[44:47],v4,s[8:11],s25 offen offset:3072 sc1
s_nop 1
ds_write_b128 v6,a[140:143] offset:17408
s_mul_i32 s46,s45,144
v_lshlrev_b32 v13,2,v15
v_add_u32 v13,s46,v13
v_lshrrev_b32 v12,3,v13
v_lshlrev_b32 v12,8,v12
v_lshl_add_u32 v12,v14,4,v12
v_and_b32 v10,4,v13
v_lshl_add_u32 v12,v10,1,v12
s_lshl_b32 s46,s44,3
s_lshl_b32 s47,s22,1
s_add_u32 s46,s46,s47
s_mul_i32 s46,s46,73728
s_add_u32 s36,s46,0x5600000
s_add_u32 s37,s36,4096
s_add_u32 s38,s36,73728
s_add_u32 s39,s38,4096
s_waitcnt lgkmcnt(0)
s_barrier
s_waitcnt vmcnt(29)
MF a[144:147],v[100:103],v[48:51],a[144:147]
ds_read_b128 v[172:175],v9 offset:0
ds_read_b128 v[176:179],v9 offset:1024
s_waitcnt vmcnt(28)
MF a[144:147],v[136:139],v[52:55],a[144:147]
ds_read_b128 v[180:183],v9 offset:2048
buffer_load_dwordx4 a[72:75],v1,s[8:11],s48 offen offset:3072 sc1
s_waitcnt vmcnt(28)
MF a[144:147],v[64:67],v[56:59],a[144:147]
s_waitcnt lgkmcnt(2)
v_add_f32 v184,v184,v172
v_add_f32 v185,v185,v173
MF a[148:151],v[104:107],v[48:51],a[148:151]
v_add_f32 v186,v186,v174
v_add_f32 v187,v187,v175
MF a[148:151],v[140:143],v[52:55],a[148:151]
s_nop 0
ds_write_b128 v7,a[144:147] offset:0
ds_read_b128 v[172:175],v9 offset:3072
MF a[148:151],v[68:71],v[56:59],a[148:151]
buffer_load_dwordx4 a[76:79],v2,s[8:11],s48 offen sc1
s_waitcnt lgkmcnt(3)
v_add_f32 v188,v188,v176
v_add_f32 v189,v189,v177
MF a[152:155],v[108:111],v[48:51],a[152:155]
v_add_f32 v190,v190,v178
v_add_f32 v191,v191,v179
MF a[152:155],v[144:147],v[52:55],a[152:155]
ds_write_b128 v7,a[148:151] offset:1024
ds_read_b128 v[176:179],v9 offset:4096
MF a[152:155],v[72:75],v[56:59],a[152:155]
s_add_u32 s48,s48,4608
buffer_load_dwordx4 a[80:83],v1,s[8:11],s48 offen offset:0 sc1
s_waitcnt lgkmcnt(4)
v_add_f32 v192,v192,v180
v_add_f32 v193,v193,v181
MF a[156:159],v[112:115],v[48:51],a[156:159]
v_add_f32 v194,v194,v182
v_add_f32 v195,v195,v183
MF a[156:159],v[148:151],v[52:55],a[156:159]
ds_write_b128 v7,a[152:155] offset:2048
ds_read_b128 v[180:183],v9 offset:5120
MF a[156:159],v[76:79],v[56:59],a[156:159]
buffer_load_dwordx4 a[84:87],v1,s[8:11],s48 offen offset:1024 sc1
s_waitcnt lgkmcnt(4)
v_add_f32 v196,v196,v172
v_add_f32 v197,v197,v173
MF a[160:163],v[116:119],v[48:51],a[160:163]
v_add_f32 v198,v198,v174
v_add_f32 v199,v199,v175
MF a[160:163],v[152:155],v[52:55],a[160:163]
ds_write_b128 v7,a[156:159] offset:3072
ds_read_b128 v[172:175],v9 offset:6144
MF a[160:163],v[80:83],v[56:59],a[160:163]
buffer_load_dwordx4 a[88:91],v1,s[8:11],s48 offen offset:2048 sc1
s_waitcnt lgkmcnt(4)
v_add_f32 v200,v200,v176
v_add_f32 v201,v201,v177
MF a[164:167],v[120:123],v[48:51],a[164:167]
v_add_f32 v202,v202,v178
v_add_f32 v203,v203,v179
MF a[164:167],v[156:159],v[52:55],a[164:167]
ds_write_b128 v7,a[160:163] offset:4096
ds_read_b128 v[176:179],v9 offset:7168
MF a[164:167],v[84:87],v[56:59],a[164:167]
buffer_load_dwordx4 a[92:95],v1,s[8:11],s48 offen offset:3072 sc1
s_waitcnt lgkmcnt(4)
v_add_f32 v204,v204,v180
v_add_f32 v205,v205,v181
MF a[168:171],v[124:127],v[48:51],a[168:171]
v_add_f32 v206,v206,v182
v_add_f32 v207,v207,v183
MF a[168:171],v[160:163],v[52:55],a[168:171]
ds_write_b128 v7,a[164:167] offset:5120
ds_read_b128 v[180:183],v9 offset:8192
MF a[168:171],v[88:91],v[56:59],a[168:171]
buffer_load_dwordx4 a[96:99],v2,s[8:11],s48 offen sc1
s_waitcnt lgkmcnt(4)
v_add_f32 v208,v208,v172
v_add_f32 v209,v209,v173
MF a[172:175],v[128:131],v[48:51],a[172:175]
v_add_f32 v210,v210,v174
v_add_f32 v211,v211,v175
MF a[172:175],v[164:167],v[52:55],a[172:175]
ds_write_b128 v7,a[168:171] offset:6144
ds_read_b128 v[172:175],v9 offset:9216
MF a[172:175],v[92:95],v[56:59],a[172:175]
s_add_u32 s48,s48,4608
buffer_load_dwordx4 a[100:103],v1,s[8:11],s48 offen offset:0 sc1
s_waitcnt lgkmcnt(4)
v_add_f32 v212,v212,v176
v_add_f32 v213,v213,v177
MF a[176:179],v[132:135],v[48:51],a[176:179]
v_add_f32 v214,v214,v178
v_add_f32 v215,v215,v179
MF a[176:179],v[168:171],v[52:55],a[176:179]
ds_write_b128 v7,a[172:175] offset:7168
ds_read_b128 v[176:179],v9 offset:10240
MF a[176:179],v[96:99],v[56:59],a[176:179]
buffer_load_dwordx4 a[104:107],v1,s[8:11],s48 offen offset:1024 sc1
s_waitcnt lgkmcnt(4)
v_add_f32 v216,v216,v180
v_add_f32 v217,v217,v181
s_waitcnt vmcnt(35)
MF a[180:183],v[100:103],v[60:63],a[180:183]
v_add_f32 v218,v218,v182
v_add_f32 v219,v219,v183
s_waitcnt vmcnt(34)
MF a[180:183],v[136:139],v[16:19],a[180:183]
ds_write_b128 v7,a[176:179] offset:8192
ds_read_b128 v[180:183],v9 offset:11264
s_waitcnt vmcnt(33)
MF a[180:183],v[64:67],v[20:23],a[180:183]
buffer_load_dwordx4 a[108:111],v1,s[8:11],s48 offen offset:2048 sc1
s_waitcnt lgkmcnt(4)
v_add_f32 v220,v220,v172
v_add_f32 v221,v221,v173
MF a[184:187],v[104:107],v[60:63],a[184:187]
v_add_f32 v222,v222,v174
v_add_f32 v223,v223,v175
MF a[184:187],v[140:143],v[16:19],a[184:187]
ds_write_b128 v7,a[180:183] offset:9216
ds_read_b128 v[172:175],v9 offset:12288
MF a[184:187],v[68:71],v[20:23],a[184:187]
buffer_load_dwordx4 a[112:115],v1,s[8:11],s48 offen offset:3072 sc1
s_waitcnt lgkmcnt(4)
v_add_f32 v224,v224,v176
v_add_f32 v225,v225,v177
MF a[188:191],v[108:111],v[60:63],a[188:191]
v_add_f32 v226,v226,v178
v_add_f32 v227,v227,v179
MF a[188:191],v[144:147],v[16:19],a[188:191]
ds_write_b128 v7,a[184:187] offset:10240
ds_read_b128 v[176:179],v9 offset:13312
MF a[188:191],v[72:75],v[20:23],a[188:191]
buffer_load_dwordx4 a[116:119],v2,s[8:11],s48 offen sc1
s_waitcnt lgkmcnt(4)
v_add_f32 v228,v228,v180
v_add_f32 v229,v229,v181
MF a[192:195],v[112:115],v[60:63],a[192:195]
v_add_f32 v230,v230,v182
v_add_f32 v231,v231,v183
MF a[192:195],v[148:151],v[16:19],a[192:195]
ds_write_b128 v7,a[188:191] offset:11264
ds_read_b128 v[180:183],v9 offset:14336
MF a[192:195],v[76:79],v[20:23],a[192:195]
s_add_u32 s48,s48,4608
buffer_load_dwordx4 a[120:123],v1,s[8:11],s48 offen offset:0 sc1
s_waitcnt lgkmcnt(4)
v_add_f32 v232,v232,v172
v_add_f32 v233,v233,v173
MF a[196:199],v[116:119],v[60:63],a[196:199]
v_add_f32 v234,v234,v174
v_add_f32 v235,v235,v175
MF a[196:199],v[152:155],v[16:19],a[196:199]
ds_write_b128 v7,a[192:195] offset:12288
ds_read_b128 v[172:175],v9 offset:15360
MF a[196:199],v[80:83],v[20:23],a[196:199]
buffer_load_dwordx4 a[124:127],v1,s[8:11],s48 offen offset:1024 sc1
s_waitcnt lgkmcnt(4)
v_add_f32 v236,v236,v176
v_add_f32 v237,v237,v177
MF a[200:203],v[120:123],v[60:63],a[200:203]
v_add_f32 v238,v238,v178
v_add_f32 v239,v239,v179
MF a[200:203],v[156:159],v[16:19],a[200:203]
ds_write_b128 v7,a[196:199] offset:13312
ds_read_b128 v[176:179],v9 offset:16384
MF a[200:203],v[84:87],v[20:23],a[200:203]
buffer_load_dwordx4 a[128:131],v1,s[8:11],s48 offen offset:2048 sc1
s_waitcnt lgkmcnt(4)
v_add_f32 v240,v240,v180
v_add_f32 v241,v241,v181
MF a[204:207],v[124:127],v[60:63],a[204:207]
v_add_f32 v242,v242,v182
v_add_f32 v243,v243,v183
MF a[204:207],v[160:163],v[16:19],a[204:207]
ds_write_b128 v7,a[200:203] offset:14336
ds_read_b128 v[180:183],v9 offset:17408
MF a[204:207],v[88:91],v[20:23],a[204:207]
buffer_load_dwordx4 a[132:135],v1,s[8:11],s48 offen offset:3072 sc1
s_waitcnt lgkmcnt(4)
v_add_f32 v244,v244,v172
v_add_f32 v245,v245,v173
MF a[208:211],v[128:131],v[60:63],a[208:211]
v_add_f32 v246,v246,v174
v_add_f32 v247,v247,v175
MF a[208:211],v[164:167],v[16:19],a[208:211]
ds_write_b128 v7,a[204:207] offset:15360
buffer_load_dwordx4 a[136:139],v2,s[8:11],s48 offen sc1
MF a[208:211],v[92:95],v[20:23],a[208:211]
s_waitcnt lgkmcnt(3)
v_add_f32 v248,v248,v176
v_add_f32 v249,v249,v177
v_add_f32 v250,v250,v178
MF a[212:215],v[132:135],v[60:63],a[212:215]
v_add_f32 v251,v251,v179
s_add_u32 s48,s48,4608
buffer_load_dwordx4 a[140:143],v1,s[8:11],s48 offen offset:0 sc1
MF a[212:215],v[168:171],v[16:19],a[212:215]
ds_write_b128 v7,a[208:211] offset:16384
s_waitcnt lgkmcnt(2)
v_add_f32 v252,v252,v180
MF a[212:215],v[96:99],v[20:23],a[212:215]
v_add_f32 v253,v253,v181
v_add_f32 v254,v254,v182
v_add_f32 v255,v255,v183
s_nop 4
ds_write_b128 v7,a[212:215] offset:17408
s_waitcnt lgkmcnt(0)
s_barrier
ds_read_b128 v[172:175],v8 offset:0
ds_read_b128 v[176:179],v8 offset:1024
ds_read_b128 v[180:183],v8 offset:2048
s_waitcnt lgkmcnt(2)
v_add_f32 v184,v184,v172
v_add_f32 v185,v185,v173
v_add_f32 v186,v186,v174
v_add_f32 v187,v187,v175
s_waitcnt vmcnt(32)
s_nop 0
MF v[184:187],v[100:103],v[24:27],v[184:187]
s_waitcnt vmcnt(31)
MF v[184:187],v[136:139],v[28:31],v[184:187]
s_waitcnt vmcnt(30)
MF v[184:187],v[64:67],v[32:35],v[184:187]
ds_read_b128 v[172:175],v8 offset:3072
s_waitcnt lgkmcnt(2)
v_add_f32 v188,v188,v176
v_add_f32 v189,v189,v177
v_add_f32 v190,v190,v178
v_add_f32 v191,v191,v179
s_nop 1
MF v[188:191],v[104:107],v[24:27],v[188:191]
v_accvgpr_read_b32 v48,a216
v_accvgpr_read_b32 v49,a217
v_lshlrev_b32 v16,16,v48
v_and_b32 v17,0xffff0000,v48
v_lshlrev_b32 v18,16,v49
MF v[188:191],v[140:143],v[28:31],v[188:191]
v_and_b32 v19,0xffff0000,v49
v_mul_f32 v184,v184,v16
v_mul_f32 v185,v185,v17
v_mul_f32 v186,v186,v18
v_mul_f32 v187,v187,v19
MF v[188:191],v[68:71],v[32:35],v[188:191]
v_cvt_pk_bf16_f32 v184,v184,v185
v_cvt_pk_bf16_f32 v185,v186,v187
buffer_store_dwordx2 v[184:185],v12,s[8:11],s36 offen offset:0 sc1
buffer_load_dwordx4 a[144:147],v1,s[8:11],s48 offen offset:1024 sc1
ds_read_b128 v[176:179],v8 offset:4096
s_waitcnt lgkmcnt(2)
v_add_f32 v192,v192,v180
v_add_f32 v193,v193,v181
v_add_f32 v194,v194,v182
v_add_f32 v195,v195,v183
s_nop 1
MF v[192:195],v[108:111],v[24:27],v[192:195]
v_accvgpr_read_b32 v50,a218
v_accvgpr_read_b32 v51,a219
v_lshlrev_b32 v20,16,v50
v_and_b32 v21,0xffff0000,v50
v_lshlrev_b32 v22,16,v51
MF v[192:195],v[144:147],v[28:31],v[192:195]
v_and_b32 v23,0xffff0000,v51
v_mul_f32 v188,v188,v20
v_mul_f32 v189,v189,v21
v_mul_f32 v190,v190,v22
v_mul_f32 v191,v191,v23
MF v[192:195],v[72:75],v[32:35],v[192:195]
v_cvt_pk_bf16_f32 v188,v188,v189
v_cvt_pk_bf16_f32 v189,v190,v191
buffer_store_dwordx2 v[188:189],v12,s[8:11],s36 offen offset:512 sc1
ds_read_b128 v[180:183],v8 offset:5120
s_waitcnt lgkmcnt(2)
v_add_f32 v196,v196,v172
v_add_f32 v197,v197,v173
v_add_f32 v198,v198,v174
v_add_f32 v199,v199,v175
s_nop 1
MF v[196:199],v[112:115],v[24:27],v[196:199]
v_accvgpr_read_b32 v48,a220
v_accvgpr_read_b32 v49,a221
v_lshlrev_b32 v16,16,v48
v_and_b32 v17,0xffff0000,v48
v_lshlrev_b32 v18,16,v49
MF v[196:199],v[148:151],v[28:31],v[196:199]
v_and_b32 v19,0xffff0000,v49
v_mul_f32 v192,v192,v16
v_mul_f32 v193,v193,v17
v_mul_f32 v194,v194,v18
v_mul_f32 v195,v195,v19
MF v[196:199],v[76:79],v[32:35],v[196:199]
v_cvt_pk_bf16_f32 v192,v192,v193
v_cvt_pk_bf16_f32 v193,v194,v195
buffer_store_dwordx2 v[192:193],v12,s[8:11],s36 offen offset:1024 sc1
buffer_load_dwordx4 a[148:151],v1,s[8:11],s48 offen offset:2048 sc1
ds_read_b128 v[172:175],v8 offset:6144
s_waitcnt lgkmcnt(2)
v_add_f32 v200,v200,v176
v_add_f32 v201,v201,v177
v_add_f32 v202,v202,v178
v_add_f32 v203,v203,v179
s_nop 1
MF v[200:203],v[116:119],v[24:27],v[200:203]
v_accvgpr_read_b32 v50,a222
v_accvgpr_read_b32 v51,a223
v_lshlrev_b32 v20,16,v50
v_and_b32 v21,0xffff0000,v50
v_lshlrev_b32 v22,16,v51
MF v[200:203],v[152:155],v[28:31],v[200:203]
v_and_b32 v23,0xffff0000,v51
v_mul_f32 v196,v196,v20
v_mul_f32 v197,v197,v21
v_mul_f32 v198,v198,v22
v_mul_f32 v199,v199,v23
MF v[200:203],v[80:83],v[32:35],v[200:203]
v_cvt_pk_bf16_f32 v196,v196,v197
v_cvt_pk_bf16_f32 v197,v198,v199
buffer_store_dwordx2 v[196:197],v12,s[8:11],s36 offen offset:1536 sc1
ds_read_b128 v[176:179],v8 offset:7168
s_waitcnt lgkmcnt(2)
v_add_f32 v204,v204,v180
v_add_f32 v205,v205,v181
v_add_f32 v206,v206,v182
v_add_f32 v207,v207,v183
s_nop 1
MF v[204:207],v[120:123],v[24:27],v[204:207]
v_accvgpr_read_b32 v48,a224
v_accvgpr_read_b32 v49,a225
v_lshlrev_b32 v16,16,v48
v_and_b32 v17,0xffff0000,v48
v_lshlrev_b32 v18,16,v49
MF v[204:207],v[156:159],v[28:31],v[204:207]
v_and_b32 v19,0xffff0000,v49
v_mul_f32 v200,v200,v16
v_mul_f32 v201,v201,v17
v_mul_f32 v202,v202,v18
v_mul_f32 v203,v203,v19
MF v[204:207],v[84:87],v[32:35],v[204:207]
v_cvt_pk_bf16_f32 v200,v200,v201
v_cvt_pk_bf16_f32 v201,v202,v203
buffer_store_dwordx2 v[200:201],v12,s[8:11],s36 offen offset:2048 sc1
buffer_load_dwordx4 a[152:155],v1,s[8:11],s48 offen offset:3072 sc1
ds_read_b128 v[180:183],v8 offset:8192
s_waitcnt lgkmcnt(2)
v_add_f32 v208,v208,v172
v_add_f32 v209,v209,v173
v_add_f32 v210,v210,v174
v_add_f32 v211,v211,v175
s_nop 1
MF v[208:211],v[124:127],v[24:27],v[208:211]
v_accvgpr_read_b32 v50,a226
v_accvgpr_read_b32 v51,a227
v_lshlrev_b32 v20,16,v50
v_and_b32 v21,0xffff0000,v50
v_lshlrev_b32 v22,16,v51
MF v[208:211],v[160:163],v[28:31],v[208:211]
v_and_b32 v23,0xffff0000,v51
v_mul_f32 v204,v204,v20
v_mul_f32 v205,v205,v21
v_mul_f32 v206,v206,v22
v_mul_f32 v207,v207,v23
MF v[208:211],v[88:91],v[32:35],v[208:211]
v_cvt_pk_bf16_f32 v204,v204,v205
v_cvt_pk_bf16_f32 v205,v206,v207
buffer_store_dwordx2 v[204:205],v12,s[8:11],s36 offen offset:2560 sc1
ds_read_b128 v[172:175],v8 offset:9216
s_waitcnt lgkmcnt(2)
v_add_f32 v212,v212,v176
v_add_f32 v213,v213,v177
v_add_f32 v214,v214,v178
v_add_f32 v215,v215,v179
s_nop 1
MF v[212:215],v[128:131],v[24:27],v[212:215]
v_accvgpr_read_b32 v48,a228
v_accvgpr_read_b32 v49,a229
v_lshlrev_b32 v16,16,v48
v_and_b32 v17,0xffff0000,v48
v_lshlrev_b32 v18,16,v49
MF v[212:215],v[164:167],v[28:31],v[212:215]
v_and_b32 v19,0xffff0000,v49
v_mul_f32 v208,v208,v16
v_mul_f32 v209,v209,v17
v_mul_f32 v210,v210,v18
v_mul_f32 v211,v211,v19
MF v[212:215],v[92:95],v[32:35],v[212:215]
v_cvt_pk_bf16_f32 v208,v208,v209
v_cvt_pk_bf16_f32 v209,v210,v211
buffer_store_dwordx2 v[208:209],v12,s[8:11],s36 offen offset:3072 sc1
buffer_load_dwordx4 a[156:159],v2,s[8:11],s48 offen sc1
ds_read_b128 v[176:179],v8 offset:10240
s_waitcnt lgkmcnt(2)
v_add_f32 v216,v216,v180
v_add_f32 v217,v217,v181
v_add_f32 v218,v218,v182
v_add_f32 v219,v219,v183
s_nop 1
MF v[216:219],v[132:135],v[24:27],v[216:219]
v_accvgpr_read_b32 v50,a230
v_accvgpr_read_b32 v51,a231
v_lshlrev_b32 v20,16,v50
v_and_b32 v21,0xffff0000,v50
v_lshlrev_b32 v22,16,v51
MF v[216:219],v[168:171],v[28:31],v[216:219]
v_and_b32 v23,0xffff0000,v51
v_mul_f32 v212,v212,v20
v_mul_f32 v213,v213,v21
v_mul_f32 v214,v214,v22
v_mul_f32 v215,v215,v23
MF v[216:219],v[96:99],v[32:35],v[216:219]
v_cvt_pk_bf16_f32 v212,v212,v213
v_cvt_pk_bf16_f32 v213,v214,v215
buffer_store_dwordx2 v[212:213],v12,s[8:11],s36 offen offset:3584 sc1
ds_read_b128 v[180:183],v8 offset:11264
s_waitcnt lgkmcnt(2)
v_add_f32 v220,v220,v172
v_add_f32 v221,v221,v173
v_add_f32 v222,v222,v174
v_add_f32 v223,v223,v175
s_waitcnt vmcnt(32)
s_nop 0
MF v[220:223],v[100:103],v[36:39],v[220:223]
v_accvgpr_read_b32 v48,a232
v_accvgpr_read_b32 v49,a233
v_lshlrev_b32 v16,16,v48
v_and_b32 v17,0xffff0000,v48
v_lshlrev_b32 v18,16,v49
s_waitcnt vmcnt(31)
MF v[220:223],v[136:139],v[40:43],v[220:223]
v_and_b32 v19,0xffff0000,v49
v_mul_f32 v216,v216,v16
v_mul_f32 v217,v217,v17
v_mul_f32 v218,v218,v18
v_mul_f32 v219,v219,v19
s_waitcnt vmcnt(30)
MF v[220:223],v[64:67],v[44:47],v[220:223]
v_cvt_pk_bf16_f32 v216,v216,v217
v_cvt_pk_bf16_f32 v217,v218,v219
buffer_store_dwordx2 v[216:217],v12,s[8:11],s37 offen offset:0 sc1
s_add_u32 s48,s48,4608
buffer_load_dwordx4 a[160:163],v1,s[8:11],s48 offen offset:0 sc1
ds_read_b128 v[172:175],v8 offset:12288
s_waitcnt lgkmcnt(2)
v_add_f32 v224,v224,v176
v_add_f32 v225,v225,v177
v_add_f32 v226,v226,v178
v_add_f32 v227,v227,v179
s_nop 1
MF v[224:227],v[104:107],v[36:39],v[224:227]
v_accvgpr_read_b32 v50,a234
v_accvgpr_read_b32 v51,a235
v_lshlrev_b32 v20,16,v50
v_and_b32 v21,0xffff0000,v50
v_lshlrev_b32 v22,16,v51
MF v[224:227],v[140:143],v[40:43],v[224:227]
v_and_b32 v23,0xffff0000,v51
v_mul_f32 v220,v220,v20
v_mul_f32 v221,v221,v21
v_mul_f32 v222,v222,v22
v_mul_f32 v223,v223,v23
MF v[224:227],v[68:71],v[44:47],v[224:227]
v_cvt_pk_bf16_f32 v220,v220,v221
v_cvt_pk_bf16_f32 v221,v222,v223
buffer_store_dwordx2 v[220:221],v12,s[8:11],s38 offen offset:0 sc1
ds_read_b128 v[176:179],v8 offset:13312
s_waitcnt lgkmcnt(2)
v_add_f32 v228,v228,v180
v_add_f32 v229,v229,v181
v_add_f32 v230,v230,v182
v_add_f32 v231,v231,v183
s_nop 1
MF v[228:231],v[108:111],v[36:39],v[228:231]
v_accvgpr_read_b32 v48,a236
v_accvgpr_read_b32 v49,a237
v_lshlrev_b32 v16,16,v48
v_and_b32 v17,0xffff0000,v48
v_lshlrev_b32 v18,16,v49
MF v[228:231],v[144:147],v[40:43],v[228:231]
v_and_b32 v19,0xffff0000,v49
v_mul_f32 v224,v224,v16
v_mul_f32 v225,v225,v17
v_mul_f32 v226,v226,v18
v_mul_f32 v227,v227,v19
MF v[228:231],v[72:75],v[44:47],v[228:231]
v_cvt_pk_bf16_f32 v224,v224,v225
v_cvt_pk_bf16_f32 v225,v226,v227
buffer_store_dwordx2 v[224:225],v12,s[8:11],s38 offen offset:512 sc1
buffer_load_dwordx4 a[164:167],v1,s[8:11],s48 offen offset:1024 sc1
ds_read_b128 v[180:183],v8 offset:14336
s_waitcnt lgkmcnt(2)
v_add_f32 v232,v232,v172
v_add_f32 v233,v233,v173
v_add_f32 v234,v234,v174
v_add_f32 v235,v235,v175
s_nop 1
MF v[232:235],v[112:115],v[36:39],v[232:235]
v_accvgpr_read_b32 v50,a238
v_accvgpr_read_b32 v51,a239
v_lshlrev_b32 v20,16,v50
v_and_b32 v21,0xffff0000,v50
v_lshlrev_b32 v22,16,v51
MF v[232:235],v[148:151],v[40:43],v[232:235]
v_and_b32 v23,0xffff0000,v51
v_mul_f32 v228,v228,v20
v_mul_f32 v229,v229,v21
v_mul_f32 v230,v230,v22
v_mul_f32 v231,v231,v23
MF v[232:235],v[76:79],v[44:47],v[232:235]
v_cvt_pk_bf16_f32 v228,v228,v229
v_cvt_pk_bf16_f32 v229,v230,v231
buffer_store_dwordx2 v[228:229],v12,s[8:11],s38 offen offset:1024 sc1
ds_read_b128 v[172:175],v8 offset:15360
s_waitcnt lgkmcnt(2)
v_add_f32 v236,v236,v176
v_add_f32 v237,v237,v177
v_add_f32 v238,v238,v178
v_add_f32 v239,v239,v179
s_nop 1
MF v[236:239],v[116:119],v[36:39],v[236:239]
v_accvgpr_read_b32 v48,a240
v_accvgpr_read_b32 v49,a241
v_lshlrev_b32 v16,16,v48
v_and_b32 v17,0xffff0000,v48
v_lshlrev_b32 v18,16,v49
MF v[236:239],v[152:155],v[40:43],v[236:239]
v_and_b32 v19,0xffff0000,v49
v_mul_f32 v232,v232,v16
v_mul_f32 v233,v233,v17
v_mul_f32 v234,v234,v18
v_mul_f32 v235,v235,v19
MF v[236:239],v[80:83],v[44:47],v[236:239]
v_cvt_pk_bf16_f32 v232,v232,v233
v_cvt_pk_bf16_f32 v233,v234,v235
buffer_store_dwordx2 v[232:233],v12,s[8:11],s38 offen offset:1536 sc1
buffer_load_dwordx4 a[168:171],v1,s[8:11],s48 offen offset:2048 sc1
ds_read_b128 v[176:179],v8 offset:16384
s_waitcnt lgkmcnt(2)
v_add_f32 v240,v240,v180
v_add_f32 v241,v241,v181
v_add_f32 v242,v242,v182
v_add_f32 v243,v243,v183
s_nop 1
MF v[240:243],v[120:123],v[36:39],v[240:243]
v_accvgpr_read_b32 v50,a242
v_accvgpr_read_b32 v51,a243
v_lshlrev_b32 v20,16,v50
v_and_b32 v21,0xffff0000,v50
v_lshlrev_b32 v22,16,v51
MF v[240:243],v[156:159],v[40:43],v[240:243]
v_and_b32 v23,0xffff0000,v51
v_mul_f32 v236,v236,v20
v_mul_f32 v237,v237,v21
v_mul_f32 v238,v238,v22
v_mul_f32 v239,v239,v23
MF v[240:243],v[84:87],v[44:47],v[240:243]
v_cvt_pk_bf16_f32 v236,v236,v237
v_cvt_pk_bf16_f32 v237,v238,v239
buffer_store_dwordx2 v[236:237],v12,s[8:11],s38 offen offset:2048 sc1
ds_read_b128 v[180:183],v8 offset:17408
s_waitcnt lgkmcnt(2)
v_add_f32 v244,v244,v172
v_add_f32 v245,v245,v173
v_add_f32 v246,v246,v174
v_add_f32 v247,v247,v175
s_nop 1
MF v[244:247],v[124:127],v[36:39],v[244:247]
v_accvgpr_read_b32 v48,a244
v_accvgpr_read_b32 v49,a245
v_lshlrev_b32 v16,16,v48
v_and_b32 v17,0xffff0000,v48
v_lshlrev_b32 v18,16,v49
MF v[244:247],v[160:163],v[40:43],v[244:247]
v_and_b32 v19,0xffff0000,v49
v_mul_f32 v240,v240,v16
v_mul_f32 v241,v241,v17
v_mul_f32 v242,v242,v18
v_mul_f32 v243,v243,v19
MF v[244:247],v[88:91],v[44:47],v[244:247]
v_cvt_pk_bf16_f32 v240,v240,v241
v_cvt_pk_bf16_f32 v241,v242,v243
buffer_store_dwordx2 v[240:241],v12,s[8:11],s38 offen offset:2560 sc1
buffer_load_dwordx4 a[172:175],v1,s[8:11],s48 offen offset:3072 sc1
s_waitcnt lgkmcnt(1)
v_add_f32 v248,v248,v176
v_add_f32 v249,v249,v177
v_add_f32 v250,v250,v178
v_add_f32 v251,v251,v179
s_nop 1
MF v[248:251],v[128:131],v[36:39],v[248:251]
v_accvgpr_read_b32 v50,a246
v_accvgpr_read_b32 v51,a247
v_lshlrev_b32 v20,16,v50
v_and_b32 v21,0xffff0000,v50
v_lshlrev_b32 v22,16,v51
MF v[248:251],v[164:167],v[40:43],v[248:251]
v_and_b32 v23,0xffff0000,v51
v_mul_f32 v244,v244,v20
v_mul_f32 v245,v245,v21
v_mul_f32 v246,v246,v22
v_mul_f32 v247,v247,v23
MF v[248:251],v[92:95],v[44:47],v[248:251]
v_cvt_pk_bf16_f32 v244,v244,v245
v_cvt_pk_bf16_f32 v245,v246,v247
buffer_store_dwordx2 v[244:245],v12,s[8:11],s38 offen offset:3072 sc1
s_waitcnt lgkmcnt(0)
v_add_f32 v252,v252,v180
v_add_f32 v253,v253,v181
v_add_f32 v254,v254,v182
v_add_f32 v255,v255,v183
s_nop 1
MF v[252:255],v[132:135],v[36:39],v[252:255]
v_accvgpr_read_b32 v48,a248
v_accvgpr_read_b32 v49,a249
v_lshlrev_b32 v16,16,v48
v_and_b32 v17,0xffff0000,v48
v_lshlrev_b32 v18,16,v49
MF v[252:255],v[168:171],v[40:43],v[252:255]
v_and_b32 v19,0xffff0000,v49
v_mul_f32 v248,v248,v16
v_mul_f32 v249,v249,v17
v_mul_f32 v250,v250,v18
v_mul_f32 v251,v251,v19
MF v[252:255],v[96:99],v[44:47],v[252:255]
v_cvt_pk_bf16_f32 v248,v248,v249
v_cvt_pk_bf16_f32 v249,v250,v251
buffer_store_dwordx2 v[248:249],v12,s[8:11],s38 offen offset:3584 sc1
buffer_load_dwordx4 a[176:179],v2,s[8:11],s48 offen sc1
v_accvgpr_read_b32 v50,a250
v_accvgpr_read_b32 v51,a251
v_lshlrev_b32 v20,16,v50
v_and_b32 v21,0xffff0000,v50
v_lshlrev_b32 v22,16,v51
v_and_b32 v23,0xffff0000,v51
v_mul_f32 v252,v252,v20
v_mul_f32 v253,v253,v21
v_mul_f32 v254,v254,v22
v_mul_f32 v255,v255,v23
v_cvt_pk_bf16_f32 v252,v252,v253
v_cvt_pk_bf16_f32 v253,v254,v255
buffer_store_dwordx2 v[252:253],v12,s[8:11],s39 offen offset:0 sc1
s_lshl_b32 s78,s44,11
s_lshl_b32 s47,s45,4
s_add_u32 s78,s78,s47
s_lshl_b32 s47,s22,2
s_add_u32 s78,s78,s47
s_add_u32 s78,s78,0x1350000
PH_k5_1:
s_lshl_b32 s44,s3,2
s_and_b32 s45,s23,3
s_add_u32 s44,s44,s45
s_lshr_b32 s45,s23,2
v_and_b32 v2,7,v0
v_lshl_add_u32 v2,v15,3,v2
v_lshlrev_b32 v2,4,v2
v_add_u32 v2,4096,v2
s_mul_i32 s55,s22,18
s_mov_b32 s56,0
s_add_u32 s46,s22,0
s_and_b32 s46,s46,3
s_lshl_b32 s47,s44,2
s_add_u32 s46,s46,s47
s_mul_i32 s46,s46,72
s_add_u32 s46,s46,s55
s_lshl_b32 s46,s46,10
s_add_u32 s24,s46,0x5600000
s_add_u32 s46,s22,1
s_and_b32 s46,s46,3
s_lshl_b32 s47,s44,2
s_add_u32 s46,s46,s47
s_mul_i32 s46,s46,72
s_add_u32 s46,s46,s55
s_lshl_b32 s46,s46,10
s_add_u32 s25,s46,0x5600000
s_add_u32 s46,s22,2
s_and_b32 s46,s46,3
s_lshl_b32 s47,s44,2
s_add_u32 s46,s46,s47
s_mul_i32 s46,s46,72
s_add_u32 s46,s46,s55
s_lshl_b32 s46,s46,10
s_add_u32 s26,s46,0x5600000
s_add_u32 s46,s22,3
s_and_b32 s46,s46,3
s_lshl_b32 s47,s44,2
s_add_u32 s46,s46,s47
s_mul_i32 s46,s46,72
s_add_u32 s46,s46,s55
s_lshl_b32 s46,s46,10
s_add_u32 s27,s46,0x5600000
s_mul_i32 s46,s45,72
s_add_u32 s46,s46,s55
s_mul_i32 s28,s46,4608
s_add_u32 s28,s28,0x1080000
s_add_u32 s28,s28,36864
s_lshr_b32 s51,s44,1
s_lshl_b32 s79,s51,11
s_add_u32 s79,s79,0x1350000
s_add_u32 s28,s28,4608
buffer_load_dwordx4 v[176:179],v1,s[8:11],s28 offen offset:0 sc1
buffer_load_dwordx4 v[180:183],v1,s[8:11],s28 offen offset:1024 sc1
buffer_load_dwordx4 v[184:187],v1,s[8:11],s28 offen offset:2048 sc1
buffer_load_dwordx4 v[188:191],v1,s[8:11],s28 offen offset:3072 sc1
buffer_load_dwordx4 v[192:195],v2,s[8:11],s28 offen sc1
v_mov_b32 v13,1
v_mov_b32 v12,0
s_waitcnt vmcnt(5)
s_mov_b32 exec_lo,0x1
s_mov_b32 exec_hi,0x0
buffer_atomic_or v13,v12,s[8:11],s78 offen sc1
s_mov_b64 exec,-1
v_lshlrev_b32 v198,2,v0
s_cmp_eq_u32 s22,0
s_cselect_b32 s79,s79,0x40000000
v_mov_b32 v199,0
buffer_atomic_or v199,v198,s[8:11],s79 offen sc0 sc1
s_mul_i32 s46,s45,72
v_lshlrev_b32 v4,2,v15
v_add_u32 v4,s46,v4
v_lshrrev_b32 v5,3,v4
v_lshlrev_b32 v5,8,v5
v_lshl_add_u32 v5,v14,4,v5
v_and_b32 v10,4,v4
v_lshl_add_u32 v5,v10,1,v5
v_mul_u32_u24 v200,1152,v14
v_lshl_add_u32 v200,v4,1,v200
v_add_u32 v4,16,v4
v_lshrrev_b32 v6,3,v4
v_lshlrev_b32 v6,8,v6
v_lshl_add_u32 v6,v14,4,v6
v_and_b32 v10,4,v4
v_lshl_add_u32 v6,v10,1,v6
v_mul_u32_u24 v201,1152,v14
v_lshl_add_u32 v201,v4,1,v201
v_add_u32 v4,16,v4
v_lshrrev_b32 v7,3,v4
v_lshlrev_b32 v7,8,v7
v_lshl_add_u32 v7,v14,4,v7
v_and_b32 v10,4,v4
v_lshl_add_u32 v7,v10,1,v7
v_mul_u32_u24 v202,1152,v14
v_lshl_add_u32 v202,v4,1,v202
v_add_u32 v4,16,v4
v_lshrrev_b32 v8,3,v4
v_lshlrev_b32 v8,8,v8
v_lshl_add_u32 v8,v14,4,v8
v_and_b32 v10,4,v4
v_lshl_add_u32 v8,v10,1,v8
v_mul_u32_u24 v203,1152,v14
v_lshl_add_u32 v203,v4,1,v203
v_add_u32 v4,16,v4
v_lshrrev_b32 v9,3,v4
v_lshlrev_b32 v9,8,v9
v_lshl_add_u32 v9,v14,4,v9
v_and_b32 v10,4,v4
v_lshl_add_u32 v9,v10,1,v9
v_mul_u32_u24 v204,1152,v14
v_lshl_add_u32 v204,v4,1,v204
v_cmp_gt_u32 vcc,2,v15
v_mov_b32 v10,0x7ff00000
s_nop 0
v_cndmask_b32 v9,v10,v9,vcc
v_cndmask_b32 v204,v10,v204,vcc
s_lshl_b32 s50,s44,2
s_add_u32 s50,s50,s22
s_mul_i32 s52,s50,18432
s_add_u32 s54,s52,0x1b80000
s_add_u32 s57,s52,0x1400000
buffer_load_dwordx2 v[206:207],v5,s[8:11],s54 offen sc1
buffer_load_dwordx2 v[208:209],v6,s[8:11],s54 offen sc1
buffer_load_dwordx2 v[210:211],v7,s[8:11],s54 offen sc1
buffer_load_dwordx2 v[212:213],v8,s[8:11],s54 offen sc1
buffer_load_dwordx2 v[214:215],v9,s[8:11],s54 offen sc1
s_add_u32 s28,s28,4608
buffer_load_dwordx4 v[32:35],v1,s[8:11],s28 offen offset:0 sc1
buffer_load_dwordx4 v[36:39],v1,s[8:11],s28 offen offset:1024 sc1
buffer_load_dwordx4 v[40:43],v1,s[8:11],s28 offen offset:2048 sc1
buffer_load_dwordx4 v[44:47],v1,s[8:11],s28 offen offset:3072 sc1
buffer_load_dwordx4 v[48:51],v2,s[8:11],s28 offen sc1
s_add_u32 s46,s22,1
s_and_b32 s46,s46,3
s_mul_i32 s46,s46,3
s_add_u32 s46,s46,0
s_mul_i32 s46,s46,5120
s_add_u32 s46,s46,98304
v_add_u32 v241,s46,v1
s_add_u32 s46,s22,2
s_and_b32 s46,s46,3
s_mul_i32 s46,s46,3
s_add_u32 s46,s46,1
s_mul_i32 s46,s46,5120
s_add_u32 s46,s46,98304
v_add_u32 v242,s46,v1
s_add_u32 s46,s22,3
s_and_b32 s46,s46,3
s_mul_i32 s46,s46,3
s_add_u32 s46,s46,2
s_mul_i32 s46,s46,5120
s_add_u32 s46,s46,98304
v_add_u32 v243,s46,v1
s_mul_i32 s46,s22,15360
s_add_u32 s46,s46,98304
v_add_u32 v240,s46,v1
v_mov_b32 v244,0
v_mov_b32 v245,0
v_mov_b32 v246,0
v_mov_b32 v247,0
s_waitcnt vmcnt(5)
v_lshlrev_b32 v216,16,v206
v_and_b32 v217,0xffff0000,v206
v_lshlrev_b32 v218,16,v207
v_and_b32 v219,0xffff0000,v207
v_lshlrev_b32 v220,16,v208
v_and_b32 v221,0xffff0000,v208
v_lshlrev_b32 v222,16,v209
v_and_b32 v223,0xffff0000,v209
v_lshlrev_b32 v224,16,v210
v_and_b32 v225,0xffff0000,v210
v_lshlrev_b32 v226,16,v211
v_and_b32 v227,0xffff0000,v211
v_lshlrev_b32 v228,16,v212
v_and_b32 v229,0xffff0000,v212
v_lshlrev_b32 v230,16,v213
v_and_b32 v231,0xffff0000,v213
v_lshlrev_b32 v232,16,v214
v_and_b32 v233,0xffff0000,v214
v_lshlrev_b32 v234,16,v215
v_and_b32 v235,0xffff0000,v215
v_cmp_eq_u32 vcc,0,v199
s_cbranch_vccz DW_mega_kernel_19G
s_mov_b32 s53,0
s_cmp_lg_u32 s22,0
s_cbranch_scc1 DW_mega_kernel_19G
DW_mega_kernel_19:
s_nop 7
s_nop 3
v_mov_b32 v199,0
buffer_atomic_or v199,v198,s[8:11],s79 offen sc0 sc1
s_add_u32 s53,s53,1
s_waitcnt vmcnt(0)
v_cmp_eq_u32 vcc,0,v199
s_cbranch_vccz DW_mega_kernel_19G
s_cmp_lt_u32 s53,100000
s_cbranch_scc1 DW_mega_kernel_19
DW_mega_kernel_19G:
s_nop 7
s_nop 3
s_barrier
buffer_load_dwordx4 v[16:19],v1,s[8:11],s24 offen offset:0 sc1
buffer_load_dwordx4 v[20:23],v1,s[8:11],s25 offen offset:0 sc1
buffer_load_dwordx4 v[24:27],v1,s[8:11],s26 offen offset:0 sc1
buffer_load_dwordx4 v[28:31],v1,s[8:11],s27 offen offset:0 sc1
buffer_load_dwordx4 v[52:55],v1,s[8:11],s24 offen offset:1024 sc1
buffer_load_dwordx4 v[56:59],v1,s[8:11],s25 offen offset:1024 sc1
buffer_load_dwordx4 v[60:63],v1,s[8:11],s26 offen offset:1024 sc1
buffer_load_dwordx4 v[64:67],v1,s[8:11],s27 offen offset:1024 sc1
buffer_load_dwordx4 v[88:91],v1,s[8:11],s24 offen offset:2048 sc1
buffer_load_dwordx4 v[92:95],v1,s[8:11],s25 offen offset:2048 sc1
buffer_load_dwordx4 v[96:99],v1,s[8:11],s26 offen offset:2048 sc1
buffer_load_dwordx4 v[100:103],v1,s[8:11],s27 offen offset:2048 sc1
buffer_load_dwordx4 v[124:127],v1,s[8:11],s24 offen offset:3072 sc1
buffer_load_dwordx4 v[128:131],v1,s[8:11],s25 offen offset:3072 sc1
buffer_load_dwordx4 v[132:135],v1,s[8:11],s26 offen offset:3072 sc1
buffer_load_dwordx4 v[136:139],v1,s[8:11],s27 offen offset:3072 sc1
s_add_u32 s24,s24,4096
s_add_u32 s25,s25,4096
s_add_u32 s26,s26,4096
s_add_u32 s27,s27,4096
buffer_load_dwordx4 v[160:163],v1,s[8:11],s24 offen offset:0 sc1
buffer_load_dwordx4 v[164:167],v1,s[8:11],s25 offen offset:0 sc1
buffer_load_dwordx4 v[168:171],v1,s[8:11],s26 offen offset:0 sc1
buffer_load_dwordx4 v[172:175],v1,s[8:11],s27 offen offset:0 sc1
s_waitcnt vmcnt(19)
MF v[216:219],a[0:3],v[16:19],v[216:219]
s_add_u32 s28,s28,4608
buffer_load_dwordx4 v[68:71],v1,s[8:11],s28 offen offset:0 sc1
MF v[220:223],a[4:7],v[16:19],v[220:223]
MF v[224:227],a[8:11],v[16:19],v[224:227]
buffer_load_dwordx4 v[72:75],v1,s[8:11],s28 offen offset:1024 sc1
MF v[228:231],a[12:15],v[16:19],v[228:231]
MF v[232:235],a[16:19],v[16:19],v[232:235]
buffer_load_dwordx4 v[76:79],v1,s[8:11],s28 offen offset:2048 sc1
s_waitcnt vmcnt(21)
MF a[192:195],a[0:3],v[20:23],0
MF a[196:199],a[4:7],v[20:23],0
buffer_load_dwordx4 v[80:83],v1,s[8:11],s28 offen offset:3072 sc1
MF a[200:203],a[8:11],v[20:23],0
MF a[204:207],a[12:15],v[20:23],0
buffer_load_dwordx4 v[84:87],v2,s[8:11],s28 offen sc1
MF a[208:211],a[16:19],v[20:23],0
s_waitcnt vmcnt(22)
MF a[212:215],a[0:3],v[24:27],0
MF a[216:219],a[4:7],v[24:27],0
MF a[220:223],a[8:11],v[24:27],0
MF a[224:227],a[12:15],v[24:27],0
MF a[228:231],a[16:19],v[24:27],0
s_waitcnt vmcnt(21)
MF a[232:235],a[0:3],v[28:31],0
MF a[236:239],a[4:7],v[28:31],0
MF a[240:243],a[8:11],v[28:31],0
MF a[244:247],a[12:15],v[28:31],0
MF a[248:251],a[16:19],v[28:31],0
s_waitcnt vmcnt(20)
MF v[216:219],a[20:23],v[52:55],v[216:219]
buffer_load_dwordx4 v[16:19],v1,s[8:11],s24 offen offset:1024 sc1
MF v[220:223],a[24:27],v[52:55],v[220:223]
MF v[224:227],a[28:31],v[52:55],v[224:227]
buffer_load_dwordx4 v[20:23],v1,s[8:11],s25 offen offset:1024 sc1
MF v[228:231],a[32:35],v[52:55],v[228:231]
MF v[232:235],a[36:39],v[52:55],v[232:235]
buffer_load_dwordx4 v[24:27],v1,s[8:11],s26 offen offset:1024 sc1
s_waitcnt vmcnt(22)
MF a[192:195],a[20:23],v[56:59],a[192:195]
MF a[196:199],a[24:27],v[56:59],a[196:199]
buffer_load_dwordx4 v[28:31],v1,s[8:11],s27 offen offset:1024 sc1
MF a[200:203],a[28:31],v[56:59],a[200:203]
MF a[204:207],a[32:35],v[56:59],a[204:207]
s_add_u32 s28,s28,4608
buffer_load_dwordx4 v[104:107],v1,s[8:11],s28 offen offset:0 sc1
MF a[208:211],a[36:39],v[56:59],a[208:211]
s_waitcnt vmcnt(23)
MF a[212:215],a[20:23],v[60:63],a[212:215]
buffer_load_dwordx4 v[108:111],v1,s[8:11],s28 offen offset:1024 sc1
MF a[216:219],a[24:27],v[60:63],a[216:219]
MF a[220:223],a[28:31],v[60:63],a[220:223]
buffer_load_dwordx4 v[112:115],v1,s[8:11],s28 offen offset:2048 sc1
MF a[224:227],a[32:35],v[60:63],a[224:227]
MF a[228:231],a[36:39],v[60:63],a[228:231]
buffer_load_dwordx4 v[116:119],v1,s[8:11],s28 offen offset:3072 sc1
s_waitcnt vmcnt(25)
MF a[232:235],a[20:23],v[64:67],a[232:235]
MF a[236:239],a[24:27],v[64:67],a[236:239]
buffer_load_dwordx4 v[120:123],v2,s[8:11],s28 offen sc1
MF a[240:243],a[28:31],v[64:67],a[240:243]
MF a[244:247],a[32:35],v[64:67],a[244:247]
MF a[248:251],a[36:39],v[64:67],a[248:251]
s_waitcnt vmcnt(25)
MF v[216:219],a[40:43],v[88:91],v[216:219]
buffer_load_dwordx4 v[52:55],v1,s[8:11],s24 offen offset:2048 sc1
MF v[220:223],a[44:47],v[88:91],v[220:223]
MF v[224:227],a[48:51],v[88:91],v[224:227]
buffer_load_dwordx4 v[56:59],v1,s[8:11],s25 offen offset:2048 sc1
MF v[228:231],a[52:55],v[88:91],v[228:231]
MF v[232:235],a[56:59],v[88:91],v[232:235]
buffer_load_dwordx4 v[60:63],v1,s[8:11],s26 offen offset:2048 sc1
s_waitcnt vmcnt(27)
MF a[192:195],a[40:43],v[92:95],a[192:195]
MF a[196:199],a[44:47],v[92:95],a[196:199]
buffer_load_dwordx4 v[64:67],v1,s[8:11],s27 offen offset:2048 sc1
MF a[200:203],a[48:51],v[92:95],a[200:203]
MF a[204:207],a[52:55],v[92:95],a[204:207]
s_add_u32 s28,s28,4608
buffer_load_dwordx4 v[140:143],v1,s[8:11],s28 offen offset:0 sc1
MF a[208:211],a[56:59],v[92:95],a[208:211]
s_waitcnt vmcnt(28)
MF a[212:215],a[40:43],v[96:99],a[212:215]
buffer_load_dwordx4 v[144:147],v1,s[8:11],s28 offen offset:1024 sc1
MF a[216:219],a[44:47],v[96:99],a[216:219]
MF a[220:223],a[48:51],v[96:99],a[220:223]
buffer_load_dwordx4 v[148:151],v1,s[8:11],s28 offen offset:2048 sc1
MF a[224:227],a[52:55],v[96:99],a[224:227]
MF a[228:231],a[56:59],v[96:99],a[228:231]
buffer_load_dwordx4 v[152:155],v1,s[8:11],s28 offen offset:3072 sc1
s_waitcnt vmcnt(30)
MF a[232:235],a[40:43],v[100:103],a[232:235]
MF a[236:239],a[44:47],v[100:103],a[236:239]
buffer_load_dwordx4 v[156:159],v2,s[8:11],s28 offen sc1
MF a[240:243],a[48:51],v[100:103],a[240:243]
MF a[244:247],a[52:55],v[100:103],a[244:247]
MF a[248:251],a[56:59],v[100:103],a[248:251]
s_waitcnt vmcnt(30)
MF v[216:219],a[60:63],v[124:127],v[216:219]
buffer_load_dwordx4 v[88:91],v1,s[8:11],s24 offen offset:3072 sc1
MF v[220:223],a[64:67],v[124:127],v[220:223]
MF v[224:227],a[68:71],v[124:127],v[224:227]
buffer_load_dwordx4 v[92:95],v1,s[8:11],s25 offen offset:3072 sc1
MF v[228:231],a[72:75],v[124:127],v[228:231]
MF v[232:235],a[76:79],v[124:127],v[232:235]
buffer_load_dwordx4 v[96:99],v1,s[8:11],s26 offen offset:3072 sc1
s_waitcnt vmcnt(32)
MF a[192:195],a[60:63],v[128:131],a[192:195]
MF a[196:199],a[64:67],v[128:131],a[196:199]
buffer_load_dwordx4 v[100:103],v1,s[8:11],s27 offen offset:3072 sc1
MF a[200:203],a[68:71],v[128:131],a[200:203]
MF a[204:207],a[72:75],v[128:131],a[204:207]
MF a[208:211],a[76:79],v[128:131],a[208:211]
s_waitcnt vmcnt(32)
MF a[212:215],a[60:63],v[132:135],a[212:215]
MF a[216:219],a[64:67],v[132:135],a[216:219]
MF a[220:223],a[68:71],v[132:135],a[220:223]
MF a[224:227],a[72:75],v[132:135],a[224:227]
MF a[228:231],a[76:79],v[132:135],a[228:231]
s_waitcnt vmcnt(31)
MF a[232:235],a[60:63],v[136:139],a[232:235]
MF a[236:239],a[64:67],v[136:139],a[236:239]
MF a[240:243],a[68:71],v[136:139],a[240:243]
MF a[244:247],a[72:75],v[136:139],a[244:247]
MF a[248:251],a[76:79],v[136:139],a[248:251]
s_waitcnt vmcnt(30)
MF v[216:219],a[80:83],v[160:163],v[216:219]
s_add_u32 s24,s24,4096
s_add_u32 s25,s25,4096
s_add_u32 s26,s26,4096
s_add_u32 s27,s27,4096
buffer_load_dwordx4 v[124:127],v1,s[8:11],s24 offen offset:0 sc1
MF v[220:223],a[84:87],v[160:163],v[220:223]
MF v[224:227],a[88:91],v[160:163],v[224:227]
buffer_load_dwordx4 v[128:131],v1,s[8:11],s25 offen offset:0 sc1
MF v[228:231],a[92:95],v[160:163],v[228:231]
MF v[232:235],a[96:99],v[160:163],v[232:235]
buffer_load_dwordx4 v[132:135],v1,s[8:11],s26 offen offset:0 sc1
s_waitcnt vmcnt(32)
MF a[192:195],a[80:83],v[164:167],a[192:195]
MF a[196:199],a[84:87],v[164:167],a[196:199]
buffer_load_dwordx4 v[136:139],v1,s[8:11],s27 offen offset:0 sc1
MF a[200:203],a[88:91],v[164:167],a[200:203]
MF a[204:207],a[92:95],v[164:167],a[204:207]
MF a[208:211],a[96:99],v[164:167],a[208:211]
s_waitcnt vmcnt(32)
MF a[212:215],a[80:83],v[168:171],a[212:215]
MF a[216:219],a[84:87],v[168:171],a[216:219]
MF a[220:223],a[88:91],v[168:171],a[220:223]
MF a[224:227],a[92:95],v[168:171],a[224:227]
MF a[228:231],a[96:99],v[168:171],a[228:231]
s_waitcnt vmcnt(31)
MF a[232:235],a[80:83],v[172:175],a[232:235]
MF a[236:239],a[84:87],v[172:175],a[236:239]
MF a[240:243],a[88:91],v[172:175],a[240:243]
MF a[244:247],a[92:95],v[172:175],a[244:247]
MF a[248:251],a[96:99],v[172:175],a[248:251]
s_waitcnt vmcnt(25)
MF v[216:219],a[100:103],v[16:19],v[216:219]
buffer_load_dwordx4 v[160:163],v1,s[8:11],s24 offen offset:1024 sc1
MF v[220:223],a[104:107],v[16:19],v[220:223]
MF v[224:227],a[108:111],v[16:19],v[224:227]
buffer_load_dwordx4 v[164:167],v1,s[8:11],s25 offen offset:1024 sc1
MF v[228:231],a[112:115],v[16:19],v[228:231]
MF v[232:235],a[116:119],v[16:19],v[232:235]
buffer_load_dwordx4 v[168:171],v1,s[8:11],s26 offen offset:1024 sc1
s_waitcnt vmcnt(27)
MF a[192:195],a[100:103],v[20:23],a[192:195]
MF a[196:199],a[104:107],v[20:23],a[196:199]
buffer_load_dwordx4 v[172:175],v1,s[8:11],s27 offen offset:1024 sc1
MF a[200:203],a[108:111],v[20:23],a[200:203]
MF a[204:207],a[112:115],v[20:23],a[204:207]
MF a[208:211],a[116:119],v[20:23],a[208:211]
s_waitcnt vmcnt(27)
MF a[212:215],a[100:103],v[24:27],a[212:215]
MF a[216:219],a[104:107],v[24:27],a[216:219]
MF a[220:223],a[108:111],v[24:27],a[220:223]
MF a[224:227],a[112:115],v[24:27],a[224:227]
MF a[228:231],a[116:119],v[24:27],a[228:231]
s_waitcnt vmcnt(26)
MF a[232:235],a[100:103],v[28:31],a[232:235]
MF a[236:239],a[104:107],v[28:31],a[236:239]
MF a[240:243],a[108:111],v[28:31],a[240:243]
MF a[244:247],a[112:115],v[28:31],a[244:247]
MF a[248:251],a[116:119],v[28:31],a[248:251]
s_waitcnt vmcnt(20)
MF v[216:219],a[120:123],v[52:55],v[216:219]
buffer_load_dwordx4 v[16:19],v1,s[8:11],s24 offen offset:2048 sc1
MF v[220:223],a[124:127],v[52:55],v[220:223]
MF v[224:227],a[128:131],v[52:55],v[224:227]
buffer_load_dwordx4 v[20:23],v1,s[8:11],s25 offen offset:2048 sc1
MF v[228:231],a[132:135],v[52:55],v[228:231]
MF v[232:235],a[136:139],v[52:55],v[232:235]
buffer_load_dwordx4 v[24:27],v1,s[8:11],s26 offen offset:2048 sc1
s_waitcnt vmcnt(22)
MF a[192:195],a[120:123],v[56:59],a[192:195]
MF a[196:199],a[124:127],v[56:59],a[196:199]
buffer_load_dwordx4 v[28:31],v1,s[8:11],s27 offen offset:2048 sc1
MF a[200:203],a[128:131],v[56:59],a[200:203]
MF a[204:207],a[132:135],v[56:59],a[204:207]
MF a[208:211],a[136:139],v[56:59],a[208:211]
s_waitcnt vmcnt(22)
MF a[212:215],a[120:123],v[60:63],a[212:215]
MF a[216:219],a[124:127],v[60:63],a[216:219]
MF a[220:223],a[128:131],v[60:63],a[220:223]
MF a[224:227],a[132:135],v[60:63],a[224:227]
MF a[228:231],a[136:139],v[60:63],a[228:231]
s_waitcnt vmcnt(21)
MF a[232:235],a[120:123],v[64:67],a[232:235]
MF a[236:239],a[124:127],v[64:67],a[236:239]
MF a[240:243],a[128:131],v[64:67],a[240:243]
MF a[244:247],a[132:135],v[64:67],a[244:247]
MF a[248:251],a[136:139],v[64:67],a[248:251]
s_waitcnt vmcnt(15)
MF v[216:219],a[140:143],v[88:91],v[216:219]
buffer_load_dwordx4 v[52:55],v1,s[8:11],s24 offen offset:3072 sc1
MF v[220:223],a[144:147],v[88:91],v[220:223]
MF v[224:227],a[148:151],v[88:91],v[224:227]
buffer_load_dwordx4 v[56:59],v1,s[8:11],s25 offen offset:3072 sc1
MF v[228:231],a[152:155],v[88:91],v[228:231]
MF v[232:235],a[156:159],v[88:91],v[232:235]
buffer_load_dwordx4 v[60:63],v1,s[8:11],s26 offen offset:3072 sc1
s_waitcnt vmcnt(17)
MF a[192:195],a[140:143],v[92:95],a[192:195]
MF a[196:199],a[144:147],v[92:95],a[196:199]
buffer_load_dwordx4 v[64:67],v1,s[8:11],s27 offen offset:3072 sc1
MF a[200:203],a[148:151],v[92:95],a[200:203]
MF a[204:207],a[152:155],v[92:95],a[204:207]
MF a[208:211],a[156:159],v[92:95],a[208:211]
s_waitcnt vmcnt(17)
MF a[212:215],a[140:143],v[96:99],a[212:215]
MF a[216:219],a[144:147],v[96:99],a[216:219]
MF a[220:223],a[148:151],v[96:99],a[220:223]
MF a[224:227],a[152:155],v[96:99],a[224:227]
MF a[228:231],a[156:159],v[96:99],a[228:231]
s_waitcnt vmcnt(16)
MF a[232:235],a[140:143],v[100:103],a[232:235]
MF a[236:239],a[144:147],v[100:103],a[236:239]
MF a[240:243],a[148:151],v[100:103],a[240:243]
MF a[244:247],a[152:155],v[100:103],a[244:247]
MF a[248:251],a[156:159],v[100:103],a[248:251]
s_waitcnt vmcnt(15)
MF v[216:219],a[160:163],v[124:127],v[216:219]
s_add_u32 s24,s24,4096
s_add_u32 s25,s25,4096
s_add_u32 s26,s26,4096
s_add_u32 s27,s27,4096
buffer_load_dwordx4 v[88:91],v1,s[8:11],s24 offen offset:0 sc1
MF v[220:223],a[164:167],v[124:127],v[220:223]
MF v[224:227],a[168:171],v[124:127],v[224:227]
buffer_load_dwordx4 v[92:95],v1,s[8:11],s25 offen offset:0 sc1
MF v[228:231],a[172:175],v[124:127],v[228:231]
MF v[232:235],a[176:179],v[124:127],v[232:235]
buffer_load_dwordx4 v[96:99],v1,s[8:11],s26 offen offset:0 sc1
s_waitcnt vmcnt(17)
MF a[192:195],a[160:163],v[128:131],a[192:195]
MF a[196:199],a[164:167],v[128:131],a[196:199]
buffer_load_dwordx4 v[100:103],v1,s[8:11],s27 offen offset:0 sc1
MF a[200:203],a[168:171],v[128:131],a[200:203]
MF a[204:207],a[172:175],v[128:131],a[204:207]
MF a[208:211],a[176:179],v[128:131],a[208:211]
s_waitcnt vmcnt(17)
MF a[212:215],a[160:163],v[132:135],a[212:215]
MF a[216:219],a[164:167],v[132:135],a[216:219]
MF a[220:223],a[168:171],v[132:135],a[220:223]
MF a[224:227],a[172:175],v[132:135],a[224:227]
MF a[228:231],a[176:179],v[132:135],a[228:231]
s_waitcnt vmcnt(16)
MF a[232:235],a[160:163],v[136:139],a[232:235]
MF a[236:239],a[164:167],v[136:139],a[236:239]
MF a[240:243],a[168:171],v[136:139],a[240:243]
MF a[244:247],a[172:175],v[136:139],a[244:247]
MF a[248:251],a[176:179],v[136:139],a[248:251]
s_waitcnt vmcnt(15)
MF v[216:219],v[176:179],v[160:163],v[216:219]
buffer_load_dwordx4 v[124:127],v1,s[8:11],s24 offen offset:1024 sc1
MF v[220:223],v[180:183],v[160:163],v[220:223]
MF v[224:227],v[184:187],v[160:163],v[224:227]
buffer_load_dwordx4 v[128:131],v1,s[8:11],s25 offen offset:1024 sc1
MF v[228:231],v[188:191],v[160:163],v[228:231]
MF v[232:235],v[192:195],v[160:163],v[232:235]
buffer_load_dwordx4 v[132:135],v1,s[8:11],s26 offen offset:1024 sc1
s_waitcnt vmcnt(17)
MF a[192:195],v[176:179],v[164:167],a[192:195]
MF a[196:199],v[180:183],v[164:167],a[196:199]
buffer_load_dwordx4 v[136:139],v1,s[8:11],s27 offen offset:1024 sc1
MF a[200:203],v[184:187],v[164:167],a[200:203]
MF a[204:207],v[188:191],v[164:167],a[204:207]
MF a[208:211],v[192:195],v[164:167],a[208:211]
s_waitcnt vmcnt(17)
MF a[212:215],v[176:179],v[168:171],a[212:215]
MF a[216:219],v[180:183],v[168:171],a[216:219]
MF a[220:223],v[184:187],v[168:171],a[220:223]
MF a[224:227],v[188:191],v[168:171],a[224:227]
MF a[228:231],v[192:195],v[168:171],a[228:231]
s_waitcnt vmcnt(16)
MF a[232:235],v[176:179],v[172:175],a[232:235]
MF a[236:239],v[180:183],v[172:175],a[236:239]
MF a[240:243],v[184:187],v[172:175],a[240:243]
MF a[244:247],v[188:191],v[172:175],a[244:247]
MF a[248:251],v[192:195],v[172:175],a[248:251]
s_waitcnt vmcnt(15)
MF v[216:219],v[32:35],v[16:19],v[216:219]
buffer_load_dwordx4 v[160:163],v1,s[8:11],s24 offen offset:2048 sc1
MF v[220:223],v[36:39],v[16:19],v[220:223]
MF v[224:227],v[40:43],v[16:19],v[224:227]
buffer_load_dwordx4 v[164:167],v1,s[8:11],s25 offen offset:2048 sc1
MF v[228:231],v[44:47],v[16:19],v[228:231]
MF v[232:235],v[48:51],v[16:19],v[232:235]
buffer_load_dwordx4 v[168:171],v1,s[8:11],s26 offen offset:2048 sc1
s_waitcnt vmcnt(17)
MF a[192:195],v[32:35],v[20:23],a[192:195]
MF a[196:199],v[36:39],v[20:23],a[196:199]
buffer_load_dwordx4 v[172:175],v1,s[8:11],s27 offen offset:2048 sc1
MF a[200:203],v[40:43],v[20:23],a[200:203]
MF a[204:207],v[44:47],v[20:23],a[204:207]
s_add_u32 s28,s28,4608
buffer_load_dwordx4 v[176:179],v1,s[8:11],s28 offen offset:0 sc1
MF a[208:211],v[48:51],v[20:23],a[208:211]
s_waitcnt vmcnt(18)
MF a[212:215],v[32:35],v[24:27],a[212:215]
buffer_load_dwordx4 v[180:183],v1,s[8:11],s28 offen offset:1024 sc1
MF a[216:219],v[36:39],v[24:27],a[216:219]
MF a[220:223],v[40:43],v[24:27],a[220:223]
buffer_load_dwordx4 v[184:187],v1,s[8:11],s28 offen offset:2048 sc1
MF a[224:227],v[44:47],v[24:27],a[224:227]
MF a[228:231],v[48:51],v[24:27],a[228:231]
buffer_load_dwordx4 v[188:191],v1,s[8:11],s28 offen offset:3072 sc1
s_waitcnt vmcnt(20)
MF a[232:235],v[32:35],v[28:31],a[232:235]
MF a[236:239],v[36:39],v[28:31],a[236:239]
buffer_load_dwordx4 v[192:195],v2,s[8:11],s28 offen sc1
MF a[240:243],v[40:43],v[28:31],a[240:243]
MF a[244:247],v[44:47],v[28:31],a[244:247]
MF a[248:251],v[48:51],v[28:31],a[248:251]
s_waitcnt vmcnt(20)
MF v[216:219],v[68:71],v[52:55],v[216:219]
buffer_load_dwordx4 v[16:19],v1,s[8:11],s24 offen offset:3072 sc1
MF v[220:223],v[72:75],v[52:55],v[220:223]
MF v[224:227],v[76:79],v[52:55],v[224:227]
buffer_load_dwordx4 v[20:23],v1,s[8:11],s25 offen offset:3072 sc1
MF v[228:231],v[80:83],v[52:55],v[228:231]
MF v[232:235],v[84:87],v[52:55],v[232:235]
buffer_load_dwordx4 v[24:27],v1,s[8:11],s26 offen offset:3072 sc1
s_waitcnt vmcnt(22)
MF a[192:195],v[68:71],v[56:59],a[192:195]
MF a[196:199],v[72:75],v[56:59],a[196:199]
buffer_load_dwordx4 v[28:31],v1,s[8:11],s27 offen offset:3072 sc1
MF a[200:203],v[76:79],v[56:59],a[200:203]
MF a[204:207],v[80:83],v[56:59],a[204:207]
s_add_u32 s28,s28,4608
buffer_load_dwordx4 v[32:35],v1,s[8:11],s28 offen offset:0 sc1
MF a[208:211],v[84:87],v[56:59],a[208:211]
s_waitcnt vmcnt(23)
MF a[212:215],v[68:71],v[60:63],a[212:215]
buffer_load_dwordx4 v[36:39],v1,s[8:11],s28 offen offset:1024 sc1
MF a[216:219],v[72:75],v[60:63],a[216:219]
MF a[220:223],v[76:79],v[60:63],a[220:223]
buffer_load_dwordx4 v[40:43],v1,s[8:11],s28 offen offset:2048 sc1
MF a[224:227],v[80:83],v[60:63],a[224:227]
MF a[228:231],v[84:87],v[60:63],a[228:231]
buffer_load_dwordx4 v[44:47],v1,s[8:11],s28 offen offset:3072 sc1
s_waitcnt vmcnt(25)
MF a[232:235],v[68:71],v[64:67],a[232:235]
MF a[236:239],v[72:75],v[64:67],a[236:239]
buffer_load_dwordx4 v[48:51],v2,s[8:11],s28 offen sc1
MF a[240:243],v[76:79],v[64:67],a[240:243]
MF a[244:247],v[80:83],v[64:67],a[244:247]
MF a[248:251],v[84:87],v[64:67],a[248:251]
s_waitcnt vmcnt(25)
MF v[216:219],v[104:107],v[88:91],v[216:219]
s_add_u32 s24,s24,4096
s_add_u32 s25,s25,4096
s_add_u32 s26,s26,4096
s_add_u32 s27,s27,4096
buffer_load_dwordx4 v[52:55],v1,s[8:11],s24 offen offset:0 sc1
MF v[220:223],v[108:111],v[88:91],v[220:223]
MF v[224:227],v[112:115],v[88:91],v[224:227]
buffer_load_dwordx4 v[56:59],v1,s[8:11],s25 offen offset:0 sc1
MF v[228:231],v[116:119],v[88:91],v[228:231]
MF v[232:235],v[120:123],v[88:91],v[232:235]
buffer_load_dwordx4 v[60:63],v1,s[8:11],s26 offen offset:0 sc1
s_waitcnt vmcnt(27)
MF a[192:195],v[104:107],v[92:95],a[192:195]
MF a[196:199],v[108:111],v[92:95],a[196:199]
buffer_load_dwordx4 v[64:67],v1,s[8:11],s27 offen offset:0 sc1
MF a[200:203],v[112:115],v[92:95],a[200:203]
MF a[204:207],v[116:119],v[92:95],a[204:207]
s_add_u32 s28,s28,4608
buffer_load_dwordx4 v[68:71],v1,s[8:11],s28 offen offset:0 sc1
MF a[208:211],v[120:123],v[92:95],a[208:211]
s_waitcnt vmcnt(28)
MF a[212:215],v[104:107],v[96:99],a[212:215]
buffer_load_dwordx4 v[72:75],v1,s[8:11],s28 offen offset:1024 sc1
MF a[216:219],v[108:111],v[96:99],a[216:219]
MF a[220:223],v[112:115],v[96:99],a[220:223]
buffer_load_dwordx4 v[76:79],v1,s[8:11],s28 offen offset:2048 sc1
MF a[224:227],v[116:119],v[96:99],a[224:227]
MF a[228:231],v[120:123],v[96:99],a[228:231]
buffer_load_dwordx4 v[80:83],v1,s[8:11],s28 offen offset:3072 sc1
s_waitcnt vmcnt(30)
MF a[232:235],v[104:107],v[100:103],a[232:235]
MF a[236:239],v[108:111],v[100:103],a[236:239]
buffer_load_dwordx4 v[84:87],v2,s[8:11],s28 offen sc1
MF a[240:243],v[112:115],v[100:103],a[240:243]
MF a[244:247],v[116:119],v[100:103],a[244:247]
MF a[248:251],v[120:123],v[100:103],a[248:251]
s_waitcnt vmcnt(30)
MF v[216:219],v[140:143],v[124:127],v[216:219]
buffer_load_dwordx4 v[88:91],v1,s[8:11],s24 offen offset:1024 sc1
MF v[220:223],v[144:147],v[124:127],v[220:223]
MF v[224:227],v[148:151],v[124:127],v[224:227]
buffer_load_dwordx4 v[92:95],v1,s[8:11],s25 offen offset:1024 sc1
MF v[228:231],v[152:155],v[124:127],v[228:231]
MF v[232:235],v[156:159],v[124:127],v[232:235]
buffer_load_dwordx4 v[96:99],v1,s[8:11],s26 offen offset:1024 sc1
s_waitcnt vmcnt(32)
MF a[192:195],v[140:143],v[128:131],a[192:195]
MF a[196:199],v[144:147],v[128:131],a[196:199]
buffer_load_dwordx4 v[100:103],v1,s[8:11],s27 offen offset:1024 sc1
MF a[200:203],v[148:151],v[128:131],a[200:203]
MF a[204:207],v[152:155],v[128:131],a[204:207]
s_add_u32 s28,s28,4608
buffer_load_dwordx4 v[104:107],v1,s[8:11],s28 offen offset:0 sc1
MF a[208:211],v[156:159],v[128:131],a[208:211]
s_waitcnt vmcnt(33)
MF a[212:215],v[140:143],v[132:135],a[212:215]
buffer_load_dwordx4 v[108:111],v1,s[8:11],s28 offen offset:1024 sc1
MF a[216:219],v[144:147],v[132:135],a[216:219]
MF a[220:223],v[148:151],v[132:135],a[220:223]
buffer_load_dwordx4 v[112:115],v1,s[8:11],s28 offen offset:2048 sc1
MF a[224:227],v[152:155],v[132:135],a[224:227]
MF a[228:231],v[156:159],v[132:135],a[228:231]
buffer_load_dwordx4 v[116:119],v1,s[8:11],s28 offen offset:3072 sc1
s_waitcnt vmcnt(35)
MF a[232:235],v[140:143],v[136:139],a[232:235]
MF a[236:239],v[144:147],v[136:139],a[236:239]
buffer_load_dwordx4 v[120:123],v2,s[8:11],s28 offen sc1
MF a[240:243],v[148:151],v[136:139],a[240:243]
MF a[244:247],v[152:155],v[136:139],a[244:247]
MF a[248:251],v[156:159],v[136:139],a[248:251]
s_waitcnt vmcnt(35)
s_waitcnt vmcnt(31)
MF v[216:219],v[176:179],v[160:163],v[216:219]
s_waitcnt vmcnt(30)
MF v[220:223],v[180:183],v[160:163],v[220:223]
s_waitcnt vmcnt(29)
MF v[224:227],v[184:187],v[160:163],v[224:227]
s_waitcnt vmcnt(28)
MF v[228:231],v[188:191],v[160:163],v[228:231]
s_waitcnt vmcnt(27)
MF v[232:235],v[192:195],v[160:163],v[232:235]
MF a[192:195],v[176:179],v[164:167],a[192:195]
MF a[196:199],v[180:183],v[164:167],a[196:199]
MF a[200:203],v[184:187],v[164:167],a[200:203]
MF a[204:207],v[188:191],v[164:167],a[204:207]
MF a[208:211],v[192:195],v[164:167],a[208:211]
MF a[212:215],v[176:179],v[168:171],a[212:215]
MF a[216:219],v[180:183],v[168:171],a[216:219]
MF a[220:223],v[184:187],v[168:171],a[220:223]
MF a[224:227],v[188:191],v[168:171],a[224:227]
MF a[228:231],v[192:195],v[168:171],a[228:231]
MF a[232:235],v[176:179],v[172:175],a[232:235]
MF a[236:239],v[180:183],v[172:175],a[236:239]
MF a[240:243],v[184:187],v[172:175],a[240:243]
MF a[244:247],v[188:191],v[172:175],a[244:247]
MF a[248:251],v[192:195],v[172:175],a[248:251]
s_waitcnt vmcnt(26)
s_waitcnt vmcnt(22)
MF v[216:219],v[32:35],v[16:19],v[216:219]
s_waitcnt vmcnt(21)
MF v[220:223],v[36:39],v[16:19],v[220:223]
s_waitcnt vmcnt(20)
MF v[224:227],v[40:43],v[16:19],v[224:227]
s_waitcnt vmcnt(19)
MF v[228:231],v[44:47],v[16:19],v[228:231]
s_waitcnt vmcnt(18)
MF v[232:235],v[48:51],v[16:19],v[232:235]
MF a[192:195],v[32:35],v[20:23],a[192:195]
MF a[196:199],v[36:39],v[20:23],a[196:199]
MF a[200:203],v[40:43],v[20:23],a[200:203]
MF a[204:207],v[44:47],v[20:23],a[204:207]
MF a[208:211],v[48:51],v[20:23],a[208:211]
MF a[212:215],v[32:35],v[24:27],a[212:215]
MF a[216:219],v[36:39],v[24:27],a[216:219]
MF a[220:223],v[40:43],v[24:27],a[220:223]
MF a[224:227],v[44:47],v[24:27],a[224:227]
MF a[228:231],v[48:51],v[24:27],a[228:231]
MF a[232:235],v[32:35],v[28:31],a[232:235]
MF a[236:239],v[36:39],v[28:31],a[236:239]
MF a[240:243],v[40:43],v[28:31],a[240:243]
MF a[244:247],v[44:47],v[28:31],a[244:247]
MF a[248:251],v[48:51],v[28:31],a[248:251]
s_waitcnt vmcnt(17)
s_waitcnt vmcnt(13)
MF v[216:219],v[68:71],v[52:55],v[216:219]
s_waitcnt vmcnt(12)
MF v[220:223],v[72:75],v[52:55],v[220:223]
s_waitcnt vmcnt(11)
MF v[224:227],v[76:79],v[52:55],v[224:227]
s_waitcnt vmcnt(10)
MF v[228:231],v[80:83],v[52:55],v[228:231]
s_waitcnt vmcnt(9)
MF v[232:235],v[84:87],v[52:55],v[232:235]
MF a[192:195],v[68:71],v[56:59],a[192:195]
MF a[196:199],v[72:75],v[56:59],a[196:199]
MF a[200:203],v[76:79],v[56:59],a[200:203]
MF a[204:207],v[80:83],v[56:59],a[204:207]
MF a[208:211],v[84:87],v[56:59],a[208:211]
MF a[212:215],v[68:71],v[60:63],a[212:215]
MF a[216:219],v[72:75],v[60:63],a[216:219]
MF a[220:223],v[76:79],v[60:63],a[220:223]
MF a[224:227],v[80:83],v[60:63],a[224:227]
MF a[228:231],v[84:87],v[60:63],a[228:231]
MF a[232:235],v[68:71],v[64:67],a[232:235]
MF a[236:239],v[72:75],v[64:67],a[236:239]
MF a[240:243],v[76:79],v[64:67],a[240:243]
MF a[244:247],v[80:83],v[64:67],a[244:247]
MF a[248:251],v[84:87],v[64:67],a[248:251]
s_waitcnt vmcnt(7)
s_waitcnt vmcnt(4)
MF a[192:195],v[104:107],v[92:95],a[192:195]
s_waitcnt vmcnt(3)
MF a[196:199],v[108:111],v[92:95],a[196:199]
s_waitcnt vmcnt(2)
MF a[200:203],v[112:115],v[92:95],a[200:203]
s_waitcnt vmcnt(1)
MF a[204:207],v[116:119],v[92:95],a[204:207]
s_waitcnt vmcnt(0)
MF a[208:211],v[120:123],v[92:95],a[208:211]
MF a[212:215],v[104:107],v[96:99],a[212:215]
MF a[216:219],v[108:111],v[96:99],a[216:219]
MF a[220:223],v[112:115],v[96:99],a[220:223]
ds_write_b128 v241,a[192:195] offset:0
MF a[224:227],v[116:119],v[96:99],a[224:227]
ds_write_b128 v241,a[196:199] offset:1024
MF a[228:231],v[120:123],v[96:99],a[228:231]
ds_write_b128 v241,a[200:203] offset:2048
MF a[232:235],v[104:107],v[100:103],a[232:235]
ds_write_b128 v241,a[204:207] offset:3072
MF a[236:239],v[108:111],v[100:103],a[236:239]
ds_write_b128 v241,a[208:211] offset:4096
MF a[240:243],v[112:115],v[100:103],a[240:243]
ds_write_b128 v242,a[212:215] offset:0
MF a[244:247],v[116:119],v[100:103],a[244:247]
ds_write_b128 v242,a[216:219] offset:1024
MF a[248:251],v[120:123],v[100:103],a[248:251]
ds_write_b128 v242,a[220:223] offset:2048
MF v[216:219],v[104:107],v[88:91],v[216:219]
ds_write_b128 v242,a[224:227] offset:3072
MF v[220:223],v[108:111],v[88:91],v[220:223]
ds_write_b128 v242,a[228:231] offset:4096
MF v[224:227],v[112:115],v[88:91],v[224:227]
ds_write_b128 v243,a[232:235] offset:0
MF v[228:231],v[116:119],v[88:91],v[228:231]
ds_write_b128 v243,a[236:239] offset:1024
MF v[232:235],v[120:123],v[88:91],v[232:235]
ds_write_b128 v243,a[240:243] offset:2048
ds_write_b128 v243,a[244:247] offset:3072
ds_write_b128 v243,a[248:251] offset:4096
s_waitcnt lgkmcnt(0)
s_barrier
ds_read_b128 v[16:19],v240 offset:0
ds_read_b128 v[20:23],v240 offset:5120
ds_read_b128 v[24:27],v240 offset:10240
ds_read_b128 v[28:31],v240 offset:1024
ds_read_b128 v[32:35],v240 offset:6144
ds_read_b128 v[36:39],v240 offset:11264
ds_read_b128 v[40:43],v240 offset:2048
ds_read_b128 v[44:47],v240 offset:7168
ds_read_b128 v[48:51],v240 offset:12288
ds_read_b128 v[52:55],v240 offset:3072
ds_read_b128 v[56:59],v240 offset:8192
ds_read_b128 v[60:63],v240 offset:13312
ds_read_b128 v[64:67],v240 offset:4096
ds_read_b128 v[68:71],v240 offset:9216
ds_read_b128 v[72:75],v240 offset:14336
s_waitcnt lgkmcnt(12)
v_pk_add_f32 v[16:17],v[16:17],v[20:21]
v_pk_add_f32 v[216:217],v[216:217],v[24:25]
v_pk_add_f32 v[18:19],v[18:19],v[22:23]
v_pk_add_f32 v[218:219],v[218:219],v[26:27]
v_pk_add_f32 v[216:217],v[216:217],v[16:17]
v_pk_add_f32 v[218:219],v[218:219],v[18:19]
v_cvt_pk_bf16_f32 v16,v216,v217
v_cvt_pk_bf16_f32 v17,v218,v219
buffer_store_dwordx2 v[16:17],v200,s[16:19],s52 offen
s_waitcnt lgkmcnt(9)
v_pk_add_f32 v[28:29],v[28:29],v[32:33]
v_pk_add_f32 v[220:221],v[220:221],v[36:37]
v_pk_add_f32 v[30:31],v[30:31],v[34:35]
v_pk_add_f32 v[222:223],v[222:223],v[38:39]
v_pk_add_f32 v[220:221],v[220:221],v[28:29]
v_pk_add_f32 v[222:223],v[222:223],v[30:31]
v_cvt_pk_bf16_f32 v28,v220,v221
v_cvt_pk_bf16_f32 v29,v222,v223
buffer_store_dwordx2 v[28:29],v201,s[16:19],s52 offen
s_waitcnt lgkmcnt(6)
v_pk_add_f32 v[40:41],v[40:41],v[44:45]
v_pk_add_f32 v[224:225],v[224:225],v[48:49]
v_pk_add_f32 v[42:43],v[42:43],v[46:47]
v_pk_add_f32 v[226:227],v[226:227],v[50:51]
v_pk_add_f32 v[224:225],v[224:225],v[40:41]
v_pk_add_f32 v[226:227],v[226:227],v[42:43]
v_cvt_pk_bf16_f32 v40,v224,v225
v_cvt_pk_bf16_f32 v41,v226,v227
buffer_store_dwordx2 v[40:41],v202,s[16:19],s52 offen
s_waitcnt lgkmcnt(3)
v_pk_add_f32 v[52:53],v[52:53],v[56:57]
v_pk_add_f32 v[228:229],v[228:229],v[60:61]
v_pk_add_f32 v[54:55],v[54:55],v[58:59]
v_pk_add_f32 v[230:231],v[230:231],v[62:63]
v_pk_add_f32 v[228:229],v[228:229],v[52:53]
v_pk_add_f32 v[230:231],v[230:231],v[54:55]
v_cvt_pk_bf16_f32 v52,v228,v229
v_cvt_pk_bf16_f32 v53,v230,v231
buffer_store_dwordx2 v[52:53],v203,s[16:19],s52 offen
s_waitcnt lgkmcnt(0)
s_mov_b32 exec_lo,0xffffffff
s_mov_b32 exec_hi,0x0
v_pk_add_f32 v[64:65],v[64:65],v[68:69]
v_pk_add_f32 v[232:233],v[232:233],v[72:73]
v_pk_add_f32 v[66:67],v[66:67],v[70:71]
v_pk_add_f32 v[234:235],v[234:235],v[74:75]
v_pk_add_f32 v[232:233],v[232:233],v[64:65]
v_pk_add_f32 v[234:235],v[234:235],v[66:67]
v_cvt_pk_bf16_f32 v64,v232,v233
v_cvt_pk_bf16_f32 v65,v234,v235
buffer_store_dwordx2 v[64:65],v204,s[16:19],s52 offen
s_mov_b64 exec,-1
s_barrier
s_mov_b64 exec,-1
s_and_b32 s46,s44,1
s_lshl_b32 s46,s46,3
s_add_u32 s46,s46,s45
s_lshl_b32 s78,s51,11
s_lshl_b32 s47,s46,4
s_add_u32 s78,s78,s47
s_lshl_b32 s47,s22,2
s_add_u32 s78,s78,s47
s_add_u32 s78,s78,0x1358000
s_mov_b64 exec,-1
END_mega_kernel:
s_nop 7
s_nop 3
s_endpgm

CODE_END:
.section .rodata,"a"
.p2align 6
.amdhsa_kernel p0_kernel
  .amdhsa_next_free_vgpr 56
  .amdhsa_next_free_sgpr 102
  .amdhsa_accum_offset 56
  .amdhsa_group_segment_fixed_size 0
  .amdhsa_kernarg_size 88
  .amdhsa_user_sgpr_count 2
  .amdhsa_user_sgpr_kernarg_segment_ptr 1
  .amdhsa_system_sgpr_workgroup_id_x 1
.end_amdhsa_kernel

.section .rodata,"a"
.p2align 6
.amdhsa_kernel mega_kernel
  .amdhsa_next_free_vgpr 512
  .amdhsa_next_free_sgpr 102
  .amdhsa_accum_offset 256
  .amdhsa_group_segment_fixed_size 0
  .amdhsa_kernarg_size 88
  .amdhsa_user_sgpr_count 2
  .amdhsa_user_sgpr_kernarg_segment_ptr 1
  .amdhsa_system_sgpr_workgroup_id_x 1
.end_amdhsa_kernel
```
